```python
import torch

def _softmax(x, axis=-1):
    return torch.softmax(x, dim=axis)

def _gelu(x):
    return torch.nn.functional.gelu(x, approximate='tanh')

def _silu(x):
    return torch.nn.functional.silu(x)

def _sigmoid(x):
    return torch.sigmoid(x)

def _layernorm(x, axis=-1, eps=1e-05):
    m = x.mean(dim=axis, keepdim=True)
    v = x.var(dim=axis, keepdim=True, unbiased=False)
    return (x - m) / torch.sqrt(v + eps)

def _scatter_add(tgt, idx, src, axis=0):
    return tgt.clone().index_add_(axis, idx, src)

def _segment_sum(src, seg, n):
    out = torch.zeros((n,) + src.shape[1:], dtype=src.dtype)
    return out.index_add_(0, seg, src)

def _pad(x, pw):
    flat = tuple((v for pair in reversed(pw) for v in pair))
    return torch.nn.functional.pad(x, flat)
kernel_name = 'parallel_sum__sliding_local_dilated__mixer_gmlp__prompt'

def setup_inputs():

    _w = lambda a: (lambda t: t.to(torch.bfloat16) if t.is_floating_point() else t)(torch.as_tensor(a))

    def _A_setup():
        B, S, D = (1, 2048, 512)
        return {'x': _w((lambda *s: torch.randn(*s, dtype=torch.bfloat16) * 0.05)(B, S, D)), 'wqkv': _w((lambda *s: torch.randn(*s, dtype=torch.bfloat16) * 0.1)(D, 3 * D)), 'wo': _w((lambda *s: torch.randn(*s, dtype=torch.bfloat16) * 0.05)(D, D))}
    _A_in = _A_setup()

    def _B_setup():
        B, S, D, F = (1, 2048, 512, 1792)
        Fh = F // 2
        return {'x': _w((lambda *s: torch.randn(*s, dtype=torch.bfloat16) * 0.05)(B, S, D)), 'w_in': _w((lambda *s: torch.randn(*s, dtype=torch.bfloat16) * 0.4)(D, 2 * Fh)), 'w_sp': _w(0.01 * (lambda *s: torch.randn(*s, dtype=torch.bfloat16) * 0.4)(S, S)), 'b_sp': _w(1.0 + 0.01 * (lambda *s: torch.randn(*s, dtype=torch.bfloat16) * 0.05)(S)), 'w_out': _w((lambda *s: torch.randn(*s, dtype=torch.bfloat16) * 0.05)(Fh, D))}
    _B_in = _B_setup()
    return {'A_x': _A_in['x'], 'A_wqkv': _A_in['wqkv'], 'A_wo': _A_in['wo'], 'B_x': _B_in['x'], 'B_w_in': _B_in['w_in'], 'B_w_sp': _B_in['w_sp'], 'B_b_sp': _B_in['b_sp'], 'B_w_out': _B_in['w_out']}

def reference(A_x, A_wqkv, A_wo, B_x, B_w_in, B_w_sp, B_b_sp, B_w_out):

    def _A_ref(x, wqkv, wo):
        B, S, D = x.shape
        H = 32
        Dh = D // H
        W, dil = (8, 2)
        qkv = (lambda x, *d: x.permute(*d))((x @ wqkv).reshape(B, S, 3, H, Dh), 2, 0, 3, 1, 4)
        q, k, v = (qkv[0], qkv[1], qkv[2])
        scale = Dh ** (-0.5)
        pos = torch.arange(S)
        off = torch.arange(W) * dil
        idx = pos[:, None] - off[None, :]
        mask = idx >= 0
        idx_c = torch.where(mask, idx, 0).reshape(-1)
        kg = k[:, :, idx_c, :].reshape(B, H, S, W, Dh)
        vg = v[:, :, idx_c, :].reshape(B, H, S, W, Dh)
        logits = torch.einsum('bhsd,bhswd->bhsw', q, kg) * scale
        logits = torch.where(mask[None, None, :, :], logits, -1000000000.0)
        attn = _softmax(logits, axis=-1)
        o = torch.einsum('bhsw,bhswd->bhsd', attn, vg)
        return (lambda x, *d: x.permute(*d))(o, 0, 2, 1, 3).reshape(B, S, D) @ wo

    def _B_ref(x, w_in, w_sp, b_sp, w_out):
        B, S, D = x.shape
        F = w_in.shape[-1]
        Fh = F // 2
        z = _gelu(torch.einsum('bsd,df->bsf', x, w_in))
        z1 = z[..., :Fh].clone()
        z2 = _layernorm(z[..., Fh:], axis=-1)
        g = torch.einsum('ts,bsf->btf', w_sp, z2) + b_sp[None, :, None]
        return torch.einsum('bsf,fd->bsd', z1 * g, w_out)
    x = A_x
    xn = _layernorm(x, axis=-1)
    return x + _A_ref(xn, A_wqkv, A_wo) + _B_ref(xn, B_w_in, B_w_sp, B_b_sp, B_w_out)
```

```asm
; @launch grid=(256,1,1) block=(256,1,1) lds=163840
.amdgcn_target "amdgcn-amd-amdhsa--gfx950"
.text
.globl parallel_sum__sliding_local_dilated__mixer_gmlp__prompt_kernel
.p2align 8
.type parallel_sum__sliding_local_dilated__mixer_gmlp__prompt_kernel,@function
parallel_sum__sliding_local_dilated__mixer_gmlp__prompt_kernel:
s_cmp_ge_u32 s2, 256
s_cbranch_scc1 L_end
s_load_dwordx16 s[48:63], s[0:1], 0
s_load_dwordx4 s[64:67], s[0:1], 64
s_load_dwordx2 s[68:69], s[0:1], 80
v_lshrrev_b32 v29, 6, v0
v_and_b32 v0, 63, v0
v_readfirstlane_b32 s44, v29
s_and_b32 s82, s2, 7
s_lshr_b32 s83, s2, 3
s_getpc_b64 s[36:37]
L_pc0:
s_mov_b32 s38, L_codeend-L_pc0
s_mov_b32 s39, 0x20000
s_lshl_b32 s84, s83, 2
s_add_u32 s84, s84, s44
s_lshl_b32 s84, s84, 7
v_lshlrev_b32 v30, 14, v0
buffer_load_dword v255, v30, s[36:39], s84 offen
s_lshr_b32 s84, s82, 1
s_lshl_b32 s84, s84, 2
s_bfe_u32 s47, s83, 0x20002
s_add_u32 s45, s84, s47
s_and_b32 s84, s82, 1
s_lshl_b32 s84, s84, 2
s_and_b32 s85, s83, 3
s_add_u32 s46, s84, s85
s_lshr_b32 s82, s83, 4
s_lshl_b32 s84, s82, 2
s_add_u32 s85, s85, s84
s_lshl_b32 s84, s47, 1
s_add_u32 s85, s85, s84
s_lshl_b32 s82, s82, 2
s_and_b32 s85, s85, 7
s_lshl_b32 s72, s85, 7
v_lshrrev_b32 v29, 3, v0
v_lshrrev_b32 v30, 4, v0
v_and_b32 v31, 7, v0
v_xor_b32 v31, v31, v30
v_lshlrev_b32 v31, 4, v31
v_lshl_add_u32 v4, v29, 10, v31
v_xor_b32 v5, 64, v4
v_add_u32 v5, 7168, v5
v_add_u32 v6, 14336, v4
v_add_u32 v7, 14336, v5
s_lshl_b32 s84, s45, 17
s_lshl_b32 s85, s44, 15
s_add_u32 s75, s84, s85
s_cmp_ge_u32 s82, 4
s_cbranch_scc1 L_p1q
s_mov_b32 s72, 0
s_lshr_b32 s83, s46, 1
s_and_b32 s84, s83, 1
s_lshl_b32 s84, s84, 1
s_sub_u32 s84, 8, s84
s_and_b32 s85, s46, 1
s_mul_i32 s84, s84, s85
s_mul_i32 s83, s83, 14
s_add_u32 s100, s83, s84
s_and_b32 s82, s100, 0xfc
s_lshl_b32 s82, s82, 5
s_add_u32 s82, s82, 1792
s_mul_i32 s77, s44, 20480
s_add_u32 s77, s77, 73728
s_lshl_b32 s74, s44, 12
v_bfe_u32 v29, v0, 1, 3
v_xor_b32 v29, v29, v30
v_lshlrev_b32 v29, 5, v29
v_and_b32 v31, 1, v0
v_lshl_or_b32 v29, v31, 4, v29
s_lshl_b32 s83, s44, 4
v_add_u32 v30, s83, v30
v_mul_u32_u24 v30, 3584, v30
v_add_u32 v12, v30, v29
v_add_u32 v13, 13312, v12
v_xor_b32 v29, 128, v29
v_add_u32 v14, v30, v29
v_add_u32 v15, 39936, v14
v_add_u32 v14, 26624, v14
s_waitcnt lgkmcnt(0)
s_add_u32 s4, s48, s75
s_addc_u32 s5, s49, 0
s_sub_u32 s6, 0x200000, s75
s_mov_b32 s7, 0x20000
s_add_u32 s12, s56, s82
s_addc_u32 s13, s57, 0
s_sub_u32 s14, 0x1c0000, s82
s_mov_b32 s15, 0x20000
s_mov_b32 s75, s82
s_lshr_b32 s83, s46, 1
s_xor_b32 s83, s83, s46
s_bitcmp1_b32 s83, 0
s_cbranch_scc1 L_p1z6
s_add_u32 m0, s77, 0
s_nop 0
buffer_load_dwordx4 v4, s[4:7], s72 offen offset:0 lds
buffer_load_dwordx4 v5, s[4:7], s72 offen offset:1024 lds
buffer_load_dwordx4 v6, s[4:7], s72 offen offset:2048 lds
buffer_load_dwordx4 v7, s[4:7], s72 offen offset:3072 lds
s_add_u32 m0, s74, 0
s_mul_i32 s82, s72, 1792
buffer_load_dwordx4 v12, s[12:15], s82 offen offset:0 lds
buffer_load_dwordx4 v13, s[12:15], s82 offen offset:1024 lds
buffer_load_dwordx4 v14, s[12:15], s82 offen offset:2048 lds
buffer_load_dwordx4 v15, s[12:15], s82 offen offset:3072 lds
s_add_u32 s72, s72, 128
s_and_b32 s72, s72, 0x380
s_mov_b32 s20, s68
s_mov_b32 s21, s69
s_mov_b32 s22, 0x1000000
s_mov_b32 s23, 0x20000
buffer_load_dword v28, off, s[20:23], 0 sc1
s_mov_b32 s8, s48
s_mov_b32 s9, s49
s_mov_b32 s10, 0x200000
s_mov_b32 s11, 0x20000
s_mov_b32 s24, s52
s_mov_b32 s25, s53
s_mov_b32 s26, 0x80000
s_mov_b32 s27, 0x20000
s_mov_b32 s28, s62
s_mov_b32 s29, s63
s_mov_b32 s30, 0xe0000
s_mov_b32 s31, 0x20000
s_mov_b32 s32, s64
s_mov_b32 s33, s65
s_mov_b32 s34, 0x200000
s_mov_b32 s35, 0x20000
s_mov_b32 s36, s60
s_mov_b32 s37, s61
s_mov_b32 s38, 0x1000
s_mov_b32 s39, 0x20000
s_mov_b32 s40, s66
s_mov_b32 s41, s67
s_mov_b32 s42, 256
s_mov_b32 s43, 0x20000
s_and_b32 s84, s2, 7
s_lshr_b32 s85, s2, 3
s_lshr_b32 s68, s85, 2
s_and_b32 s3, s85, 3
s_lshr_b32 s85, s84, 1
s_lshl_b32 s85, s85, 3
s_add_u32 s70, s85, s68
s_and_b32 s84, s84, 1
s_lshl_b32 s84, s84, 2
s_add_u32 s71, s84, s3
s_and_b32 s76, s68, 3
s_lshl_b32 s76, s76, 8
s_lshl_b32 s84, s70, 18
s_lshl_b32 s85, s44, 10
s_add_u32 s84, s84, s85
s_sub_u32 s16, s58, 3072
s_subb_u32 s17, s59, 0
s_add_u32 s16, s16, s84
s_addc_u32 s17, s17, 0
s_sub_u32 s18, 0x800c00, s84
s_mov_b32 s19, 0x20000
s_and_b32 s84, s44, 2
s_lshl_b32 s64, s84, 16
s_xor_b32 s65, s64, 0x20000
s_add_u32 s85, s44, 1
s_and_b32 s84, s85, 2
s_lshl_b32 s66, s84, 16
s_xor_b32 s67, s66, 0x20000
v_lshrrev_b32 v29, 3, v0
v_lshrrev_b32 v30, 4, v0
v_and_b32 v31, 7, v0
v_xor_b32 v31, v31, v30
v_lshlrev_b32 v31, 4, v31
v_lshl_add_u32 v31, v29, 12, v31
v_xor_b32 v30, 64, v31
s_and_b32 s84, s44, 1
s_lshl_b32 s84, s84, 16
s_xor_b32 s85, s84, 0x10000
s_add_u32 s83, s84, 3072
v_add_u32 v8, s83, v31
s_add_u32 s83, s84, 34816
v_add_u32 v9, s83, v30
s_add_u32 s83, s85, 1024
v_add_u32 v10, s83, v31
s_add_u32 s83, s85, 32768
v_add_u32 v11, s83, v30
v_lshlrev_b32 v1, 4, v0
v_and_b32 v29, 15, v0
v_lshrrev_b32 v30, 4, v0
v_lshrrev_b32 v31, 1, v29
v_xor_b32 v31, v31, v30
v_lshlrev_b32 v31, 4, v31
v_lshl_add_u32 v31, v29, 7, v31
v_add_u32 v2, s77, v31
v_xor_b32 v3, 64, v2
s_mov_b32 s86, 0x3b000000
s_mov_b32 s87, 0x3727c5ac
s_mov_b32 s88, 0x3a924925
s_mov_b32 s89, 0x3727c5ac
s_mov_b32 s90, 0xbdd2d3e8
s_mov_b32 s91, 0xc0135761
s_mov_b32 s92, 0xaaaaaaaa
s_mov_b32 s93, 0xaaaaaaaa
s_mov_b32 s94, 0xcccccccc
s_mov_b32 s95, 0xcccccccc
v_mov_b32 v24, 0x3f803f80
v_mov_b32 v25, 0x3f803f80
v_mov_b32 v26, 0x3f803f80
v_mov_b32 v27, 0x3f803f80
v_bfe_u32 v29, v0, 2, 2
v_lshrrev_b32 v30, 4, v0
v_lshl_add_u32 v31, v30, 3, v29
v_lshlrev_b32 v31, 8, v31
v_and_b32 v30, 1, v30
v_lshl_or_b32 v29, v30, 2, v29
v_and_b32 v30, 3, v0
v_lshl_or_b32 v31, v30, 3, v31
s_and_b32 s97, s100, 3
s_add_u32 s84, s44, 0
s_cmp_ge_u32 s84, 4
s_cselect_b32 s85, 4, 0
s_sub_u32 s84, s84, s85
s_lshl_b32 s84, s84, 1
s_add_u32 s78, s84, s97
v_xor_b32 v30, s78, v29
v_lshl_or_b32 v16, v30, 5, v31
v_xor_b32 v17, 32, v16
s_add_u32 s84, s44, 1
s_cmp_ge_u32 s84, 4
s_cselect_b32 s85, 4, 0
s_sub_u32 s84, s84, s85
s_lshl_b32 s84, s84, 1
s_add_u32 s79, s84, s97
v_xor_b32 v30, s79, v29
v_lshl_or_b32 v18, v30, 5, v31
v_xor_b32 v19, 32, v18
s_add_u32 s84, s44, 2
s_cmp_ge_u32 s84, 4
s_cselect_b32 s85, 4, 0
s_sub_u32 s84, s84, s85
s_lshl_b32 s84, s84, 1
s_add_u32 s80, s84, s97
v_xor_b32 v30, s80, v29
v_lshl_or_b32 v20, v30, 5, v31
v_xor_b32 v21, 32, v20
s_add_u32 s84, s44, 3
s_cmp_ge_u32 s84, 4
s_cselect_b32 s85, 4, 0
s_sub_u32 s84, s84, s85
s_lshl_b32 s84, s84, 1
s_add_u32 s81, s84, s97
v_xor_b32 v30, s81, v29
v_lshl_or_b32 v22, v30, 5, v31
v_xor_b32 v23, 32, v22
s_xor_b32 s97, s46, 1
s_lshr_b32 s83, s97, 1
s_and_b32 s84, s83, 1
s_lshl_b32 s84, s84, 1
s_sub_u32 s84, 8, s84
s_and_b32 s85, s97, 1
s_mul_i32 s84, s84, s85
s_mul_i32 s83, s83, 14
s_add_u32 s101, s83, s84
s_and_b32 s84, s101, 0xfc
s_lshl_b32 s84, s84, 5
s_sub_u32 s75, s75, s84
v_lshrrev_b32 v29, 1, v0
s_lshl_b32 s84, s47, 7
s_lshl_b32 s85, s44, 5
s_add_u32 s84, s84, s85
v_add_u32 v29, s84, v29
v_mul_u32_u24 v29, 3584, v29
v_and_b32 v30, 1, v0
v_lshl_add_u32 v29, v30, 7, v29
v_subrev_u32 v191, s75, v29
v_and_b32 v29, 15, v0
s_lshl_b32 s84, s3, 4
v_add_u32 v29, s84, v29
v_lshlrev_b32 v29, 12, v29
v_lshrrev_b32 v30, 4, v0
v_lshl_add_u32 v30, v30, 7, s76
v_and_b32 v30, 0x380, v30
v_add_u32 v188, v29, v30
s_waitcnt vmcnt(1)
s_barrier
ds_read_b128 a[128:131], v2 offset:0
ds_read_b128 a[132:135], v2 offset:2048
ds_read_b128 a[136:139], v3 offset:0
ds_read_b128 a[140:143], v3 offset:2048
ds_read_b64_tr_b16 v[32:33], v16 offset:0
ds_read_b64_tr_b16 v[34:35], v16 offset:1024
ds_read_b64_tr_b16 v[36:37], v17 offset:0
ds_read_b64_tr_b16 v[38:39], v17 offset:1024
ds_read_b64_tr_b16 v[40:41], v18 offset:0
ds_read_b64_tr_b16 v[42:43], v18 offset:1024
ds_read_b64_tr_b16 v[44:45], v19 offset:0
ds_read_b64_tr_b16 v[46:47], v19 offset:1024
ds_read_b64_tr_b16 v[48:49], v20 offset:0
ds_read_b64_tr_b16 v[50:51], v20 offset:1024
ds_read_b64_tr_b16 v[52:53], v21 offset:0
ds_read_b64_tr_b16 v[54:55], v21 offset:1024
s_waitcnt lgkmcnt(8)
v_mfma_f32_16x16x32_bf16 v[64:67], a[128:131], v[32:35], 0
ds_read_b64_tr_b16 v[56:57], v22 offset:0
s_add_u32 m0, s77, 4096
s_nop 0
buffer_load_dwordx4 v4, s[4:7], s72 offen offset:0 lds
v_mfma_f32_16x16x32_bf16 v[68:71], a[132:135], v[32:35], 0
ds_read_b64_tr_b16 v[58:59], v22 offset:1024
buffer_load_dwordx4 v5, s[4:7], s72 offen offset:1024 lds
v_mfma_f32_16x16x32_bf16 v[144:147], v[24:27], v[32:35], 0
buffer_load_dwordx4 v6, s[4:7], s72 offen offset:2048 lds
v_mfma_f32_16x16x32_bf16 v[72:75], a[128:131], v[36:39], 0
ds_read_b64_tr_b16 v[60:61], v23 offset:0
buffer_load_dwordx4 v7, s[4:7], s72 offen offset:3072 lds
s_add_u32 m0, s74, 16384
v_mfma_f32_16x16x32_bf16 v[76:79], a[132:135], v[36:39], 0
ds_read_b64_tr_b16 v[62:63], v23 offset:1024
s_mul_i32 s82, s72, 1792
buffer_load_dwordx4 v12, s[12:15], s82 offen offset:0 lds
v_mfma_f32_16x16x32_bf16 v[148:151], v[24:27], v[36:39], 0
buffer_load_dwordx4 v13, s[12:15], s82 offen offset:1024 lds
s_waitcnt lgkmcnt(8)
v_mfma_f32_16x16x32_bf16 v[80:83], a[128:131], v[40:43], 0
ds_read_b64_tr_b16 v[32:33], v16 offset:8192
buffer_load_dwordx4 v14, s[12:15], s82 offen offset:2048 lds
v_mfma_f32_16x16x32_bf16 v[84:87], a[132:135], v[40:43], 0
ds_read_b64_tr_b16 v[34:35], v16 offset:9216
buffer_load_dwordx4 v15, s[12:15], s82 offen offset:3072 lds
s_add_u32 s72, s72, 128
v_mfma_f32_16x16x32_bf16 v[136:139], a[128:131], a[128:131], 0
s_and_b32 s72, s72, 0x380
s_add_u32 m0, s77, 8192
v_mfma_f32_16x16x32_bf16 v[88:91], a[128:131], v[44:47], 0
ds_read_b64_tr_b16 v[36:37], v17 offset:8192
buffer_load_dwordx4 v4, s[4:7], s72 offen offset:0 lds
v_mfma_f32_16x16x32_bf16 v[92:95], a[132:135], v[44:47], 0
ds_read_b64_tr_b16 v[38:39], v17 offset:9216
v_mfma_f32_16x16x32_bf16 v[140:143], a[132:135], a[132:135], 0
buffer_load_dwordx4 v5, s[4:7], s72 offen offset:1024 lds
s_waitcnt lgkmcnt(8)
v_mfma_f32_16x16x32_bf16 v[96:99], a[128:131], v[48:51], 0
ds_read_b64_tr_b16 v[40:41], v18 offset:8192
v_mfma_f32_16x16x32_bf16 v[100:103], a[132:135], v[48:51], 0
ds_read_b64_tr_b16 v[42:43], v18 offset:9216
buffer_load_dwordx4 v6, s[4:7], s72 offen offset:2048 lds
v_mfma_f32_16x16x32_bf16 v[128:131], a[128:131], v[24:27], 0
v_mfma_f32_16x16x32_bf16 v[104:107], a[128:131], v[52:55], 0
ds_read_b64_tr_b16 v[44:45], v19 offset:8192
buffer_load_dwordx4 v7, s[4:7], s72 offen offset:3072 lds
v_mfma_f32_16x16x32_bf16 v[108:111], a[132:135], v[52:55], 0
ds_read_b64_tr_b16 v[46:47], v19 offset:9216
s_add_u32 m0, s74, 32768
v_mfma_f32_16x16x32_bf16 v[132:135], a[132:135], v[24:27], 0
s_mul_i32 s82, s72, 1792
s_waitcnt lgkmcnt(8)
v_mfma_f32_16x16x32_bf16 v[112:115], a[128:131], v[56:59], 0
ds_read_b64_tr_b16 v[48:49], v20 offset:8192
buffer_load_dwordx4 v12, s[12:15], s82 offen offset:0 lds
v_mfma_f32_16x16x32_bf16 v[116:119], a[132:135], v[56:59], 0
ds_read_b64_tr_b16 v[50:51], v20 offset:9216
v_mfma_f32_16x16x32_bf16 v[120:123], a[128:131], v[60:63], 0
ds_read_b64_tr_b16 v[52:53], v21 offset:8192
buffer_load_dwordx4 v13, s[12:15], s82 offen offset:1024 lds
v_mfma_f32_16x16x32_bf16 v[124:127], a[132:135], v[60:63], 0
ds_read_b64_tr_b16 v[54:55], v21 offset:9216
s_waitcnt lgkmcnt(8)
v_mfma_f32_16x16x32_bf16 v[64:67], a[136:139], v[32:35], v[64:67]
ds_read_b64_tr_b16 v[56:57], v22 offset:8192
buffer_load_dwordx4 v14, s[12:15], s82 offen offset:2048 lds
v_mfma_f32_16x16x32_bf16 v[68:71], a[140:143], v[32:35], v[68:71]
ds_read_b64_tr_b16 v[58:59], v22 offset:9216
v_mfma_f32_16x16x32_bf16 v[144:147], v[24:27], v[32:35], v[144:147]
buffer_load_dwordx4 v15, s[12:15], s82 offen offset:3072 lds
s_add_u32 s72, s72, 128
v_mfma_f32_16x16x32_bf16 v[72:75], a[136:139], v[36:39], v[72:75]
ds_read_b64_tr_b16 v[60:61], v23 offset:8192
s_and_b32 s72, s72, 0x380
v_mfma_f32_16x16x32_bf16 v[76:79], a[140:143], v[36:39], v[76:79]
ds_read_b64_tr_b16 v[62:63], v23 offset:9216
s_waitcnt vmcnt(16)
v_add_u32 v28, 0x9e3779b9, v28
v_mfma_f32_16x16x32_bf16 v[148:151], v[24:27], v[36:39], v[148:151]
v_cmp_eq_u32 vcc, 0, v28
v_mov_b32 v29, 0x9e3779b9
s_lshl_b32 s85, s2, 2
v_cndmask_b32 v28, v28, v29, vcc
s_waitcnt lgkmcnt(8)
v_mfma_f32_16x16x32_bf16 v[80:83], a[136:139], v[40:43], v[80:83]
s_waitcnt vmcnt(8)
s_barrier
ds_read_b64_tr_b16 v[32:33], v16 offset:16384
v_mfma_f32_16x16x32_bf16 v[84:87], a[140:143], v[40:43], v[84:87]
ds_read_b64_tr_b16 v[34:35], v16 offset:17408
s_or_b32 s85, s85, s44
v_mfma_f32_16x16x32_bf16 v[136:139], a[136:139], a[136:139], v[136:139]
ds_read_b128 a[144:147], v2 offset:4096
s_lshl_b32 s85, s85, 6
v_mfma_f32_16x16x32_bf16 v[88:91], a[136:139], v[44:47], v[88:91]
ds_read_b128 a[148:151], v2 offset:6144
ds_read_b64_tr_b16 v[36:37], v17 offset:16384
v_mfma_f32_16x16x32_bf16 v[92:95], a[140:143], v[44:47], v[92:95]
ds_read_b128 a[152:155], v3 offset:4096
ds_read_b64_tr_b16 v[38:39], v17 offset:17408
v_mfma_f32_16x16x32_bf16 v[140:143], a[140:143], a[140:143], v[140:143]
ds_read_b128 a[156:159], v3 offset:6144
s_waitcnt lgkmcnt(12)
v_mfma_f32_16x16x32_bf16 v[96:99], a[136:139], v[48:51], v[96:99]
ds_read_b64_tr_b16 v[40:41], v18 offset:16384
v_or_b32 v29, s85, v0
v_cmp_eq_u32 vcc, 0, v29
v_mov_b32 v30, 0x7ffffff0
s_nop 0
v_cndmask_b32 v29, v30, 0, vcc
buffer_store_dword v28, v29, s[20:23], 0 offen sc1
buffer_store_dword v28, v29, s[40:43], 0 offen sc1
v_mfma_f32_16x16x32_bf16 v[100:103], a[140:143], v[48:51], v[100:103]
ds_read_b64_tr_b16 v[42:43], v18 offset:17408
s_add_u32 m0, s77, 12288
v_mfma_f32_16x16x32_bf16 v[128:131], a[136:139], v[24:27], v[128:131]
buffer_load_dwordx4 v4, s[4:7], s72 offen offset:0 lds
v_mfma_f32_16x16x32_bf16 v[104:107], a[136:139], v[52:55], v[104:107]
ds_read_b64_tr_b16 v[44:45], v19 offset:16384
v_mfma_f32_16x16x32_bf16 v[108:111], a[140:143], v[52:55], v[108:111]
ds_read_b64_tr_b16 v[46:47], v19 offset:17408
v_mfma_f32_16x16x32_bf16 v[132:135], a[140:143], v[24:27], v[132:135]
s_waitcnt lgkmcnt(12)
v_mfma_f32_16x16x32_bf16 v[112:115], a[136:139], v[56:59], v[112:115]
ds_read_b64_tr_b16 v[48:49], v20 offset:16384
buffer_load_dwordx4 v5, s[4:7], s72 offen offset:1024 lds
v_mfma_f32_16x16x32_bf16 v[116:119], a[140:143], v[56:59], v[116:119]
ds_read_b64_tr_b16 v[50:51], v20 offset:17408
v_mfma_f32_16x16x32_bf16 v[120:123], a[136:139], v[60:63], v[120:123]
ds_read_b64_tr_b16 v[52:53], v21 offset:16384
v_mfma_f32_16x16x32_bf16 v[124:127], a[140:143], v[60:63], v[124:127]
ds_read_b64_tr_b16 v[54:55], v21 offset:17408
s_waitcnt lgkmcnt(9)
v_mfma_f32_16x16x32_bf16 v[64:67], a[144:147], v[32:35], v[64:67]
ds_read_b64_tr_b16 v[56:57], v22 offset:16384
buffer_load_dwordx4 v6, s[4:7], s72 offen offset:2048 lds
v_mfma_f32_16x16x32_bf16 v[68:71], a[148:151], v[32:35], v[68:71]
ds_read_b64_tr_b16 v[58:59], v22 offset:17408
v_mfma_f32_16x16x32_bf16 v[144:147], v[24:27], v[32:35], v[144:147]
v_mfma_f32_16x16x32_bf16 v[72:75], a[144:147], v[36:39], v[72:75]
ds_read_b64_tr_b16 v[60:61], v23 offset:16384
v_mfma_f32_16x16x32_bf16 v[76:79], a[148:151], v[36:39], v[76:79]
ds_read_b64_tr_b16 v[62:63], v23 offset:17408
buffer_load_dwordx4 v7, s[4:7], s72 offen offset:3072 lds
v_mfma_f32_16x16x32_bf16 v[148:151], v[24:27], v[36:39], v[148:151]
s_add_u32 m0, s74, 49152
s_waitcnt lgkmcnt(8)
v_mfma_f32_16x16x32_bf16 v[80:83], a[144:147], v[40:43], v[80:83]
ds_read_b64_tr_b16 v[32:33], v16 offset:24576
s_mul_i32 s82, s72, 1792
v_mfma_f32_16x16x32_bf16 v[84:87], a[148:151], v[40:43], v[84:87]
ds_read_b64_tr_b16 v[34:35], v16 offset:25600
v_mfma_f32_16x16x32_bf16 v[136:139], a[144:147], a[144:147], v[136:139]
buffer_load_dwordx4 v12, s[12:15], s82 offen offset:0 lds
v_mfma_f32_16x16x32_bf16 v[88:91], a[144:147], v[44:47], v[88:91]
ds_read_b64_tr_b16 v[36:37], v17 offset:24576
v_mfma_f32_16x16x32_bf16 v[92:95], a[148:151], v[44:47], v[92:95]
ds_read_b64_tr_b16 v[38:39], v17 offset:25600
v_mfma_f32_16x16x32_bf16 v[140:143], a[148:151], a[148:151], v[140:143]
s_waitcnt lgkmcnt(8)
v_mfma_f32_16x16x32_bf16 v[96:99], a[144:147], v[48:51], v[96:99]
ds_read_b64_tr_b16 v[40:41], v18 offset:24576
buffer_load_dwordx4 v13, s[12:15], s82 offen offset:1024 lds
v_mfma_f32_16x16x32_bf16 v[100:103], a[148:151], v[48:51], v[100:103]
ds_read_b64_tr_b16 v[42:43], v18 offset:25600
v_mfma_f32_16x16x32_bf16 v[128:131], a[144:147], v[24:27], v[128:131]
v_mfma_f32_16x16x32_bf16 v[104:107], a[144:147], v[52:55], v[104:107]
ds_read_b64_tr_b16 v[44:45], v19 offset:24576
v_mfma_f32_16x16x32_bf16 v[108:111], a[148:151], v[52:55], v[108:111]
ds_read_b64_tr_b16 v[46:47], v19 offset:25600
buffer_load_dwordx4 v14, s[12:15], s82 offen offset:2048 lds
v_mfma_f32_16x16x32_bf16 v[132:135], a[148:151], v[24:27], v[132:135]
s_waitcnt lgkmcnt(8)
v_mfma_f32_16x16x32_bf16 v[112:115], a[144:147], v[56:59], v[112:115]
ds_read_b64_tr_b16 v[48:49], v20 offset:24576
v_mfma_f32_16x16x32_bf16 v[116:119], a[148:151], v[56:59], v[116:119]
ds_read_b64_tr_b16 v[50:51], v20 offset:25600
v_mfma_f32_16x16x32_bf16 v[120:123], a[144:147], v[60:63], v[120:123]
ds_read_b64_tr_b16 v[52:53], v21 offset:24576
buffer_load_dwordx4 v15, s[12:15], s82 offen offset:3072 lds
v_mfma_f32_16x16x32_bf16 v[124:127], a[148:151], v[60:63], v[124:127]
ds_read_b64_tr_b16 v[54:55], v21 offset:25600
s_waitcnt lgkmcnt(8)
v_mfma_f32_16x16x32_bf16 v[64:67], a[152:155], v[32:35], v[64:67]
ds_read_b64_tr_b16 v[56:57], v22 offset:24576
s_add_u32 s72, s72, 128
v_mfma_f32_16x16x32_bf16 v[68:71], a[156:159], v[32:35], v[68:71]
ds_read_b64_tr_b16 v[58:59], v22 offset:25600
s_and_b32 s72, s72, 0x380
v_mfma_f32_16x16x32_bf16 v[144:147], v[24:27], v[32:35], v[144:147]
v_mfma_f32_16x16x32_bf16 v[72:75], a[152:155], v[36:39], v[72:75]
ds_read_b64_tr_b16 v[60:61], v23 offset:24576
v_mfma_f32_16x16x32_bf16 v[76:79], a[156:159], v[36:39], v[76:79]
ds_read_b64_tr_b16 v[62:63], v23 offset:25600
v_mfma_f32_16x16x32_bf16 v[148:151], v[24:27], v[36:39], v[148:151]
s_waitcnt lgkmcnt(8)
v_mfma_f32_16x16x32_bf16 v[80:83], a[152:155], v[40:43], v[80:83]
s_waitcnt vmcnt(10)
s_barrier
ds_read_b64_tr_b16 v[32:33], v16 offset:32768
v_mfma_f32_16x16x32_bf16 v[84:87], a[156:159], v[40:43], v[84:87]
ds_read_b64_tr_b16 v[34:35], v16 offset:33792
v_mfma_f32_16x16x32_bf16 v[136:139], a[152:155], a[152:155], v[136:139]
ds_read_b128 a[160:163], v2 offset:8192
s_add_u32 m0, s77, 16384
v_mfma_f32_16x16x32_bf16 v[88:91], a[152:155], v[44:47], v[88:91]
ds_read_b128 a[164:167], v2 offset:10240
ds_read_b64_tr_b16 v[36:37], v17 offset:32768
v_mfma_f32_16x16x32_bf16 v[92:95], a[156:159], v[44:47], v[92:95]
ds_read_b128 a[168:171], v3 offset:8192
ds_read_b64_tr_b16 v[38:39], v17 offset:33792
v_mfma_f32_16x16x32_bf16 v[140:143], a[156:159], a[156:159], v[140:143]
ds_read_b128 a[172:175], v3 offset:10240
s_waitcnt lgkmcnt(12)
v_mfma_f32_16x16x32_bf16 v[96:99], a[152:155], v[48:51], v[96:99]
ds_read_b64_tr_b16 v[40:41], v18 offset:32768
buffer_load_dwordx4 v4, s[4:7], s72 offen offset:0 lds
v_mfma_f32_16x16x32_bf16 v[100:103], a[156:159], v[48:51], v[100:103]
ds_read_b64_tr_b16 v[42:43], v18 offset:33792
v_mfma_f32_16x16x32_bf16 v[128:131], a[152:155], v[24:27], v[128:131]
v_mfma_f32_16x16x32_bf16 v[104:107], a[152:155], v[52:55], v[104:107]
ds_read_b64_tr_b16 v[44:45], v19 offset:32768
v_mfma_f32_16x16x32_bf16 v[108:111], a[156:159], v[52:55], v[108:111]
ds_read_b64_tr_b16 v[46:47], v19 offset:33792
buffer_load_dwordx4 v5, s[4:7], s72 offen offset:1024 lds
v_mfma_f32_16x16x32_bf16 v[132:135], a[156:159], v[24:27], v[132:135]
s_waitcnt lgkmcnt(12)
v_mfma_f32_16x16x32_bf16 v[112:115], a[152:155], v[56:59], v[112:115]
ds_read_b64_tr_b16 v[48:49], v20 offset:32768
v_mfma_f32_16x16x32_bf16 v[116:119], a[156:159], v[56:59], v[116:119]
ds_read_b64_tr_b16 v[50:51], v20 offset:33792
v_mfma_f32_16x16x32_bf16 v[120:123], a[152:155], v[60:63], v[120:123]
ds_read_b64_tr_b16 v[52:53], v21 offset:32768
buffer_load_dwordx4 v6, s[4:7], s72 offen offset:2048 lds
v_mfma_f32_16x16x32_bf16 v[124:127], a[156:159], v[60:63], v[124:127]
ds_read_b64_tr_b16 v[54:55], v21 offset:33792
s_waitcnt lgkmcnt(9)
v_mfma_f32_16x16x32_bf16 v[64:67], a[160:163], v[32:35], v[64:67]
ds_read_b64_tr_b16 v[56:57], v22 offset:32768
v_mfma_f32_16x16x32_bf16 v[68:71], a[164:167], v[32:35], v[68:71]
ds_read_b64_tr_b16 v[58:59], v22 offset:33792
v_mfma_f32_16x16x32_bf16 v[144:147], v[24:27], v[32:35], v[144:147]
buffer_load_dwordx4 v7, s[4:7], s72 offen offset:3072 lds
s_add_u32 m0, s74, 0
v_mfma_f32_16x16x32_bf16 v[72:75], a[160:163], v[36:39], v[72:75]
ds_read_b64_tr_b16 v[60:61], v23 offset:32768
s_mul_i32 s82, s72, 1792
v_mfma_f32_16x16x32_bf16 v[76:79], a[164:167], v[36:39], v[76:79]
ds_read_b64_tr_b16 v[62:63], v23 offset:33792
v_mfma_f32_16x16x32_bf16 v[148:151], v[24:27], v[36:39], v[148:151]
s_waitcnt lgkmcnt(8)
v_mfma_f32_16x16x32_bf16 v[80:83], a[160:163], v[40:43], v[80:83]
ds_read_b64_tr_b16 v[32:33], v16 offset:40960
buffer_load_dwordx4 v12, s[12:15], s82 offen offset:0 lds
v_mfma_f32_16x16x32_bf16 v[84:87], a[164:167], v[40:43], v[84:87]
ds_read_b64_tr_b16 v[34:35], v16 offset:41984
v_mfma_f32_16x16x32_bf16 v[136:139], a[160:163], a[160:163], v[136:139]
v_mfma_f32_16x16x32_bf16 v[88:91], a[160:163], v[44:47], v[88:91]
ds_read_b64_tr_b16 v[36:37], v17 offset:40960
v_mfma_f32_16x16x32_bf16 v[92:95], a[164:167], v[44:47], v[92:95]
ds_read_b64_tr_b16 v[38:39], v17 offset:41984
buffer_load_dwordx4 v13, s[12:15], s82 offen offset:1024 lds
v_mfma_f32_16x16x32_bf16 v[140:143], a[164:167], a[164:167], v[140:143]
s_waitcnt lgkmcnt(8)
v_mfma_f32_16x16x32_bf16 v[96:99], a[160:163], v[48:51], v[96:99]
ds_read_b64_tr_b16 v[40:41], v18 offset:40960
v_mfma_f32_16x16x32_bf16 v[100:103], a[164:167], v[48:51], v[100:103]
ds_read_b64_tr_b16 v[42:43], v18 offset:41984
v_mfma_f32_16x16x32_bf16 v[128:131], a[160:163], v[24:27], v[128:131]
buffer_load_dwordx4 v14, s[12:15], s82 offen offset:2048 lds
v_mfma_f32_16x16x32_bf16 v[104:107], a[160:163], v[52:55], v[104:107]
ds_read_b64_tr_b16 v[44:45], v19 offset:40960
v_mfma_f32_16x16x32_bf16 v[108:111], a[164:167], v[52:55], v[108:111]
ds_read_b64_tr_b16 v[46:47], v19 offset:41984
v_mfma_f32_16x16x32_bf16 v[132:135], a[164:167], v[24:27], v[132:135]
s_waitcnt lgkmcnt(8)
v_mfma_f32_16x16x32_bf16 v[112:115], a[160:163], v[56:59], v[112:115]
ds_read_b64_tr_b16 v[48:49], v20 offset:40960
buffer_load_dwordx4 v15, s[12:15], s82 offen offset:3072 lds
v_mfma_f32_16x16x32_bf16 v[116:119], a[164:167], v[56:59], v[116:119]
ds_read_b64_tr_b16 v[50:51], v20 offset:41984
s_add_u32 s72, s72, 128
v_mfma_f32_16x16x32_bf16 v[120:123], a[160:163], v[60:63], v[120:123]
ds_read_b64_tr_b16 v[52:53], v21 offset:40960
s_and_b32 s72, s72, 0x380
v_mfma_f32_16x16x32_bf16 v[124:127], a[164:167], v[60:63], v[124:127]
ds_read_b64_tr_b16 v[54:55], v21 offset:41984
s_waitcnt lgkmcnt(8)
v_mfma_f32_16x16x32_bf16 v[64:67], a[168:171], v[32:35], v[64:67]
ds_read_b64_tr_b16 v[56:57], v22 offset:40960
s_mov_b32 exec_hi, 0
buffer_load_dword v189, v191, s[12:15], 0 offen
s_mov_b64 exec, -1
v_mfma_f32_16x16x32_bf16 v[68:71], a[172:175], v[32:35], v[68:71]
ds_read_b64_tr_b16 v[58:59], v22 offset:41984
v_mfma_f32_16x16x32_bf16 v[144:147], v[24:27], v[32:35], v[144:147]
v_mfma_f32_16x16x32_bf16 v[72:75], a[168:171], v[36:39], v[72:75]
ds_read_b64_tr_b16 v[60:61], v23 offset:40960
v_mfma_f32_16x16x32_bf16 v[76:79], a[172:175], v[36:39], v[76:79]
ds_read_b64_tr_b16 v[62:63], v23 offset:41984
v_mfma_f32_16x16x32_bf16 v[148:151], v[24:27], v[36:39], v[148:151]
s_waitcnt lgkmcnt(8)
v_mfma_f32_16x16x32_bf16 v[80:83], a[168:171], v[40:43], v[80:83]
s_waitcnt vmcnt(9)
s_barrier
ds_read_b64_tr_b16 v[32:33], v16 offset:49152
v_mfma_f32_16x16x32_bf16 v[84:87], a[172:175], v[40:43], v[84:87]
ds_read_b64_tr_b16 v[34:35], v16 offset:50176
v_mfma_f32_16x16x32_bf16 v[136:139], a[168:171], a[168:171], v[136:139]
ds_read_b128 a[176:179], v2 offset:12288
v_mfma_f32_16x16x32_bf16 v[88:91], a[168:171], v[44:47], v[88:91]
ds_read_b128 a[180:183], v2 offset:14336
ds_read_b64_tr_b16 v[36:37], v17 offset:49152
v_mfma_f32_16x16x32_bf16 v[92:95], a[172:175], v[44:47], v[92:95]
ds_read_b128 a[184:187], v3 offset:12288
ds_read_b64_tr_b16 v[38:39], v17 offset:50176
v_mfma_f32_16x16x32_bf16 v[140:143], a[172:175], a[172:175], v[140:143]
ds_read_b128 a[188:191], v3 offset:14336
s_waitcnt lgkmcnt(12)
v_mfma_f32_16x16x32_bf16 v[96:99], a[168:171], v[48:51], v[96:99]
ds_read_b64_tr_b16 v[40:41], v18 offset:49152
s_add_u32 m0, s77, 0
v_mfma_f32_16x16x32_bf16 v[100:103], a[172:175], v[48:51], v[100:103]
ds_read_b64_tr_b16 v[42:43], v18 offset:50176
buffer_load_dwordx4 v4, s[4:7], s72 offen offset:0 lds
v_mfma_f32_16x16x32_bf16 v[128:131], a[168:171], v[24:27], v[128:131]
v_mfma_f32_16x16x32_bf16 v[104:107], a[168:171], v[52:55], v[104:107]
ds_read_b64_tr_b16 v[44:45], v19 offset:49152
v_mfma_f32_16x16x32_bf16 v[108:111], a[172:175], v[52:55], v[108:111]
ds_read_b64_tr_b16 v[46:47], v19 offset:50176
v_mfma_f32_16x16x32_bf16 v[132:135], a[172:175], v[24:27], v[132:135]
buffer_load_dwordx4 v5, s[4:7], s72 offen offset:1024 lds
s_waitcnt lgkmcnt(12)
v_mfma_f32_16x16x32_bf16 v[112:115], a[168:171], v[56:59], v[112:115]
ds_read_b64_tr_b16 v[48:49], v20 offset:49152
v_mfma_f32_16x16x32_bf16 v[116:119], a[172:175], v[56:59], v[116:119]
ds_read_b64_tr_b16 v[50:51], v20 offset:50176
v_mfma_f32_16x16x32_bf16 v[120:123], a[168:171], v[60:63], v[120:123]
ds_read_b64_tr_b16 v[52:53], v21 offset:49152
v_mfma_f32_16x16x32_bf16 v[124:127], a[172:175], v[60:63], v[124:127]
ds_read_b64_tr_b16 v[54:55], v21 offset:50176
s_waitcnt lgkmcnt(9)
v_mfma_f32_16x16x32_bf16 v[64:67], a[176:179], v[32:35], v[64:67]
ds_read_b64_tr_b16 v[56:57], v22 offset:49152
buffer_load_dwordx4 v6, s[4:7], s72 offen offset:2048 lds
v_mfma_f32_16x16x32_bf16 v[68:71], a[180:183], v[32:35], v[68:71]
ds_read_b64_tr_b16 v[58:59], v22 offset:50176
v_mfma_f32_16x16x32_bf16 v[144:147], v[24:27], v[32:35], v[144:147]
v_mfma_f32_16x16x32_bf16 v[72:75], a[176:179], v[36:39], v[72:75]
ds_read_b64_tr_b16 v[60:61], v23 offset:49152
v_mfma_f32_16x16x32_bf16 v[76:79], a[180:183], v[36:39], v[76:79]
ds_read_b64_tr_b16 v[62:63], v23 offset:50176
buffer_load_dwordx4 v7, s[4:7], s72 offen offset:3072 lds
v_mfma_f32_16x16x32_bf16 v[148:151], v[24:27], v[36:39], v[148:151]
s_add_u32 m0, s74, 16384
s_waitcnt lgkmcnt(8)
v_mfma_f32_16x16x32_bf16 v[80:83], a[176:179], v[40:43], v[80:83]
ds_read_b64_tr_b16 v[32:33], v16 offset:57344
s_mul_i32 s82, s72, 1792
v_mfma_f32_16x16x32_bf16 v[84:87], a[180:183], v[40:43], v[84:87]
ds_read_b64_tr_b16 v[34:35], v16 offset:58368
v_mfma_f32_16x16x32_bf16 v[136:139], a[176:179], a[176:179], v[136:139]
buffer_load_dwordx4 v12, s[12:15], s82 offen offset:0 lds
v_mfma_f32_16x16x32_bf16 v[88:91], a[176:179], v[44:47], v[88:91]
ds_read_b64_tr_b16 v[36:37], v17 offset:57344
v_mfma_f32_16x16x32_bf16 v[92:95], a[180:183], v[44:47], v[92:95]
ds_read_b64_tr_b16 v[38:39], v17 offset:58368
v_mfma_f32_16x16x32_bf16 v[140:143], a[180:183], a[180:183], v[140:143]
s_waitcnt lgkmcnt(8)
v_mfma_f32_16x16x32_bf16 v[96:99], a[176:179], v[48:51], v[96:99]
ds_read_b64_tr_b16 v[40:41], v18 offset:57344
buffer_load_dwordx4 v13, s[12:15], s82 offen offset:1024 lds
v_mfma_f32_16x16x32_bf16 v[100:103], a[180:183], v[48:51], v[100:103]
ds_read_b64_tr_b16 v[42:43], v18 offset:58368
v_mfma_f32_16x16x32_bf16 v[128:131], a[176:179], v[24:27], v[128:131]
v_mfma_f32_16x16x32_bf16 v[104:107], a[176:179], v[52:55], v[104:107]
ds_read_b64_tr_b16 v[44:45], v19 offset:57344
v_mfma_f32_16x16x32_bf16 v[108:111], a[180:183], v[52:55], v[108:111]
ds_read_b64_tr_b16 v[46:47], v19 offset:58368
buffer_load_dwordx4 v14, s[12:15], s82 offen offset:2048 lds
v_mfma_f32_16x16x32_bf16 v[132:135], a[180:183], v[24:27], v[132:135]
s_waitcnt lgkmcnt(8)
v_mfma_f32_16x16x32_bf16 v[112:115], a[176:179], v[56:59], v[112:115]
ds_read_b64_tr_b16 v[48:49], v20 offset:57344
v_mfma_f32_16x16x32_bf16 v[116:119], a[180:183], v[56:59], v[116:119]
ds_read_b64_tr_b16 v[50:51], v20 offset:58368
v_mfma_f32_16x16x32_bf16 v[120:123], a[176:179], v[60:63], v[120:123]
ds_read_b64_tr_b16 v[52:53], v21 offset:57344
buffer_load_dwordx4 v15, s[12:15], s82 offen offset:3072 lds
v_mfma_f32_16x16x32_bf16 v[124:127], a[180:183], v[60:63], v[124:127]
ds_read_b64_tr_b16 v[54:55], v21 offset:58368
s_waitcnt lgkmcnt(8)
v_mfma_f32_16x16x32_bf16 v[64:67], a[184:187], v[32:35], v[64:67]
ds_read_b64_tr_b16 v[56:57], v22 offset:57344
s_add_u32 s72, s72, 128
v_mfma_f32_16x16x32_bf16 v[68:71], a[188:191], v[32:35], v[68:71]
ds_read_b64_tr_b16 v[58:59], v22 offset:58368
s_and_b32 s72, s72, 0x380
v_mfma_f32_16x16x32_bf16 v[144:147], v[24:27], v[32:35], v[144:147]
v_mfma_f32_16x16x32_bf16 v[72:75], a[184:187], v[36:39], v[72:75]
ds_read_b64_tr_b16 v[60:61], v23 offset:57344
v_mfma_f32_16x16x32_bf16 v[76:79], a[188:191], v[36:39], v[76:79]
ds_read_b64_tr_b16 v[62:63], v23 offset:58368
v_mfma_f32_16x16x32_bf16 v[148:151], v[24:27], v[36:39], v[148:151]
s_waitcnt lgkmcnt(8)
v_mfma_f32_16x16x32_bf16 v[80:83], a[184:187], v[40:43], v[80:83]
s_waitcnt vmcnt(9)
s_barrier
ds_read_b64_tr_b16 v[32:33], v16 offset:0
v_mfma_f32_16x16x32_bf16 v[84:87], a[188:191], v[40:43], v[84:87]
ds_read_b64_tr_b16 v[34:35], v16 offset:1024
v_mfma_f32_16x16x32_bf16 v[136:139], a[184:187], a[184:187], v[136:139]
ds_read_b128 a[192:195], v2 offset:16384
v_mfma_f32_16x16x32_bf16 v[88:91], a[184:187], v[44:47], v[88:91]
ds_read_b128 a[196:199], v2 offset:18432
ds_read_b64_tr_b16 v[36:37], v17 offset:0
v_mfma_f32_16x16x32_bf16 v[92:95], a[188:191], v[44:47], v[92:95]
ds_read_b128 a[200:203], v3 offset:16384
ds_read_b64_tr_b16 v[38:39], v17 offset:1024
v_mfma_f32_16x16x32_bf16 v[140:143], a[188:191], a[188:191], v[140:143]
ds_read_b128 a[204:207], v3 offset:18432
s_waitcnt lgkmcnt(12)
v_mfma_f32_16x16x32_bf16 v[96:99], a[184:187], v[48:51], v[96:99]
ds_read_b64_tr_b16 v[40:41], v18 offset:0
s_add_u32 m0, s77, 4096
v_mfma_f32_16x16x32_bf16 v[100:103], a[188:191], v[48:51], v[100:103]
ds_read_b64_tr_b16 v[42:43], v18 offset:1024
buffer_load_dwordx4 v4, s[4:7], s72 offen offset:0 lds
v_mfma_f32_16x16x32_bf16 v[128:131], a[184:187], v[24:27], v[128:131]
v_mfma_f32_16x16x32_bf16 v[104:107], a[184:187], v[52:55], v[104:107]
ds_read_b64_tr_b16 v[44:45], v19 offset:0
v_mfma_f32_16x16x32_bf16 v[108:111], a[188:191], v[52:55], v[108:111]
ds_read_b64_tr_b16 v[46:47], v19 offset:1024
v_mfma_f32_16x16x32_bf16 v[132:135], a[188:191], v[24:27], v[132:135]
buffer_load_dwordx4 v5, s[4:7], s72 offen offset:1024 lds
s_waitcnt lgkmcnt(12)
v_mfma_f32_16x16x32_bf16 v[112:115], a[184:187], v[56:59], v[112:115]
ds_read_b64_tr_b16 v[48:49], v20 offset:0
v_mfma_f32_16x16x32_bf16 v[116:119], a[188:191], v[56:59], v[116:119]
ds_read_b64_tr_b16 v[50:51], v20 offset:1024
v_mfma_f32_16x16x32_bf16 v[120:123], a[184:187], v[60:63], v[120:123]
ds_read_b64_tr_b16 v[52:53], v21 offset:0
v_mfma_f32_16x16x32_bf16 v[124:127], a[188:191], v[60:63], v[124:127]
ds_read_b64_tr_b16 v[54:55], v21 offset:1024
s_waitcnt lgkmcnt(9)
v_mfma_f32_16x16x32_bf16 v[64:67], a[192:195], v[32:35], v[64:67]
ds_read_b64_tr_b16 v[56:57], v22 offset:0
buffer_load_dwordx4 v6, s[4:7], s72 offen offset:2048 lds
v_mfma_f32_16x16x32_bf16 v[68:71], a[196:199], v[32:35], v[68:71]
ds_read_b64_tr_b16 v[58:59], v22 offset:1024
v_mfma_f32_16x16x32_bf16 v[144:147], v[24:27], v[32:35], v[144:147]
v_mfma_f32_16x16x32_bf16 v[72:75], a[192:195], v[36:39], v[72:75]
ds_read_b64_tr_b16 v[60:61], v23 offset:0
v_mfma_f32_16x16x32_bf16 v[76:79], a[196:199], v[36:39], v[76:79]
ds_read_b64_tr_b16 v[62:63], v23 offset:1024
buffer_load_dwordx4 v7, s[4:7], s72 offen offset:3072 lds
v_mfma_f32_16x16x32_bf16 v[148:151], v[24:27], v[36:39], v[148:151]
s_add_u32 m0, s74, 32768
s_waitcnt lgkmcnt(8)
v_mfma_f32_16x16x32_bf16 v[80:83], a[192:195], v[40:43], v[80:83]
ds_read_b64_tr_b16 v[32:33], v16 offset:8192
s_mul_i32 s82, s72, 1792
v_mfma_f32_16x16x32_bf16 v[84:87], a[196:199], v[40:43], v[84:87]
ds_read_b64_tr_b16 v[34:35], v16 offset:9216
v_mfma_f32_16x16x32_bf16 v[136:139], a[192:195], a[192:195], v[136:139]
buffer_load_dwordx4 v12, s[12:15], s82 offen offset:0 lds
v_mfma_f32_16x16x32_bf16 v[88:91], a[192:195], v[44:47], v[88:91]
ds_read_b64_tr_b16 v[36:37], v17 offset:8192
v_mfma_f32_16x16x32_bf16 v[92:95], a[196:199], v[44:47], v[92:95]
ds_read_b64_tr_b16 v[38:39], v17 offset:9216
v_mfma_f32_16x16x32_bf16 v[140:143], a[196:199], a[196:199], v[140:143]
s_waitcnt lgkmcnt(8)
v_mfma_f32_16x16x32_bf16 v[96:99], a[192:195], v[48:51], v[96:99]
ds_read_b64_tr_b16 v[40:41], v18 offset:8192
buffer_load_dwordx4 v13, s[12:15], s82 offen offset:1024 lds
v_mfma_f32_16x16x32_bf16 v[100:103], a[196:199], v[48:51], v[100:103]
ds_read_b64_tr_b16 v[42:43], v18 offset:9216
v_mfma_f32_16x16x32_bf16 v[128:131], a[192:195], v[24:27], v[128:131]
v_mfma_f32_16x16x32_bf16 v[104:107], a[192:195], v[52:55], v[104:107]
ds_read_b64_tr_b16 v[44:45], v19 offset:8192
v_mfma_f32_16x16x32_bf16 v[108:111], a[196:199], v[52:55], v[108:111]
ds_read_b64_tr_b16 v[46:47], v19 offset:9216
buffer_load_dwordx4 v14, s[12:15], s82 offen offset:2048 lds
v_mfma_f32_16x16x32_bf16 v[132:135], a[196:199], v[24:27], v[132:135]
s_waitcnt lgkmcnt(8)
v_mfma_f32_16x16x32_bf16 v[112:115], a[192:195], v[56:59], v[112:115]
ds_read_b64_tr_b16 v[48:49], v20 offset:8192
v_mfma_f32_16x16x32_bf16 v[116:119], a[196:199], v[56:59], v[116:119]
ds_read_b64_tr_b16 v[50:51], v20 offset:9216
v_mfma_f32_16x16x32_bf16 v[120:123], a[192:195], v[60:63], v[120:123]
ds_read_b64_tr_b16 v[52:53], v21 offset:8192
buffer_load_dwordx4 v15, s[12:15], s82 offen offset:3072 lds
v_mfma_f32_16x16x32_bf16 v[124:127], a[196:199], v[60:63], v[124:127]
ds_read_b64_tr_b16 v[54:55], v21 offset:9216
s_waitcnt lgkmcnt(8)
v_mfma_f32_16x16x32_bf16 v[64:67], a[200:203], v[32:35], v[64:67]
ds_read_b64_tr_b16 v[56:57], v22 offset:8192
s_add_u32 s72, s72, 128
v_mfma_f32_16x16x32_bf16 v[68:71], a[204:207], v[32:35], v[68:71]
ds_read_b64_tr_b16 v[58:59], v22 offset:9216
s_and_b32 s72, s72, 0x380
v_mfma_f32_16x16x32_bf16 v[144:147], v[24:27], v[32:35], v[144:147]
v_mfma_f32_16x16x32_bf16 v[72:75], a[200:203], v[36:39], v[72:75]
ds_read_b64_tr_b16 v[60:61], v23 offset:8192
v_mfma_f32_16x16x32_bf16 v[76:79], a[204:207], v[36:39], v[76:79]
ds_read_b64_tr_b16 v[62:63], v23 offset:9216
v_mfma_f32_16x16x32_bf16 v[148:151], v[24:27], v[36:39], v[148:151]
s_waitcnt lgkmcnt(8)
v_mfma_f32_16x16x32_bf16 v[80:83], a[200:203], v[40:43], v[80:83]
s_waitcnt vmcnt(8)
s_barrier
ds_read_b64_tr_b16 v[32:33], v16 offset:16384
v_mfma_f32_16x16x32_bf16 v[84:87], a[204:207], v[40:43], v[84:87]
ds_read_b64_tr_b16 v[34:35], v16 offset:17408
v_mfma_f32_16x16x32_bf16 v[136:139], a[200:203], a[200:203], v[136:139]
ds_read_b128 a[208:211], v2 offset:0
v_mfma_f32_16x16x32_bf16 v[88:91], a[200:203], v[44:47], v[88:91]
ds_read_b128 a[212:215], v2 offset:2048
ds_read_b64_tr_b16 v[36:37], v17 offset:16384
v_mfma_f32_16x16x32_bf16 v[92:95], a[204:207], v[44:47], v[92:95]
ds_read_b128 a[216:219], v3 offset:0
ds_read_b64_tr_b16 v[38:39], v17 offset:17408
v_mfma_f32_16x16x32_bf16 v[140:143], a[204:207], a[204:207], v[140:143]
ds_read_b128 a[220:223], v3 offset:2048
s_waitcnt lgkmcnt(12)
v_mfma_f32_16x16x32_bf16 v[96:99], a[200:203], v[48:51], v[96:99]
ds_read_b64_tr_b16 v[40:41], v18 offset:16384
s_add_u32 m0, s77, 8192
v_mfma_f32_16x16x32_bf16 v[100:103], a[204:207], v[48:51], v[100:103]
ds_read_b64_tr_b16 v[42:43], v18 offset:17408
buffer_load_dwordx4 v4, s[4:7], s72 offen offset:0 lds
v_mfma_f32_16x16x32_bf16 v[128:131], a[200:203], v[24:27], v[128:131]
v_mfma_f32_16x16x32_bf16 v[104:107], a[200:203], v[52:55], v[104:107]
ds_read_b64_tr_b16 v[44:45], v19 offset:16384
v_mfma_f32_16x16x32_bf16 v[108:111], a[204:207], v[52:55], v[108:111]
ds_read_b64_tr_b16 v[46:47], v19 offset:17408
v_mfma_f32_16x16x32_bf16 v[132:135], a[204:207], v[24:27], v[132:135]
buffer_load_dwordx4 v5, s[4:7], s72 offen offset:1024 lds
s_waitcnt lgkmcnt(12)
v_mfma_f32_16x16x32_bf16 v[112:115], a[200:203], v[56:59], v[112:115]
ds_read_b64_tr_b16 v[48:49], v20 offset:16384
v_mfma_f32_16x16x32_bf16 v[116:119], a[204:207], v[56:59], v[116:119]
ds_read_b64_tr_b16 v[50:51], v20 offset:17408
v_mfma_f32_16x16x32_bf16 v[120:123], a[200:203], v[60:63], v[120:123]
ds_read_b64_tr_b16 v[52:53], v21 offset:16384
v_mfma_f32_16x16x32_bf16 v[124:127], a[204:207], v[60:63], v[124:127]
ds_read_b64_tr_b16 v[54:55], v21 offset:17408
s_waitcnt lgkmcnt(9)
v_mfma_f32_16x16x32_bf16 v[64:67], a[208:211], v[32:35], v[64:67]
ds_read_b64_tr_b16 v[56:57], v22 offset:16384
buffer_load_dwordx4 v6, s[4:7], s72 offen offset:2048 lds
v_mfma_f32_16x16x32_bf16 v[68:71], a[212:215], v[32:35], v[68:71]
ds_read_b64_tr_b16 v[58:59], v22 offset:17408
v_mfma_f32_16x16x32_bf16 v[144:147], v[24:27], v[32:35], v[144:147]
v_mfma_f32_16x16x32_bf16 v[72:75], a[208:211], v[36:39], v[72:75]
ds_read_b64_tr_b16 v[60:61], v23 offset:16384
v_mfma_f32_16x16x32_bf16 v[76:79], a[212:215], v[36:39], v[76:79]
ds_read_b64_tr_b16 v[62:63], v23 offset:17408
buffer_load_dwordx4 v7, s[4:7], s72 offen offset:3072 lds
v_mfma_f32_16x16x32_bf16 v[148:151], v[24:27], v[36:39], v[148:151]
s_add_u32 m0, s74, 49152
s_waitcnt lgkmcnt(8)
v_mfma_f32_16x16x32_bf16 v[80:83], a[208:211], v[40:43], v[80:83]
ds_read_b64_tr_b16 v[32:33], v16 offset:24576
s_mul_i32 s82, s72, 1792
v_mfma_f32_16x16x32_bf16 v[84:87], a[212:215], v[40:43], v[84:87]
ds_read_b64_tr_b16 v[34:35], v16 offset:25600
v_mfma_f32_16x16x32_bf16 v[136:139], a[208:211], a[208:211], v[136:139]
buffer_load_dwordx4 v12, s[12:15], s82 offen offset:0 lds
v_mfma_f32_16x16x32_bf16 v[88:91], a[208:211], v[44:47], v[88:91]
ds_read_b64_tr_b16 v[36:37], v17 offset:24576
v_mfma_f32_16x16x32_bf16 v[92:95], a[212:215], v[44:47], v[92:95]
ds_read_b64_tr_b16 v[38:39], v17 offset:25600
v_mfma_f32_16x16x32_bf16 v[140:143], a[212:215], a[212:215], v[140:143]
s_waitcnt lgkmcnt(8)
v_mfma_f32_16x16x32_bf16 v[96:99], a[208:211], v[48:51], v[96:99]
ds_read_b64_tr_b16 v[40:41], v18 offset:24576
buffer_load_dwordx4 v13, s[12:15], s82 offen offset:1024 lds
v_mfma_f32_16x16x32_bf16 v[100:103], a[212:215], v[48:51], v[100:103]
ds_read_b64_tr_b16 v[42:43], v18 offset:25600
v_mfma_f32_16x16x32_bf16 v[128:131], a[208:211], v[24:27], v[128:131]
v_mfma_f32_16x16x32_bf16 v[104:107], a[208:211], v[52:55], v[104:107]
ds_read_b64_tr_b16 v[44:45], v19 offset:24576
v_mfma_f32_16x16x32_bf16 v[108:111], a[212:215], v[52:55], v[108:111]
ds_read_b64_tr_b16 v[46:47], v19 offset:25600
buffer_load_dwordx4 v14, s[12:15], s82 offen offset:2048 lds
v_mfma_f32_16x16x32_bf16 v[132:135], a[212:215], v[24:27], v[132:135]
s_waitcnt lgkmcnt(8)
v_mfma_f32_16x16x32_bf16 v[112:115], a[208:211], v[56:59], v[112:115]
ds_read_b64_tr_b16 v[48:49], v20 offset:24576
v_mfma_f32_16x16x32_bf16 v[116:119], a[212:215], v[56:59], v[116:119]
ds_read_b64_tr_b16 v[50:51], v20 offset:25600
v_mfma_f32_16x16x32_bf16 v[120:123], a[208:211], v[60:63], v[120:123]
ds_read_b64_tr_b16 v[52:53], v21 offset:24576
buffer_load_dwordx4 v15, s[12:15], s82 offen offset:3072 lds
v_mfma_f32_16x16x32_bf16 v[124:127], a[212:215], v[60:63], v[124:127]
ds_read_b64_tr_b16 v[54:55], v21 offset:25600
s_waitcnt lgkmcnt(8)
v_mfma_f32_16x16x32_bf16 v[64:67], a[216:219], v[32:35], v[64:67]
ds_read_b64_tr_b16 v[56:57], v22 offset:24576
s_add_u32 s72, s72, 128
v_mfma_f32_16x16x32_bf16 v[68:71], a[220:223], v[32:35], v[68:71]
ds_read_b64_tr_b16 v[58:59], v22 offset:25600
s_and_b32 s72, s72, 0x380
v_mfma_f32_16x16x32_bf16 v[144:147], v[24:27], v[32:35], v[144:147]
buffer_load_dword v28, off, s[40:43], 0 sc1
v_mfma_f32_16x16x32_bf16 v[72:75], a[216:219], v[36:39], v[72:75]
ds_read_b64_tr_b16 v[60:61], v23 offset:24576
v_mfma_f32_16x16x32_bf16 v[76:79], a[220:223], v[36:39], v[76:79]
ds_read_b64_tr_b16 v[62:63], v23 offset:25600
v_mfma_f32_16x16x32_bf16 v[148:151], v[24:27], v[36:39], v[148:151]
s_waitcnt lgkmcnt(8)
v_mfma_f32_16x16x32_bf16 v[80:83], a[216:219], v[40:43], v[80:83]
s_waitcnt vmcnt(9)
s_barrier
ds_read_b64_tr_b16 v[32:33], v16 offset:32768
v_mfma_f32_16x16x32_bf16 v[84:87], a[220:223], v[40:43], v[84:87]
ds_read_b64_tr_b16 v[34:35], v16 offset:33792
s_mov_b32 exec_lo, 0x0
s_mov_b32 exec_hi, 0xffffffff
buffer_load_dword v189, v191, s[12:15], 0 offen
s_mov_b64 exec, -1
v_mfma_f32_16x16x32_bf16 v[136:139], a[216:219], a[216:219], v[136:139]
ds_read_b128 a[224:227], v2 offset:4096
v_mfma_f32_16x16x32_bf16 v[88:91], a[216:219], v[44:47], v[88:91]
ds_read_b128 a[228:231], v2 offset:6144
ds_read_b64_tr_b16 v[36:37], v17 offset:32768
v_mfma_f32_16x16x32_bf16 v[92:95], a[220:223], v[44:47], v[92:95]
ds_read_b128 a[232:235], v3 offset:4096
ds_read_b64_tr_b16 v[38:39], v17 offset:33792
v_mfma_f32_16x16x32_bf16 v[140:143], a[220:223], a[220:223], v[140:143]
ds_read_b128 a[236:239], v3 offset:6144
s_waitcnt lgkmcnt(12)
v_mfma_f32_16x16x32_bf16 v[96:99], a[216:219], v[48:51], v[96:99]
ds_read_b64_tr_b16 v[40:41], v18 offset:32768
s_add_u32 m0, s77, 12288
s_add_u32 s82, s64, s76
s_add_u32 s83, s66, s76
buffer_load_dwordx4 v8, s[16:19], s82 offen offset:0 lds
buffer_load_dwordx4 v9, s[16:19], s82 offen offset:1024 lds
buffer_load_dwordx4 v10, s[16:19], s83 offen offset:2048 lds
buffer_load_dwordx4 v11, s[16:19], s83 offen offset:3072 lds
v_mfma_f32_16x16x32_bf16 v[100:103], a[220:223], v[48:51], v[100:103]
ds_read_b64_tr_b16 v[42:43], v18 offset:33792
v_mfma_f32_16x16x32_bf16 v[128:131], a[216:219], v[24:27], v[128:131]
s_add_u32 m0, s77, 16384
s_add_u32 s82, s65, s76
v_mfma_f32_16x16x32_bf16 v[104:107], a[216:219], v[52:55], v[104:107]
ds_read_b64_tr_b16 v[44:45], v19 offset:32768
s_add_u32 s83, s67, s76
v_mfma_f32_16x16x32_bf16 v[108:111], a[220:223], v[52:55], v[108:111]
ds_read_b64_tr_b16 v[46:47], v19 offset:33792
buffer_load_dwordx4 v8, s[16:19], s82 offen offset:0 lds
v_mfma_f32_16x16x32_bf16 v[132:135], a[220:223], v[24:27], v[132:135]
s_waitcnt lgkmcnt(12)
v_mfma_f32_16x16x32_bf16 v[112:115], a[216:219], v[56:59], v[112:115]
ds_read_b64_tr_b16 v[48:49], v20 offset:32768
v_mfma_f32_16x16x32_bf16 v[116:119], a[220:223], v[56:59], v[116:119]
ds_read_b64_tr_b16 v[50:51], v20 offset:33792
v_mfma_f32_16x16x32_bf16 v[120:123], a[216:219], v[60:63], v[120:123]
ds_read_b64_tr_b16 v[52:53], v21 offset:32768
buffer_load_dwordx4 v9, s[16:19], s82 offen offset:1024 lds
v_mfma_f32_16x16x32_bf16 v[124:127], a[220:223], v[60:63], v[124:127]
ds_read_b64_tr_b16 v[54:55], v21 offset:33792
s_waitcnt lgkmcnt(9)
v_mfma_f32_16x16x32_bf16 v[64:67], a[224:227], v[32:35], v[64:67]
ds_read_b64_tr_b16 v[56:57], v22 offset:32768
v_mfma_f32_16x16x32_bf16 v[68:71], a[228:231], v[32:35], v[68:71]
ds_read_b64_tr_b16 v[58:59], v22 offset:33792
v_mfma_f32_16x16x32_bf16 v[144:147], v[24:27], v[32:35], v[144:147]
buffer_load_dwordx4 v10, s[16:19], s83 offen offset:2048 lds
v_mfma_f32_16x16x32_bf16 v[72:75], a[224:227], v[36:39], v[72:75]
ds_read_b64_tr_b16 v[60:61], v23 offset:32768
v_mfma_f32_16x16x32_bf16 v[76:79], a[228:231], v[36:39], v[76:79]
ds_read_b64_tr_b16 v[62:63], v23 offset:33792
v_mfma_f32_16x16x32_bf16 v[148:151], v[24:27], v[36:39], v[148:151]
s_waitcnt lgkmcnt(8)
v_mfma_f32_16x16x32_bf16 v[80:83], a[224:227], v[40:43], v[80:83]
ds_read_b64_tr_b16 v[32:33], v16 offset:40960
buffer_load_dwordx4 v11, s[16:19], s83 offen offset:3072 lds
v_mfma_f32_16x16x32_bf16 v[84:87], a[228:231], v[40:43], v[84:87]
ds_read_b64_tr_b16 v[34:35], v16 offset:41984
s_waitcnt vmcnt(4)
v_mfma_f32_16x16x32_bf16 v[136:139], a[224:227], a[224:227], v[136:139]
ds_read_b128 a[0:3], v2 offset:12288
ds_read_b128 a[4:7], v2 offset:14336
v_mfma_f32_16x16x32_bf16 v[88:91], a[224:227], v[44:47], v[88:91]
ds_read_b64_tr_b16 v[36:37], v17 offset:40960
ds_read_b128 a[16:19], v3 offset:12288
v_mfma_f32_16x16x32_bf16 v[92:95], a[228:231], v[44:47], v[92:95]
ds_read_b64_tr_b16 v[38:39], v17 offset:41984
ds_read_b128 a[20:23], v3 offset:14336
v_mfma_f32_16x16x32_bf16 v[140:143], a[228:231], a[228:231], v[140:143]
s_waitcnt lgkmcnt(12)
v_mfma_f32_16x16x32_bf16 v[96:99], a[224:227], v[48:51], v[96:99]
ds_read_b64_tr_b16 v[40:41], v18 offset:40960
s_add_u32 m0, s77, 0
v_mfma_f32_16x16x32_bf16 v[100:103], a[228:231], v[48:51], v[100:103]
ds_read_b64_tr_b16 v[42:43], v18 offset:41984
s_add_u32 s76, s76, 128
v_mfma_f32_16x16x32_bf16 v[128:131], a[224:227], v[24:27], v[128:131]
s_and_b32 s76, s76, 0x380
s_add_u32 s82, s64, s76
v_mfma_f32_16x16x32_bf16 v[104:107], a[224:227], v[52:55], v[104:107]
ds_read_b64_tr_b16 v[44:45], v19 offset:40960
s_add_u32 s83, s66, s76
v_mfma_f32_16x16x32_bf16 v[108:111], a[228:231], v[52:55], v[108:111]
ds_read_b64_tr_b16 v[46:47], v19 offset:41984
buffer_load_dwordx4 v8, s[16:19], s82 offen offset:0 lds
v_mfma_f32_16x16x32_bf16 v[132:135], a[228:231], v[24:27], v[132:135]
s_waitcnt lgkmcnt(12)
v_mfma_f32_16x16x32_bf16 v[112:115], a[224:227], v[56:59], v[112:115]
ds_read_b64_tr_b16 v[48:49], v20 offset:40960
v_mfma_f32_16x16x32_bf16 v[116:119], a[228:231], v[56:59], v[116:119]
ds_read_b64_tr_b16 v[50:51], v20 offset:41984
v_mfma_f32_16x16x32_bf16 v[120:123], a[224:227], v[60:63], v[120:123]
ds_read_b64_tr_b16 v[52:53], v21 offset:40960
buffer_load_dwordx4 v9, s[16:19], s82 offen offset:1024 lds
v_mfma_f32_16x16x32_bf16 v[124:127], a[228:231], v[60:63], v[124:127]
ds_read_b64_tr_b16 v[54:55], v21 offset:41984
s_waitcnt lgkmcnt(9)
v_mfma_f32_16x16x32_bf16 v[64:67], a[232:235], v[32:35], v[64:67]
ds_read_b64_tr_b16 v[56:57], v22 offset:40960
v_and_b32 v29, 15, v0
v_mfma_f32_16x16x32_bf16 v[68:71], a[236:239], v[32:35], v[68:71]
ds_read_b64_tr_b16 v[58:59], v22 offset:41984
v_lshlrev_b32 v29, 2, v29
v_mfma_f32_16x16x32_bf16 v[144:147], v[24:27], v[32:35], v[144:147]
buffer_load_dwordx4 v10, s[16:19], s83 offen offset:2048 lds
v_add_u32 v29, 65536, v29
v_mfma_f32_16x16x32_bf16 v[72:75], a[232:235], v[36:39], v[72:75]
ds_read_b64_tr_b16 v[60:61], v23 offset:40960
s_lshl_b32 s84, s78, 6
v_mfma_f32_16x16x32_bf16 v[76:79], a[236:239], v[36:39], v[76:79]
ds_read_b64_tr_b16 v[62:63], v23 offset:41984
v_add_u32 v30, s84, v29
v_mfma_f32_16x16x32_bf16 v[148:151], v[24:27], v[36:39], v[148:151]
v_lshrrev_b32 v31, 4, v0
s_waitcnt lgkmcnt(8)
v_mfma_f32_16x16x32_bf16 v[80:83], a[232:235], v[40:43], v[80:83]
s_barrier
ds_read_b64_tr_b16 v[32:33], v16 offset:49152
v_mfma_f32_16x16x32_bf16 v[84:87], a[236:239], v[40:43], v[84:87]
ds_read_b64_tr_b16 v[34:35], v16 offset:50176
buffer_load_dwordx4 v11, s[16:19], s83 offen offset:3072 lds
v_mfma_f32_16x16x32_bf16 v[136:139], a[232:235], a[232:235], v[136:139]
ds_read_b128 a[240:243], v2 offset:8192
s_waitcnt vmcnt(4)
v_mfma_f32_16x16x32_bf16 v[88:91], a[232:235], v[44:47], v[88:91]
ds_read_b128 a[244:247], v2 offset:10240
ds_read_b64_tr_b16 v[36:37], v17 offset:49152
v_mfma_f32_16x16x32_bf16 v[92:95], a[236:239], v[44:47], v[92:95]
ds_read_b128 a[248:251], v3 offset:8192
ds_read_b64_tr_b16 v[38:39], v17 offset:50176
v_mfma_f32_16x16x32_bf16 v[140:143], a[236:239], a[236:239], v[140:143]
ds_read_b128 a[252:255], v3 offset:10240
s_waitcnt lgkmcnt(12)
v_mfma_f32_16x16x32_bf16 v[96:99], a[232:235], v[48:51], v[96:99]
ds_read_b64_tr_b16 v[40:41], v16 offset:57344
ds_read_b128 a[8:11], v2 offset:16384
v_mfma_f32_16x16x32_bf16 v[100:103], a[236:239], v[48:51], v[100:103]
ds_read_b64_tr_b16 v[42:43], v16 offset:58368
ds_read_b128 a[12:15], v2 offset:18432
v_mfma_f32_16x16x32_bf16 v[128:131], a[232:235], v[24:27], v[128:131]
ds_read_b128 a[24:27], v3 offset:16384
ds_read_b128 a[28:31], v3 offset:18432
v_mfma_f32_16x16x32_bf16 v[104:107], a[232:235], v[52:55], v[104:107]
ds_read_b64_tr_b16 v[44:45], v17 offset:57344
v_mfma_f32_16x16x32_bf16 v[108:111], a[236:239], v[52:55], v[108:111]
ds_read_b64_tr_b16 v[46:47], v17 offset:58368
s_add_u32 m0, s77, 4096
v_mfma_f32_16x16x32_bf16 v[132:135], a[236:239], v[24:27], v[132:135]
s_add_u32 s82, s65, s76
s_waitcnt lgkmcnt(15)
v_mfma_f32_16x16x32_bf16 v[112:115], a[232:235], v[56:59], v[112:115]
ds_read_b64_tr_b16 v[48:49], v18 offset:49152
s_add_u32 s83, s67, s76
v_mfma_f32_16x16x32_bf16 v[116:119], a[236:239], v[56:59], v[116:119]
ds_read_b64_tr_b16 v[50:51], v18 offset:50176
buffer_load_dwordx4 v8, s[16:19], s82 offen offset:0 lds
v_mfma_f32_16x16x32_bf16 v[120:123], a[232:235], v[60:63], v[120:123]
ds_read_b64_tr_b16 v[52:53], v19 offset:49152
v_mul_u32_u24 v31, 80, v31
v_mfma_f32_16x16x32_bf16 v[124:127], a[236:239], v[60:63], v[124:127]
ds_read_b64_tr_b16 v[54:55], v19 offset:50176
s_waitcnt lgkmcnt(13)
v_mfma_f32_16x16x32_bf16 v[64:67], a[240:243], v[32:35], v[64:67]
ds_read_b64_tr_b16 v[56:57], v20 offset:49152
v_mfma_f32_16x16x32_bf16 v[68:71], a[244:247], v[32:35], v[68:71]
ds_read_b64_tr_b16 v[58:59], v20 offset:50176
buffer_load_dwordx4 v9, s[16:19], s82 offen offset:1024 lds
v_mfma_f32_16x16x32_bf16 v[144:147], v[24:27], v[32:35], v[144:147]
v_mfma_f32_16x16x32_bf16 v[136:139], a[240:243], a[240:243], v[136:139]
v_mfma_f32_16x16x32_bf16 v[140:143], a[244:247], a[244:247], v[140:143]
v_mfma_f32_16x16x32_bf16 v[72:75], a[240:243], v[36:39], v[72:75]
ds_read_b64_tr_b16 v[60:61], v21 offset:49152
buffer_load_dwordx4 v10, s[16:19], s83 offen offset:2048 lds
v_mfma_f32_16x16x32_bf16 v[76:79], a[244:247], v[36:39], v[76:79]
ds_read_b64_tr_b16 v[62:63], v21 offset:50176
v_mfma_f32_16x16x32_bf16 v[148:151], v[24:27], v[36:39], v[148:151]
v_mfma_f32_16x16x32_bf16 v[128:131], a[240:243], v[24:27], v[128:131]
v_mfma_f32_16x16x32_bf16 v[132:135], a[244:247], v[24:27], v[132:135]
buffer_load_dwordx4 v11, s[16:19], s83 offen offset:3072 lds
s_waitcnt lgkmcnt(8)
v_mfma_f32_16x16x32_bf16 v[64:67], a[248:251], v[40:43], v[64:67]
ds_read_b64_tr_b16 v[32:33], v22 offset:49152
s_waitcnt vmcnt(4)
v_mfma_f32_16x16x32_bf16 v[68:71], a[252:255], v[40:43], v[68:71]
ds_read_b64_tr_b16 v[34:35], v22 offset:50176
ds_read_b128 a[32:35], v2 offset:0
v_mfma_f32_16x16x32_bf16 v[144:147], v[24:27], v[40:43], v[144:147]
ds_read_b128 a[36:39], v2 offset:2048
ds_read_b128 a[48:51], v3 offset:0
v_mfma_f32_16x16x32_bf16 v[136:139], a[248:251], a[248:251], v[136:139]
ds_read_b128 a[52:55], v3 offset:2048
v_mfma_f32_16x16x32_bf16 v[140:143], a[252:255], a[252:255], v[140:143]
s_add_u32 m0, s77, 8192
s_add_u32 s76, s76, 128
v_mfma_f32_16x16x32_bf16 v[72:75], a[248:251], v[44:47], v[72:75]
ds_read_b64_tr_b16 v[36:37], v23 offset:49152
s_and_b32 s76, s76, 0x380
v_mfma_f32_16x16x32_bf16 v[76:79], a[252:255], v[44:47], v[76:79]
ds_read_b64_tr_b16 v[38:39], v23 offset:50176
s_add_u32 s82, s64, s76
v_mfma_f32_16x16x32_bf16 v[148:151], v[24:27], v[44:47], v[148:151]
s_add_u32 s83, s66, s76
buffer_load_dwordx4 v8, s[16:19], s82 offen offset:0 lds
v_mfma_f32_16x16x32_bf16 v[128:131], a[248:251], v[24:27], v[128:131]
v_mfma_f32_16x16x32_bf16 v[132:135], a[252:255], v[24:27], v[132:135]
s_waitcnt lgkmcnt(12)
v_mfma_f32_16x16x32_bf16 v[80:83], a[240:243], v[48:51], v[80:83]
ds_read_b64_tr_b16 v[40:41], v18 offset:57344
v_mfma_f32_16x16x32_bf16 v[84:87], a[244:247], v[48:51], v[84:87]
ds_read_b64_tr_b16 v[42:43], v18 offset:58368
buffer_load_dwordx4 v9, s[16:19], s82 offen offset:1024 lds
v_mfma_f32_16x16x32_bf16 v[88:91], a[240:243], v[52:55], v[88:91]
ds_read_b64_tr_b16 v[44:45], v19 offset:57344
v_mfma_f32_16x16x32_bf16 v[92:95], a[244:247], v[52:55], v[92:95]
ds_read_b64_tr_b16 v[46:47], v19 offset:58368
ds_write_b32 v30, v144
s_waitcnt lgkmcnt(13)
v_mfma_f32_16x16x32_bf16 v[96:99], a[240:243], v[56:59], v[96:99]
ds_read_b64_tr_b16 v[48:49], v20 offset:57344
ds_write_b32 v30, v148 offset:64
v_mfma_f32_16x16x32_bf16 v[100:103], a[244:247], v[56:59], v[100:103]
ds_read_b64_tr_b16 v[50:51], v20 offset:58368
buffer_load_dwordx4 v10, s[16:19], s83 offen offset:2048 lds
v_mfma_f32_16x16x32_bf16 v[104:107], a[240:243], v[60:63], v[104:107]
ds_read_b64_tr_b16 v[52:53], v21 offset:57344
v_mfma_f32_16x16x32_bf16 v[108:111], a[244:247], v[60:63], v[108:111]
ds_read_b64_tr_b16 v[54:55], v21 offset:58368
s_waitcnt lgkmcnt(3)
v_mfma_f32_16x16x32_bf16 v[112:115], a[240:243], v[32:35], v[112:115]
ds_read_b64_tr_b16 v[56:57], v22 offset:57344
s_barrier
s_lshl_b32 s84, s78, 6
v_mfma_f32_16x16x32_bf16 v[116:119], a[244:247], v[32:35], v[116:119]
ds_read_b64_tr_b16 v[58:59], v22 offset:58368
buffer_load_dwordx4 v11, s[16:19], s83 offen offset:3072 lds
v_add_u32 v30, s84, v29
v_mfma_f32_16x16x32_bf16 v[120:123], a[240:243], v[36:39], v[120:123]
ds_read_b64_tr_b16 v[60:61], v23 offset:57344
ds_read_b32 v152, v30
ds_read_b32 v153, v30 offset:64
v_mfma_f32_16x16x32_bf16 v[124:127], a[244:247], v[36:39], v[124:127]
ds_read_b64_tr_b16 v[62:63], v23 offset:58368
s_lshl_b32 s84, s79, 6
v_mfma_f32_16x16x32_bf16 v[80:83], a[248:251], v[40:43], v[80:83]
v_add_u32 v30, s84, v29
ds_read_b32 v154, v30
ds_read_b32 v155, v30 offset:64
v_mfma_f32_16x16x32_bf16 v[84:87], a[252:255], v[40:43], v[84:87]
s_lshl_b32 s84, s80, 6
v_add_u32 v30, s84, v29
ds_read_b32 v156, v30
v_mfma_f32_16x16x32_bf16 v[88:91], a[248:251], v[44:47], v[88:91]
ds_read_b32 v157, v30 offset:64
s_lshl_b32 s84, s81, 6
v_add_u32 v30, s84, v29
v_mfma_f32_16x16x32_bf16 v[92:95], a[252:255], v[44:47], v[92:95]
ds_read_b32 v158, v30
ds_read_b32 v159, v30 offset:64
s_waitcnt lgkmcnt(12)
v_mfma_f32_16x16x32_bf16 v[96:99], a[248:251], v[48:51], v[96:99]
ds_bpermute_b32 v144, v31, v136 offset:0
ds_bpermute_b32 v145, v31, v137 offset:4
ds_bpermute_b32 v146, v31, v138 offset:8
v_mfma_f32_16x16x32_bf16 v[100:103], a[252:255], v[48:51], v[100:103]
ds_bpermute_b32 v147, v31, v139 offset:12
ds_bpermute_b32 v148, v31, v140 offset:0
ds_bpermute_b32 v149, v31, v141 offset:4
v_mfma_f32_16x16x32_bf16 v[104:107], a[248:251], v[52:55], v[104:107]
ds_bpermute_b32 v150, v31, v142 offset:8
ds_bpermute_b32 v151, v31, v143 offset:12
v_mfma_f32_16x16x32_bf16 v[108:111], a[252:255], v[52:55], v[108:111]
s_waitcnt lgkmcnt(14)
v_mfma_f32_16x16x32_bf16 v[112:115], a[248:251], v[56:59], v[112:115]
v_mfma_f32_16x16x32_bf16 v[116:119], a[252:255], v[56:59], v[116:119]
v_mfma_f32_16x16x32_bf16 v[120:123], a[248:251], v[60:63], v[120:123]
v_mfma_f32_16x16x32_bf16 v[124:127], a[252:255], v[60:63], v[124:127]
v_pk_mul_f32 v[128:129], v[128:129], s[86:87] op_sel_hi:[1,0]
v_pk_mul_f32 v[130:131], v[130:131], s[86:87] op_sel_hi:[1,0]
v_pk_mul_f32 v[132:133], v[132:133], s[86:87] op_sel_hi:[1,0]
v_pk_mul_f32 v[134:135], v[134:135], s[86:87] op_sel_hi:[1,0]
s_waitcnt lgkmcnt(6)
v_pk_mul_f32 v[144:145], v[144:145], s[86:87] op_sel_hi:[1,0]
s_waitcnt lgkmcnt(4)
v_pk_mul_f32 v[146:147], v[146:147], s[86:87] op_sel_hi:[1,0]
s_waitcnt lgkmcnt(2)
v_pk_mul_f32 v[148:149], v[148:149], s[86:87] op_sel_hi:[1,0]
s_waitcnt lgkmcnt(0)
v_pk_mul_f32 v[150:151], v[150:151], s[86:87] op_sel_hi:[1,0]
v_pk_fma_f32 v[144:145], v[128:129], v[128:129], v[144:145] neg_lo:[1,0,0] neg_hi:[1,0,0]
v_pk_fma_f32 v[146:147], v[130:131], v[130:131], v[146:147] neg_lo:[1,0,0] neg_hi:[1,0,0]
v_pk_fma_f32 v[148:149], v[132:133], v[132:133], v[148:149] neg_lo:[1,0,0] neg_hi:[1,0,0]
v_pk_fma_f32 v[150:151], v[134:135], v[134:135], v[150:151] neg_lo:[1,0,0] neg_hi:[1,0,0]
v_max_f32 v144, 0, v144
v_max_f32 v145, 0, v145
v_max_f32 v146, 0, v146
v_max_f32 v147, 0, v147
v_max_f32 v148, 0, v148
v_max_f32 v149, 0, v149
v_max_f32 v150, 0, v150
v_max_f32 v151, 0, v151
v_pk_add_f32 v[144:145], v[144:145], s[86:87] op_sel:[0,1] op_sel_hi:[1,1]
v_pk_add_f32 v[146:147], v[146:147], s[86:87] op_sel:[0,1] op_sel_hi:[1,1]
v_pk_add_f32 v[148:149], v[148:149], s[86:87] op_sel:[0,1] op_sel_hi:[1,1]
v_pk_add_f32 v[150:151], v[150:151], s[86:87] op_sel:[0,1] op_sel_hi:[1,1]
v_rsq_f32 v144, v144
v_rsq_f32 v145, v145
v_rsq_f32 v146, v146
v_rsq_f32 v147, v147
v_rsq_f32 v148, v148
v_rsq_f32 v149, v149
v_rsq_f32 v150, v150
v_rsq_f32 v151, v151
v_pk_mul_f32 v[128:129], v[128:129], v[144:145]
v_pk_mul_f32 v[130:131], v[130:131], v[146:147]
v_pk_mul_f32 v[132:133], v[132:133], v[148:149]
v_pk_mul_f32 v[134:135], v[134:135], v[150:151]
v_readfirstlane_b32 s73, v28
s_nop 1
s_cmp_eq_u32 s73, 0
s_cbranch_scc1 L_tagslow_1
L_tagret_2:
v_pk_mul_f32 v[32:33], v[128:129], v[152:153] op_sel_hi:[1,0]
s_sub_u32 s12, s12, s75
s_subb_u32 s13, s13, 0
v_pk_mul_f32 v[34:35], v[130:131], v[152:153] op_sel_hi:[1,0]
s_add_u32 s14, s14, s75
v_pk_mul_f32 v[36:37], v[132:133], v[152:153] op_sel_hi:[1,0]
s_add_u32 m0, s74, 0
v_pk_mul_f32 v[38:39], v[134:135], v[152:153] op_sel_hi:[1,0]
s_mul_i32 s82, s72, 1792
v_pk_fma_f32 v[64:65], v[64:65], v[144:145], v[32:33] neg_lo:[0,0,1] neg_hi:[0,0,1]
buffer_load_dwordx4 v12, s[12:15], s82 offen offset:0 lds
v_pk_fma_f32 v[66:67], v[66:67], v[146:147], v[34:35] neg_lo:[0,0,1] neg_hi:[0,0,1]
v_pk_fma_f32 v[68:69], v[68:69], v[148:149], v[36:37] neg_lo:[0,0,1] neg_hi:[0,0,1]
v_pk_fma_f32 v[70:71], v[70:71], v[150:151], v[38:39] neg_lo:[0,0,1] neg_hi:[0,0,1]
v_pk_mul_f32 v[32:33], v[64:65], v[64:65]
v_pk_mul_f32 v[34:35], v[66:67], v[66:67]
v_pk_mul_f32 v[36:37], v[68:69], v[68:69]
v_pk_mul_f32 v[38:39], v[70:71], v[70:71]
v_pk_fma_f32 v[32:33], v[32:33], s[90:91], s[90:91] op_sel:[0,0,1] op_sel_hi:[1,0,1]
v_pk_fma_f32 v[34:35], v[34:35], s[90:91], s[90:91] op_sel:[0,0,1] op_sel_hi:[1,0,1]
v_pk_fma_f32 v[36:37], v[36:37], s[90:91], s[90:91] op_sel:[0,0,1] op_sel_hi:[1,0,1]
v_pk_fma_f32 v[38:39], v[38:39], s[90:91], s[90:91] op_sel:[0,0,1] op_sel_hi:[1,0,1]
v_pk_mul_f32 v[32:33], v[32:33], v[64:65]
v_pk_mul_f32 v[34:35], v[34:35], v[66:67]
v_pk_mul_f32 v[36:37], v[36:37], v[68:69]
buffer_load_dwordx4 v13, s[12:15], s82 offen offset:1024 lds
v_pk_mul_f32 v[38:39], v[38:39], v[70:71]
v_exp_f32 v32, v32
v_exp_f32 v33, v33
v_exp_f32 v34, v34
v_exp_f32 v35, v35
v_exp_f32 v36, v36
v_exp_f32 v37, v37
v_exp_f32 v38, v38
buffer_load_dwordx4 v14, s[12:15], s82 offen offset:2048 lds
v_exp_f32 v39, v39
v_pk_add_f32 v[32:33], v[32:33], 1.0 op_sel_hi:[1,0]
v_pk_add_f32 v[34:35], v[34:35], 1.0 op_sel_hi:[1,0]
v_pk_add_f32 v[36:37], v[36:37], 1.0 op_sel_hi:[1,0]
v_pk_add_f32 v[38:39], v[38:39], 1.0 op_sel_hi:[1,0]
v_rcp_f32 v32, v32
v_rcp_f32 v33, v33
v_rcp_f32 v34, v34
v_rcp_f32 v35, v35
v_rcp_f32 v36, v36
buffer_load_dwordx4 v15, s[12:15], s82 offen offset:3072 lds
v_rcp_f32 v37, v37
s_add_u32 s72, s72, 128
v_rcp_f32 v38, v38
s_and_b32 s72, s72, 0x380
v_rcp_f32 v39, v39
s_add_u32 m0, s77, 12288
v_pk_mul_f32 v[64:65], v[64:65], v[32:33]
s_add_u32 s82, s65, s76
v_pk_mul_f32 v[66:67], v[66:67], v[34:35]
s_add_u32 s83, s67, s76
v_pk_mul_f32 v[68:69], v[68:69], v[36:37]
buffer_load_dwordx4 v8, s[16:19], s82 offen offset:0 lds
v_pk_mul_f32 v[70:71], v[70:71], v[38:39]
v_pk_mul_f32 v[168:169], v[64:65], v[64:65]
v_pk_mul_f32 v[170:171], v[66:67], v[66:67]
v_pk_mul_f32 v[172:173], v[68:69], v[68:69]
v_pk_mul_f32 v[174:175], v[70:71], v[70:71]
v_pk_mul_f32 v[40:41], v[128:129], v[152:153] op_sel:[0,1] op_sel_hi:[1,1]
v_pk_mul_f32 v[42:43], v[130:131], v[152:153] op_sel:[0,1] op_sel_hi:[1,1]
v_pk_mul_f32 v[44:45], v[132:133], v[152:153] op_sel:[0,1] op_sel_hi:[1,1]
v_pk_mul_f32 v[46:47], v[134:135], v[152:153] op_sel:[0,1] op_sel_hi:[1,1]
v_pk_fma_f32 v[72:73], v[72:73], v[144:145], v[40:41] neg_lo:[0,0,1] neg_hi:[0,0,1]
v_pk_fma_f32 v[74:75], v[74:75], v[146:147], v[42:43] neg_lo:[0,0,1] neg_hi:[0,0,1]
v_pk_fma_f32 v[76:77], v[76:77], v[148:149], v[44:45] neg_lo:[0,0,1] neg_hi:[0,0,1]
v_pk_fma_f32 v[78:79], v[78:79], v[150:151], v[46:47] neg_lo:[0,0,1] neg_hi:[0,0,1]
v_pk_mul_f32 v[40:41], v[72:73], v[72:73]
buffer_load_dwordx4 v9, s[16:19], s82 offen offset:1024 lds
v_pk_mul_f32 v[42:43], v[74:75], v[74:75]
v_pk_mul_f32 v[44:45], v[76:77], v[76:77]
v_pk_mul_f32 v[46:47], v[78:79], v[78:79]
v_pk_fma_f32 v[40:41], v[40:41], s[90:91], s[90:91] op_sel:[0,0,1] op_sel_hi:[1,0,1]
v_pk_fma_f32 v[42:43], v[42:43], s[90:91], s[90:91] op_sel:[0,0,1] op_sel_hi:[1,0,1]
v_pk_fma_f32 v[44:45], v[44:45], s[90:91], s[90:91] op_sel:[0,0,1] op_sel_hi:[1,0,1]
v_pk_fma_f32 v[46:47], v[46:47], s[90:91], s[90:91] op_sel:[0,0,1] op_sel_hi:[1,0,1]
v_pk_mul_f32 v[40:41], v[40:41], v[72:73]
v_pk_mul_f32 v[42:43], v[42:43], v[74:75]
v_pk_mul_f32 v[44:45], v[44:45], v[76:77]
v_pk_mul_f32 v[46:47], v[46:47], v[78:79]
v_exp_f32 v40, v40
v_exp_f32 v41, v41
buffer_load_dwordx4 v10, s[16:19], s83 offen offset:2048 lds
v_exp_f32 v42, v42
v_exp_f32 v43, v43
v_exp_f32 v44, v44
v_exp_f32 v45, v45
v_exp_f32 v46, v46
v_exp_f32 v47, v47
v_pk_add_f32 v[40:41], v[40:41], 1.0 op_sel_hi:[1,0]
v_pk_add_f32 v[42:43], v[42:43], 1.0 op_sel_hi:[1,0]
v_pk_add_f32 v[44:45], v[44:45], 1.0 op_sel_hi:[1,0]
buffer_load_dwordx4 v11, s[16:19], s83 offen offset:3072 lds
v_pk_add_f32 v[46:47], v[46:47], 1.0 op_sel_hi:[1,0]
s_waitcnt vmcnt(12)
ds_read_b128 a[40:43], v2 offset:4096
v_rcp_f32 v40, v40
ds_read_b128 a[44:47], v2 offset:6144
v_rcp_f32 v41, v41
ds_read_b128 a[56:59], v3 offset:4096
v_rcp_f32 v42, v42
ds_read_b128 a[60:63], v3 offset:6144
v_rcp_f32 v43, v43
s_add_u32 m0, s77, 16384
v_rcp_f32 v44, v44
s_add_u32 s76, s76, 128
v_rcp_f32 v45, v45
s_and_b32 s76, s76, 0x380
v_rcp_f32 v46, v46
s_add_u32 s82, s64, s76
v_rcp_f32 v47, v47
s_add_u32 s83, s66, s76
v_pk_mul_f32 v[72:73], v[72:73], v[40:41]
buffer_load_dwordx4 v8, s[16:19], s82 offen offset:0 lds
v_pk_mul_f32 v[74:75], v[74:75], v[42:43]
v_pk_mul_f32 v[76:77], v[76:77], v[44:45]
v_pk_mul_f32 v[78:79], v[78:79], v[46:47]
v_pk_fma_f32 v[168:169], v[72:73], v[72:73], v[168:169]
v_pk_add_f32 v[160:161], v[72:73], v[64:65]
v_pk_fma_f32 v[170:171], v[74:75], v[74:75], v[170:171]
v_pk_add_f32 v[162:163], v[74:75], v[66:67]
v_pk_fma_f32 v[172:173], v[76:77], v[76:77], v[172:173]
v_pk_add_f32 v[164:165], v[76:77], v[68:69]
v_pk_fma_f32 v[174:175], v[78:79], v[78:79], v[174:175]
v_pk_add_f32 v[166:167], v[78:79], v[70:71]
v_pk_mul_f32 v[32:33], v[128:129], v[154:155] op_sel_hi:[1,0]
v_pk_mul_f32 v[34:35], v[130:131], v[154:155] op_sel_hi:[1,0]
v_pk_mul_f32 v[36:37], v[132:133], v[154:155] op_sel_hi:[1,0]
buffer_load_dwordx4 v9, s[16:19], s82 offen offset:1024 lds
v_pk_mul_f32 v[38:39], v[134:135], v[154:155] op_sel_hi:[1,0]
v_pk_fma_f32 v[80:81], v[80:81], v[144:145], v[32:33] neg_lo:[0,0,1] neg_hi:[0,0,1]
v_pk_fma_f32 v[82:83], v[82:83], v[146:147], v[34:35] neg_lo:[0,0,1] neg_hi:[0,0,1]
v_pk_fma_f32 v[84:85], v[84:85], v[148:149], v[36:37] neg_lo:[0,0,1] neg_hi:[0,0,1]
v_pk_fma_f32 v[86:87], v[86:87], v[150:151], v[38:39] neg_lo:[0,0,1] neg_hi:[0,0,1]
v_pk_mul_f32 v[32:33], v[80:81], v[80:81]
v_pk_mul_f32 v[34:35], v[82:83], v[82:83]
v_pk_mul_f32 v[36:37], v[84:85], v[84:85]
v_pk_mul_f32 v[38:39], v[86:87], v[86:87]
v_pk_fma_f32 v[32:33], v[32:33], s[90:91], s[90:91] op_sel:[0,0,1] op_sel_hi:[1,0,1]
v_pk_fma_f32 v[34:35], v[34:35], s[90:91], s[90:91] op_sel:[0,0,1] op_sel_hi:[1,0,1]
v_pk_fma_f32 v[36:37], v[36:37], s[90:91], s[90:91] op_sel:[0,0,1] op_sel_hi:[1,0,1]
v_pk_fma_f32 v[38:39], v[38:39], s[90:91], s[90:91] op_sel:[0,0,1] op_sel_hi:[1,0,1]
v_pk_mul_f32 v[32:33], v[32:33], v[80:81]
buffer_load_dwordx4 v10, s[16:19], s83 offen offset:2048 lds
v_pk_mul_f32 v[34:35], v[34:35], v[82:83]
v_pk_mul_f32 v[36:37], v[36:37], v[84:85]
v_pk_mul_f32 v[38:39], v[38:39], v[86:87]
v_exp_f32 v32, v32
v_exp_f32 v33, v33
v_exp_f32 v34, v34
v_exp_f32 v35, v35
v_exp_f32 v36, v36
v_exp_f32 v37, v37
buffer_load_dwordx4 v11, s[16:19], s83 offen offset:3072 lds
v_exp_f32 v38, v38
s_waitcnt vmcnt(12)
ds_read_b128 a[64:67], v2 offset:8192
v_exp_f32 v39, v39
ds_read_b128 a[68:71], v2 offset:10240
v_pk_add_f32 v[32:33], v[32:33], 1.0 op_sel_hi:[1,0]
ds_read_b128 a[80:83], v3 offset:8192
v_pk_add_f32 v[34:35], v[34:35], 1.0 op_sel_hi:[1,0]
ds_read_b128 a[84:87], v3 offset:10240
v_pk_add_f32 v[36:37], v[36:37], 1.0 op_sel_hi:[1,0]
s_add_u32 m0, s77, 0
v_pk_add_f32 v[38:39], v[38:39], 1.0 op_sel_hi:[1,0]
s_add_u32 s82, s65, s76
v_rcp_f32 v32, v32
s_add_u32 s83, s67, s76
v_rcp_f32 v33, v33
buffer_load_dwordx4 v8, s[16:19], s82 offen offset:0 lds
v_rcp_f32 v34, v34
v_rcp_f32 v35, v35
v_rcp_f32 v36, v36
v_rcp_f32 v37, v37
v_rcp_f32 v38, v38
v_rcp_f32 v39, v39
v_pk_mul_f32 v[80:81], v[80:81], v[32:33]
v_pk_mul_f32 v[82:83], v[82:83], v[34:35]
v_pk_mul_f32 v[84:85], v[84:85], v[36:37]
buffer_load_dwordx4 v9, s[16:19], s82 offen offset:1024 lds
v_pk_mul_f32 v[86:87], v[86:87], v[38:39]
v_pk_fma_f32 v[168:169], v[80:81], v[80:81], v[168:169]
v_pk_add_f32 v[160:161], v[80:81], v[160:161]
v_pk_fma_f32 v[170:171], v[82:83], v[82:83], v[170:171]
v_pk_add_f32 v[162:163], v[82:83], v[162:163]
v_pk_fma_f32 v[172:173], v[84:85], v[84:85], v[172:173]
v_pk_add_f32 v[164:165], v[84:85], v[164:165]
v_pk_fma_f32 v[174:175], v[86:87], v[86:87], v[174:175]
v_pk_add_f32 v[166:167], v[86:87], v[166:167]
v_pk_mul_f32 v[40:41], v[128:129], v[154:155] op_sel:[0,1] op_sel_hi:[1,1]
v_pk_mul_f32 v[42:43], v[130:131], v[154:155] op_sel:[0,1] op_sel_hi:[1,1]
v_pk_mul_f32 v[44:45], v[132:133], v[154:155] op_sel:[0,1] op_sel_hi:[1,1]
v_pk_mul_f32 v[46:47], v[134:135], v[154:155] op_sel:[0,1] op_sel_hi:[1,1]
v_pk_fma_f32 v[88:89], v[88:89], v[144:145], v[40:41] neg_lo:[0,0,1] neg_hi:[0,0,1]
buffer_load_dwordx4 v10, s[16:19], s83 offen offset:2048 lds
v_pk_fma_f32 v[90:91], v[90:91], v[146:147], v[42:43] neg_lo:[0,0,1] neg_hi:[0,0,1]
v_pk_fma_f32 v[92:93], v[92:93], v[148:149], v[44:45] neg_lo:[0,0,1] neg_hi:[0,0,1]
v_pk_fma_f32 v[94:95], v[94:95], v[150:151], v[46:47] neg_lo:[0,0,1] neg_hi:[0,0,1]
v_pk_mul_f32 v[40:41], v[88:89], v[88:89]
v_pk_mul_f32 v[42:43], v[90:91], v[90:91]
v_pk_mul_f32 v[44:45], v[92:93], v[92:93]
v_pk_mul_f32 v[46:47], v[94:95], v[94:95]
v_pk_fma_f32 v[40:41], v[40:41], s[90:91], s[90:91] op_sel:[0,0,1] op_sel_hi:[1,0,1]
v_pk_fma_f32 v[42:43], v[42:43], s[90:91], s[90:91] op_sel:[0,0,1] op_sel_hi:[1,0,1]
v_pk_fma_f32 v[44:45], v[44:45], s[90:91], s[90:91] op_sel:[0,0,1] op_sel_hi:[1,0,1]
v_pk_fma_f32 v[46:47], v[46:47], s[90:91], s[90:91] op_sel:[0,0,1] op_sel_hi:[1,0,1]
v_pk_mul_f32 v[40:41], v[40:41], v[88:89]
v_pk_mul_f32 v[42:43], v[42:43], v[90:91]
v_pk_mul_f32 v[44:45], v[44:45], v[92:93]
buffer_load_dwordx4 v11, s[16:19], s83 offen offset:3072 lds
v_pk_mul_f32 v[46:47], v[46:47], v[94:95]
s_add_u32 m0, s74, 16384
v_exp_f32 v40, v40
s_mul_i32 s82, s72, 1792
v_exp_f32 v41, v41
v_exp_f32 v42, v42
v_exp_f32 v43, v43
v_exp_f32 v44, v44
v_exp_f32 v45, v45
buffer_load_dwordx4 v12, s[12:15], s82 offen offset:0 lds
v_exp_f32 v46, v46
v_exp_f32 v47, v47
v_pk_add_f32 v[40:41], v[40:41], 1.0 op_sel_hi:[1,0]
v_pk_add_f32 v[42:43], v[42:43], 1.0 op_sel_hi:[1,0]
v_pk_add_f32 v[44:45], v[44:45], 1.0 op_sel_hi:[1,0]
v_pk_add_f32 v[46:47], v[46:47], 1.0 op_sel_hi:[1,0]
v_rcp_f32 v40, v40
v_rcp_f32 v41, v41
v_rcp_f32 v42, v42
v_rcp_f32 v43, v43
buffer_load_dwordx4 v13, s[12:15], s82 offen offset:1024 lds
v_rcp_f32 v44, v44
v_rcp_f32 v45, v45
v_rcp_f32 v46, v46
v_rcp_f32 v47, v47
v_pk_mul_f32 v[88:89], v[88:89], v[40:41]
v_pk_mul_f32 v[90:91], v[90:91], v[42:43]
v_pk_mul_f32 v[92:93], v[92:93], v[44:45]
v_pk_mul_f32 v[94:95], v[94:95], v[46:47]
v_pk_fma_f32 v[168:169], v[88:89], v[88:89], v[168:169]
v_pk_add_f32 v[160:161], v[88:89], v[160:161]
buffer_load_dwordx4 v14, s[12:15], s82 offen offset:2048 lds
v_pk_fma_f32 v[170:171], v[90:91], v[90:91], v[170:171]
v_pk_add_f32 v[162:163], v[90:91], v[162:163]
v_pk_fma_f32 v[172:173], v[92:93], v[92:93], v[172:173]
v_pk_add_f32 v[164:165], v[92:93], v[164:165]
v_pk_fma_f32 v[174:175], v[94:95], v[94:95], v[174:175]
v_pk_add_f32 v[166:167], v[94:95], v[166:167]
v_pk_mul_f32 v[32:33], v[128:129], v[156:157] op_sel_hi:[1,0]
v_pk_mul_f32 v[34:35], v[130:131], v[156:157] op_sel_hi:[1,0]
v_pk_mul_f32 v[36:37], v[132:133], v[156:157] op_sel_hi:[1,0]
v_pk_mul_f32 v[38:39], v[134:135], v[156:157] op_sel_hi:[1,0]
v_pk_fma_f32 v[96:97], v[96:97], v[144:145], v[32:33] neg_lo:[0,0,1] neg_hi:[0,0,1]
v_pk_fma_f32 v[98:99], v[98:99], v[146:147], v[34:35] neg_lo:[0,0,1] neg_hi:[0,0,1]
v_pk_fma_f32 v[100:101], v[100:101], v[148:149], v[36:37] neg_lo:[0,0,1] neg_hi:[0,0,1]
v_pk_fma_f32 v[102:103], v[102:103], v[150:151], v[38:39] neg_lo:[0,0,1] neg_hi:[0,0,1]
buffer_load_dwordx4 v15, s[12:15], s82 offen offset:3072 lds
v_pk_mul_f32 v[32:33], v[96:97], v[96:97]
s_add_u32 s72, s72, 128
v_pk_mul_f32 v[34:35], v[98:99], v[98:99]
s_and_b32 s72, s72, 0x380
v_pk_mul_f32 v[36:37], v[100:101], v[100:101]
v_pk_mul_f32 v[38:39], v[102:103], v[102:103]
v_pk_fma_f32 v[32:33], v[32:33], s[90:91], s[90:91] op_sel:[0,0,1] op_sel_hi:[1,0,1]
v_pk_fma_f32 v[34:35], v[34:35], s[90:91], s[90:91] op_sel:[0,0,1] op_sel_hi:[1,0,1]
v_pk_fma_f32 v[36:37], v[36:37], s[90:91], s[90:91] op_sel:[0,0,1] op_sel_hi:[1,0,1]
v_pk_fma_f32 v[38:39], v[38:39], s[90:91], s[90:91] op_sel:[0,0,1] op_sel_hi:[1,0,1]
v_pk_mul_f32 v[32:33], v[32:33], v[96:97]
v_pk_mul_f32 v[34:35], v[34:35], v[98:99]
v_pk_mul_f32 v[36:37], v[36:37], v[100:101]
v_pk_mul_f32 v[38:39], v[38:39], v[102:103]
v_exp_f32 v32, v32
v_exp_f32 v33, v33
v_exp_f32 v34, v34
v_exp_f32 v35, v35
v_exp_f32 v36, v36
v_exp_f32 v37, v37
v_exp_f32 v38, v38
v_exp_f32 v39, v39
v_pk_add_f32 v[32:33], v[32:33], 1.0 op_sel_hi:[1,0]
v_pk_add_f32 v[34:35], v[34:35], 1.0 op_sel_hi:[1,0]
v_pk_add_f32 v[36:37], v[36:37], 1.0 op_sel_hi:[1,0]
v_pk_add_f32 v[38:39], v[38:39], 1.0 op_sel_hi:[1,0]
v_rcp_f32 v32, v32
v_rcp_f32 v33, v33
v_rcp_f32 v34, v34
v_rcp_f32 v35, v35
v_rcp_f32 v36, v36
v_rcp_f32 v37, v37
v_rcp_f32 v38, v38
v_rcp_f32 v39, v39
v_pk_mul_f32 v[96:97], v[96:97], v[32:33]
v_pk_mul_f32 v[98:99], v[98:99], v[34:35]
v_pk_mul_f32 v[100:101], v[100:101], v[36:37]
v_pk_mul_f32 v[102:103], v[102:103], v[38:39]
v_pk_fma_f32 v[168:169], v[96:97], v[96:97], v[168:169]
v_pk_add_f32 v[160:161], v[96:97], v[160:161]
v_pk_fma_f32 v[170:171], v[98:99], v[98:99], v[170:171]
v_pk_add_f32 v[162:163], v[98:99], v[162:163]
v_pk_fma_f32 v[172:173], v[100:101], v[100:101], v[172:173]
v_pk_add_f32 v[164:165], v[100:101], v[164:165]
v_pk_fma_f32 v[174:175], v[102:103], v[102:103], v[174:175]
v_pk_add_f32 v[166:167], v[102:103], v[166:167]
v_pk_mul_f32 v[40:41], v[128:129], v[156:157] op_sel:[0,1] op_sel_hi:[1,1]
v_pk_mul_f32 v[42:43], v[130:131], v[156:157] op_sel:[0,1] op_sel_hi:[1,1]
v_pk_mul_f32 v[44:45], v[132:133], v[156:157] op_sel:[0,1] op_sel_hi:[1,1]
v_pk_mul_f32 v[46:47], v[134:135], v[156:157] op_sel:[0,1] op_sel_hi:[1,1]
v_pk_fma_f32 v[104:105], v[104:105], v[144:145], v[40:41] neg_lo:[0,0,1] neg_hi:[0,0,1]
v_pk_fma_f32 v[106:107], v[106:107], v[146:147], v[42:43] neg_lo:[0,0,1] neg_hi:[0,0,1]
v_pk_fma_f32 v[108:109], v[108:109], v[148:149], v[44:45] neg_lo:[0,0,1] neg_hi:[0,0,1]
v_pk_fma_f32 v[110:111], v[110:111], v[150:151], v[46:47] neg_lo:[0,0,1] neg_hi:[0,0,1]
v_pk_mul_f32 v[40:41], v[104:105], v[104:105]
v_pk_mul_f32 v[42:43], v[106:107], v[106:107]
v_pk_mul_f32 v[44:45], v[108:109], v[108:109]
v_pk_mul_f32 v[46:47], v[110:111], v[110:111]
v_pk_fma_f32 v[40:41], v[40:41], s[90:91], s[90:91] op_sel:[0,0,1] op_sel_hi:[1,0,1]
v_pk_fma_f32 v[42:43], v[42:43], s[90:91], s[90:91] op_sel:[0,0,1] op_sel_hi:[1,0,1]
v_pk_fma_f32 v[44:45], v[44:45], s[90:91], s[90:91] op_sel:[0,0,1] op_sel_hi:[1,0,1]
v_pk_fma_f32 v[46:47], v[46:47], s[90:91], s[90:91] op_sel:[0,0,1] op_sel_hi:[1,0,1]
v_pk_mul_f32 v[40:41], v[40:41], v[104:105]
v_pk_mul_f32 v[42:43], v[42:43], v[106:107]
v_pk_mul_f32 v[44:45], v[44:45], v[108:109]
v_pk_mul_f32 v[46:47], v[46:47], v[110:111]
v_exp_f32 v40, v40
v_exp_f32 v41, v41
v_exp_f32 v42, v42
v_exp_f32 v43, v43
v_exp_f32 v44, v44
v_exp_f32 v45, v45
v_exp_f32 v46, v46
v_exp_f32 v47, v47
v_pk_add_f32 v[40:41], v[40:41], 1.0 op_sel_hi:[1,0]
v_pk_add_f32 v[42:43], v[42:43], 1.0 op_sel_hi:[1,0]
v_pk_add_f32 v[44:45], v[44:45], 1.0 op_sel_hi:[1,0]
v_pk_add_f32 v[46:47], v[46:47], 1.0 op_sel_hi:[1,0]
v_rcp_f32 v40, v40
v_rcp_f32 v41, v41
v_rcp_f32 v42, v42
v_rcp_f32 v43, v43
v_rcp_f32 v44, v44
v_rcp_f32 v45, v45
v_rcp_f32 v46, v46
v_rcp_f32 v47, v47
v_pk_mul_f32 v[104:105], v[104:105], v[40:41]
v_pk_mul_f32 v[106:107], v[106:107], v[42:43]
v_pk_mul_f32 v[108:109], v[108:109], v[44:45]
v_pk_mul_f32 v[110:111], v[110:111], v[46:47]
v_pk_fma_f32 v[168:169], v[104:105], v[104:105], v[168:169]
v_pk_add_f32 v[160:161], v[104:105], v[160:161]
v_pk_fma_f32 v[170:171], v[106:107], v[106:107], v[170:171]
v_pk_add_f32 v[162:163], v[106:107], v[162:163]
v_pk_fma_f32 v[172:173], v[108:109], v[108:109], v[172:173]
v_pk_add_f32 v[164:165], v[108:109], v[164:165]
v_pk_fma_f32 v[174:175], v[110:111], v[110:111], v[174:175]
v_pk_add_f32 v[166:167], v[110:111], v[166:167]
v_pk_mul_f32 v[32:33], v[128:129], v[158:159] op_sel_hi:[1,0]
v_pk_mul_f32 v[34:35], v[130:131], v[158:159] op_sel_hi:[1,0]
v_pk_mul_f32 v[36:37], v[132:133], v[158:159] op_sel_hi:[1,0]
v_pk_mul_f32 v[38:39], v[134:135], v[158:159] op_sel_hi:[1,0]
v_pk_fma_f32 v[112:113], v[112:113], v[144:145], v[32:33] neg_lo:[0,0,1] neg_hi:[0,0,1]
v_pk_fma_f32 v[114:115], v[114:115], v[146:147], v[34:35] neg_lo:[0,0,1] neg_hi:[0,0,1]
v_pk_fma_f32 v[116:117], v[116:117], v[148:149], v[36:37] neg_lo:[0,0,1] neg_hi:[0,0,1]
v_pk_fma_f32 v[118:119], v[118:119], v[150:151], v[38:39] neg_lo:[0,0,1] neg_hi:[0,0,1]
v_pk_mul_f32 v[32:33], v[112:113], v[112:113]
v_pk_mul_f32 v[34:35], v[114:115], v[114:115]
v_pk_mul_f32 v[36:37], v[116:117], v[116:117]
v_pk_mul_f32 v[38:39], v[118:119], v[118:119]
v_pk_fma_f32 v[32:33], v[32:33], s[90:91], s[90:91] op_sel:[0,0,1] op_sel_hi:[1,0,1]
v_pk_fma_f32 v[34:35], v[34:35], s[90:91], s[90:91] op_sel:[0,0,1] op_sel_hi:[1,0,1]
v_pk_fma_f32 v[36:37], v[36:37], s[90:91], s[90:91] op_sel:[0,0,1] op_sel_hi:[1,0,1]
v_pk_fma_f32 v[38:39], v[38:39], s[90:91], s[90:91] op_sel:[0,0,1] op_sel_hi:[1,0,1]
v_pk_mul_f32 v[32:33], v[32:33], v[112:113]
v_pk_mul_f32 v[34:35], v[34:35], v[114:115]
v_pk_mul_f32 v[36:37], v[36:37], v[116:117]
v_pk_mul_f32 v[38:39], v[38:39], v[118:119]
v_exp_f32 v32, v32
v_exp_f32 v33, v33
v_exp_f32 v34, v34
v_exp_f32 v35, v35
v_exp_f32 v36, v36
v_exp_f32 v37, v37
v_exp_f32 v38, v38
v_exp_f32 v39, v39
v_pk_add_f32 v[32:33], v[32:33], 1.0 op_sel_hi:[1,0]
v_pk_add_f32 v[34:35], v[34:35], 1.0 op_sel_hi:[1,0]
v_pk_add_f32 v[36:37], v[36:37], 1.0 op_sel_hi:[1,0]
v_pk_add_f32 v[38:39], v[38:39], 1.0 op_sel_hi:[1,0]
v_rcp_f32 v32, v32
v_rcp_f32 v33, v33
v_rcp_f32 v34, v34
v_rcp_f32 v35, v35
v_rcp_f32 v36, v36
v_rcp_f32 v37, v37
v_rcp_f32 v38, v38
v_rcp_f32 v39, v39
v_pk_mul_f32 v[112:113], v[112:113], v[32:33]
v_pk_mul_f32 v[114:115], v[114:115], v[34:35]
v_pk_mul_f32 v[116:117], v[116:117], v[36:37]
v_pk_mul_f32 v[118:119], v[118:119], v[38:39]
v_pk_fma_f32 v[168:169], v[112:113], v[112:113], v[168:169]
v_pk_add_f32 v[160:161], v[112:113], v[160:161]
v_pk_fma_f32 v[170:171], v[114:115], v[114:115], v[170:171]
v_pk_add_f32 v[162:163], v[114:115], v[162:163]
v_pk_fma_f32 v[172:173], v[116:117], v[116:117], v[172:173]
v_pk_add_f32 v[164:165], v[116:117], v[164:165]
v_pk_fma_f32 v[174:175], v[118:119], v[118:119], v[174:175]
v_pk_add_f32 v[166:167], v[118:119], v[166:167]
v_pk_mul_f32 v[40:41], v[128:129], v[158:159] op_sel:[0,1] op_sel_hi:[1,1]
v_pk_mul_f32 v[42:43], v[130:131], v[158:159] op_sel:[0,1] op_sel_hi:[1,1]
v_pk_mul_f32 v[44:45], v[132:133], v[158:159] op_sel:[0,1] op_sel_hi:[1,1]
v_pk_mul_f32 v[46:47], v[134:135], v[158:159] op_sel:[0,1] op_sel_hi:[1,1]
v_pk_fma_f32 v[120:121], v[120:121], v[144:145], v[40:41] neg_lo:[0,0,1] neg_hi:[0,0,1]
v_pk_fma_f32 v[122:123], v[122:123], v[146:147], v[42:43] neg_lo:[0,0,1] neg_hi:[0,0,1]
v_pk_fma_f32 v[124:125], v[124:125], v[148:149], v[44:45] neg_lo:[0,0,1] neg_hi:[0,0,1]
v_pk_fma_f32 v[126:127], v[126:127], v[150:151], v[46:47] neg_lo:[0,0,1] neg_hi:[0,0,1]
v_pk_mul_f32 v[40:41], v[120:121], v[120:121]
v_pk_mul_f32 v[42:43], v[122:123], v[122:123]
v_pk_mul_f32 v[44:45], v[124:125], v[124:125]
v_pk_mul_f32 v[46:47], v[126:127], v[126:127]
v_pk_fma_f32 v[40:41], v[40:41], s[90:91], s[90:91] op_sel:[0,0,1] op_sel_hi:[1,0,1]
v_pk_fma_f32 v[42:43], v[42:43], s[90:91], s[90:91] op_sel:[0,0,1] op_sel_hi:[1,0,1]
v_pk_fma_f32 v[44:45], v[44:45], s[90:91], s[90:91] op_sel:[0,0,1] op_sel_hi:[1,0,1]
v_pk_fma_f32 v[46:47], v[46:47], s[90:91], s[90:91] op_sel:[0,0,1] op_sel_hi:[1,0,1]
v_pk_mul_f32 v[40:41], v[40:41], v[120:121]
v_pk_mul_f32 v[42:43], v[42:43], v[122:123]
v_pk_mul_f32 v[44:45], v[44:45], v[124:125]
v_pk_mul_f32 v[46:47], v[46:47], v[126:127]
v_exp_f32 v40, v40
v_exp_f32 v41, v41
v_exp_f32 v42, v42
v_exp_f32 v43, v43
v_exp_f32 v44, v44
v_exp_f32 v45, v45
v_exp_f32 v46, v46
v_exp_f32 v47, v47
v_pk_add_f32 v[40:41], v[40:41], 1.0 op_sel_hi:[1,0]
v_pk_add_f32 v[42:43], v[42:43], 1.0 op_sel_hi:[1,0]
v_pk_add_f32 v[44:45], v[44:45], 1.0 op_sel_hi:[1,0]
v_pk_add_f32 v[46:47], v[46:47], 1.0 op_sel_hi:[1,0]
v_rcp_f32 v40, v40
v_rcp_f32 v41, v41
v_rcp_f32 v42, v42
v_rcp_f32 v43, v43
v_rcp_f32 v44, v44
v_rcp_f32 v45, v45
v_rcp_f32 v46, v46
v_rcp_f32 v47, v47
v_pk_mul_f32 v[120:121], v[120:121], v[40:41]
v_pk_mul_f32 v[122:123], v[122:123], v[42:43]
v_pk_mul_f32 v[124:125], v[124:125], v[44:45]
v_pk_mul_f32 v[126:127], v[126:127], v[46:47]
v_pk_fma_f32 v[168:169], v[120:121], v[120:121], v[168:169]
v_pk_add_f32 v[160:161], v[120:121], v[160:161]
v_pk_fma_f32 v[170:171], v[122:123], v[122:123], v[170:171]
v_pk_add_f32 v[162:163], v[122:123], v[162:163]
v_pk_fma_f32 v[172:173], v[124:125], v[124:125], v[172:173]
v_pk_add_f32 v[164:165], v[124:125], v[164:165]
v_pk_fma_f32 v[174:175], v[126:127], v[126:127], v[174:175]
v_pk_add_f32 v[166:167], v[126:127], v[166:167]
v_add_f32_dpp v32, v160, v160 row_ror:8 row_mask:0xf bank_mask:0x3
v_add_f32_dpp v33, v161, v161 row_ror:8 row_mask:0xf bank_mask:0x3
v_add_f32_dpp v34, v162, v162 row_ror:8 row_mask:0xf bank_mask:0x3
v_add_f32_dpp v35, v163, v163 row_ror:8 row_mask:0xf bank_mask:0x3
v_add_f32_dpp v36, v168, v168 row_ror:8 row_mask:0xf bank_mask:0x3
v_add_f32_dpp v37, v169, v169 row_ror:8 row_mask:0xf bank_mask:0x3
v_add_f32_dpp v38, v170, v170 row_ror:8 row_mask:0xf bank_mask:0x3
v_add_f32_dpp v39, v171, v171 row_ror:8 row_mask:0xf bank_mask:0x3
v_mov_b32 v28, s73
v_add_f32_dpp v32, v164, v164 row_ror:8 row_mask:0xf bank_mask:0xc
v_add_f32_dpp v33, v165, v165 row_ror:8 row_mask:0xf bank_mask:0xc
v_add_f32_dpp v34, v166, v166 row_ror:8 row_mask:0xf bank_mask:0xc
v_add_f32_dpp v35, v167, v167 row_ror:8 row_mask:0xf bank_mask:0xc
v_add_f32_dpp v36, v172, v172 row_ror:8 row_mask:0xf bank_mask:0xc
v_add_f32_dpp v37, v173, v173 row_ror:8 row_mask:0xf bank_mask:0xc
v_add_f32_dpp v38, v174, v174 row_ror:8 row_mask:0xf bank_mask:0xc
v_add_f32_dpp v39, v175, v175 row_ror:8 row_mask:0xf bank_mask:0xc
v_add_f32_dpp v40, v32, v32 row_ror:12 row_mask:0xf bank_mask:0x5
v_add_f32_dpp v41, v33, v33 row_ror:12 row_mask:0xf bank_mask:0x5
v_add_f32_dpp v42, v36, v36 row_ror:12 row_mask:0xf bank_mask:0x5
v_add_f32_dpp v43, v37, v37 row_ror:12 row_mask:0xf bank_mask:0x5
v_bfe_u32 v29, v0, 3, 1
v_lshlrev_b32 v29, 4, v29
v_add_f32_dpp v40, v34, v34 row_ror:4 row_mask:0xf bank_mask:0xa
v_add_f32_dpp v41, v35, v35 row_ror:4 row_mask:0xf bank_mask:0xa
v_add_f32_dpp v42, v38, v38 row_ror:4 row_mask:0xf bank_mask:0xa
v_add_f32_dpp v43, v39, v39 row_ror:4 row_mask:0xf bank_mask:0xa
v_bfe_u32 v30, v0, 4, 2
v_lshl_add_u32 v29, v30, 2, v29
v_mov_b32 v45, v28
v_add_f32_dpp v40, v40, v40 quad_perm:[1,0,3,2] row_mask:0xf bank_mask:0xf
v_add_f32_dpp v41, v41, v41 quad_perm:[1,0,3,2] row_mask:0xf bank_mask:0xf
v_add_f32_dpp v42, v42, v42 quad_perm:[1,0,3,2] row_mask:0xf bank_mask:0xf
v_add_f32_dpp v43, v43, v43 quad_perm:[1,0,3,2] row_mask:0xf bank_mask:0xf
v_bfe_u32 v30, v0, 2, 1
v_lshl_add_u32 v29, v30, 1, v29
v_add_f32_dpp v40, v40, v40 quad_perm:[2,3,0,1] row_mask:0xf bank_mask:0xf
v_add_f32_dpp v41, v41, v41 quad_perm:[2,3,0,1] row_mask:0xf bank_mask:0xf
v_add_f32_dpp v42, v42, v42 quad_perm:[2,3,0,1] row_mask:0xf bank_mask:0xf
v_add_f32_dpp v43, v43, v43 quad_perm:[2,3,0,1] row_mask:0xf bank_mask:0xf
v_and_b32 v30, 1, v0
v_add_u32 v29, v29, v30
v_lshlrev_b32 v29, 4, v29
v_mov_b32 v47, v28
v_cndmask_b32 v44, v40, v41, s[92:93]
v_cndmask_b32 v46, v42, v43, s[92:93]
s_lshl_b32 s84, s45, 14
s_lshl_b32 s85, s44, 9
s_add_u32 s0, s84, s85
s_add_u32 s0, s0, 0x20000
s_lshl_b32 s85, s46, 11
s_add_u32 s84, s85, s0
s_add_u32 s85, s84, 0x40000
buffer_store_dwordx4 v[44:47], v29, s[20:23], s85 offen sc1
v_and_b32 v30, 15, v0
v_lshrrev_b32 v31, 2, v30
v_lshl_add_u32 v31, v31, 4, v30
v_lshlrev_b32 v31, 2, v31
v_cndmask_b32 v32, v144, v145, s[92:93]
v_cndmask_b32 v33, v146, v147, s[92:93]
v_cndmask_b32 v32, v32, v33, s[94:95]
ds_bpermute_b32 v184, v31, v32
v_cndmask_b32 v34, v128, v129, s[92:93]
v_cndmask_b32 v35, v130, v131, s[92:93]
v_cndmask_b32 v34, v34, v35, s[94:95]
ds_bpermute_b32 v185, v31, v34
v_cndmask_b32 v32, v148, v149, s[92:93]
v_cndmask_b32 v33, v150, v151, s[92:93]
v_cndmask_b32 v32, v32, v33, s[94:95]
ds_bpermute_b32 v186, v31, v32
v_cndmask_b32 v34, v132, v133, s[92:93]
v_cndmask_b32 v35, v134, v135, s[92:93]
v_cndmask_b32 v34, v34, v35, s[94:95]
ds_bpermute_b32 v187, v31, v34
s_lshl_b32 s84, s78, 10
v_add_u32 v4, s84, v1
s_lshl_b32 s84, s79, 10
v_add_u32 v5, s84, v1
s_lshl_b32 s84, s80, 10
v_add_u32 v6, s84, v1
s_lshl_b32 s84, s81, 10
v_add_u32 v7, s84, v1
v_bfe_u32 v29, v0, 2, 2
v_lshrrev_b32 v30, 4, v0
v_lshl_add_u32 v31, v30, 3, v29
v_lshlrev_b32 v31, 8, v31
v_and_b32 v30, 1, v30
v_lshl_or_b32 v29, v30, 2, v29
v_and_b32 v30, 3, v0
v_lshl_or_b32 v31, v30, 3, v31
s_and_b32 s97, s101, 3
s_add_u32 s84, s44, 0
s_cmp_ge_u32 s84, 3
s_cselect_b32 s85, 3, 0
s_sub_u32 s84, s84, s85
s_lshl_b32 s84, s84, 1
s_add_u32 s78, s84, s97
v_xor_b32 v30, s78, v29
v_lshl_or_b32 v16, v30, 5, v31
v_xor_b32 v17, 32, v16
s_add_u32 s84, s44, 1
s_cmp_ge_u32 s84, 3
s_cselect_b32 s85, 3, 0
s_sub_u32 s84, s84, s85
s_lshl_b32 s84, s84, 1
s_add_u32 s79, s84, s97
v_xor_b32 v30, s79, v29
v_lshl_or_b32 v18, v30, 5, v31
v_xor_b32 v19, 32, v18
s_add_u32 s84, s44, 2
s_cmp_ge_u32 s84, 3
s_cselect_b32 s85, 3, 0
s_sub_u32 s84, s84, s85
s_lshl_b32 s84, s84, 1
s_add_u32 s80, s84, s97
v_xor_b32 v30, s80, v29
v_lshl_or_b32 v20, v30, 5, v31
v_xor_b32 v21, 32, v20
v_and_b32 v29, 31, v0
v_lshlrev_b32 v29, 4, v29
v_lshrrev_b32 v30, 5, v0
v_lshl_add_u32 v188, v30, 11, v29
s_waitcnt lgkmcnt(0)
s_waitcnt vmcnt(17)
s_barrier
ds_read_b64_tr_b16 v[32:33], v16 offset:0
ds_read_b64_tr_b16 v[34:35], v16 offset:1024
ds_read_b64_tr_b16 v[36:37], v17 offset:0
ds_read_b64_tr_b16 v[38:39], v17 offset:1024
ds_read_b64_tr_b16 v[40:41], v18 offset:0
ds_read_b64_tr_b16 v[42:43], v18 offset:1024
ds_read_b64_tr_b16 v[44:45], v19 offset:0
ds_read_b64_tr_b16 v[46:47], v19 offset:1024
ds_read_b64_tr_b16 v[48:49], v20 offset:0
ds_read_b64_tr_b16 v[50:51], v20 offset:1024
ds_read_b64_tr_b16 v[52:53], v21 offset:0
ds_read_b64_tr_b16 v[54:55], v21 offset:1024
s_waitcnt lgkmcnt(8)
v_mfma_f32_16x16x32_bf16 v[128:131], v[32:35], a[128:131], 0
ds_read_b64_tr_b16 v[56:57], v16 offset:8192
v_mfma_f32_16x16x32_bf16 v[132:135], v[32:35], a[132:135], 0
ds_read_b64_tr_b16 v[58:59], v16 offset:9216
s_add_u32 m0, s74, 32768
s_mul_i32 s82, s72, 1792
v_mfma_f32_16x16x32_bf16 v[176:179], v[32:35], v[24:27], 0
buffer_load_dwordx4 v12, s[12:15], s82 offen offset:0 lds
v_mfma_f32_16x16x32_bf16 v[136:139], v[36:39], a[128:131], 0
ds_read_b64_tr_b16 v[60:61], v17 offset:8192
v_mfma_f32_16x16x32_bf16 v[140:143], v[36:39], a[132:135], 0
ds_read_b64_tr_b16 v[62:63], v17 offset:9216
v_mfma_f32_16x16x32_bf16 v[180:183], v[36:39], v[24:27], 0
buffer_load_dwordx4 v13, s[12:15], s82 offen offset:1024 lds
s_waitcnt lgkmcnt(8)
v_mfma_f32_16x16x32_bf16 v[144:147], v[40:43], a[128:131], 0
ds_read_b64_tr_b16 v[32:33], v18 offset:8192
v_mfma_f32_16x16x32_bf16 v[148:151], v[40:43], a[132:135], 0
ds_read_b64_tr_b16 v[34:35], v18 offset:9216
v_mfma_f32_16x16x32_bf16 v[152:155], v[44:47], a[128:131], 0
ds_read_b64_tr_b16 v[36:37], v19 offset:8192
buffer_load_dwordx4 v14, s[12:15], s82 offen offset:2048 lds
v_mfma_f32_16x16x32_bf16 v[156:159], v[44:47], a[132:135], 0
ds_read_b64_tr_b16 v[38:39], v19 offset:9216
s_waitcnt lgkmcnt(8)
v_mfma_f32_16x16x32_bf16 v[160:163], v[48:51], a[128:131], 0
ds_read_b64_tr_b16 v[40:41], v20 offset:8192
v_mfma_f32_16x16x32_bf16 v[164:167], v[48:51], a[132:135], 0
ds_read_b64_tr_b16 v[42:43], v20 offset:9216
buffer_load_dwordx4 v15, s[12:15], s82 offen offset:3072 lds
s_add_u32 s72, s72, 128
v_mfma_f32_16x16x32_bf16 v[168:171], v[52:55], a[128:131], 0
ds_read_b64_tr_b16 v[44:45], v21 offset:8192
s_and_b32 s72, s72, 0x380
v_mfma_f32_16x16x32_bf16 v[172:175], v[52:55], a[132:135], 0
ds_read_b64_tr_b16 v[46:47], v21 offset:9216
s_waitcnt lgkmcnt(8)
v_mfma_f32_16x16x32_bf16 v[128:131], v[56:59], a[136:139], v[128:131]
s_waitcnt vmcnt(5)
s_barrier
ds_read_b64_tr_b16 v[48:49], v16 offset:16384
v_mfma_f32_16x16x32_bf16 v[132:135], v[56:59], a[140:143], v[132:135]
ds_read_b64_tr_b16 v[50:51], v16 offset:17408
v_mfma_f32_16x16x32_bf16 v[176:179], v[56:59], v[24:27], v[176:179]
s_add_u32 s85, s0, 0x40000
buffer_load_dwordx4 v[192:195], v188, s[20:23], s85 offen sc1
s_add_u32 s85, s0, 0x41000
v_mfma_f32_16x16x32_bf16 v[136:139], v[60:63], a[136:139], v[136:139]
ds_read_b64_tr_b16 v[52:53], v17 offset:16384
v_mfma_f32_16x16x32_bf16 v[140:143], v[60:63], a[140:143], v[140:143]
ds_read_b64_tr_b16 v[54:55], v17 offset:17408
v_mfma_f32_16x16x32_bf16 v[180:183], v[60:63], v[24:27], v[180:183]
buffer_load_dwordx4 v[196:199], v188, s[20:23], s85 offen sc1
s_add_u32 s85, s0, 0x42000
s_waitcnt lgkmcnt(8)
v_mfma_f32_16x16x32_bf16 v[144:147], v[32:35], a[136:139], v[144:147]
ds_read_b64_tr_b16 v[56:57], v18 offset:16384
v_mfma_f32_16x16x32_bf16 v[148:151], v[32:35], a[140:143], v[148:151]
ds_read_b64_tr_b16 v[58:59], v18 offset:17408
v_mfma_f32_16x16x32_bf16 v[152:155], v[36:39], a[136:139], v[152:155]
ds_read_b64_tr_b16 v[60:61], v19 offset:16384
buffer_load_dwordx4 v[200:203], v188, s[20:23], s85 offen sc1
s_add_u32 s85, s0, 0x43000
v_mfma_f32_16x16x32_bf16 v[156:159], v[36:39], a[140:143], v[156:159]
ds_read_b64_tr_b16 v[62:63], v19 offset:17408
s_waitcnt lgkmcnt(8)
v_mfma_f32_16x16x32_bf16 v[160:163], v[40:43], a[136:139], v[160:163]
ds_read_b64_tr_b16 v[32:33], v20 offset:16384
v_mfma_f32_16x16x32_bf16 v[164:167], v[40:43], a[140:143], v[164:167]
ds_read_b64_tr_b16 v[34:35], v20 offset:17408
buffer_load_dwordx4 v[204:207], v188, s[20:23], s85 offen sc1
s_add_u32 m0, s74, 49152
v_mfma_f32_16x16x32_bf16 v[168:171], v[44:47], a[136:139], v[168:171]
ds_read_b64_tr_b16 v[36:37], v21 offset:16384
s_mul_i32 s82, s72, 1792
v_mfma_f32_16x16x32_bf16 v[172:175], v[44:47], a[140:143], v[172:175]
ds_read_b64_tr_b16 v[38:39], v21 offset:17408
s_waitcnt lgkmcnt(8)
v_mfma_f32_16x16x32_bf16 v[128:131], v[48:51], a[144:147], v[128:131]
ds_read_b64_tr_b16 v[40:41], v16 offset:24576
buffer_load_dwordx4 v12, s[12:15], s82 offen offset:0 lds
v_mfma_f32_16x16x32_bf16 v[132:135], v[48:51], a[148:151], v[132:135]
ds_read_b64_tr_b16 v[42:43], v16 offset:25600
v_mfma_f32_16x16x32_bf16 v[176:179], v[48:51], v[24:27], v[176:179]
v_mfma_f32_16x16x32_bf16 v[136:139], v[52:55], a[144:147], v[136:139]
ds_read_b64_tr_b16 v[44:45], v17 offset:24576
buffer_load_dwordx4 v13, s[12:15], s82 offen offset:1024 lds
v_mfma_f32_16x16x32_bf16 v[140:143], v[52:55], a[148:151], v[140:143]
ds_read_b64_tr_b16 v[46:47], v17 offset:25600
v_mfma_f32_16x16x32_bf16 v[180:183], v[52:55], v[24:27], v[180:183]
s_waitcnt lgkmcnt(8)
v_mfma_f32_16x16x32_bf16 v[144:147], v[56:59], a[144:147], v[144:147]
ds_read_b64_tr_b16 v[48:49], v18 offset:24576
buffer_load_dwordx4 v14, s[12:15], s82 offen offset:2048 lds
v_mfma_f32_16x16x32_bf16 v[148:151], v[56:59], a[148:151], v[148:151]
ds_read_b64_tr_b16 v[50:51], v18 offset:25600
v_mfma_f32_16x16x32_bf16 v[152:155], v[60:63], a[144:147], v[152:155]
ds_read_b64_tr_b16 v[52:53], v19 offset:24576
v_mfma_f32_16x16x32_bf16 v[156:159], v[60:63], a[148:151], v[156:159]
ds_read_b64_tr_b16 v[54:55], v19 offset:25600
buffer_load_dwordx4 v15, s[12:15], s82 offen offset:3072 lds
s_waitcnt lgkmcnt(8)
v_mfma_f32_16x16x32_bf16 v[160:163], v[32:35], a[144:147], v[160:163]
ds_read_b64_tr_b16 v[56:57], v20 offset:24576
s_add_u32 s72, s72, 128
s_and_b32 s72, s72, 0x380
v_mfma_f32_16x16x32_bf16 v[164:167], v[32:35], a[148:151], v[164:167]
ds_read_b64_tr_b16 v[58:59], v20 offset:25600
v_mfma_f32_16x16x32_bf16 v[168:171], v[36:39], a[144:147], v[168:171]
ds_read_b64_tr_b16 v[60:61], v21 offset:24576
v_mfma_f32_16x16x32_bf16 v[172:175], v[36:39], a[148:151], v[172:175]
ds_read_b64_tr_b16 v[62:63], v21 offset:25600
s_waitcnt lgkmcnt(8)
v_mfma_f32_16x16x32_bf16 v[128:131], v[40:43], a[152:155], v[128:131]
s_waitcnt vmcnt(8)
s_barrier
ds_read_b64_tr_b16 v[32:33], v16 offset:32768
v_mfma_f32_16x16x32_bf16 v[132:135], v[40:43], a[156:159], v[132:135]
ds_read_b64_tr_b16 v[34:35], v16 offset:33792
v_mfma_f32_16x16x32_bf16 v[176:179], v[40:43], v[24:27], v[176:179]
v_mfma_f32_16x16x32_bf16 v[136:139], v[44:47], a[152:155], v[136:139]
ds_read_b64_tr_b16 v[36:37], v17 offset:32768
v_mfma_f32_16x16x32_bf16 v[140:143], v[44:47], a[156:159], v[140:143]
ds_read_b64_tr_b16 v[38:39], v17 offset:33792
v_mfma_f32_16x16x32_bf16 v[180:183], v[44:47], v[24:27], v[180:183]
s_waitcnt lgkmcnt(8)
v_mfma_f32_16x16x32_bf16 v[144:147], v[48:51], a[152:155], v[144:147]
ds_read_b64_tr_b16 v[40:41], v18 offset:32768
v_mfma_f32_16x16x32_bf16 v[148:151], v[48:51], a[156:159], v[148:151]
ds_read_b64_tr_b16 v[42:43], v18 offset:33792
v_mfma_f32_16x16x32_bf16 v[152:155], v[52:55], a[152:155], v[152:155]
ds_read_b64_tr_b16 v[44:45], v19 offset:32768
v_mfma_f32_16x16x32_bf16 v[156:159], v[52:55], a[156:159], v[156:159]
ds_read_b64_tr_b16 v[46:47], v19 offset:33792
s_waitcnt lgkmcnt(8)
v_mfma_f32_16x16x32_bf16 v[160:163], v[56:59], a[152:155], v[160:163]
ds_read_b64_tr_b16 v[48:49], v20 offset:32768
v_mfma_f32_16x16x32_bf16 v[164:167], v[56:59], a[156:159], v[164:167]
ds_read_b64_tr_b16 v[50:51], v20 offset:33792
v_mfma_f32_16x16x32_bf16 v[168:171], v[60:63], a[152:155], v[168:171]
ds_read_b64_tr_b16 v[52:53], v21 offset:32768
v_mfma_f32_16x16x32_bf16 v[172:175], v[60:63], a[156:159], v[172:175]
ds_read_b64_tr_b16 v[54:55], v21 offset:33792
s_waitcnt vmcnt(7)
v_xor_b32 v208, v193, v28
v_xor_b32 v195, v195, v28
s_waitcnt vmcnt(6)
v_xor_b32 v197, v197, v28
v_xor_b32 v199, v199, v28
s_waitcnt vmcnt(5)
v_xor_b32 v201, v201, v28
v_xor_b32 v203, v203, v28
s_waitcnt vmcnt(4)
v_xor_b32 v205, v205, v28
v_xor_b32 v207, v207, v28
v_or3_b32 v208, v208, v195, v197
v_or3_b32 v208, v208, v199, v201
v_or3_b32 v208, v208, v203, v205
v_or_b32 v208, v208, v207
v_cmp_ne_u32 vcc, 0, v208
s_nop 1
s_cbranch_vccnz L_pslow_3
L_pret_4:
v_add_f32 v192, v192, v196
v_add_f32 v200, v200, v204
v_add_f32 v194, v194, v198
v_add_f32 v202, v202, v206
v_add_f32 v192, v192, v200
v_add_f32 v194, v194, v202
v_mov_b32 v193, v192
v_mov_b32 v195, v194
s_lshl_b32 s85, s44, 8
s_add_u32 s85, s85, 66560
v_permlane32_swap_b32 v192, v193
v_permlane32_swap_b32 v194, v195
v_add_f32 v192, v192, v193
v_add_f32 v194, v194, v195
v_mul_f32 v192, s88, v192
v_mul_f32 v194, s88, v194
v_and_b32 v29, 31, v0
v_fma_f32 v194, -v192, v192, v194
v_lshl_add_u32 v29, v29, 2, s85
v_max_f32 v194, 0, v194
v_lshrrev_b32 v30, 4, v0
v_add_f32 v194, s89, v194
v_lshl_add_u32 v30, v30, 4, s85
v_rsq_f32 v194, v194
s_lshl_b32 s84, s45, 2
ds_write_b32 v29, v194
v_mul_f32 v192, -v192, v194
ds_write_b32 v29, v192 offset:128
ds_read_b128 v[208:211], v30 offset:0
ds_read_b128 v[216:219], v30 offset:128
ds_read_b128 v[212:215], v30 offset:64
ds_read_b128 v[220:223], v30 offset:192
s_add_u32 s84, s84, s44
s_mul_i32 s84, s84, 56
s_and_b32 s85, s100, 0xfc
s_add_u32 s84, s84, s85
s_lshl_b32 s84, s84, 10
s_add_u32 s84, s84, 0x100000
s_waitcnt lgkmcnt(2)
v_pk_fma_f32 v[64:65], v[64:65], v[208:209], v[216:217]
v_pk_fma_f32 v[66:67], v[66:67], v[210:211], v[218:219]
s_waitcnt lgkmcnt(0)
v_pk_fma_f32 v[68:69], v[68:69], v[212:213], v[220:221]
v_pk_fma_f32 v[70:71], v[70:71], v[214:215], v[222:223]
v_pk_fma_f32 v[72:73], v[72:73], v[208:209], v[216:217]
v_pk_fma_f32 v[74:75], v[74:75], v[210:211], v[218:219]
v_pk_fma_f32 v[76:77], v[76:77], v[212:213], v[220:221]
v_pk_fma_f32 v[78:79], v[78:79], v[214:215], v[222:223]
v_cvt_pk_bf16_f32 v224, v64, v65
v_cvt_pk_bf16_f32 v225, v66, v67
v_cvt_pk_bf16_f32 v226, v68, v69
v_cvt_pk_bf16_f32 v227, v70, v71
v_cvt_pk_bf16_f32 v228, v72, v73
v_cvt_pk_bf16_f32 v229, v74, v75
v_cvt_pk_bf16_f32 v230, v76, v77
v_cvt_pk_bf16_f32 v231, v78, v79
v_permlane32_swap_b32 v224, v226
v_permlane32_swap_b32 v225, v227
v_permlane32_swap_b32 v228, v230
v_permlane32_swap_b32 v229, v231
v_permlane16_swap_b32 v224, v226
v_permlane16_swap_b32 v225, v227
v_permlane16_swap_b32 v228, v230
v_permlane16_swap_b32 v229, v231
buffer_store_dwordx4 v[224:227], v4, s[20:23], s84 offen offset:0 sc1
buffer_store_dwordx4 v[228:231], v4, s[20:23], s84 offen offset:1024 sc1
v_pk_fma_f32 v[80:81], v[80:81], v[208:209], v[216:217]
v_pk_fma_f32 v[82:83], v[82:83], v[210:211], v[218:219]
v_pk_fma_f32 v[84:85], v[84:85], v[212:213], v[220:221]
v_pk_fma_f32 v[86:87], v[86:87], v[214:215], v[222:223]
v_pk_fma_f32 v[88:89], v[88:89], v[208:209], v[216:217]
v_pk_fma_f32 v[90:91], v[90:91], v[210:211], v[218:219]
v_pk_fma_f32 v[92:93], v[92:93], v[212:213], v[220:221]
v_pk_fma_f32 v[94:95], v[94:95], v[214:215], v[222:223]
v_cvt_pk_bf16_f32 v232, v80, v81
v_cvt_pk_bf16_f32 v233, v82, v83
v_cvt_pk_bf16_f32 v234, v84, v85
v_cvt_pk_bf16_f32 v235, v86, v87
v_cvt_pk_bf16_f32 v236, v88, v89
v_cvt_pk_bf16_f32 v237, v90, v91
v_cvt_pk_bf16_f32 v238, v92, v93
v_cvt_pk_bf16_f32 v239, v94, v95
v_permlane32_swap_b32 v232, v234
v_permlane32_swap_b32 v233, v235
v_permlane32_swap_b32 v236, v238
v_permlane32_swap_b32 v237, v239
v_permlane16_swap_b32 v232, v234
v_permlane16_swap_b32 v233, v235
v_permlane16_swap_b32 v236, v238
v_permlane16_swap_b32 v237, v239
buffer_store_dwordx4 v[232:235], v5, s[20:23], s84 offen offset:0 sc1
buffer_store_dwordx4 v[236:239], v5, s[20:23], s84 offen offset:1024 sc1
v_pk_fma_f32 v[96:97], v[96:97], v[208:209], v[216:217]
v_pk_fma_f32 v[98:99], v[98:99], v[210:211], v[218:219]
v_pk_fma_f32 v[100:101], v[100:101], v[212:213], v[220:221]
v_pk_fma_f32 v[102:103], v[102:103], v[214:215], v[222:223]
v_pk_fma_f32 v[104:105], v[104:105], v[208:209], v[216:217]
v_pk_fma_f32 v[106:107], v[106:107], v[210:211], v[218:219]
v_pk_fma_f32 v[108:109], v[108:109], v[212:213], v[220:221]
v_pk_fma_f32 v[110:111], v[110:111], v[214:215], v[222:223]
v_cvt_pk_bf16_f32 v224, v96, v97
v_cvt_pk_bf16_f32 v225, v98, v99
v_cvt_pk_bf16_f32 v226, v100, v101
v_cvt_pk_bf16_f32 v227, v102, v103
v_cvt_pk_bf16_f32 v228, v104, v105
v_cvt_pk_bf16_f32 v229, v106, v107
v_cvt_pk_bf16_f32 v230, v108, v109
v_cvt_pk_bf16_f32 v231, v110, v111
v_permlane32_swap_b32 v224, v226
v_permlane32_swap_b32 v225, v227
v_permlane32_swap_b32 v228, v230
v_permlane32_swap_b32 v229, v231
v_permlane16_swap_b32 v224, v226
v_permlane16_swap_b32 v225, v227
v_permlane16_swap_b32 v228, v230
v_permlane16_swap_b32 v229, v231
buffer_store_dwordx4 v[224:227], v6, s[20:23], s84 offen offset:0 sc1
buffer_store_dwordx4 v[228:231], v6, s[20:23], s84 offen offset:1024 sc1
v_pk_fma_f32 v[112:113], v[112:113], v[208:209], v[216:217]
v_pk_fma_f32 v[114:115], v[114:115], v[210:211], v[218:219]
v_pk_fma_f32 v[116:117], v[116:117], v[212:213], v[220:221]
v_pk_fma_f32 v[118:119], v[118:119], v[214:215], v[222:223]
v_pk_fma_f32 v[120:121], v[120:121], v[208:209], v[216:217]
v_pk_fma_f32 v[122:123], v[122:123], v[210:211], v[218:219]
v_pk_fma_f32 v[124:125], v[124:125], v[212:213], v[220:221]
v_pk_fma_f32 v[126:127], v[126:127], v[214:215], v[222:223]
v_cvt_pk_bf16_f32 v232, v112, v113
v_cvt_pk_bf16_f32 v233, v114, v115
v_cvt_pk_bf16_f32 v234, v116, v117
v_cvt_pk_bf16_f32 v235, v118, v119
v_cvt_pk_bf16_f32 v236, v120, v121
v_cvt_pk_bf16_f32 v237, v122, v123
v_cvt_pk_bf16_f32 v238, v124, v125
v_cvt_pk_bf16_f32 v239, v126, v127
v_permlane32_swap_b32 v232, v234
v_permlane32_swap_b32 v233, v235
v_permlane32_swap_b32 v236, v238
v_permlane32_swap_b32 v237, v239
v_permlane16_swap_b32 v232, v234
v_permlane16_swap_b32 v233, v235
v_permlane16_swap_b32 v236, v238
v_permlane16_swap_b32 v237, v239
buffer_store_dwordx4 v[232:235], v7, s[20:23], s84 offen offset:0 sc1
buffer_store_dwordx4 v[236:239], v7, s[20:23], s84 offen offset:1024 sc1
v_mfma_f32_16x16x32_bf16 v[128:131], v[32:35], a[160:163], v[128:131]
ds_read_b64_tr_b16 v[56:57], v16 offset:40960
s_add_u32 m0, s74, 0
s_mul_i32 s82, s72, 1792
v_mfma_f32_16x16x32_bf16 v[132:135], v[32:35], a[164:167], v[132:135]
ds_read_b64_tr_b16 v[58:59], v16 offset:41984
buffer_load_dwordx4 v12, s[12:15], s82 offen offset:0 lds
v_mfma_f32_16x16x32_bf16 v[176:179], v[32:35], v[24:27], v[176:179]
v_mfma_f32_16x16x32_bf16 v[136:139], v[36:39], a[160:163], v[136:139]
ds_read_b64_tr_b16 v[60:61], v17 offset:40960
v_mfma_f32_16x16x32_bf16 v[140:143], v[36:39], a[164:167], v[140:143]
ds_read_b64_tr_b16 v[62:63], v17 offset:41984
buffer_load_dwordx4 v13, s[12:15], s82 offen offset:1024 lds
v_mfma_f32_16x16x32_bf16 v[180:183], v[36:39], v[24:27], v[180:183]
v_mfma_f32_16x16x32_bf16 v[144:147], v[40:43], a[160:163], v[144:147]
ds_read_b64_tr_b16 v[32:33], v18 offset:40960
v_mfma_f32_16x16x32_bf16 v[148:151], v[40:43], a[164:167], v[148:151]
ds_read_b64_tr_b16 v[34:35], v18 offset:41984
buffer_load_dwordx4 v14, s[12:15], s82 offen offset:2048 lds
v_mfma_f32_16x16x32_bf16 v[152:155], v[44:47], a[160:163], v[152:155]
ds_read_b64_tr_b16 v[36:37], v19 offset:40960
v_mfma_f32_16x16x32_bf16 v[156:159], v[44:47], a[164:167], v[156:159]
ds_read_b64_tr_b16 v[38:39], v19 offset:41984
v_mfma_f32_16x16x32_bf16 v[160:163], v[48:51], a[160:163], v[160:163]
ds_read_b64_tr_b16 v[40:41], v20 offset:40960
buffer_load_dwordx4 v15, s[12:15], s82 offen offset:3072 lds
s_add_u32 s72, s72, 128
v_mfma_f32_16x16x32_bf16 v[164:167], v[48:51], a[164:167], v[164:167]
ds_read_b64_tr_b16 v[42:43], v20 offset:41984
s_and_b32 s72, s72, 0x380
v_mfma_f32_16x16x32_bf16 v[168:171], v[52:55], a[160:163], v[168:171]
ds_read_b64_tr_b16 v[44:45], v21 offset:40960
ds_read_b128 a[72:75], v2 offset:12288
ds_read_b128 a[76:79], v2 offset:14336
v_mfma_f32_16x16x32_bf16 v[172:175], v[52:55], a[164:167], v[172:175]
ds_read_b64_tr_b16 v[46:47], v21 offset:41984
ds_read_b128 a[88:91], v3 offset:12288
s_waitcnt lgkmcnt(11)
v_mfma_f32_16x16x32_bf16 v[128:131], v[56:59], a[168:171], v[128:131]
s_waitcnt vmcnt(12)
s_barrier
ds_read_b64_tr_b16 v[48:49], v16 offset:49152
v_mfma_f32_16x16x32_bf16 v[132:135], v[56:59], a[172:175], v[132:135]
ds_read_b64_tr_b16 v[50:51], v16 offset:50176
ds_read_b128 a[92:95], v3 offset:14336
v_mfma_f32_16x16x32_bf16 v[176:179], v[56:59], v[24:27], v[176:179]
s_add_u32 m0, s77, 4096
s_add_u32 s76, s76, 128
s_and_b32 s76, s76, 0x380
v_mfma_f32_16x16x32_bf16 v[136:139], v[60:63], a[168:171], v[136:139]
ds_read_b64_tr_b16 v[52:53], v17 offset:49152
s_add_u32 s82, s64, s76
s_add_u32 s83, s66, s76
v_mfma_f32_16x16x32_bf16 v[140:143], v[60:63], a[172:175], v[140:143]
ds_read_b64_tr_b16 v[54:55], v17 offset:50176
buffer_load_dwordx4 v8, s[16:19], s82 offen offset:0 lds
buffer_load_dwordx4 v9, s[16:19], s82 offen offset:1024 lds
buffer_load_dwordx4 v10, s[16:19], s83 offen offset:2048 lds
buffer_load_dwordx4 v11, s[16:19], s83 offen offset:3072 lds
v_mfma_f32_16x16x32_bf16 v[180:183], v[60:63], v[24:27], v[180:183]
s_add_u32 m0, s74, 16384
s_mul_i32 s82, s72, 1792
s_waitcnt lgkmcnt(12)
v_mfma_f32_16x16x32_bf16 v[144:147], v[32:35], a[168:171], v[144:147]
ds_read_b64_tr_b16 v[56:57], v18 offset:49152
buffer_load_dwordx4 v12, s[12:15], s82 offen offset:0 lds
v_mfma_f32_16x16x32_bf16 v[148:151], v[32:35], a[172:175], v[148:151]
ds_read_b64_tr_b16 v[58:59], v18 offset:50176
v_mfma_f32_16x16x32_bf16 v[152:155], v[36:39], a[168:171], v[152:155]
ds_read_b64_tr_b16 v[60:61], v19 offset:49152
v_mfma_f32_16x16x32_bf16 v[156:159], v[36:39], a[172:175], v[156:159]
ds_read_b64_tr_b16 v[62:63], v19 offset:50176
buffer_load_dwordx4 v13, s[12:15], s82 offen offset:1024 lds
s_waitcnt lgkmcnt(10)
v_mfma_f32_16x16x32_bf16 v[160:163], v[40:43], a[168:171], v[160:163]
ds_read_b64_tr_b16 v[32:33], v20 offset:49152
v_mfma_f32_16x16x32_bf16 v[164:167], v[40:43], a[172:175], v[164:167]
ds_read_b64_tr_b16 v[34:35], v20 offset:50176
v_mfma_f32_16x16x32_bf16 v[168:171], v[44:47], a[168:171], v[168:171]
ds_read_b64_tr_b16 v[36:37], v21 offset:49152
buffer_load_dwordx4 v14, s[12:15], s82 offen offset:2048 lds
v_mfma_f32_16x16x32_bf16 v[172:175], v[44:47], a[172:175], v[172:175]
ds_read_b64_tr_b16 v[38:39], v21 offset:50176
s_waitcnt lgkmcnt(8)
v_mfma_f32_16x16x32_bf16 v[128:131], v[48:51], a[176:179], v[128:131]
ds_read_b64_tr_b16 v[40:41], v16 offset:57344
v_mfma_f32_16x16x32_bf16 v[132:135], v[48:51], a[180:183], v[132:135]
ds_read_b64_tr_b16 v[42:43], v16 offset:58368
buffer_load_dwordx4 v15, s[12:15], s82 offen offset:3072 lds
s_add_u32 s72, s72, 128
v_mfma_f32_16x16x32_bf16 v[176:179], v[48:51], v[24:27], v[176:179]
s_and_b32 s72, s72, 0x380
ds_read_b128 a[96:99], v2 offset:16384
v_mfma_f32_16x16x32_bf16 v[136:139], v[52:55], a[176:179], v[136:139]
ds_read_b64_tr_b16 v[44:45], v17 offset:57344
ds_read_b128 a[100:103], v2 offset:18432
ds_read_b128 a[112:115], v3 offset:16384
v_mfma_f32_16x16x32_bf16 v[140:143], v[52:55], a[180:183], v[140:143]
ds_read_b64_tr_b16 v[46:47], v17 offset:58368
ds_read_b128 a[116:119], v3 offset:18432
v_mfma_f32_16x16x32_bf16 v[180:183], v[52:55], v[24:27], v[180:183]
s_add_u32 m0, s77, 8192
s_add_u32 s82, s65, s76
s_waitcnt lgkmcnt(12)
v_mfma_f32_16x16x32_bf16 v[144:147], v[56:59], a[176:179], v[144:147]
ds_read_b64_tr_b16 v[48:49], v18 offset:57344
s_add_u32 s83, s67, s76
buffer_load_dwordx4 v8, s[16:19], s82 offen offset:0 lds
v_mfma_f32_16x16x32_bf16 v[148:151], v[56:59], a[180:183], v[148:151]
ds_read_b64_tr_b16 v[50:51], v18 offset:58368
v_mfma_f32_16x16x32_bf16 v[152:155], v[60:63], a[176:179], v[152:155]
ds_read_b64_tr_b16 v[52:53], v19 offset:57344
v_mfma_f32_16x16x32_bf16 v[156:159], v[60:63], a[180:183], v[156:159]
ds_read_b64_tr_b16 v[54:55], v19 offset:58368
buffer_load_dwordx4 v9, s[16:19], s82 offen offset:1024 lds
s_waitcnt lgkmcnt(12)
v_mfma_f32_16x16x32_bf16 v[160:163], v[32:35], a[176:179], v[160:163]
ds_read_b64_tr_b16 v[56:57], v20 offset:57344
v_mfma_f32_16x16x32_bf16 v[164:167], v[32:35], a[180:183], v[164:167]
ds_read_b64_tr_b16 v[58:59], v20 offset:58368
v_mfma_f32_16x16x32_bf16 v[168:171], v[36:39], a[176:179], v[168:171]
ds_read_b64_tr_b16 v[60:61], v21 offset:57344
buffer_load_dwordx4 v10, s[16:19], s83 offen offset:2048 lds
v_mfma_f32_16x16x32_bf16 v[172:175], v[36:39], a[180:183], v[172:175]
ds_read_b64_tr_b16 v[62:63], v21 offset:58368
s_waitcnt lgkmcnt(9)
v_mfma_f32_16x16x32_bf16 v[128:131], v[40:43], a[184:187], v[128:131]
s_waitcnt vmcnt(11)
s_barrier
ds_read_b64_tr_b16 v[32:33], v16 offset:0
v_mfma_f32_16x16x32_bf16 v[132:135], v[40:43], a[188:191], v[132:135]
ds_read_b64_tr_b16 v[34:35], v16 offset:1024
buffer_load_dwordx4 v11, s[16:19], s83 offen offset:3072 lds
v_mfma_f32_16x16x32_bf16 v[176:179], v[40:43], v[24:27], v[176:179]
s_lshl_b32 s84, s45, 3
s_add_u32 s84, s84, s46
s_lshl_b32 s84, s84, 5
v_mfma_f32_16x16x32_bf16 v[136:139], v[44:47], a[184:187], v[136:139]
ds_read_b64_tr_b16 v[36:37], v17 offset:0
s_add_u32 s84, s84, s44
s_lshl_b32 s84, s84, 2
v_mfma_f32_16x16x32_bf16 v[140:143], v[44:47], a[188:191], v[140:143]
ds_read_b64_tr_b16 v[38:39], v17 offset:1024
s_add_u32 s84, s84, 0x4000
v_mfma_f32_16x16x32_bf16 v[180:183], v[44:47], v[24:27], v[180:183]
buffer_store_dword v28, off, s[20:23], s84 sc1
s_add_u32 m0, s74, 32768
s_waitcnt lgkmcnt(8)
v_mfma_f32_16x16x32_bf16 v[144:147], v[48:51], a[184:187], v[144:147]
ds_read_b64_tr_b16 v[40:41], v18 offset:0
s_mul_i32 s82, s72, 1792
v_mfma_f32_16x16x32_bf16 v[148:151], v[48:51], a[188:191], v[148:151]
ds_read_b64_tr_b16 v[42:43], v18 offset:1024
v_mfma_f32_16x16x32_bf16 v[152:155], v[52:55], a[184:187], v[152:155]
ds_read_b64_tr_b16 v[44:45], v19 offset:0
buffer_load_dwordx4 v12, s[12:15], s82 offen offset:0 lds
v_mfma_f32_16x16x32_bf16 v[156:159], v[52:55], a[188:191], v[156:159]
ds_read_b64_tr_b16 v[46:47], v19 offset:1024
s_waitcnt lgkmcnt(8)
v_mfma_f32_16x16x32_bf16 v[160:163], v[56:59], a[184:187], v[160:163]
ds_read_b64_tr_b16 v[48:49], v20 offset:0
v_mfma_f32_16x16x32_bf16 v[164:167], v[56:59], a[188:191], v[164:167]
ds_read_b64_tr_b16 v[50:51], v20 offset:1024
buffer_load_dwordx4 v13, s[12:15], s82 offen offset:1024 lds
v_mfma_f32_16x16x32_bf16 v[168:171], v[60:63], a[184:187], v[168:171]
ds_read_b64_tr_b16 v[52:53], v21 offset:0
v_mfma_f32_16x16x32_bf16 v[172:175], v[60:63], a[188:191], v[172:175]
ds_read_b64_tr_b16 v[54:55], v21 offset:1024
s_waitcnt lgkmcnt(8)
v_mfma_f32_16x16x32_bf16 v[128:131], v[32:35], a[192:195], v[128:131]
ds_read_b64_tr_b16 v[56:57], v16 offset:8192
buffer_load_dwordx4 v14, s[12:15], s82 offen offset:2048 lds
v_mfma_f32_16x16x32_bf16 v[132:135], v[32:35], a[196:199], v[132:135]
ds_read_b64_tr_b16 v[58:59], v16 offset:9216
v_mfma_f32_16x16x32_bf16 v[176:179], v[32:35], v[24:27], v[176:179]
v_mfma_f32_16x16x32_bf16 v[136:139], v[36:39], a[192:195], v[136:139]
ds_read_b64_tr_b16 v[60:61], v17 offset:8192
buffer_load_dwordx4 v15, s[12:15], s82 offen offset:3072 lds
s_add_u32 s72, s72, 128
v_mfma_f32_16x16x32_bf16 v[140:143], v[36:39], a[196:199], v[140:143]
ds_read_b64_tr_b16 v[62:63], v17 offset:9216
s_and_b32 s72, s72, 0x380
v_mfma_f32_16x16x32_bf16 v[180:183], v[36:39], v[24:27], v[180:183]
ds_read_b128 a[104:107], v2 offset:0
ds_read_b128 a[108:111], v2 offset:2048
s_waitcnt lgkmcnt(10)
v_mfma_f32_16x16x32_bf16 v[144:147], v[40:43], a[192:195], v[144:147]
ds_read_b64_tr_b16 v[32:33], v18 offset:8192
ds_read_b128 a[120:123], v3 offset:0
ds_read_b128 a[124:127], v3 offset:2048
v_mfma_f32_16x16x32_bf16 v[148:151], v[40:43], a[196:199], v[148:151]
ds_read_b64_tr_b16 v[34:35], v18 offset:9216
s_add_u32 m0, s77, 12288
v_mfma_f32_16x16x32_bf16 v[152:155], v[44:47], a[192:195], v[152:155]
ds_read_b64_tr_b16 v[36:37], v19 offset:8192
s_add_u32 s76, s76, 128
s_and_b32 s76, s76, 0x380
v_mfma_f32_16x16x32_bf16 v[156:159], v[44:47], a[196:199], v[156:159]
ds_read_b64_tr_b16 v[38:39], v19 offset:9216
s_add_u32 s82, s64, s76
s_waitcnt lgkmcnt(12)
v_mfma_f32_16x16x32_bf16 v[160:163], v[48:51], a[192:195], v[160:163]
ds_read_b64_tr_b16 v[40:41], v20 offset:8192
s_add_u32 s83, s66, s76
buffer_load_dwordx4 v8, s[16:19], s82 offen offset:0 lds
v_mfma_f32_16x16x32_bf16 v[164:167], v[48:51], a[196:199], v[164:167]
ds_read_b64_tr_b16 v[42:43], v20 offset:9216
v_mfma_f32_16x16x32_bf16 v[168:171], v[52:55], a[192:195], v[168:171]
ds_read_b64_tr_b16 v[44:45], v21 offset:8192
v_mfma_f32_16x16x32_bf16 v[172:175], v[52:55], a[196:199], v[172:175]
ds_read_b64_tr_b16 v[46:47], v21 offset:9216
buffer_load_dwordx4 v9, s[16:19], s82 offen offset:1024 lds
s_waitcnt lgkmcnt(12)
v_mfma_f32_16x16x32_bf16 v[128:131], v[56:59], a[200:203], v[128:131]
s_waitcnt vmcnt(11)
s_barrier
ds_read_b64_tr_b16 v[48:49], v16 offset:16384
v_mfma_f32_16x16x32_bf16 v[132:135], v[56:59], a[204:207], v[132:135]
ds_read_b64_tr_b16 v[50:51], v16 offset:17408
v_mfma_f32_16x16x32_bf16 v[176:179], v[56:59], v[24:27], v[176:179]
buffer_load_dwordx4 v10, s[16:19], s83 offen offset:2048 lds
v_mfma_f32_16x16x32_bf16 v[136:139], v[60:63], a[200:203], v[136:139]
ds_read_b64_tr_b16 v[52:53], v17 offset:16384
v_mfma_f32_16x16x32_bf16 v[140:143], v[60:63], a[204:207], v[140:143]
ds_read_b64_tr_b16 v[54:55], v17 offset:17408
buffer_load_dwordx4 v11, s[16:19], s83 offen offset:3072 lds
s_add_u32 m0, s74, 49152
v_mfma_f32_16x16x32_bf16 v[180:183], v[60:63], v[24:27], v[180:183]
s_mul_i32 s82, s72, 1792
buffer_load_dwordx4 v12, s[12:15], s82 offen offset:0 lds
s_waitcnt lgkmcnt(8)
v_mfma_f32_16x16x32_bf16 v[144:147], v[32:35], a[200:203], v[144:147]
ds_read_b64_tr_b16 v[56:57], v18 offset:16384
v_mfma_f32_16x16x32_bf16 v[148:151], v[32:35], a[204:207], v[148:151]
ds_read_b64_tr_b16 v[58:59], v18 offset:17408
v_mfma_f32_16x16x32_bf16 v[152:155], v[36:39], a[200:203], v[152:155]
ds_read_b64_tr_b16 v[60:61], v19 offset:16384
buffer_load_dwordx4 v13, s[12:15], s82 offen offset:1024 lds
v_mfma_f32_16x16x32_bf16 v[156:159], v[36:39], a[204:207], v[156:159]
ds_read_b64_tr_b16 v[62:63], v19 offset:17408
s_waitcnt lgkmcnt(8)
v_mfma_f32_16x16x32_bf16 v[160:163], v[40:43], a[200:203], v[160:163]
ds_read_b64_tr_b16 v[32:33], v20 offset:16384
v_mfma_f32_16x16x32_bf16 v[164:167], v[40:43], a[204:207], v[164:167]
ds_read_b64_tr_b16 v[34:35], v20 offset:17408
buffer_load_dwordx4 v14, s[12:15], s82 offen offset:2048 lds
v_mfma_f32_16x16x32_bf16 v[168:171], v[44:47], a[200:203], v[168:171]
ds_read_b64_tr_b16 v[36:37], v21 offset:16384
v_mfma_f32_16x16x32_bf16 v[172:175], v[44:47], a[204:207], v[172:175]
ds_read_b64_tr_b16 v[38:39], v21 offset:17408
s_waitcnt lgkmcnt(8)
v_mfma_f32_16x16x32_bf16 v[128:131], v[48:51], a[208:211], v[128:131]
ds_read_b64_tr_b16 v[40:41], v16 offset:24576
buffer_load_dwordx4 v15, s[12:15], s82 offen offset:3072 lds
s_add_u32 s72, s72, 128
v_mfma_f32_16x16x32_bf16 v[132:135], v[48:51], a[212:215], v[132:135]
ds_read_b64_tr_b16 v[42:43], v16 offset:25600
s_and_b32 s72, s72, 0x380
v_mfma_f32_16x16x32_bf16 v[176:179], v[48:51], v[24:27], v[176:179]
ds_read_b128 v[192:195], v2 offset:4096
ds_read_b128 v[196:199], v2 offset:6144
ds_read_b128 v[208:211], v3 offset:4096
v_mfma_f32_16x16x32_bf16 v[136:139], v[52:55], a[208:211], v[136:139]
ds_read_b64_tr_b16 v[44:45], v17 offset:24576
ds_read_b128 v[212:215], v3 offset:6144
v_mfma_f32_16x16x32_bf16 v[140:143], v[52:55], a[212:215], v[140:143]
ds_read_b64_tr_b16 v[46:47], v17 offset:25600
s_add_u32 m0, s77, 16384
s_add_u32 s82, s65, s76
v_mfma_f32_16x16x32_bf16 v[180:183], v[52:55], v[24:27], v[180:183]
s_add_u32 s83, s67, s76
buffer_load_dwordx4 v8, s[16:19], s82 offen offset:0 lds
s_waitcnt lgkmcnt(12)
v_mfma_f32_16x16x32_bf16 v[144:147], v[56:59], a[208:211], v[144:147]
ds_read_b64_tr_b16 v[48:49], v18 offset:24576
v_mfma_f32_16x16x32_bf16 v[148:151], v[56:59], a[212:215], v[148:151]
ds_read_b64_tr_b16 v[50:51], v18 offset:25600
v_mfma_f32_16x16x32_bf16 v[152:155], v[60:63], a[208:211], v[152:155]
ds_read_b64_tr_b16 v[52:53], v19 offset:24576
buffer_load_dwordx4 v9, s[16:19], s82 offen offset:1024 lds
v_mfma_f32_16x16x32_bf16 v[156:159], v[60:63], a[212:215], v[156:159]
ds_read_b64_tr_b16 v[54:55], v19 offset:25600
s_waitcnt lgkmcnt(12)
v_mfma_f32_16x16x32_bf16 v[160:163], v[32:35], a[208:211], v[160:163]
ds_read_b64_tr_b16 v[56:57], v20 offset:24576
v_mfma_f32_16x16x32_bf16 v[164:167], v[32:35], a[212:215], v[164:167]
ds_read_b64_tr_b16 v[58:59], v20 offset:25600
buffer_load_dwordx4 v10, s[16:19], s83 offen offset:2048 lds
v_mfma_f32_16x16x32_bf16 v[168:171], v[36:39], a[208:211], v[168:171]
ds_read_b64_tr_b16 v[60:61], v21 offset:24576
v_mfma_f32_16x16x32_bf16 v[172:175], v[36:39], a[212:215], v[172:175]
ds_read_b64_tr_b16 v[62:63], v21 offset:25600
s_waitcnt lgkmcnt(8)
v_mfma_f32_16x16x32_bf16 v[128:131], v[40:43], a[216:219], v[128:131]
s_waitcnt vmcnt(11)
s_barrier
ds_read_b64_tr_b16 v[32:33], v16 offset:32768
v_mfma_f32_16x16x32_bf16 v[132:135], v[40:43], a[220:223], v[132:135]
ds_read_b64_tr_b16 v[34:35], v16 offset:33792
buffer_load_dwordx4 v11, s[16:19], s83 offen offset:3072 lds
v_mfma_f32_16x16x32_bf16 v[176:179], v[40:43], v[24:27], v[176:179]
ds_read_b128 v[200:203], v2 offset:8192
ds_read_b128 v[204:207], v2 offset:10240
v_mfma_f32_16x16x32_bf16 v[136:139], v[44:47], a[216:219], v[136:139]
ds_read_b64_tr_b16 v[36:37], v17 offset:32768
ds_read_b128 v[216:219], v3 offset:8192
ds_read_b128 v[220:223], v3 offset:10240
v_mfma_f32_16x16x32_bf16 v[140:143], v[44:47], a[220:223], v[140:143]
ds_read_b64_tr_b16 v[38:39], v17 offset:33792
s_add_u32 m0, s77, 0
v_mfma_f32_16x16x32_bf16 v[180:183], v[44:47], v[24:27], v[180:183]
s_add_u32 s76, s76, 128
s_and_b32 s76, s76, 0x380
s_waitcnt lgkmcnt(12)
v_mfma_f32_16x16x32_bf16 v[144:147], v[48:51], a[216:219], v[144:147]
ds_read_b64_tr_b16 v[40:41], v18 offset:32768
s_add_u32 s82, s64, s76
s_add_u32 s83, s66, s76
v_mfma_f32_16x16x32_bf16 v[148:151], v[48:51], a[220:223], v[148:151]
ds_read_b64_tr_b16 v[42:43], v18 offset:33792
buffer_load_dwordx4 v8, s[16:19], s82 offen offset:0 lds
v_mfma_f32_16x16x32_bf16 v[152:155], v[52:55], a[216:219], v[152:155]
ds_read_b64_tr_b16 v[44:45], v19 offset:32768
v_mfma_f32_16x16x32_bf16 v[156:159], v[52:55], a[220:223], v[156:159]
ds_read_b64_tr_b16 v[46:47], v19 offset:33792
s_waitcnt lgkmcnt(12)
v_mfma_f32_16x16x32_bf16 v[160:163], v[56:59], a[216:219], v[160:163]
ds_read_b64_tr_b16 v[48:49], v20 offset:32768
buffer_load_dwordx4 v9, s[16:19], s82 offen offset:1024 lds
v_mfma_f32_16x16x32_bf16 v[164:167], v[56:59], a[220:223], v[164:167]
ds_read_b64_tr_b16 v[50:51], v20 offset:33792
v_mfma_f32_16x16x32_bf16 v[168:171], v[60:63], a[216:219], v[168:171]
ds_read_b64_tr_b16 v[52:53], v21 offset:32768
v_mfma_f32_16x16x32_bf16 v[172:175], v[60:63], a[220:223], v[172:175]
ds_read_b64_tr_b16 v[54:55], v21 offset:33792
buffer_load_dwordx4 v10, s[16:19], s83 offen offset:2048 lds
s_waitcnt lgkmcnt(8)
v_mfma_f32_16x16x32_bf16 v[128:131], v[32:35], a[224:227], v[128:131]
ds_read_b64_tr_b16 v[56:57], v16 offset:40960
v_mfma_f32_16x16x32_bf16 v[132:135], v[32:35], a[228:231], v[132:135]
ds_read_b64_tr_b16 v[58:59], v16 offset:41984
v_mfma_f32_16x16x32_bf16 v[176:179], v[32:35], v[24:27], v[176:179]
buffer_load_dwordx4 v11, s[16:19], s83 offen offset:3072 lds
v_mfma_f32_16x16x32_bf16 v[136:139], v[36:39], a[224:227], v[136:139]
ds_read_b64_tr_b16 v[60:61], v17 offset:40960
v_mfma_f32_16x16x32_bf16 v[140:143], v[36:39], a[228:231], v[140:143]
ds_read_b64_tr_b16 v[62:63], v17 offset:41984
v_mfma_f32_16x16x32_bf16 v[180:183], v[36:39], v[24:27], v[180:183]
s_waitcnt lgkmcnt(8)
v_mfma_f32_16x16x32_bf16 v[144:147], v[40:43], a[224:227], v[144:147]
ds_read_b64_tr_b16 v[32:33], v18 offset:40960
v_mfma_f32_16x16x32_bf16 v[148:151], v[40:43], a[228:231], v[148:151]
ds_read_b64_tr_b16 v[34:35], v18 offset:41984
v_mfma_f32_16x16x32_bf16 v[152:155], v[44:47], a[224:227], v[152:155]
ds_read_b64_tr_b16 v[36:37], v19 offset:40960
v_mfma_f32_16x16x32_bf16 v[156:159], v[44:47], a[228:231], v[156:159]
ds_read_b64_tr_b16 v[38:39], v19 offset:41984
s_waitcnt lgkmcnt(8)
v_mfma_f32_16x16x32_bf16 v[160:163], v[48:51], a[224:227], v[160:163]
ds_read_b64_tr_b16 v[40:41], v20 offset:40960
v_mfma_f32_16x16x32_bf16 v[164:167], v[48:51], a[228:231], v[164:167]
ds_read_b64_tr_b16 v[42:43], v20 offset:41984
v_mfma_f32_16x16x32_bf16 v[168:171], v[52:55], a[224:227], v[168:171]
ds_read_b64_tr_b16 v[44:45], v21 offset:40960
v_mfma_f32_16x16x32_bf16 v[172:175], v[52:55], a[228:231], v[172:175]
ds_read_b64_tr_b16 v[46:47], v21 offset:41984
s_waitcnt lgkmcnt(8)
v_mfma_f32_16x16x32_bf16 v[128:131], v[56:59], a[232:235], v[128:131]
s_waitcnt vmcnt(8)
s_barrier
ds_read_b64_tr_b16 v[48:49], v16 offset:49152
v_mfma_f32_16x16x32_bf16 v[132:135], v[56:59], a[236:239], v[132:135]
ds_read_b64_tr_b16 v[50:51], v16 offset:50176
v_lshrrev_b32 v29, 4, v0
v_lshlrev_b32 v29, 4, v29
v_mfma_f32_16x16x32_bf16 v[176:179], v[56:59], v[24:27], v[176:179]
ds_read_b128 v[224:227], v2 offset:12288
ds_read_b128 v[228:231], v2 offset:14336
v_mfma_f32_16x16x32_bf16 v[136:139], v[60:63], a[232:235], v[136:139]
ds_read_b64_tr_b16 v[52:53], v17 offset:49152
ds_read_b128 v[240:243], v3 offset:12288
ds_read_b128 v[244:247], v3 offset:14336
v_mfma_f32_16x16x32_bf16 v[140:143], v[60:63], a[236:239], v[140:143]
ds_read_b64_tr_b16 v[54:55], v17 offset:50176
s_add_u32 m0, s77, 4096
v_mfma_f32_16x16x32_bf16 v[180:183], v[60:63], v[24:27], v[180:183]
s_add_u32 s82, s65, s76
s_add_u32 s83, s67, s76
s_waitcnt lgkmcnt(12)
v_mfma_f32_16x16x32_bf16 v[144:147], v[32:35], a[232:235], v[144:147]
ds_read_b64_tr_b16 v[56:57], v16 offset:57344
buffer_load_dwordx4 v8, s[16:19], s82 offen offset:0 lds
v_add_u32 v29, 66048, v29
v_mfma_f32_16x16x32_bf16 v[148:151], v[32:35], a[236:239], v[148:151]
ds_read_b64_tr_b16 v[58:59], v16 offset:58368
s_lshl_b32 s84, s78, 6
v_add_u32 v30, s84, v29
v_mfma_f32_16x16x32_bf16 v[152:155], v[36:39], a[232:235], v[152:155]
ds_read_b64_tr_b16 v[60:61], v17 offset:57344
v_mfma_f32_16x16x32_bf16 v[156:159], v[36:39], a[236:239], v[156:159]
ds_read_b64_tr_b16 v[62:63], v17 offset:58368
buffer_load_dwordx4 v9, s[16:19], s82 offen offset:1024 lds
s_waitcnt lgkmcnt(12)
v_mfma_f32_16x16x32_bf16 v[160:163], v[40:43], a[232:235], v[160:163]
ds_read_b64_tr_b16 v[32:33], v18 offset:49152
v_mfma_f32_16x16x32_bf16 v[164:167], v[40:43], a[236:239], v[164:167]
ds_read_b64_tr_b16 v[34:35], v18 offset:50176
v_mfma_f32_16x16x32_bf16 v[168:171], v[44:47], a[232:235], v[168:171]
ds_read_b64_tr_b16 v[36:37], v19 offset:49152
buffer_load_dwordx4 v10, s[16:19], s83 offen offset:2048 lds
v_mfma_f32_16x16x32_bf16 v[172:175], v[44:47], a[236:239], v[172:175]
ds_read_b64_tr_b16 v[38:39], v19 offset:50176
s_waitcnt lgkmcnt(8)
v_mfma_f32_16x16x32_bf16 v[128:131], v[48:51], a[240:243], v[128:131]
ds_read_b64_tr_b16 v[40:41], v20 offset:49152
v_mfma_f32_16x16x32_bf16 v[132:135], v[48:51], a[244:247], v[132:135]
ds_read_b64_tr_b16 v[42:43], v20 offset:50176
buffer_load_dwordx4 v11, s[16:19], s83 offen offset:3072 lds
s_lshl_b32 s84, s71, 2
v_mfma_f32_16x16x32_bf16 v[176:179], v[48:51], v[24:27], v[176:179]
s_lshr_b32 s85, 0x76443200, s84
s_and_b32 s85, s85, 15
v_mov_b32 v5, s85
v_mfma_f32_16x16x32_bf16 v[136:139], v[52:55], a[240:243], v[136:139]
ds_read_b64_tr_b16 v[44:45], v21 offset:49152
s_lshr_b32 s85, 0x77543310, s84
s_and_b32 s85, s85, 15
v_mfma_f32_16x16x32_bf16 v[140:143], v[52:55], a[244:247], v[140:143]
ds_read_b64_tr_b16 v[46:47], v21 offset:50176
v_mov_b32 v6, s85
v_cndmask_b32 v5, v5, v6, s[92:93]
v_mfma_f32_16x16x32_bf16 v[180:183], v[52:55], v[24:27], v[180:183]
v_lshlrev_b32 v5, 7, v5
v_bfe_u32 v6, v0, 1, 2
s_waitcnt lgkmcnt(8)
v_mfma_f32_16x16x32_bf16 v[128:131], v[56:59], a[248:251], v[128:131]
ds_read_b64_tr_b16 v[48:49], v18 offset:57344
v_lshl_add_u32 v6, v6, 10, v5
s_lshl_b32 s100, s44, 12
v_mfma_f32_16x16x32_bf16 v[132:135], v[56:59], a[252:255], v[132:135]
ds_read_b64_tr_b16 v[50:51], v18 offset:58368
s_add_u32 s100, s100, 0x4000
v_and_b32 v4, 1, v0
v_mfma_f32_16x16x32_bf16 v[176:179], v[56:59], v[24:27], v[176:179]
v_lshlrev_b32 v4, 7, v4
s_lshr_b32 s97, s70, 1
s_lshl_b32 s97, s97, 2
v_mfma_f32_16x16x32_bf16 v[136:139], v[60:63], a[248:251], v[136:139]
ds_read_b64_tr_b16 v[52:53], v19 offset:57344
s_add_u32 s97, s97, s44
s_lshl_b32 s97, s97, 8
v_mfma_f32_16x16x32_bf16 v[140:143], v[60:63], a[252:255], v[140:143]
ds_read_b64_tr_b16 v[54:55], v19 offset:58368
s_add_u32 s97, s97, 0xc000
buffer_load_dwordx4 v[12:15], v6, s[20:23], s100 offen sc1
v_mfma_f32_16x16x32_bf16 v[180:183], v[60:63], v[24:27], v[180:183]
s_waitcnt lgkmcnt(8)
v_mfma_f32_16x16x32_bf16 v[144:147], v[32:35], a[240:243], v[144:147]
ds_read_b64_tr_b16 v[56:57], v20 offset:57344
v_mfma_f32_16x16x32_bf16 v[148:151], v[32:35], a[244:247], v[148:151]
ds_read_b64_tr_b16 v[58:59], v20 offset:58368
v_mfma_f32_16x16x32_bf16 v[152:155], v[36:39], a[240:243], v[152:155]
ds_read_b64_tr_b16 v[60:61], v21 offset:57344
v_mfma_f32_16x16x32_bf16 v[156:159], v[36:39], a[244:247], v[156:159]
ds_read_b64_tr_b16 v[62:63], v21 offset:58368
ds_write_b128 v30, v[176:179]
s_waitcnt lgkmcnt(9)
v_mfma_f32_16x16x32_bf16 v[160:163], v[40:43], a[240:243], v[160:163]
ds_write_b128 v30, v[180:183] offset:64
v_mfma_f32_16x16x32_bf16 v[164:167], v[40:43], a[244:247], v[164:167]
v_mfma_f32_16x16x32_bf16 v[168:171], v[44:47], a[240:243], v[168:171]
v_mfma_f32_16x16x32_bf16 v[172:175], v[44:47], a[244:247], v[172:175]
s_waitcnt lgkmcnt(0)
s_barrier
v_mfma_f32_16x16x32_bf16 v[144:147], v[48:51], a[248:251], v[144:147]
s_lshl_b32 s84, s78, 6
v_add_u32 v30, s84, v29
ds_read_b128 v[64:67], v30
v_mfma_f32_16x16x32_bf16 v[148:151], v[48:51], a[252:255], v[148:151]
ds_read_b128 v[68:71], v30 offset:64
s_lshl_b32 s84, s79, 6
v_add_u32 v30, s84, v29
v_mfma_f32_16x16x32_bf16 v[152:155], v[52:55], a[248:251], v[152:155]
ds_read_b128 v[72:75], v30
ds_read_b128 v[76:79], v30 offset:64
s_lshl_b32 s84, s80, 6
v_mfma_f32_16x16x32_bf16 v[156:159], v[52:55], a[252:255], v[156:159]
v_add_u32 v30, s84, v29
ds_read_b128 v[80:83], v30
v_mfma_f32_16x16x32_bf16 v[160:163], v[56:59], a[248:251], v[160:163]
ds_read_b128 v[84:87], v30 offset:64
v_mfma_f32_16x16x32_bf16 v[164:167], v[56:59], a[252:255], v[164:167]
v_mfma_f32_16x16x32_bf16 v[168:171], v[60:63], a[248:251], v[168:171]
v_mfma_f32_16x16x32_bf16 v[172:175], v[60:63], a[252:255], v[172:175]
s_lshl_b32 s85, s45, 3
s_lshl_b32 s84, s44, 1
s_add_u32 s85, s85, s84
s_mul_i32 s85, s85, 28672
s_and_b32 s84, s101, 0xfc
s_lshl_b32 s84, s84, 9
s_add_u32 s85, s85, s84
s_add_u32 s85, s85, 0x500000
v_add_u32 v29, 28672, v1
s_waitcnt vmcnt(9)
ds_read_b128 v[232:235], v2 offset:16384
s_lshl_b32 s84, s78, 9
ds_read_b128 v[236:239], v2 offset:18432
s_add_u32 s78, s84, s85
ds_read_b128 v[248:251], v3 offset:16384
s_waitcnt lgkmcnt(8)
v_pk_mul_f32 v[32:33], v[64:65], v[184:185] op_sel:[0,1] op_sel_hi:[1,1]
ds_read_b128 v[252:255], v3 offset:18432
v_pk_mul_f32 v[34:35], v[66:67], v[184:185] op_sel:[0,1] op_sel_hi:[1,1]
s_add_u32 m0, s77, 8192
s_waitcnt lgkmcnt(8)
v_pk_mul_f32 v[36:37], v[68:69], v[184:185] op_sel:[0,1] op_sel_hi:[1,1]
s_add_u32 s76, s76, 128
v_pk_mul_f32 v[38:39], v[70:71], v[184:185] op_sel:[0,1] op_sel_hi:[1,1]
s_and_b32 s76, s76, 0x380
v_pk_fma_f32 v[128:129], v[128:129], v[184:185], v[32:33] op_sel_hi:[1,0,1] neg_lo:[0,0,1] neg_hi:[0,0,1]
s_add_u32 s82, s64, s76
v_pk_fma_f32 v[130:131], v[130:131], v[184:185], v[34:35] op_sel_hi:[1,0,1] neg_lo:[0,0,1] neg_hi:[0,0,1]
s_add_u32 s83, s66, s76
v_pk_fma_f32 v[136:137], v[136:137], v[184:185], v[36:37] op_sel_hi:[1,0,1] neg_lo:[0,0,1] neg_hi:[0,0,1]
buffer_load_dwordx4 v8, s[16:19], s82 offen offset:0 lds
v_pk_fma_f32 v[138:139], v[138:139], v[184:185], v[38:39] op_sel_hi:[1,0,1] neg_lo:[0,0,1] neg_hi:[0,0,1]
v_cvt_pk_bf16_f32 v40, v128, v129
v_cvt_pk_bf16_f32 v41, v130, v131
v_cvt_pk_bf16_f32 v42, v136, v137
v_cvt_pk_bf16_f32 v43, v138, v139
buffer_store_dwordx4 v[40:43], v1, s[20:23], s78 offen sc1
v_pk_mul_f32 v[32:33], v[64:65], v[186:187] op_sel:[0,1] op_sel_hi:[1,1]
v_pk_mul_f32 v[34:35], v[66:67], v[186:187] op_sel:[0,1] op_sel_hi:[1,1]
v_pk_mul_f32 v[36:37], v[68:69], v[186:187] op_sel:[0,1] op_sel_hi:[1,1]
v_pk_mul_f32 v[38:39], v[70:71], v[186:187] op_sel:[0,1] op_sel_hi:[1,1]
v_pk_fma_f32 v[132:133], v[132:133], v[186:187], v[32:33] op_sel_hi:[1,0,1] neg_lo:[0,0,1] neg_hi:[0,0,1]
v_pk_fma_f32 v[134:135], v[134:135], v[186:187], v[34:35] op_sel_hi:[1,0,1] neg_lo:[0,0,1] neg_hi:[0,0,1]
buffer_load_dwordx4 v9, s[16:19], s82 offen offset:1024 lds
v_pk_fma_f32 v[140:141], v[140:141], v[186:187], v[36:37] op_sel_hi:[1,0,1] neg_lo:[0,0,1] neg_hi:[0,0,1]
v_pk_fma_f32 v[142:143], v[142:143], v[186:187], v[38:39] op_sel_hi:[1,0,1] neg_lo:[0,0,1] neg_hi:[0,0,1]
v_cvt_pk_bf16_f32 v44, v132, v133
v_cvt_pk_bf16_f32 v45, v134, v135
v_cvt_pk_bf16_f32 v46, v140, v141
v_cvt_pk_bf16_f32 v47, v142, v143
buffer_store_dwordx4 v[44:47], v29, s[20:23], s78 offen sc1
s_lshl_b32 s84, s79, 9
s_add_u32 s79, s84, s85
s_waitcnt lgkmcnt(7)
v_pk_mul_f32 v[32:33], v[72:73], v[184:185] op_sel:[0,1] op_sel_hi:[1,1]
v_pk_mul_f32 v[34:35], v[74:75], v[184:185] op_sel:[0,1] op_sel_hi:[1,1]
s_waitcnt lgkmcnt(6)
v_pk_mul_f32 v[36:37], v[76:77], v[184:185] op_sel:[0,1] op_sel_hi:[1,1]
buffer_load_dwordx4 v10, s[16:19], s83 offen offset:2048 lds
v_pk_mul_f32 v[38:39], v[78:79], v[184:185] op_sel:[0,1] op_sel_hi:[1,1]
v_pk_fma_f32 v[144:145], v[144:145], v[184:185], v[32:33] op_sel_hi:[1,0,1] neg_lo:[0,0,1] neg_hi:[0,0,1]
v_pk_fma_f32 v[146:147], v[146:147], v[184:185], v[34:35] op_sel_hi:[1,0,1] neg_lo:[0,0,1] neg_hi:[0,0,1]
v_pk_fma_f32 v[152:153], v[152:153], v[184:185], v[36:37] op_sel_hi:[1,0,1] neg_lo:[0,0,1] neg_hi:[0,0,1]
v_pk_fma_f32 v[154:155], v[154:155], v[184:185], v[38:39] op_sel_hi:[1,0,1] neg_lo:[0,0,1] neg_hi:[0,0,1]
v_cvt_pk_bf16_f32 v48, v144, v145
v_cvt_pk_bf16_f32 v49, v146, v147
v_cvt_pk_bf16_f32 v50, v152, v153
v_cvt_pk_bf16_f32 v51, v154, v155
buffer_store_dwordx4 v[48:51], v1, s[20:23], s79 offen sc1
v_pk_mul_f32 v[32:33], v[72:73], v[186:187] op_sel:[0,1] op_sel_hi:[1,1]
v_pk_mul_f32 v[34:35], v[74:75], v[186:187] op_sel:[0,1] op_sel_hi:[1,1]
buffer_load_dwordx4 v11, s[16:19], s83 offen offset:3072 lds
v_pk_mul_f32 v[36:37], v[76:77], v[186:187] op_sel:[0,1] op_sel_hi:[1,1]
s_add_u32 m0, s77, 12288
v_pk_mul_f32 v[38:39], v[78:79], v[186:187] op_sel:[0,1] op_sel_hi:[1,1]
s_add_u32 s82, s65, s76
v_pk_fma_f32 v[148:149], v[148:149], v[186:187], v[32:33] op_sel_hi:[1,0,1] neg_lo:[0,0,1] neg_hi:[0,0,1]
s_add_u32 s83, s67, s76
v_pk_fma_f32 v[150:151], v[150:151], v[186:187], v[34:35] op_sel_hi:[1,0,1] neg_lo:[0,0,1] neg_hi:[0,0,1]
v_pk_fma_f32 v[156:157], v[156:157], v[186:187], v[36:37] op_sel_hi:[1,0,1] neg_lo:[0,0,1] neg_hi:[0,0,1]
v_pk_fma_f32 v[158:159], v[158:159], v[186:187], v[38:39] op_sel_hi:[1,0,1] neg_lo:[0,0,1] neg_hi:[0,0,1]
v_cvt_pk_bf16_f32 v52, v148, v149
v_cvt_pk_bf16_f32 v53, v150, v151
buffer_load_dwordx4 v8, s[16:19], s82 offen offset:0 lds
v_cvt_pk_bf16_f32 v54, v156, v157
v_cvt_pk_bf16_f32 v55, v158, v159
buffer_store_dwordx4 v[52:55], v29, s[20:23], s79 offen sc1
s_lshl_b32 s84, s80, 9
s_add_u32 s80, s84, s85
s_waitcnt lgkmcnt(5)
v_pk_mul_f32 v[32:33], v[80:81], v[184:185] op_sel:[0,1] op_sel_hi:[1,1]
v_pk_mul_f32 v[34:35], v[82:83], v[184:185] op_sel:[0,1] op_sel_hi:[1,1]
s_waitcnt lgkmcnt(4)
v_pk_mul_f32 v[36:37], v[84:85], v[184:185] op_sel:[0,1] op_sel_hi:[1,1]
v_pk_mul_f32 v[38:39], v[86:87], v[184:185] op_sel:[0,1] op_sel_hi:[1,1]
v_pk_fma_f32 v[160:161], v[160:161], v[184:185], v[32:33] op_sel_hi:[1,0,1] neg_lo:[0,0,1] neg_hi:[0,0,1]
v_pk_fma_f32 v[162:163], v[162:163], v[184:185], v[34:35] op_sel_hi:[1,0,1] neg_lo:[0,0,1] neg_hi:[0,0,1]
v_pk_fma_f32 v[168:169], v[168:169], v[184:185], v[36:37] op_sel_hi:[1,0,1] neg_lo:[0,0,1] neg_hi:[0,0,1]
buffer_load_dwordx4 v9, s[16:19], s82 offen offset:1024 lds
v_pk_fma_f32 v[170:171], v[170:171], v[184:185], v[38:39] op_sel_hi:[1,0,1] neg_lo:[0,0,1] neg_hi:[0,0,1]
v_cvt_pk_bf16_f32 v56, v160, v161
v_cvt_pk_bf16_f32 v57, v162, v163
v_cvt_pk_bf16_f32 v58, v168, v169
v_cvt_pk_bf16_f32 v59, v170, v171
buffer_store_dwordx4 v[56:59], v1, s[20:23], s80 offen sc1
v_pk_mul_f32 v[32:33], v[80:81], v[186:187] op_sel:[0,1] op_sel_hi:[1,1]
v_pk_mul_f32 v[34:35], v[82:83], v[186:187] op_sel:[0,1] op_sel_hi:[1,1]
v_pk_mul_f32 v[36:37], v[84:85], v[186:187] op_sel:[0,1] op_sel_hi:[1,1]
v_pk_mul_f32 v[38:39], v[86:87], v[186:187] op_sel:[0,1] op_sel_hi:[1,1]
v_pk_fma_f32 v[164:165], v[164:165], v[186:187], v[32:33] op_sel_hi:[1,0,1] neg_lo:[0,0,1] neg_hi:[0,0,1]
v_pk_fma_f32 v[166:167], v[166:167], v[186:187], v[34:35] op_sel_hi:[1,0,1] neg_lo:[0,0,1] neg_hi:[0,0,1]
buffer_load_dwordx4 v10, s[16:19], s83 offen offset:2048 lds
v_pk_fma_f32 v[172:173], v[172:173], v[186:187], v[36:37] op_sel_hi:[1,0,1] neg_lo:[0,0,1] neg_hi:[0,0,1]
v_pk_fma_f32 v[174:175], v[174:175], v[186:187], v[38:39] op_sel_hi:[1,0,1] neg_lo:[0,0,1] neg_hi:[0,0,1]
v_cvt_pk_bf16_f32 v60, v164, v165
v_cvt_pk_bf16_f32 v61, v166, v167
v_cvt_pk_bf16_f32 v62, v172, v173
v_cvt_pk_bf16_f32 v63, v174, v175
buffer_store_dwordx4 v[60:63], v29, s[20:23], s80 offen sc1
s_xor_b32 s85, s46, 1
s_lshl_b32 s84, s45, 3
s_add_u32 s84, s84, s85
s_lshl_b32 s84, s84, 5
s_add_u32 s84, s84, s44
buffer_load_dwordx4 v11, s[16:19], s83 offen offset:3072 lds
s_lshl_b32 s84, s84, 2
s_waitcnt vmcnt(19)
ds_read_b128 a[128:131], v2 offset:0
s_add_u32 s0, s84, 0x8000
ds_read_b128 a[132:135], v2 offset:2048
ds_read_b128 a[144:147], v3 offset:0
ds_read_b128 a[148:151], v3 offset:2048
s_waitcnt vmcnt(15)
ds_read_b128 a[136:139], v2 offset:4096
ds_read_b128 a[140:143], v2 offset:6144
ds_read_b128 a[152:155], v3 offset:4096
ds_read_b128 a[156:159], v3 offset:6144
s_waitcnt vmcnt(7)
ds_read_b128 a[160:163], v2 offset:8192
ds_read_b128 a[164:167], v2 offset:10240
ds_read_b128 a[176:179], v3 offset:8192
ds_read_b128 a[180:183], v3 offset:10240
s_waitcnt vmcnt(0)
ds_read_b128 a[168:171], v2 offset:12288
ds_read_b128 a[172:175], v2 offset:14336
ds_read_b128 a[184:187], v3 offset:12288
ds_read_b128 a[188:191], v3 offset:14336
v_xor_b32 v30, v12, v28
v_xor_b32 v13, v13, v28
v_xor_b32 v14, v14, v28
v_xor_b32 v15, v15, v28
v_or3_b32 v30, v30, v13, v14
v_or_b32 v30, v30, v15
v_cmp_ne_u32 vcc, 0, v30
s_nop 1
s_cbranch_vccnz L_pslow_5
L_pret_6:
s_waitcnt lgkmcnt(0)
s_branch L_p2
L_p1z6:
s_add_u32 m0, s77, 0
s_nop 0
buffer_load_dwordx4 v4, s[4:7], s72 offen offset:0 lds
buffer_load_dwordx4 v5, s[4:7], s72 offen offset:1024 lds
buffer_load_dwordx4 v6, s[4:7], s72 offen offset:2048 lds
buffer_load_dwordx4 v7, s[4:7], s72 offen offset:3072 lds
s_add_u32 m0, s74, 0
s_mul_i32 s82, s72, 1792
buffer_load_dwordx4 v12, s[12:15], s82 offen offset:0 lds
buffer_load_dwordx4 v13, s[12:15], s82 offen offset:1024 lds
buffer_load_dwordx4 v14, s[12:15], s82 offen offset:2048 lds
buffer_load_dwordx4 v15, s[12:15], s82 offen offset:3072 lds
s_add_u32 s72, s72, 128
s_and_b32 s72, s72, 0x380
s_mov_b32 s20, s68
s_mov_b32 s21, s69
s_mov_b32 s22, 0x1000000
s_mov_b32 s23, 0x20000
buffer_load_dword v28, off, s[20:23], 0 sc1
s_mov_b32 s8, s48
s_mov_b32 s9, s49
s_mov_b32 s10, 0x200000
s_mov_b32 s11, 0x20000
s_mov_b32 s24, s52
s_mov_b32 s25, s53
s_mov_b32 s26, 0x80000
s_mov_b32 s27, 0x20000
s_mov_b32 s28, s62
s_mov_b32 s29, s63
s_mov_b32 s30, 0xe0000
s_mov_b32 s31, 0x20000
s_mov_b32 s32, s64
s_mov_b32 s33, s65
s_mov_b32 s34, 0x200000
s_mov_b32 s35, 0x20000
s_mov_b32 s36, s60
s_mov_b32 s37, s61
s_mov_b32 s38, 0x1000
s_mov_b32 s39, 0x20000
s_mov_b32 s40, s66
s_mov_b32 s41, s67
s_mov_b32 s42, 256
s_mov_b32 s43, 0x20000
s_and_b32 s84, s2, 7
s_lshr_b32 s85, s2, 3
s_lshr_b32 s68, s85, 2
s_and_b32 s3, s85, 3
s_lshr_b32 s85, s84, 1
s_lshl_b32 s85, s85, 3
s_add_u32 s70, s85, s68
s_and_b32 s84, s84, 1
s_lshl_b32 s84, s84, 2
s_add_u32 s71, s84, s3
s_and_b32 s76, s68, 3
s_lshl_b32 s76, s76, 8
s_lshl_b32 s84, s70, 18
s_lshl_b32 s85, s44, 10
s_add_u32 s84, s84, s85
s_sub_u32 s16, s58, 3072
s_subb_u32 s17, s59, 0
s_add_u32 s16, s16, s84
s_addc_u32 s17, s17, 0
s_sub_u32 s18, 0x800c00, s84
s_mov_b32 s19, 0x20000
s_and_b32 s84, s44, 2
s_lshl_b32 s64, s84, 16
s_xor_b32 s65, s64, 0x20000
s_add_u32 s85, s44, 1
s_and_b32 s84, s85, 2
s_lshl_b32 s66, s84, 16
s_xor_b32 s67, s66, 0x20000
v_lshrrev_b32 v29, 3, v0
v_lshrrev_b32 v30, 4, v0
v_and_b32 v31, 7, v0
v_xor_b32 v31, v31, v30
v_lshlrev_b32 v31, 4, v31
v_lshl_add_u32 v31, v29, 12, v31
v_xor_b32 v30, 64, v31
s_and_b32 s84, s44, 1
s_lshl_b32 s84, s84, 16
s_xor_b32 s85, s84, 0x10000
s_add_u32 s83, s84, 3072
v_add_u32 v8, s83, v31
s_add_u32 s83, s84, 34816
v_add_u32 v9, s83, v30
s_add_u32 s83, s85, 1024
v_add_u32 v10, s83, v31
s_add_u32 s83, s85, 32768
v_add_u32 v11, s83, v30
v_lshlrev_b32 v1, 4, v0
v_and_b32 v29, 15, v0
v_lshrrev_b32 v30, 4, v0
v_lshrrev_b32 v31, 1, v29
v_xor_b32 v31, v31, v30
v_lshlrev_b32 v31, 4, v31
v_lshl_add_u32 v31, v29, 7, v31
v_add_u32 v2, s77, v31
v_xor_b32 v3, 64, v2
s_mov_b32 s86, 0x3b000000
s_mov_b32 s87, 0x3727c5ac
s_mov_b32 s88, 0x3a924925
s_mov_b32 s89, 0x3727c5ac
s_mov_b32 s90, 0xbdd2d3e8
s_mov_b32 s91, 0xc0135761
s_mov_b32 s92, 0xaaaaaaaa
s_mov_b32 s93, 0xaaaaaaaa
s_mov_b32 s94, 0xcccccccc
s_mov_b32 s95, 0xcccccccc
v_mov_b32 v24, 0x3f803f80
v_mov_b32 v25, 0x3f803f80
v_mov_b32 v26, 0x3f803f80
v_mov_b32 v27, 0x3f803f80
v_bfe_u32 v29, v0, 2, 2
v_lshrrev_b32 v30, 4, v0
v_lshl_add_u32 v31, v30, 3, v29
v_lshlrev_b32 v31, 8, v31
v_and_b32 v30, 1, v30
v_lshl_or_b32 v29, v30, 2, v29
v_and_b32 v30, 3, v0
v_lshl_or_b32 v31, v30, 3, v31
s_and_b32 s97, s100, 3
s_add_u32 s84, s44, 0
s_cmp_ge_u32 s84, 3
s_cselect_b32 s85, 3, 0
s_sub_u32 s84, s84, s85
s_lshl_b32 s84, s84, 1
s_add_u32 s78, s84, s97
v_xor_b32 v30, s78, v29
v_lshl_or_b32 v16, v30, 5, v31
v_xor_b32 v17, 32, v16
s_add_u32 s84, s44, 1
s_cmp_ge_u32 s84, 3
s_cselect_b32 s85, 3, 0
s_sub_u32 s84, s84, s85
s_lshl_b32 s84, s84, 1
s_add_u32 s79, s84, s97
v_xor_b32 v30, s79, v29
v_lshl_or_b32 v18, v30, 5, v31
v_xor_b32 v19, 32, v18
s_add_u32 s84, s44, 2
s_cmp_ge_u32 s84, 3
s_cselect_b32 s85, 3, 0
s_sub_u32 s84, s84, s85
s_lshl_b32 s84, s84, 1
s_add_u32 s80, s84, s97
v_xor_b32 v30, s80, v29
v_lshl_or_b32 v20, v30, 5, v31
v_xor_b32 v21, 32, v20
s_xor_b32 s97, s46, 1
s_lshr_b32 s83, s97, 1
s_and_b32 s84, s83, 1
s_lshl_b32 s84, s84, 1
s_sub_u32 s84, 8, s84
s_and_b32 s85, s97, 1
s_mul_i32 s84, s84, s85
s_mul_i32 s83, s83, 14
s_add_u32 s101, s83, s84
s_and_b32 s84, s101, 0xfc
s_lshl_b32 s84, s84, 5
s_sub_u32 s75, s75, s84
v_lshrrev_b32 v29, 1, v0
s_lshl_b32 s84, s47, 7
s_lshl_b32 s85, s44, 5
s_add_u32 s84, s84, s85
v_add_u32 v29, s84, v29
v_mul_u32_u24 v29, 3584, v29
v_and_b32 v30, 1, v0
v_lshl_add_u32 v29, v30, 7, v29
v_subrev_u32 v191, s75, v29
v_and_b32 v29, 15, v0
s_lshl_b32 s84, s3, 4
v_add_u32 v29, s84, v29
v_lshlrev_b32 v29, 12, v29
v_lshrrev_b32 v30, 4, v0
v_lshl_add_u32 v30, v30, 7, s76
v_and_b32 v30, 0x380, v30
v_add_u32 v188, v29, v30
s_waitcnt vmcnt(1)
s_barrier
ds_read_b128 a[128:131], v2 offset:0
ds_read_b128 a[132:135], v2 offset:2048
ds_read_b128 a[136:139], v3 offset:0
ds_read_b128 a[140:143], v3 offset:2048
ds_read_b64_tr_b16 v[32:33], v16 offset:0
ds_read_b64_tr_b16 v[34:35], v16 offset:1024
ds_read_b64_tr_b16 v[36:37], v17 offset:0
ds_read_b64_tr_b16 v[38:39], v17 offset:1024
ds_read_b64_tr_b16 v[40:41], v18 offset:0
ds_read_b64_tr_b16 v[42:43], v18 offset:1024
ds_read_b64_tr_b16 v[44:45], v19 offset:0
ds_read_b64_tr_b16 v[46:47], v19 offset:1024
ds_read_b64_tr_b16 v[48:49], v20 offset:0
ds_read_b64_tr_b16 v[50:51], v20 offset:1024
ds_read_b64_tr_b16 v[52:53], v21 offset:0
ds_read_b64_tr_b16 v[54:55], v21 offset:1024
s_waitcnt lgkmcnt(8)
v_mfma_f32_16x16x32_bf16 v[64:67], a[128:131], v[32:35], 0
ds_read_b64_tr_b16 v[56:57], v16 offset:8192
s_add_u32 m0, s77, 4096
s_nop 0
buffer_load_dwordx4 v4, s[4:7], s72 offen offset:0 lds
v_mfma_f32_16x16x32_bf16 v[68:71], a[132:135], v[32:35], 0
ds_read_b64_tr_b16 v[58:59], v16 offset:9216
buffer_load_dwordx4 v5, s[4:7], s72 offen offset:1024 lds
v_mfma_f32_16x16x32_bf16 v[128:131], v[24:27], v[32:35], 0
buffer_load_dwordx4 v6, s[4:7], s72 offen offset:2048 lds
v_mfma_f32_16x16x32_bf16 v[72:75], a[128:131], v[36:39], 0
ds_read_b64_tr_b16 v[60:61], v17 offset:8192
buffer_load_dwordx4 v7, s[4:7], s72 offen offset:3072 lds
s_add_u32 m0, s74, 16384
v_mfma_f32_16x16x32_bf16 v[76:79], a[132:135], v[36:39], 0
ds_read_b64_tr_b16 v[62:63], v17 offset:9216
s_mul_i32 s82, s72, 1792
buffer_load_dwordx4 v12, s[12:15], s82 offen offset:0 lds
v_mfma_f32_16x16x32_bf16 v[132:135], v[24:27], v[36:39], 0
buffer_load_dwordx4 v13, s[12:15], s82 offen offset:1024 lds
s_waitcnt lgkmcnt(8)
v_mfma_f32_16x16x32_bf16 v[80:83], a[128:131], v[40:43], 0
ds_read_b64_tr_b16 v[32:33], v18 offset:8192
buffer_load_dwordx4 v14, s[12:15], s82 offen offset:2048 lds
buffer_load_dwordx4 v15, s[12:15], s82 offen offset:3072 lds
s_add_u32 s72, s72, 128
s_and_b32 s72, s72, 0x380
s_add_u32 m0, s77, 8192
v_mfma_f32_16x16x32_bf16 v[84:87], a[132:135], v[40:43], 0
ds_read_b64_tr_b16 v[34:35], v18 offset:9216
buffer_load_dwordx4 v4, s[4:7], s72 offen offset:0 lds
v_mfma_f32_16x16x32_bf16 v[120:123], a[128:131], a[128:131], 0
v_mfma_f32_16x16x32_bf16 v[88:91], a[128:131], v[44:47], 0
ds_read_b64_tr_b16 v[36:37], v19 offset:8192
buffer_load_dwordx4 v5, s[4:7], s72 offen offset:1024 lds
v_mfma_f32_16x16x32_bf16 v[92:95], a[132:135], v[44:47], 0
ds_read_b64_tr_b16 v[38:39], v19 offset:9216
v_mfma_f32_16x16x32_bf16 v[124:127], a[132:135], a[132:135], 0
buffer_load_dwordx4 v6, s[4:7], s72 offen offset:2048 lds
s_waitcnt lgkmcnt(8)
v_mfma_f32_16x16x32_bf16 v[96:99], a[128:131], v[48:51], 0
ds_read_b64_tr_b16 v[40:41], v20 offset:8192
v_mfma_f32_16x16x32_bf16 v[100:103], a[132:135], v[48:51], 0
ds_read_b64_tr_b16 v[42:43], v20 offset:9216
buffer_load_dwordx4 v7, s[4:7], s72 offen offset:3072 lds
v_mfma_f32_16x16x32_bf16 v[112:115], a[128:131], v[24:27], 0
s_add_u32 m0, s74, 32768
s_mul_i32 s82, s72, 1792
v_mfma_f32_16x16x32_bf16 v[104:107], a[128:131], v[52:55], 0
ds_read_b64_tr_b16 v[44:45], v21 offset:8192
buffer_load_dwordx4 v12, s[12:15], s82 offen offset:0 lds
v_mfma_f32_16x16x32_bf16 v[108:111], a[132:135], v[52:55], 0
ds_read_b64_tr_b16 v[46:47], v21 offset:9216
v_mfma_f32_16x16x32_bf16 v[116:119], a[132:135], v[24:27], 0
buffer_load_dwordx4 v13, s[12:15], s82 offen offset:1024 lds
s_waitcnt lgkmcnt(8)
v_mfma_f32_16x16x32_bf16 v[64:67], a[136:139], v[56:59], v[64:67]
s_waitcnt vmcnt(6)
s_barrier
ds_read_b64_tr_b16 v[48:49], v16 offset:16384
v_mfma_f32_16x16x32_bf16 v[68:71], a[140:143], v[56:59], v[68:71]
ds_read_b64_tr_b16 v[50:51], v16 offset:17408
buffer_load_dwordx4 v14, s[12:15], s82 offen offset:2048 lds
v_mfma_f32_16x16x32_bf16 v[128:131], v[24:27], v[56:59], v[128:131]
ds_read_b128 a[144:147], v2 offset:4096
v_mfma_f32_16x16x32_bf16 v[72:75], a[136:139], v[60:63], v[72:75]
ds_read_b128 a[148:151], v2 offset:6144
ds_read_b64_tr_b16 v[52:53], v17 offset:16384
v_mfma_f32_16x16x32_bf16 v[76:79], a[140:143], v[60:63], v[76:79]
ds_read_b128 a[152:155], v3 offset:4096
ds_read_b64_tr_b16 v[54:55], v17 offset:17408
v_mfma_f32_16x16x32_bf16 v[132:135], v[24:27], v[60:63], v[132:135]
ds_read_b128 a[156:159], v3 offset:6144
s_waitcnt lgkmcnt(12)
v_mfma_f32_16x16x32_bf16 v[80:83], a[136:139], v[32:35], v[80:83]
ds_read_b64_tr_b16 v[56:57], v18 offset:16384
buffer_load_dwordx4 v15, s[12:15], s82 offen offset:3072 lds
s_add_u32 s72, s72, 128
s_and_b32 s72, s72, 0x380
v_add_u32 v28, 0x9e3779b9, v28
v_cmp_eq_u32 vcc, 0, v28
v_mov_b32 v29, 0x9e3779b9
s_lshl_b32 s85, s2, 2
v_cndmask_b32 v28, v28, v29, vcc
s_or_b32 s85, s85, s44
s_lshl_b32 s85, s85, 6
v_or_b32 v29, s85, v0
v_cmp_eq_u32 vcc, 0, v29
v_mov_b32 v30, 0x7ffffff0
s_nop 0
v_cndmask_b32 v29, v30, 0, vcc
buffer_store_dword v28, v29, s[20:23], 0 offen sc1
buffer_store_dword v28, v29, s[40:43], 0 offen sc1
v_mfma_f32_16x16x32_bf16 v[84:87], a[140:143], v[32:35], v[84:87]
ds_read_b64_tr_b16 v[58:59], v18 offset:17408
s_add_u32 m0, s77, 12288
v_mfma_f32_16x16x32_bf16 v[120:123], a[136:139], a[136:139], v[120:123]
buffer_load_dwordx4 v4, s[4:7], s72 offen offset:0 lds
v_mfma_f32_16x16x32_bf16 v[88:91], a[136:139], v[36:39], v[88:91]
ds_read_b64_tr_b16 v[60:61], v19 offset:16384
v_mfma_f32_16x16x32_bf16 v[92:95], a[140:143], v[36:39], v[92:95]
ds_read_b64_tr_b16 v[62:63], v19 offset:17408
v_mfma_f32_16x16x32_bf16 v[124:127], a[140:143], a[140:143], v[124:127]
s_waitcnt lgkmcnt(12)
v_mfma_f32_16x16x32_bf16 v[96:99], a[136:139], v[40:43], v[96:99]
ds_read_b64_tr_b16 v[32:33], v20 offset:16384
buffer_load_dwordx4 v5, s[4:7], s72 offen offset:1024 lds
v_mfma_f32_16x16x32_bf16 v[100:103], a[140:143], v[40:43], v[100:103]
ds_read_b64_tr_b16 v[34:35], v20 offset:17408
v_mfma_f32_16x16x32_bf16 v[112:115], a[136:139], v[24:27], v[112:115]
v_mfma_f32_16x16x32_bf16 v[104:107], a[136:139], v[44:47], v[104:107]
ds_read_b64_tr_b16 v[36:37], v21 offset:16384
v_mfma_f32_16x16x32_bf16 v[108:111], a[140:143], v[44:47], v[108:111]
ds_read_b64_tr_b16 v[38:39], v21 offset:17408
buffer_load_dwordx4 v6, s[4:7], s72 offen offset:2048 lds
v_mfma_f32_16x16x32_bf16 v[116:119], a[140:143], v[24:27], v[116:119]
s_waitcnt lgkmcnt(9)
v_mfma_f32_16x16x32_bf16 v[64:67], a[144:147], v[48:51], v[64:67]
ds_read_b64_tr_b16 v[40:41], v16 offset:24576
v_mfma_f32_16x16x32_bf16 v[68:71], a[148:151], v[48:51], v[68:71]
ds_read_b64_tr_b16 v[42:43], v16 offset:25600
v_mfma_f32_16x16x32_bf16 v[128:131], v[24:27], v[48:51], v[128:131]
buffer_load_dwordx4 v7, s[4:7], s72 offen offset:3072 lds
s_add_u32 m0, s74, 49152
v_mfma_f32_16x16x32_bf16 v[72:75], a[144:147], v[52:55], v[72:75]
ds_read_b64_tr_b16 v[44:45], v17 offset:24576
s_mul_i32 s82, s72, 1792
v_mfma_f32_16x16x32_bf16 v[76:79], a[148:151], v[52:55], v[76:79]
ds_read_b64_tr_b16 v[46:47], v17 offset:25600
v_mfma_f32_16x16x32_bf16 v[132:135], v[24:27], v[52:55], v[132:135]
s_waitcnt lgkmcnt(8)
v_mfma_f32_16x16x32_bf16 v[80:83], a[144:147], v[56:59], v[80:83]
ds_read_b64_tr_b16 v[48:49], v18 offset:24576
buffer_load_dwordx4 v12, s[12:15], s82 offen offset:0 lds
v_mfma_f32_16x16x32_bf16 v[84:87], a[148:151], v[56:59], v[84:87]
ds_read_b64_tr_b16 v[50:51], v18 offset:25600
v_mfma_f32_16x16x32_bf16 v[120:123], a[144:147], a[144:147], v[120:123]
v_mfma_f32_16x16x32_bf16 v[88:91], a[144:147], v[60:63], v[88:91]
ds_read_b64_tr_b16 v[52:53], v19 offset:24576
v_mfma_f32_16x16x32_bf16 v[92:95], a[148:151], v[60:63], v[92:95]
ds_read_b64_tr_b16 v[54:55], v19 offset:25600
buffer_load_dwordx4 v13, s[12:15], s82 offen offset:1024 lds
v_mfma_f32_16x16x32_bf16 v[124:127], a[148:151], a[148:151], v[124:127]
s_waitcnt lgkmcnt(8)
v_mfma_f32_16x16x32_bf16 v[96:99], a[144:147], v[32:35], v[96:99]
ds_read_b64_tr_b16 v[56:57], v20 offset:24576
v_mfma_f32_16x16x32_bf16 v[100:103], a[148:151], v[32:35], v[100:103]
ds_read_b64_tr_b16 v[58:59], v20 offset:25600
v_mfma_f32_16x16x32_bf16 v[112:115], a[144:147], v[24:27], v[112:115]
buffer_load_dwordx4 v14, s[12:15], s82 offen offset:2048 lds
v_mfma_f32_16x16x32_bf16 v[104:107], a[144:147], v[36:39], v[104:107]
ds_read_b64_tr_b16 v[60:61], v21 offset:24576
v_mfma_f32_16x16x32_bf16 v[108:111], a[148:151], v[36:39], v[108:111]
ds_read_b64_tr_b16 v[62:63], v21 offset:25600
v_mfma_f32_16x16x32_bf16 v[116:119], a[148:151], v[24:27], v[116:119]
s_waitcnt lgkmcnt(8)
v_mfma_f32_16x16x32_bf16 v[64:67], a[152:155], v[40:43], v[64:67]
s_waitcnt vmcnt(9)
s_barrier
ds_read_b64_tr_b16 v[32:33], v16 offset:32768
v_mfma_f32_16x16x32_bf16 v[68:71], a[156:159], v[40:43], v[68:71]
ds_read_b64_tr_b16 v[34:35], v16 offset:33792
buffer_load_dwordx4 v15, s[12:15], s82 offen offset:3072 lds
v_mfma_f32_16x16x32_bf16 v[128:131], v[24:27], v[40:43], v[128:131]
ds_read_b128 a[160:163], v2 offset:8192
s_add_u32 s72, s72, 128
v_mfma_f32_16x16x32_bf16 v[72:75], a[152:155], v[44:47], v[72:75]
ds_read_b128 a[164:167], v2 offset:10240
ds_read_b64_tr_b16 v[36:37], v17 offset:32768
v_mfma_f32_16x16x32_bf16 v[76:79], a[156:159], v[44:47], v[76:79]
ds_read_b128 a[168:171], v3 offset:8192
ds_read_b64_tr_b16 v[38:39], v17 offset:33792
v_mfma_f32_16x16x32_bf16 v[132:135], v[24:27], v[44:47], v[132:135]
ds_read_b128 a[172:175], v3 offset:10240
s_waitcnt lgkmcnt(12)
v_mfma_f32_16x16x32_bf16 v[80:83], a[152:155], v[48:51], v[80:83]
ds_read_b64_tr_b16 v[40:41], v18 offset:32768
s_and_b32 s72, s72, 0x380
v_mfma_f32_16x16x32_bf16 v[84:87], a[156:159], v[48:51], v[84:87]
ds_read_b64_tr_b16 v[42:43], v18 offset:33792
s_add_u32 m0, s77, 16384
v_mfma_f32_16x16x32_bf16 v[120:123], a[152:155], a[152:155], v[120:123]
buffer_load_dwordx4 v4, s[4:7], s72 offen offset:0 lds
v_mfma_f32_16x16x32_bf16 v[88:91], a[152:155], v[52:55], v[88:91]
ds_read_b64_tr_b16 v[44:45], v19 offset:32768
v_mfma_f32_16x16x32_bf16 v[92:95], a[156:159], v[52:55], v[92:95]
ds_read_b64_tr_b16 v[46:47], v19 offset:33792
v_mfma_f32_16x16x32_bf16 v[124:127], a[156:159], a[156:159], v[124:127]
s_waitcnt lgkmcnt(12)
v_mfma_f32_16x16x32_bf16 v[96:99], a[152:155], v[56:59], v[96:99]
ds_read_b64_tr_b16 v[48:49], v20 offset:32768
buffer_load_dwordx4 v5, s[4:7], s72 offen offset:1024 lds
v_mfma_f32_16x16x32_bf16 v[100:103], a[156:159], v[56:59], v[100:103]
ds_read_b64_tr_b16 v[50:51], v20 offset:33792
v_mfma_f32_16x16x32_bf16 v[112:115], a[152:155], v[24:27], v[112:115]
v_mfma_f32_16x16x32_bf16 v[104:107], a[152:155], v[60:63], v[104:107]
ds_read_b64_tr_b16 v[52:53], v21 offset:32768
v_mfma_f32_16x16x32_bf16 v[108:111], a[156:159], v[60:63], v[108:111]
ds_read_b64_tr_b16 v[54:55], v21 offset:33792
buffer_load_dwordx4 v6, s[4:7], s72 offen offset:2048 lds
v_mfma_f32_16x16x32_bf16 v[116:119], a[156:159], v[24:27], v[116:119]
s_waitcnt lgkmcnt(9)
v_mfma_f32_16x16x32_bf16 v[64:67], a[160:163], v[32:35], v[64:67]
ds_read_b64_tr_b16 v[56:57], v16 offset:40960
v_mfma_f32_16x16x32_bf16 v[68:71], a[164:167], v[32:35], v[68:71]
ds_read_b64_tr_b16 v[58:59], v16 offset:41984
v_mfma_f32_16x16x32_bf16 v[128:131], v[24:27], v[32:35], v[128:131]
buffer_load_dwordx4 v7, s[4:7], s72 offen offset:3072 lds
s_add_u32 m0, s74, 0
v_mfma_f32_16x16x32_bf16 v[72:75], a[160:163], v[36:39], v[72:75]
ds_read_b64_tr_b16 v[60:61], v17 offset:40960
s_mul_i32 s82, s72, 1792
v_mfma_f32_16x16x32_bf16 v[76:79], a[164:167], v[36:39], v[76:79]
ds_read_b64_tr_b16 v[62:63], v17 offset:41984
v_mfma_f32_16x16x32_bf16 v[132:135], v[24:27], v[36:39], v[132:135]
s_waitcnt lgkmcnt(8)
v_mfma_f32_16x16x32_bf16 v[80:83], a[160:163], v[40:43], v[80:83]
ds_read_b64_tr_b16 v[32:33], v18 offset:40960
buffer_load_dwordx4 v12, s[12:15], s82 offen offset:0 lds
v_mfma_f32_16x16x32_bf16 v[84:87], a[164:167], v[40:43], v[84:87]
ds_read_b64_tr_b16 v[34:35], v18 offset:41984
v_mfma_f32_16x16x32_bf16 v[120:123], a[160:163], a[160:163], v[120:123]
v_mfma_f32_16x16x32_bf16 v[88:91], a[160:163], v[44:47], v[88:91]
ds_read_b64_tr_b16 v[36:37], v19 offset:40960
v_mfma_f32_16x16x32_bf16 v[92:95], a[164:167], v[44:47], v[92:95]
ds_read_b64_tr_b16 v[38:39], v19 offset:41984
buffer_load_dwordx4 v13, s[12:15], s82 offen offset:1024 lds
v_mfma_f32_16x16x32_bf16 v[124:127], a[164:167], a[164:167], v[124:127]
s_waitcnt lgkmcnt(8)
v_mfma_f32_16x16x32_bf16 v[96:99], a[160:163], v[48:51], v[96:99]
ds_read_b64_tr_b16 v[40:41], v20 offset:40960
v_mfma_f32_16x16x32_bf16 v[100:103], a[164:167], v[48:51], v[100:103]
ds_read_b64_tr_b16 v[42:43], v20 offset:41984
v_mfma_f32_16x16x32_bf16 v[112:115], a[160:163], v[24:27], v[112:115]
buffer_load_dwordx4 v14, s[12:15], s82 offen offset:2048 lds
v_mfma_f32_16x16x32_bf16 v[104:107], a[160:163], v[52:55], v[104:107]
ds_read_b64_tr_b16 v[44:45], v21 offset:40960
v_mfma_f32_16x16x32_bf16 v[108:111], a[164:167], v[52:55], v[108:111]
ds_read_b64_tr_b16 v[46:47], v21 offset:41984
v_mfma_f32_16x16x32_bf16 v[116:119], a[164:167], v[24:27], v[116:119]
s_waitcnt lgkmcnt(8)
v_mfma_f32_16x16x32_bf16 v[64:67], a[168:171], v[56:59], v[64:67]
s_waitcnt vmcnt(7)
s_barrier
ds_read_b64_tr_b16 v[48:49], v16 offset:49152
v_mfma_f32_16x16x32_bf16 v[68:71], a[172:175], v[56:59], v[68:71]
ds_read_b64_tr_b16 v[50:51], v16 offset:50176
buffer_load_dwordx4 v15, s[12:15], s82 offen offset:3072 lds
v_mfma_f32_16x16x32_bf16 v[128:131], v[24:27], v[56:59], v[128:131]
ds_read_b128 a[176:179], v2 offset:12288
s_add_u32 s72, s72, 128
v_mfma_f32_16x16x32_bf16 v[72:75], a[168:171], v[60:63], v[72:75]
ds_read_b128 a[180:183], v2 offset:14336
ds_read_b64_tr_b16 v[52:53], v17 offset:49152
v_mfma_f32_16x16x32_bf16 v[76:79], a[172:175], v[60:63], v[76:79]
ds_read_b128 a[184:187], v3 offset:12288
ds_read_b64_tr_b16 v[54:55], v17 offset:50176
v_mfma_f32_16x16x32_bf16 v[132:135], v[24:27], v[60:63], v[132:135]
ds_read_b128 a[188:191], v3 offset:14336
s_waitcnt lgkmcnt(12)
v_mfma_f32_16x16x32_bf16 v[80:83], a[168:171], v[32:35], v[80:83]
ds_read_b64_tr_b16 v[56:57], v18 offset:49152
s_and_b32 s72, s72, 0x380
s_mov_b32 exec_hi, 0
buffer_load_dword v189, v191, s[12:15], 0 offen
s_mov_b64 exec, -1
v_mfma_f32_16x16x32_bf16 v[84:87], a[172:175], v[32:35], v[84:87]
ds_read_b64_tr_b16 v[58:59], v18 offset:50176
v_mfma_f32_16x16x32_bf16 v[120:123], a[168:171], a[168:171], v[120:123]
s_add_u32 m0, s77, 0
s_nop 0
buffer_load_dwordx4 v4, s[4:7], s72 offen offset:0 lds
v_mfma_f32_16x16x32_bf16 v[88:91], a[168:171], v[36:39], v[88:91]
ds_read_b64_tr_b16 v[60:61], v19 offset:49152
v_mfma_f32_16x16x32_bf16 v[92:95], a[172:175], v[36:39], v[92:95]
ds_read_b64_tr_b16 v[62:63], v19 offset:50176
v_mfma_f32_16x16x32_bf16 v[124:127], a[172:175], a[172:175], v[124:127]
s_waitcnt lgkmcnt(12)
v_mfma_f32_16x16x32_bf16 v[96:99], a[168:171], v[40:43], v[96:99]
ds_read_b64_tr_b16 v[32:33], v20 offset:49152
buffer_load_dwordx4 v5, s[4:7], s72 offen offset:1024 lds
v_mfma_f32_16x16x32_bf16 v[100:103], a[172:175], v[40:43], v[100:103]
ds_read_b64_tr_b16 v[34:35], v20 offset:50176
v_mfma_f32_16x16x32_bf16 v[112:115], a[168:171], v[24:27], v[112:115]
v_mfma_f32_16x16x32_bf16 v[104:107], a[168:171], v[44:47], v[104:107]
ds_read_b64_tr_b16 v[36:37], v21 offset:49152
v_mfma_f32_16x16x32_bf16 v[108:111], a[172:175], v[44:47], v[108:111]
ds_read_b64_tr_b16 v[38:39], v21 offset:50176
buffer_load_dwordx4 v6, s[4:7], s72 offen offset:2048 lds
v_mfma_f32_16x16x32_bf16 v[116:119], a[172:175], v[24:27], v[116:119]
s_waitcnt lgkmcnt(9)
v_mfma_f32_16x16x32_bf16 v[64:67], a[176:179], v[48:51], v[64:67]
ds_read_b64_tr_b16 v[40:41], v16 offset:57344
v_mfma_f32_16x16x32_bf16 v[68:71], a[180:183], v[48:51], v[68:71]
ds_read_b64_tr_b16 v[42:43], v16 offset:58368
v_mfma_f32_16x16x32_bf16 v[128:131], v[24:27], v[48:51], v[128:131]
buffer_load_dwordx4 v7, s[4:7], s72 offen offset:3072 lds
s_add_u32 m0, s74, 16384
v_mfma_f32_16x16x32_bf16 v[72:75], a[176:179], v[52:55], v[72:75]
ds_read_b64_tr_b16 v[44:45], v17 offset:57344
s_mul_i32 s82, s72, 1792
v_mfma_f32_16x16x32_bf16 v[76:79], a[180:183], v[52:55], v[76:79]
ds_read_b64_tr_b16 v[46:47], v17 offset:58368
v_mfma_f32_16x16x32_bf16 v[132:135], v[24:27], v[52:55], v[132:135]
s_waitcnt lgkmcnt(8)
v_mfma_f32_16x16x32_bf16 v[80:83], a[176:179], v[56:59], v[80:83]
ds_read_b64_tr_b16 v[48:49], v18 offset:57344
buffer_load_dwordx4 v12, s[12:15], s82 offen offset:0 lds
v_mfma_f32_16x16x32_bf16 v[84:87], a[180:183], v[56:59], v[84:87]
ds_read_b64_tr_b16 v[50:51], v18 offset:58368
v_mfma_f32_16x16x32_bf16 v[120:123], a[176:179], a[176:179], v[120:123]
v_mfma_f32_16x16x32_bf16 v[88:91], a[176:179], v[60:63], v[88:91]
ds_read_b64_tr_b16 v[52:53], v19 offset:57344
v_mfma_f32_16x16x32_bf16 v[92:95], a[180:183], v[60:63], v[92:95]
ds_read_b64_tr_b16 v[54:55], v19 offset:58368
buffer_load_dwordx4 v13, s[12:15], s82 offen offset:1024 lds
v_mfma_f32_16x16x32_bf16 v[124:127], a[180:183], a[180:183], v[124:127]
s_waitcnt lgkmcnt(8)
v_mfma_f32_16x16x32_bf16 v[96:99], a[176:179], v[32:35], v[96:99]
ds_read_b64_tr_b16 v[56:57], v20 offset:57344
v_mfma_f32_16x16x32_bf16 v[100:103], a[180:183], v[32:35], v[100:103]
ds_read_b64_tr_b16 v[58:59], v20 offset:58368
v_mfma_f32_16x16x32_bf16 v[112:115], a[176:179], v[24:27], v[112:115]
buffer_load_dwordx4 v14, s[12:15], s82 offen offset:2048 lds
v_mfma_f32_16x16x32_bf16 v[104:107], a[176:179], v[36:39], v[104:107]
ds_read_b64_tr_b16 v[60:61], v21 offset:57344
v_mfma_f32_16x16x32_bf16 v[108:111], a[180:183], v[36:39], v[108:111]
ds_read_b64_tr_b16 v[62:63], v21 offset:58368
v_mfma_f32_16x16x32_bf16 v[116:119], a[180:183], v[24:27], v[116:119]
s_waitcnt lgkmcnt(8)
v_mfma_f32_16x16x32_bf16 v[64:67], a[184:187], v[40:43], v[64:67]
s_waitcnt vmcnt(8)
s_barrier
ds_read_b64_tr_b16 v[32:33], v16 offset:0
v_mfma_f32_16x16x32_bf16 v[68:71], a[188:191], v[40:43], v[68:71]
ds_read_b64_tr_b16 v[34:35], v16 offset:1024
buffer_load_dwordx4 v15, s[12:15], s82 offen offset:3072 lds
v_mfma_f32_16x16x32_bf16 v[128:131], v[24:27], v[40:43], v[128:131]
ds_read_b128 a[192:195], v2 offset:16384
s_add_u32 s72, s72, 128
v_mfma_f32_16x16x32_bf16 v[72:75], a[184:187], v[44:47], v[72:75]
ds_read_b128 a[196:199], v2 offset:18432
ds_read_b64_tr_b16 v[36:37], v17 offset:0
v_mfma_f32_16x16x32_bf16 v[76:79], a[188:191], v[44:47], v[76:79]
ds_read_b128 a[200:203], v3 offset:16384
ds_read_b64_tr_b16 v[38:39], v17 offset:1024
v_mfma_f32_16x16x32_bf16 v[132:135], v[24:27], v[44:47], v[132:135]
ds_read_b128 a[204:207], v3 offset:18432
s_waitcnt lgkmcnt(12)
v_mfma_f32_16x16x32_bf16 v[80:83], a[184:187], v[48:51], v[80:83]
ds_read_b64_tr_b16 v[40:41], v18 offset:0
s_and_b32 s72, s72, 0x380
v_mfma_f32_16x16x32_bf16 v[84:87], a[188:191], v[48:51], v[84:87]
ds_read_b64_tr_b16 v[42:43], v18 offset:1024
v_mfma_f32_16x16x32_bf16 v[120:123], a[184:187], a[184:187], v[120:123]
s_add_u32 m0, s77, 4096
s_nop 0
buffer_load_dwordx4 v4, s[4:7], s72 offen offset:0 lds
v_mfma_f32_16x16x32_bf16 v[88:91], a[184:187], v[52:55], v[88:91]
ds_read_b64_tr_b16 v[44:45], v19 offset:0
v_mfma_f32_16x16x32_bf16 v[92:95], a[188:191], v[52:55], v[92:95]
ds_read_b64_tr_b16 v[46:47], v19 offset:1024
v_mfma_f32_16x16x32_bf16 v[124:127], a[188:191], a[188:191], v[124:127]
s_waitcnt lgkmcnt(12)
v_mfma_f32_16x16x32_bf16 v[96:99], a[184:187], v[56:59], v[96:99]
ds_read_b64_tr_b16 v[48:49], v20 offset:0
buffer_load_dwordx4 v5, s[4:7], s72 offen offset:1024 lds
v_mfma_f32_16x16x32_bf16 v[100:103], a[188:191], v[56:59], v[100:103]
ds_read_b64_tr_b16 v[50:51], v20 offset:1024
v_mfma_f32_16x16x32_bf16 v[112:115], a[184:187], v[24:27], v[112:115]
v_mfma_f32_16x16x32_bf16 v[104:107], a[184:187], v[60:63], v[104:107]
ds_read_b64_tr_b16 v[52:53], v21 offset:0
v_mfma_f32_16x16x32_bf16 v[108:111], a[188:191], v[60:63], v[108:111]
ds_read_b64_tr_b16 v[54:55], v21 offset:1024
buffer_load_dwordx4 v6, s[4:7], s72 offen offset:2048 lds
v_mfma_f32_16x16x32_bf16 v[116:119], a[188:191], v[24:27], v[116:119]
s_waitcnt lgkmcnt(9)
v_mfma_f32_16x16x32_bf16 v[64:67], a[192:195], v[32:35], v[64:67]
ds_read_b64_tr_b16 v[56:57], v16 offset:8192
v_mfma_f32_16x16x32_bf16 v[68:71], a[196:199], v[32:35], v[68:71]
ds_read_b64_tr_b16 v[58:59], v16 offset:9216
v_mfma_f32_16x16x32_bf16 v[128:131], v[24:27], v[32:35], v[128:131]
buffer_load_dwordx4 v7, s[4:7], s72 offen offset:3072 lds
s_add_u32 m0, s74, 32768
v_mfma_f32_16x16x32_bf16 v[72:75], a[192:195], v[36:39], v[72:75]
ds_read_b64_tr_b16 v[60:61], v17 offset:8192
s_mul_i32 s82, s72, 1792
v_mfma_f32_16x16x32_bf16 v[76:79], a[196:199], v[36:39], v[76:79]
ds_read_b64_tr_b16 v[62:63], v17 offset:9216
v_mfma_f32_16x16x32_bf16 v[132:135], v[24:27], v[36:39], v[132:135]
s_waitcnt lgkmcnt(8)
v_mfma_f32_16x16x32_bf16 v[80:83], a[192:195], v[40:43], v[80:83]
ds_read_b64_tr_b16 v[32:33], v18 offset:8192
buffer_load_dwordx4 v12, s[12:15], s82 offen offset:0 lds
v_mfma_f32_16x16x32_bf16 v[84:87], a[196:199], v[40:43], v[84:87]
ds_read_b64_tr_b16 v[34:35], v18 offset:9216
v_mfma_f32_16x16x32_bf16 v[120:123], a[192:195], a[192:195], v[120:123]
v_mfma_f32_16x16x32_bf16 v[88:91], a[192:195], v[44:47], v[88:91]
ds_read_b64_tr_b16 v[36:37], v19 offset:8192
v_mfma_f32_16x16x32_bf16 v[92:95], a[196:199], v[44:47], v[92:95]
ds_read_b64_tr_b16 v[38:39], v19 offset:9216
buffer_load_dwordx4 v13, s[12:15], s82 offen offset:1024 lds
v_mfma_f32_16x16x32_bf16 v[124:127], a[196:199], a[196:199], v[124:127]
s_waitcnt lgkmcnt(8)
v_mfma_f32_16x16x32_bf16 v[96:99], a[192:195], v[48:51], v[96:99]
ds_read_b64_tr_b16 v[40:41], v20 offset:8192
v_mfma_f32_16x16x32_bf16 v[100:103], a[196:199], v[48:51], v[100:103]
ds_read_b64_tr_b16 v[42:43], v20 offset:9216
v_mfma_f32_16x16x32_bf16 v[112:115], a[192:195], v[24:27], v[112:115]
buffer_load_dwordx4 v14, s[12:15], s82 offen offset:2048 lds
v_mfma_f32_16x16x32_bf16 v[104:107], a[192:195], v[52:55], v[104:107]
ds_read_b64_tr_b16 v[44:45], v21 offset:8192
v_mfma_f32_16x16x32_bf16 v[108:111], a[196:199], v[52:55], v[108:111]
ds_read_b64_tr_b16 v[46:47], v21 offset:9216
v_mfma_f32_16x16x32_bf16 v[116:119], a[196:199], v[24:27], v[116:119]
s_waitcnt lgkmcnt(8)
v_mfma_f32_16x16x32_bf16 v[64:67], a[200:203], v[56:59], v[64:67]
s_waitcnt vmcnt(7)
s_barrier
ds_read_b64_tr_b16 v[48:49], v16 offset:16384
v_mfma_f32_16x16x32_bf16 v[68:71], a[204:207], v[56:59], v[68:71]
ds_read_b64_tr_b16 v[50:51], v16 offset:17408
buffer_load_dwordx4 v15, s[12:15], s82 offen offset:3072 lds
v_mfma_f32_16x16x32_bf16 v[128:131], v[24:27], v[56:59], v[128:131]
ds_read_b128 a[208:211], v2 offset:0
s_add_u32 s72, s72, 128
v_mfma_f32_16x16x32_bf16 v[72:75], a[200:203], v[60:63], v[72:75]
ds_read_b128 a[212:215], v2 offset:2048
ds_read_b64_tr_b16 v[52:53], v17 offset:16384
v_mfma_f32_16x16x32_bf16 v[76:79], a[204:207], v[60:63], v[76:79]
ds_read_b128 a[216:219], v3 offset:0
ds_read_b64_tr_b16 v[54:55], v17 offset:17408
v_mfma_f32_16x16x32_bf16 v[132:135], v[24:27], v[60:63], v[132:135]
ds_read_b128 a[220:223], v3 offset:2048
s_waitcnt lgkmcnt(12)
v_mfma_f32_16x16x32_bf16 v[80:83], a[200:203], v[32:35], v[80:83]
ds_read_b64_tr_b16 v[56:57], v18 offset:16384
s_and_b32 s72, s72, 0x380
v_mfma_f32_16x16x32_bf16 v[84:87], a[204:207], v[32:35], v[84:87]
ds_read_b64_tr_b16 v[58:59], v18 offset:17408
v_mfma_f32_16x16x32_bf16 v[120:123], a[200:203], a[200:203], v[120:123]
s_add_u32 m0, s77, 8192
s_nop 0
buffer_load_dwordx4 v4, s[4:7], s72 offen offset:0 lds
v_mfma_f32_16x16x32_bf16 v[88:91], a[200:203], v[36:39], v[88:91]
ds_read_b64_tr_b16 v[60:61], v19 offset:16384
v_mfma_f32_16x16x32_bf16 v[92:95], a[204:207], v[36:39], v[92:95]
ds_read_b64_tr_b16 v[62:63], v19 offset:17408
v_mfma_f32_16x16x32_bf16 v[124:127], a[204:207], a[204:207], v[124:127]
s_waitcnt lgkmcnt(12)
v_mfma_f32_16x16x32_bf16 v[96:99], a[200:203], v[40:43], v[96:99]
ds_read_b64_tr_b16 v[32:33], v20 offset:16384
buffer_load_dwordx4 v5, s[4:7], s72 offen offset:1024 lds
v_mfma_f32_16x16x32_bf16 v[100:103], a[204:207], v[40:43], v[100:103]
ds_read_b64_tr_b16 v[34:35], v20 offset:17408
v_mfma_f32_16x16x32_bf16 v[112:115], a[200:203], v[24:27], v[112:115]
v_mfma_f32_16x16x32_bf16 v[104:107], a[200:203], v[44:47], v[104:107]
ds_read_b64_tr_b16 v[36:37], v21 offset:16384
v_mfma_f32_16x16x32_bf16 v[108:111], a[204:207], v[44:47], v[108:111]
ds_read_b64_tr_b16 v[38:39], v21 offset:17408
buffer_load_dwordx4 v6, s[4:7], s72 offen offset:2048 lds
v_mfma_f32_16x16x32_bf16 v[116:119], a[204:207], v[24:27], v[116:119]
s_waitcnt lgkmcnt(9)
v_mfma_f32_16x16x32_bf16 v[64:67], a[208:211], v[48:51], v[64:67]
ds_read_b64_tr_b16 v[40:41], v16 offset:24576
v_mfma_f32_16x16x32_bf16 v[68:71], a[212:215], v[48:51], v[68:71]
ds_read_b64_tr_b16 v[42:43], v16 offset:25600
v_mfma_f32_16x16x32_bf16 v[128:131], v[24:27], v[48:51], v[128:131]
buffer_load_dwordx4 v7, s[4:7], s72 offen offset:3072 lds
s_add_u32 m0, s74, 49152
v_mfma_f32_16x16x32_bf16 v[72:75], a[208:211], v[52:55], v[72:75]
ds_read_b64_tr_b16 v[44:45], v17 offset:24576
s_mul_i32 s82, s72, 1792
v_mfma_f32_16x16x32_bf16 v[76:79], a[212:215], v[52:55], v[76:79]
ds_read_b64_tr_b16 v[46:47], v17 offset:25600
v_mfma_f32_16x16x32_bf16 v[132:135], v[24:27], v[52:55], v[132:135]
s_waitcnt lgkmcnt(8)
v_mfma_f32_16x16x32_bf16 v[80:83], a[208:211], v[56:59], v[80:83]
ds_read_b64_tr_b16 v[48:49], v18 offset:24576
buffer_load_dwordx4 v12, s[12:15], s82 offen offset:0 lds
v_mfma_f32_16x16x32_bf16 v[84:87], a[212:215], v[56:59], v[84:87]
ds_read_b64_tr_b16 v[50:51], v18 offset:25600
v_mfma_f32_16x16x32_bf16 v[120:123], a[208:211], a[208:211], v[120:123]
v_mfma_f32_16x16x32_bf16 v[88:91], a[208:211], v[60:63], v[88:91]
ds_read_b64_tr_b16 v[52:53], v19 offset:24576
v_mfma_f32_16x16x32_bf16 v[92:95], a[212:215], v[60:63], v[92:95]
ds_read_b64_tr_b16 v[54:55], v19 offset:25600
buffer_load_dwordx4 v13, s[12:15], s82 offen offset:1024 lds
v_mfma_f32_16x16x32_bf16 v[124:127], a[212:215], a[212:215], v[124:127]
s_waitcnt lgkmcnt(8)
v_mfma_f32_16x16x32_bf16 v[96:99], a[208:211], v[32:35], v[96:99]
ds_read_b64_tr_b16 v[56:57], v20 offset:24576
v_mfma_f32_16x16x32_bf16 v[100:103], a[212:215], v[32:35], v[100:103]
ds_read_b64_tr_b16 v[58:59], v20 offset:25600
v_mfma_f32_16x16x32_bf16 v[112:115], a[208:211], v[24:27], v[112:115]
buffer_load_dwordx4 v14, s[12:15], s82 offen offset:2048 lds
v_mfma_f32_16x16x32_bf16 v[104:107], a[208:211], v[36:39], v[104:107]
ds_read_b64_tr_b16 v[60:61], v21 offset:24576
v_mfma_f32_16x16x32_bf16 v[108:111], a[212:215], v[36:39], v[108:111]
ds_read_b64_tr_b16 v[62:63], v21 offset:25600
v_mfma_f32_16x16x32_bf16 v[116:119], a[212:215], v[24:27], v[116:119]
s_waitcnt lgkmcnt(8)
v_mfma_f32_16x16x32_bf16 v[64:67], a[216:219], v[40:43], v[64:67]
s_waitcnt vmcnt(7)
s_barrier
ds_read_b64_tr_b16 v[32:33], v16 offset:32768
v_mfma_f32_16x16x32_bf16 v[68:71], a[220:223], v[40:43], v[68:71]
ds_read_b64_tr_b16 v[34:35], v16 offset:33792
buffer_load_dwordx4 v15, s[12:15], s82 offen offset:3072 lds
v_mfma_f32_16x16x32_bf16 v[128:131], v[24:27], v[40:43], v[128:131]
ds_read_b128 a[224:227], v2 offset:4096
s_add_u32 s72, s72, 128
v_mfma_f32_16x16x32_bf16 v[72:75], a[216:219], v[44:47], v[72:75]
ds_read_b128 a[228:231], v2 offset:6144
ds_read_b64_tr_b16 v[36:37], v17 offset:32768
v_mfma_f32_16x16x32_bf16 v[76:79], a[220:223], v[44:47], v[76:79]
ds_read_b128 a[232:235], v3 offset:4096
ds_read_b64_tr_b16 v[38:39], v17 offset:33792
v_mfma_f32_16x16x32_bf16 v[132:135], v[24:27], v[44:47], v[132:135]
ds_read_b128 a[236:239], v3 offset:6144
s_waitcnt lgkmcnt(12)
v_mfma_f32_16x16x32_bf16 v[80:83], a[216:219], v[48:51], v[80:83]
ds_read_b64_tr_b16 v[40:41], v18 offset:32768
s_and_b32 s72, s72, 0x380
buffer_load_dword v28, off, s[40:43], 0 sc1
s_mov_b32 exec_lo, 0x0
s_mov_b32 exec_hi, 0xffffffff
buffer_load_dword v189, v191, s[12:15], 0 offen
s_mov_b64 exec, -1
s_add_u32 m0, s77, 12288
s_add_u32 s82, s64, s76
s_add_u32 s83, s66, s76
buffer_load_dwordx4 v8, s[16:19], s82 offen offset:0 lds
buffer_load_dwordx4 v9, s[16:19], s82 offen offset:1024 lds
buffer_load_dwordx4 v10, s[16:19], s83 offen offset:2048 lds
buffer_load_dwordx4 v11, s[16:19], s83 offen offset:3072 lds
v_mfma_f32_16x16x32_bf16 v[84:87], a[220:223], v[48:51], v[84:87]
ds_read_b64_tr_b16 v[42:43], v18 offset:33792
v_mfma_f32_16x16x32_bf16 v[120:123], a[216:219], a[216:219], v[120:123]
s_add_u32 m0, s77, 16384
s_add_u32 s82, s65, s76
v_mfma_f32_16x16x32_bf16 v[88:91], a[216:219], v[52:55], v[88:91]
ds_read_b64_tr_b16 v[44:45], v19 offset:32768
s_add_u32 s83, s67, s76
v_mfma_f32_16x16x32_bf16 v[92:95], a[220:223], v[52:55], v[92:95]
ds_read_b64_tr_b16 v[46:47], v19 offset:33792
buffer_load_dwordx4 v8, s[16:19], s82 offen offset:0 lds
v_mfma_f32_16x16x32_bf16 v[124:127], a[220:223], a[220:223], v[124:127]
s_waitcnt lgkmcnt(12)
v_mfma_f32_16x16x32_bf16 v[96:99], a[216:219], v[56:59], v[96:99]
ds_read_b64_tr_b16 v[48:49], v20 offset:32768
v_mfma_f32_16x16x32_bf16 v[100:103], a[220:223], v[56:59], v[100:103]
ds_read_b64_tr_b16 v[50:51], v20 offset:33792
v_mfma_f32_16x16x32_bf16 v[112:115], a[216:219], v[24:27], v[112:115]
buffer_load_dwordx4 v9, s[16:19], s82 offen offset:1024 lds
v_mfma_f32_16x16x32_bf16 v[104:107], a[216:219], v[60:63], v[104:107]
ds_read_b64_tr_b16 v[52:53], v21 offset:32768
v_mfma_f32_16x16x32_bf16 v[108:111], a[220:223], v[60:63], v[108:111]
ds_read_b64_tr_b16 v[54:55], v21 offset:33792
v_mfma_f32_16x16x32_bf16 v[116:119], a[220:223], v[24:27], v[116:119]
s_waitcnt lgkmcnt(9)
v_mfma_f32_16x16x32_bf16 v[64:67], a[224:227], v[32:35], v[64:67]
ds_read_b64_tr_b16 v[56:57], v16 offset:40960
buffer_load_dwordx4 v10, s[16:19], s83 offen offset:2048 lds
v_mfma_f32_16x16x32_bf16 v[68:71], a[228:231], v[32:35], v[68:71]
ds_read_b64_tr_b16 v[58:59], v16 offset:41984
v_mfma_f32_16x16x32_bf16 v[128:131], v[24:27], v[32:35], v[128:131]
v_mfma_f32_16x16x32_bf16 v[72:75], a[224:227], v[36:39], v[72:75]
ds_read_b64_tr_b16 v[60:61], v17 offset:40960
v_mfma_f32_16x16x32_bf16 v[76:79], a[228:231], v[36:39], v[76:79]
ds_read_b64_tr_b16 v[62:63], v17 offset:41984
buffer_load_dwordx4 v11, s[16:19], s83 offen offset:3072 lds
v_mfma_f32_16x16x32_bf16 v[132:135], v[24:27], v[36:39], v[132:135]
s_waitcnt vmcnt(4)
s_waitcnt lgkmcnt(8)
v_mfma_f32_16x16x32_bf16 v[80:83], a[224:227], v[40:43], v[80:83]
ds_read_b64_tr_b16 v[32:33], v18 offset:40960
ds_read_b128 a[0:3], v2 offset:12288
v_mfma_f32_16x16x32_bf16 v[84:87], a[228:231], v[40:43], v[84:87]
ds_read_b64_tr_b16 v[34:35], v18 offset:41984
ds_read_b128 a[4:7], v2 offset:14336
v_mfma_f32_16x16x32_bf16 v[120:123], a[224:227], a[224:227], v[120:123]
ds_read_b128 a[16:19], v3 offset:12288
ds_read_b128 a[20:23], v3 offset:14336
v_mfma_f32_16x16x32_bf16 v[88:91], a[224:227], v[44:47], v[88:91]
ds_read_b64_tr_b16 v[36:37], v19 offset:40960
v_mfma_f32_16x16x32_bf16 v[92:95], a[228:231], v[44:47], v[92:95]
ds_read_b64_tr_b16 v[38:39], v19 offset:41984
s_add_u32 m0, s77, 0
v_mfma_f32_16x16x32_bf16 v[124:127], a[228:231], a[228:231], v[124:127]
s_add_u32 s76, s76, 128
s_waitcnt lgkmcnt(12)
v_mfma_f32_16x16x32_bf16 v[96:99], a[224:227], v[48:51], v[96:99]
ds_read_b64_tr_b16 v[40:41], v20 offset:40960
s_and_b32 s76, s76, 0x380
v_mfma_f32_16x16x32_bf16 v[100:103], a[228:231], v[48:51], v[100:103]
ds_read_b64_tr_b16 v[42:43], v20 offset:41984
s_add_u32 s82, s64, s76
v_mfma_f32_16x16x32_bf16 v[112:115], a[224:227], v[24:27], v[112:115]
s_add_u32 s83, s66, s76
buffer_load_dwordx4 v8, s[16:19], s82 offen offset:0 lds
v_mfma_f32_16x16x32_bf16 v[104:107], a[224:227], v[52:55], v[104:107]
ds_read_b64_tr_b16 v[44:45], v21 offset:40960
v_mfma_f32_16x16x32_bf16 v[108:111], a[228:231], v[52:55], v[108:111]
ds_read_b64_tr_b16 v[46:47], v21 offset:41984
v_mfma_f32_16x16x32_bf16 v[116:119], a[228:231], v[24:27], v[116:119]
s_waitcnt lgkmcnt(12)
v_mfma_f32_16x16x32_bf16 v[64:67], a[232:235], v[56:59], v[64:67]
s_barrier
ds_read_b64_tr_b16 v[48:49], v16 offset:49152
v_mfma_f32_16x16x32_bf16 v[68:71], a[236:239], v[56:59], v[68:71]
ds_read_b64_tr_b16 v[50:51], v16 offset:50176
buffer_load_dwordx4 v9, s[16:19], s82 offen offset:1024 lds
v_mfma_f32_16x16x32_bf16 v[128:131], v[24:27], v[56:59], v[128:131]
ds_read_b128 a[240:243], v2 offset:8192
v_and_b32 v29, 15, v0
v_mfma_f32_16x16x32_bf16 v[72:75], a[232:235], v[60:63], v[72:75]
ds_read_b128 a[244:247], v2 offset:10240
ds_read_b64_tr_b16 v[52:53], v17 offset:49152
v_mfma_f32_16x16x32_bf16 v[76:79], a[236:239], v[60:63], v[76:79]
ds_read_b128 a[248:251], v3 offset:8192
ds_read_b64_tr_b16 v[54:55], v17 offset:50176
v_mfma_f32_16x16x32_bf16 v[132:135], v[24:27], v[60:63], v[132:135]
ds_read_b128 a[252:255], v3 offset:10240
s_waitcnt lgkmcnt(12)
v_mfma_f32_16x16x32_bf16 v[80:83], a[232:235], v[32:35], v[80:83]
ds_read_b64_tr_b16 v[56:57], v16 offset:57344
buffer_load_dwordx4 v10, s[16:19], s83 offen offset:2048 lds
buffer_load_dwordx4 v11, s[16:19], s83 offen offset:3072 lds
v_mfma_f32_16x16x32_bf16 v[84:87], a[236:239], v[32:35], v[84:87]
ds_read_b64_tr_b16 v[58:59], v16 offset:58368
s_waitcnt vmcnt(4)
v_mfma_f32_16x16x32_bf16 v[120:123], a[232:235], a[232:235], v[120:123]
ds_read_b128 a[8:11], v2 offset:16384
ds_read_b128 a[12:15], v2 offset:18432
v_mfma_f32_16x16x32_bf16 v[88:91], a[232:235], v[36:39], v[88:91]
ds_read_b64_tr_b16 v[60:61], v17 offset:57344
ds_read_b128 a[24:27], v3 offset:16384
v_mfma_f32_16x16x32_bf16 v[92:95], a[236:239], v[36:39], v[92:95]
ds_read_b64_tr_b16 v[62:63], v17 offset:58368
ds_read_b128 a[28:31], v3 offset:18432
v_mfma_f32_16x16x32_bf16 v[124:127], a[236:239], a[236:239], v[124:127]
s_waitcnt lgkmcnt(15)
v_mfma_f32_16x16x32_bf16 v[96:99], a[232:235], v[40:43], v[96:99]
ds_read_b64_tr_b16 v[32:33], v18 offset:49152
s_add_u32 m0, s77, 4096
v_mfma_f32_16x16x32_bf16 v[100:103], a[236:239], v[40:43], v[100:103]
ds_read_b64_tr_b16 v[34:35], v18 offset:50176
s_add_u32 s82, s65, s76
v_mfma_f32_16x16x32_bf16 v[112:115], a[232:235], v[24:27], v[112:115]
s_add_u32 s83, s67, s76
buffer_load_dwordx4 v8, s[16:19], s82 offen offset:0 lds
v_mfma_f32_16x16x32_bf16 v[104:107], a[232:235], v[44:47], v[104:107]
ds_read_b64_tr_b16 v[36:37], v19 offset:49152
v_lshlrev_b32 v29, 2, v29
v_mfma_f32_16x16x32_bf16 v[108:111], a[236:239], v[44:47], v[108:111]
ds_read_b64_tr_b16 v[38:39], v19 offset:50176
v_add_u32 v29, 65536, v29
v_mfma_f32_16x16x32_bf16 v[116:119], a[236:239], v[24:27], v[116:119]
s_lshl_b32 s84, s78, 6
s_waitcnt lgkmcnt(13)
v_mfma_f32_16x16x32_bf16 v[64:67], a[240:243], v[48:51], v[64:67]
ds_read_b64_tr_b16 v[40:41], v20 offset:49152
buffer_load_dwordx4 v9, s[16:19], s82 offen offset:1024 lds
v_mfma_f32_16x16x32_bf16 v[68:71], a[244:247], v[48:51], v[68:71]
ds_read_b64_tr_b16 v[42:43], v20 offset:50176
v_add_u32 v30, s84, v29
v_mfma_f32_16x16x32_bf16 v[128:131], v[24:27], v[48:51], v[128:131]
v_lshrrev_b32 v31, 4, v0
v_mul_u32_u24 v31, 80, v31
v_mfma_f32_16x16x32_bf16 v[120:123], a[240:243], a[240:243], v[120:123]
v_mfma_f32_16x16x32_bf16 v[124:127], a[244:247], a[244:247], v[124:127]
buffer_load_dwordx4 v10, s[16:19], s83 offen offset:2048 lds
v_mfma_f32_16x16x32_bf16 v[72:75], a[240:243], v[52:55], v[72:75]
ds_read_b64_tr_b16 v[44:45], v21 offset:49152
v_mfma_f32_16x16x32_bf16 v[76:79], a[244:247], v[52:55], v[76:79]
ds_read_b64_tr_b16 v[46:47], v21 offset:50176
v_mfma_f32_16x16x32_bf16 v[132:135], v[24:27], v[52:55], v[132:135]
v_mfma_f32_16x16x32_bf16 v[112:115], a[240:243], v[24:27], v[112:115]
buffer_load_dwordx4 v11, s[16:19], s83 offen offset:3072 lds
s_waitcnt vmcnt(4)
v_mfma_f32_16x16x32_bf16 v[116:119], a[244:247], v[24:27], v[116:119]
ds_read_b128 a[32:35], v2 offset:0
s_waitcnt lgkmcnt(10)
v_mfma_f32_16x16x32_bf16 v[64:67], a[248:251], v[56:59], v[64:67]
ds_read_b64_tr_b16 v[48:49], v18 offset:57344
ds_read_b128 a[36:39], v2 offset:2048
v_mfma_f32_16x16x32_bf16 v[68:71], a[252:255], v[56:59], v[68:71]
ds_read_b64_tr_b16 v[50:51], v18 offset:58368
ds_read_b128 a[48:51], v3 offset:0
v_mfma_f32_16x16x32_bf16 v[128:131], v[24:27], v[56:59], v[128:131]
ds_read_b128 a[52:55], v3 offset:2048
v_mfma_f32_16x16x32_bf16 v[120:123], a[248:251], a[248:251], v[120:123]
s_add_u32 m0, s77, 8192
s_add_u32 s76, s76, 128
v_mfma_f32_16x16x32_bf16 v[124:127], a[252:255], a[252:255], v[124:127]
s_and_b32 s76, s76, 0x380
s_add_u32 s82, s64, s76
v_mfma_f32_16x16x32_bf16 v[72:75], a[248:251], v[60:63], v[72:75]
ds_read_b64_tr_b16 v[52:53], v19 offset:57344
s_add_u32 s83, s66, s76
v_mfma_f32_16x16x32_bf16 v[76:79], a[252:255], v[60:63], v[76:79]
ds_read_b64_tr_b16 v[54:55], v19 offset:58368
buffer_load_dwordx4 v8, s[16:19], s82 offen offset:0 lds
v_mfma_f32_16x16x32_bf16 v[132:135], v[24:27], v[60:63], v[132:135]
v_mfma_f32_16x16x32_bf16 v[112:115], a[248:251], v[24:27], v[112:115]
v_mfma_f32_16x16x32_bf16 v[116:119], a[252:255], v[24:27], v[116:119]
s_waitcnt lgkmcnt(12)
v_mfma_f32_16x16x32_bf16 v[80:83], a[240:243], v[32:35], v[80:83]
ds_read_b64_tr_b16 v[56:57], v20 offset:57344
buffer_load_dwordx4 v9, s[16:19], s82 offen offset:1024 lds
v_mfma_f32_16x16x32_bf16 v[84:87], a[244:247], v[32:35], v[84:87]
ds_read_b64_tr_b16 v[58:59], v20 offset:58368
v_mfma_f32_16x16x32_bf16 v[88:91], a[240:243], v[36:39], v[88:91]
ds_read_b64_tr_b16 v[60:61], v21 offset:57344
v_mfma_f32_16x16x32_bf16 v[92:95], a[244:247], v[36:39], v[92:95]
ds_read_b64_tr_b16 v[62:63], v21 offset:58368
ds_write_b32 v30, v128
s_waitcnt lgkmcnt(13)
v_mfma_f32_16x16x32_bf16 v[96:99], a[240:243], v[40:43], v[96:99]
buffer_load_dwordx4 v10, s[16:19], s83 offen offset:2048 lds
ds_write_b32 v30, v132 offset:64
v_mfma_f32_16x16x32_bf16 v[100:103], a[244:247], v[40:43], v[100:103]
v_mfma_f32_16x16x32_bf16 v[104:107], a[240:243], v[44:47], v[104:107]
v_mfma_f32_16x16x32_bf16 v[108:111], a[244:247], v[44:47], v[108:111]
s_waitcnt lgkmcnt(0)
s_barrier
v_mfma_f32_16x16x32_bf16 v[80:83], a[248:251], v[48:51], v[80:83]
buffer_load_dwordx4 v11, s[16:19], s83 offen offset:3072 lds
s_lshl_b32 s84, s78, 6
v_add_u32 v30, s84, v29
v_mfma_f32_16x16x32_bf16 v[84:87], a[252:255], v[48:51], v[84:87]
ds_read_b32 v136, v30
ds_read_b32 v137, v30 offset:64
s_lshl_b32 s84, s79, 6
v_mfma_f32_16x16x32_bf16 v[88:91], a[248:251], v[52:55], v[88:91]
v_add_u32 v30, s84, v29
ds_read_b32 v138, v30
ds_read_b32 v139, v30 offset:64
v_mfma_f32_16x16x32_bf16 v[92:95], a[252:255], v[52:55], v[92:95]
s_lshl_b32 s84, s80, 6
v_add_u32 v30, s84, v29
v_mfma_f32_16x16x32_bf16 v[96:99], a[248:251], v[56:59], v[96:99]
ds_read_b32 v140, v30
ds_read_b32 v141, v30 offset:64
ds_bpermute_b32 v128, v31, v120 offset:0
v_mfma_f32_16x16x32_bf16 v[100:103], a[252:255], v[56:59], v[100:103]
ds_bpermute_b32 v129, v31, v121 offset:4
ds_bpermute_b32 v130, v31, v122 offset:8
ds_bpermute_b32 v131, v31, v123 offset:12
v_mfma_f32_16x16x32_bf16 v[104:107], a[248:251], v[60:63], v[104:107]
ds_bpermute_b32 v132, v31, v124 offset:0
ds_bpermute_b32 v133, v31, v125 offset:4
ds_bpermute_b32 v134, v31, v126 offset:8
v_mfma_f32_16x16x32_bf16 v[108:111], a[252:255], v[60:63], v[108:111]
ds_bpermute_b32 v135, v31, v127 offset:12
v_pk_mul_f32 v[112:113], v[112:113], s[86:87] op_sel_hi:[1,0]
v_pk_mul_f32 v[114:115], v[114:115], s[86:87] op_sel_hi:[1,0]
v_pk_mul_f32 v[116:117], v[116:117], s[86:87] op_sel_hi:[1,0]
v_pk_mul_f32 v[118:119], v[118:119], s[86:87] op_sel_hi:[1,0]
s_waitcnt lgkmcnt(6)
v_pk_mul_f32 v[128:129], v[128:129], s[86:87] op_sel_hi:[1,0]
s_waitcnt lgkmcnt(4)
v_pk_mul_f32 v[130:131], v[130:131], s[86:87] op_sel_hi:[1,0]
s_waitcnt lgkmcnt(2)
v_pk_mul_f32 v[132:133], v[132:133], s[86:87] op_sel_hi:[1,0]
s_waitcnt lgkmcnt(0)
v_pk_mul_f32 v[134:135], v[134:135], s[86:87] op_sel_hi:[1,0]
v_pk_fma_f32 v[128:129], v[112:113], v[112:113], v[128:129] neg_lo:[1,0,0] neg_hi:[1,0,0]
v_pk_fma_f32 v[130:131], v[114:115], v[114:115], v[130:131] neg_lo:[1,0,0] neg_hi:[1,0,0]
v_pk_fma_f32 v[132:133], v[116:117], v[116:117], v[132:133] neg_lo:[1,0,0] neg_hi:[1,0,0]
v_pk_fma_f32 v[134:135], v[118:119], v[118:119], v[134:135] neg_lo:[1,0,0] neg_hi:[1,0,0]
v_max_f32 v128, 0, v128
v_max_f32 v129, 0, v129
v_max_f32 v130, 0, v130
v_max_f32 v131, 0, v131
v_max_f32 v132, 0, v132
v_max_f32 v133, 0, v133
v_max_f32 v134, 0, v134
v_max_f32 v135, 0, v135
v_pk_add_f32 v[128:129], v[128:129], s[86:87] op_sel:[0,1] op_sel_hi:[1,1]
v_pk_add_f32 v[130:131], v[130:131], s[86:87] op_sel:[0,1] op_sel_hi:[1,1]
v_pk_add_f32 v[132:133], v[132:133], s[86:87] op_sel:[0,1] op_sel_hi:[1,1]
v_pk_add_f32 v[134:135], v[134:135], s[86:87] op_sel:[0,1] op_sel_hi:[1,1]
v_rsq_f32 v128, v128
v_rsq_f32 v129, v129
v_rsq_f32 v130, v130
v_rsq_f32 v131, v131
v_rsq_f32 v132, v132
v_rsq_f32 v133, v133
v_rsq_f32 v134, v134
v_rsq_f32 v135, v135
v_pk_mul_f32 v[112:113], v[112:113], v[128:129]
v_pk_mul_f32 v[114:115], v[114:115], v[130:131]
v_pk_mul_f32 v[116:117], v[116:117], v[132:133]
v_pk_mul_f32 v[118:119], v[118:119], v[134:135]
v_readfirstlane_b32 s73, v28
s_nop 1
s_cmp_eq_u32 s73, 0
s_cbranch_scc1 L_tagslow_7
L_tagret_8:
v_cndmask_b32 v52, v128, v129, s[92:93]
v_cndmask_b32 v53, v130, v131, s[92:93]
v_cndmask_b32 v54, v132, v133, s[92:93]
v_cndmask_b32 v55, v134, v135, s[92:93]
s_mov_b32 vcc_lo, 0xf0f0f0f0
s_mov_b32 vcc_hi, 0xf0f0f0f0
v_cndmask_b32 v52, v52, v53, s[94:95]
v_cndmask_b32 v54, v54, v55, s[94:95]
v_cndmask_b32 v48, v52, v54, vcc
v_mov_b32 v49, s73
v_cndmask_b32 v52, v112, v113, s[92:93]
v_cndmask_b32 v53, v114, v115, s[92:93]
v_cndmask_b32 v54, v116, v117, s[92:93]
v_cndmask_b32 v55, v118, v119, s[92:93]
v_cndmask_b32 v52, v52, v53, s[94:95]
v_cndmask_b32 v54, v54, v55, s[94:95]
v_cndmask_b32 v50, v52, v54, vcc
v_mov_b32 v51, s73
v_bfe_u32 v29, v0, 2, 1
v_lshrrev_b32 v30, 4, v0
v_lshl_add_u32 v29, v29, 2, v30
v_and_b32 v30, 3, v0
v_lshl_add_u32 v29, v29, 2, v30
v_lshlrev_b32 v29, 4, v29
s_lshr_b32 s84, s46, 2
s_lshl_b32 s84, s84, 6
s_lshl_b32 s85, s45, 2
s_add_u32 s84, s84, s85
s_add_u32 s84, s84, s44
s_lshl_b32 s84, s84, 9
s_add_u32 s84, s84, 0xc0000
s_bitcmp1_b32 s46, 0
s_cselect_b32 s84, s84, 0x40000000
buffer_store_dwordx4 v[48:51], v29, s[20:23], s84 offen sc1
v_pk_mul_f32 v[32:33], v[112:113], v[136:137] op_sel_hi:[1,0]
s_sub_u32 s12, s12, s75
s_subb_u32 s13, s13, 0
v_pk_mul_f32 v[34:35], v[114:115], v[136:137] op_sel_hi:[1,0]
s_add_u32 s14, s14, s75
v_pk_mul_f32 v[36:37], v[116:117], v[136:137] op_sel_hi:[1,0]
s_add_u32 m0, s74, 0
v_pk_mul_f32 v[38:39], v[118:119], v[136:137] op_sel_hi:[1,0]
s_mul_i32 s82, s72, 1792
v_pk_fma_f32 v[64:65], v[64:65], v[128:129], v[32:33] neg_lo:[0,0,1] neg_hi:[0,0,1]
buffer_load_dwordx4 v12, s[12:15], s82 offen offset:0 lds
v_pk_fma_f32 v[66:67], v[66:67], v[130:131], v[34:35] neg_lo:[0,0,1] neg_hi:[0,0,1]
v_pk_fma_f32 v[68:69], v[68:69], v[132:133], v[36:37] neg_lo:[0,0,1] neg_hi:[0,0,1]
v_pk_fma_f32 v[70:71], v[70:71], v[134:135], v[38:39] neg_lo:[0,0,1] neg_hi:[0,0,1]
v_pk_mul_f32 v[32:33], v[64:65], v[64:65]
v_pk_mul_f32 v[34:35], v[66:67], v[66:67]
v_pk_mul_f32 v[36:37], v[68:69], v[68:69]
v_pk_mul_f32 v[38:39], v[70:71], v[70:71]
v_pk_fma_f32 v[32:33], v[32:33], s[90:91], s[90:91] op_sel:[0,0,1] op_sel_hi:[1,0,1]
v_pk_fma_f32 v[34:35], v[34:35], s[90:91], s[90:91] op_sel:[0,0,1] op_sel_hi:[1,0,1]
v_pk_fma_f32 v[36:37], v[36:37], s[90:91], s[90:91] op_sel:[0,0,1] op_sel_hi:[1,0,1]
v_pk_fma_f32 v[38:39], v[38:39], s[90:91], s[90:91] op_sel:[0,0,1] op_sel_hi:[1,0,1]
v_pk_mul_f32 v[32:33], v[32:33], v[64:65]
v_pk_mul_f32 v[34:35], v[34:35], v[66:67]
v_pk_mul_f32 v[36:37], v[36:37], v[68:69]
buffer_load_dwordx4 v13, s[12:15], s82 offen offset:1024 lds
v_pk_mul_f32 v[38:39], v[38:39], v[70:71]
v_exp_f32 v32, v32
v_exp_f32 v33, v33
v_exp_f32 v34, v34
v_exp_f32 v35, v35
v_exp_f32 v36, v36
v_exp_f32 v37, v37
v_exp_f32 v38, v38
buffer_load_dwordx4 v14, s[12:15], s82 offen offset:2048 lds
v_exp_f32 v39, v39
v_pk_add_f32 v[32:33], v[32:33], 1.0 op_sel_hi:[1,0]
v_pk_add_f32 v[34:35], v[34:35], 1.0 op_sel_hi:[1,0]
v_pk_add_f32 v[36:37], v[36:37], 1.0 op_sel_hi:[1,0]
v_pk_add_f32 v[38:39], v[38:39], 1.0 op_sel_hi:[1,0]
v_rcp_f32 v32, v32
v_rcp_f32 v33, v33
v_rcp_f32 v34, v34
v_rcp_f32 v35, v35
v_rcp_f32 v36, v36
buffer_load_dwordx4 v15, s[12:15], s82 offen offset:3072 lds
v_rcp_f32 v37, v37
s_add_u32 s72, s72, 128
v_rcp_f32 v38, v38
s_and_b32 s72, s72, 0x380
v_rcp_f32 v39, v39
s_add_u32 m0, s77, 12288
v_pk_mul_f32 v[64:65], v[64:65], v[32:33]
s_add_u32 s82, s65, s76
v_pk_mul_f32 v[66:67], v[66:67], v[34:35]
s_add_u32 s83, s67, s76
v_pk_mul_f32 v[68:69], v[68:69], v[36:37]
buffer_load_dwordx4 v8, s[16:19], s82 offen offset:0 lds
v_pk_mul_f32 v[70:71], v[70:71], v[38:39]
v_pk_mul_f32 v[152:153], v[64:65], v[64:65]
v_pk_mul_f32 v[154:155], v[66:67], v[66:67]
v_pk_mul_f32 v[156:157], v[68:69], v[68:69]
v_pk_mul_f32 v[158:159], v[70:71], v[70:71]
v_pk_mul_f32 v[40:41], v[112:113], v[136:137] op_sel:[0,1] op_sel_hi:[1,1]
v_pk_mul_f32 v[42:43], v[114:115], v[136:137] op_sel:[0,1] op_sel_hi:[1,1]
v_pk_mul_f32 v[44:45], v[116:117], v[136:137] op_sel:[0,1] op_sel_hi:[1,1]
v_pk_mul_f32 v[46:47], v[118:119], v[136:137] op_sel:[0,1] op_sel_hi:[1,1]
v_pk_fma_f32 v[72:73], v[72:73], v[128:129], v[40:41] neg_lo:[0,0,1] neg_hi:[0,0,1]
v_pk_fma_f32 v[74:75], v[74:75], v[130:131], v[42:43] neg_lo:[0,0,1] neg_hi:[0,0,1]
v_pk_fma_f32 v[76:77], v[76:77], v[132:133], v[44:45] neg_lo:[0,0,1] neg_hi:[0,0,1]
v_pk_fma_f32 v[78:79], v[78:79], v[134:135], v[46:47] neg_lo:[0,0,1] neg_hi:[0,0,1]
v_pk_mul_f32 v[40:41], v[72:73], v[72:73]
buffer_load_dwordx4 v9, s[16:19], s82 offen offset:1024 lds
v_pk_mul_f32 v[42:43], v[74:75], v[74:75]
v_pk_mul_f32 v[44:45], v[76:77], v[76:77]
v_pk_mul_f32 v[46:47], v[78:79], v[78:79]
v_pk_fma_f32 v[40:41], v[40:41], s[90:91], s[90:91] op_sel:[0,0,1] op_sel_hi:[1,0,1]
v_pk_fma_f32 v[42:43], v[42:43], s[90:91], s[90:91] op_sel:[0,0,1] op_sel_hi:[1,0,1]
v_pk_fma_f32 v[44:45], v[44:45], s[90:91], s[90:91] op_sel:[0,0,1] op_sel_hi:[1,0,1]
v_pk_fma_f32 v[46:47], v[46:47], s[90:91], s[90:91] op_sel:[0,0,1] op_sel_hi:[1,0,1]
v_pk_mul_f32 v[40:41], v[40:41], v[72:73]
v_pk_mul_f32 v[42:43], v[42:43], v[74:75]
v_pk_mul_f32 v[44:45], v[44:45], v[76:77]
v_pk_mul_f32 v[46:47], v[46:47], v[78:79]
v_exp_f32 v40, v40
v_exp_f32 v41, v41
buffer_load_dwordx4 v10, s[16:19], s83 offen offset:2048 lds
v_exp_f32 v42, v42
v_exp_f32 v43, v43
v_exp_f32 v44, v44
v_exp_f32 v45, v45
v_exp_f32 v46, v46
v_exp_f32 v47, v47
v_pk_add_f32 v[40:41], v[40:41], 1.0 op_sel_hi:[1,0]
v_pk_add_f32 v[42:43], v[42:43], 1.0 op_sel_hi:[1,0]
v_pk_add_f32 v[44:45], v[44:45], 1.0 op_sel_hi:[1,0]
buffer_load_dwordx4 v11, s[16:19], s83 offen offset:3072 lds
v_pk_add_f32 v[46:47], v[46:47], 1.0 op_sel_hi:[1,0]
s_waitcnt vmcnt(13)
ds_read_b128 a[40:43], v2 offset:4096
v_rcp_f32 v40, v40
ds_read_b128 a[44:47], v2 offset:6144
v_rcp_f32 v41, v41
ds_read_b128 a[56:59], v3 offset:4096
v_rcp_f32 v42, v42
ds_read_b128 a[60:63], v3 offset:6144
v_rcp_f32 v43, v43
s_add_u32 m0, s77, 16384
v_rcp_f32 v44, v44
s_add_u32 s76, s76, 128
v_rcp_f32 v45, v45
s_and_b32 s76, s76, 0x380
v_rcp_f32 v46, v46
s_add_u32 s82, s64, s76
v_rcp_f32 v47, v47
s_add_u32 s83, s66, s76
v_pk_mul_f32 v[72:73], v[72:73], v[40:41]
buffer_load_dwordx4 v8, s[16:19], s82 offen offset:0 lds
v_pk_mul_f32 v[74:75], v[74:75], v[42:43]
v_pk_mul_f32 v[76:77], v[76:77], v[44:45]
v_pk_mul_f32 v[78:79], v[78:79], v[46:47]
v_pk_fma_f32 v[152:153], v[72:73], v[72:73], v[152:153]
v_pk_add_f32 v[144:145], v[72:73], v[64:65]
v_pk_fma_f32 v[154:155], v[74:75], v[74:75], v[154:155]
v_pk_add_f32 v[146:147], v[74:75], v[66:67]
v_pk_fma_f32 v[156:157], v[76:77], v[76:77], v[156:157]
v_pk_add_f32 v[148:149], v[76:77], v[68:69]
v_pk_fma_f32 v[158:159], v[78:79], v[78:79], v[158:159]
v_pk_add_f32 v[150:151], v[78:79], v[70:71]
v_pk_mul_f32 v[32:33], v[112:113], v[138:139] op_sel_hi:[1,0]
v_pk_mul_f32 v[34:35], v[114:115], v[138:139] op_sel_hi:[1,0]
v_pk_mul_f32 v[36:37], v[116:117], v[138:139] op_sel_hi:[1,0]
buffer_load_dwordx4 v9, s[16:19], s82 offen offset:1024 lds
v_pk_mul_f32 v[38:39], v[118:119], v[138:139] op_sel_hi:[1,0]
v_pk_fma_f32 v[80:81], v[80:81], v[128:129], v[32:33] neg_lo:[0,0,1] neg_hi:[0,0,1]
v_pk_fma_f32 v[82:83], v[82:83], v[130:131], v[34:35] neg_lo:[0,0,1] neg_hi:[0,0,1]
v_pk_fma_f32 v[84:85], v[84:85], v[132:133], v[36:37] neg_lo:[0,0,1] neg_hi:[0,0,1]
v_pk_fma_f32 v[86:87], v[86:87], v[134:135], v[38:39] neg_lo:[0,0,1] neg_hi:[0,0,1]
v_pk_mul_f32 v[32:33], v[80:81], v[80:81]
v_pk_mul_f32 v[34:35], v[82:83], v[82:83]
v_pk_mul_f32 v[36:37], v[84:85], v[84:85]
v_pk_mul_f32 v[38:39], v[86:87], v[86:87]
v_pk_fma_f32 v[32:33], v[32:33], s[90:91], s[90:91] op_sel:[0,0,1] op_sel_hi:[1,0,1]
v_pk_fma_f32 v[34:35], v[34:35], s[90:91], s[90:91] op_sel:[0,0,1] op_sel_hi:[1,0,1]
v_pk_fma_f32 v[36:37], v[36:37], s[90:91], s[90:91] op_sel:[0,0,1] op_sel_hi:[1,0,1]
v_pk_fma_f32 v[38:39], v[38:39], s[90:91], s[90:91] op_sel:[0,0,1] op_sel_hi:[1,0,1]
v_pk_mul_f32 v[32:33], v[32:33], v[80:81]
buffer_load_dwordx4 v10, s[16:19], s83 offen offset:2048 lds
v_pk_mul_f32 v[34:35], v[34:35], v[82:83]
v_pk_mul_f32 v[36:37], v[36:37], v[84:85]
v_pk_mul_f32 v[38:39], v[38:39], v[86:87]
v_exp_f32 v32, v32
v_exp_f32 v33, v33
v_exp_f32 v34, v34
v_exp_f32 v35, v35
v_exp_f32 v36, v36
v_exp_f32 v37, v37
buffer_load_dwordx4 v11, s[16:19], s83 offen offset:3072 lds
v_exp_f32 v38, v38
s_waitcnt vmcnt(13)
ds_read_b128 a[64:67], v2 offset:8192
v_exp_f32 v39, v39
ds_read_b128 a[68:71], v2 offset:10240
v_pk_add_f32 v[32:33], v[32:33], 1.0 op_sel_hi:[1,0]
ds_read_b128 a[80:83], v3 offset:8192
v_pk_add_f32 v[34:35], v[34:35], 1.0 op_sel_hi:[1,0]
ds_read_b128 a[84:87], v3 offset:10240
v_pk_add_f32 v[36:37], v[36:37], 1.0 op_sel_hi:[1,0]
s_add_u32 m0, s77, 0
v_pk_add_f32 v[38:39], v[38:39], 1.0 op_sel_hi:[1,0]
s_add_u32 s82, s65, s76
v_rcp_f32 v32, v32
s_add_u32 s83, s67, s76
v_rcp_f32 v33, v33
buffer_load_dwordx4 v8, s[16:19], s82 offen offset:0 lds
v_rcp_f32 v34, v34
v_rcp_f32 v35, v35
v_rcp_f32 v36, v36
v_rcp_f32 v37, v37
v_rcp_f32 v38, v38
v_rcp_f32 v39, v39
v_pk_mul_f32 v[80:81], v[80:81], v[32:33]
v_pk_mul_f32 v[82:83], v[82:83], v[34:35]
v_pk_mul_f32 v[84:85], v[84:85], v[36:37]
buffer_load_dwordx4 v9, s[16:19], s82 offen offset:1024 lds
v_pk_mul_f32 v[86:87], v[86:87], v[38:39]
v_pk_fma_f32 v[152:153], v[80:81], v[80:81], v[152:153]
v_pk_add_f32 v[144:145], v[80:81], v[144:145]
v_pk_fma_f32 v[154:155], v[82:83], v[82:83], v[154:155]
v_pk_add_f32 v[146:147], v[82:83], v[146:147]
v_pk_fma_f32 v[156:157], v[84:85], v[84:85], v[156:157]
v_pk_add_f32 v[148:149], v[84:85], v[148:149]
v_pk_fma_f32 v[158:159], v[86:87], v[86:87], v[158:159]
v_pk_add_f32 v[150:151], v[86:87], v[150:151]
v_pk_mul_f32 v[40:41], v[112:113], v[138:139] op_sel:[0,1] op_sel_hi:[1,1]
v_pk_mul_f32 v[42:43], v[114:115], v[138:139] op_sel:[0,1] op_sel_hi:[1,1]
v_pk_mul_f32 v[44:45], v[116:117], v[138:139] op_sel:[0,1] op_sel_hi:[1,1]
v_pk_mul_f32 v[46:47], v[118:119], v[138:139] op_sel:[0,1] op_sel_hi:[1,1]
v_pk_fma_f32 v[88:89], v[88:89], v[128:129], v[40:41] neg_lo:[0,0,1] neg_hi:[0,0,1]
buffer_load_dwordx4 v10, s[16:19], s83 offen offset:2048 lds
v_pk_fma_f32 v[90:91], v[90:91], v[130:131], v[42:43] neg_lo:[0,0,1] neg_hi:[0,0,1]
v_pk_fma_f32 v[92:93], v[92:93], v[132:133], v[44:45] neg_lo:[0,0,1] neg_hi:[0,0,1]
v_pk_fma_f32 v[94:95], v[94:95], v[134:135], v[46:47] neg_lo:[0,0,1] neg_hi:[0,0,1]
v_pk_mul_f32 v[40:41], v[88:89], v[88:89]
v_pk_mul_f32 v[42:43], v[90:91], v[90:91]
v_pk_mul_f32 v[44:45], v[92:93], v[92:93]
v_pk_mul_f32 v[46:47], v[94:95], v[94:95]
v_pk_fma_f32 v[40:41], v[40:41], s[90:91], s[90:91] op_sel:[0,0,1] op_sel_hi:[1,0,1]
v_pk_fma_f32 v[42:43], v[42:43], s[90:91], s[90:91] op_sel:[0,0,1] op_sel_hi:[1,0,1]
v_pk_fma_f32 v[44:45], v[44:45], s[90:91], s[90:91] op_sel:[0,0,1] op_sel_hi:[1,0,1]
v_pk_fma_f32 v[46:47], v[46:47], s[90:91], s[90:91] op_sel:[0,0,1] op_sel_hi:[1,0,1]
v_pk_mul_f32 v[40:41], v[40:41], v[88:89]
v_pk_mul_f32 v[42:43], v[42:43], v[90:91]
v_pk_mul_f32 v[44:45], v[44:45], v[92:93]
buffer_load_dwordx4 v11, s[16:19], s83 offen offset:3072 lds
v_pk_mul_f32 v[46:47], v[46:47], v[94:95]
s_add_u32 m0, s74, 16384
v_exp_f32 v40, v40
s_mul_i32 s82, s72, 1792
v_exp_f32 v41, v41
v_exp_f32 v42, v42
v_exp_f32 v43, v43
v_exp_f32 v44, v44
v_exp_f32 v45, v45
buffer_load_dwordx4 v12, s[12:15], s82 offen offset:0 lds
v_exp_f32 v46, v46
v_exp_f32 v47, v47
v_pk_add_f32 v[40:41], v[40:41], 1.0 op_sel_hi:[1,0]
v_pk_add_f32 v[42:43], v[42:43], 1.0 op_sel_hi:[1,0]
v_pk_add_f32 v[44:45], v[44:45], 1.0 op_sel_hi:[1,0]
v_pk_add_f32 v[46:47], v[46:47], 1.0 op_sel_hi:[1,0]
v_rcp_f32 v40, v40
v_rcp_f32 v41, v41
v_rcp_f32 v42, v42
v_rcp_f32 v43, v43
buffer_load_dwordx4 v13, s[12:15], s82 offen offset:1024 lds
v_rcp_f32 v44, v44
v_rcp_f32 v45, v45
v_rcp_f32 v46, v46
v_rcp_f32 v47, v47
v_pk_mul_f32 v[88:89], v[88:89], v[40:41]
v_pk_mul_f32 v[90:91], v[90:91], v[42:43]
v_pk_mul_f32 v[92:93], v[92:93], v[44:45]
v_pk_mul_f32 v[94:95], v[94:95], v[46:47]
v_pk_fma_f32 v[152:153], v[88:89], v[88:89], v[152:153]
v_pk_add_f32 v[144:145], v[88:89], v[144:145]
buffer_load_dwordx4 v14, s[12:15], s82 offen offset:2048 lds
v_pk_fma_f32 v[154:155], v[90:91], v[90:91], v[154:155]
v_pk_add_f32 v[146:147], v[90:91], v[146:147]
v_pk_fma_f32 v[156:157], v[92:93], v[92:93], v[156:157]
v_pk_add_f32 v[148:149], v[92:93], v[148:149]
v_pk_fma_f32 v[158:159], v[94:95], v[94:95], v[158:159]
v_pk_add_f32 v[150:151], v[94:95], v[150:151]
v_pk_mul_f32 v[32:33], v[112:113], v[140:141] op_sel_hi:[1,0]
v_pk_mul_f32 v[34:35], v[114:115], v[140:141] op_sel_hi:[1,0]
v_pk_mul_f32 v[36:37], v[116:117], v[140:141] op_sel_hi:[1,0]
v_pk_mul_f32 v[38:39], v[118:119], v[140:141] op_sel_hi:[1,0]
v_pk_fma_f32 v[96:97], v[96:97], v[128:129], v[32:33] neg_lo:[0,0,1] neg_hi:[0,0,1]
v_pk_fma_f32 v[98:99], v[98:99], v[130:131], v[34:35] neg_lo:[0,0,1] neg_hi:[0,0,1]
v_pk_fma_f32 v[100:101], v[100:101], v[132:133], v[36:37] neg_lo:[0,0,1] neg_hi:[0,0,1]
v_pk_fma_f32 v[102:103], v[102:103], v[134:135], v[38:39] neg_lo:[0,0,1] neg_hi:[0,0,1]
buffer_load_dwordx4 v15, s[12:15], s82 offen offset:3072 lds
v_pk_mul_f32 v[32:33], v[96:97], v[96:97]
s_add_u32 s72, s72, 128
v_pk_mul_f32 v[34:35], v[98:99], v[98:99]
s_and_b32 s72, s72, 0x380
v_pk_mul_f32 v[36:37], v[100:101], v[100:101]
v_pk_mul_f32 v[38:39], v[102:103], v[102:103]
v_pk_fma_f32 v[32:33], v[32:33], s[90:91], s[90:91] op_sel:[0,0,1] op_sel_hi:[1,0,1]
v_pk_fma_f32 v[34:35], v[34:35], s[90:91], s[90:91] op_sel:[0,0,1] op_sel_hi:[1,0,1]
v_pk_fma_f32 v[36:37], v[36:37], s[90:91], s[90:91] op_sel:[0,0,1] op_sel_hi:[1,0,1]
v_pk_fma_f32 v[38:39], v[38:39], s[90:91], s[90:91] op_sel:[0,0,1] op_sel_hi:[1,0,1]
v_pk_mul_f32 v[32:33], v[32:33], v[96:97]
v_pk_mul_f32 v[34:35], v[34:35], v[98:99]
v_pk_mul_f32 v[36:37], v[36:37], v[100:101]
v_pk_mul_f32 v[38:39], v[38:39], v[102:103]
v_exp_f32 v32, v32
v_exp_f32 v33, v33
v_exp_f32 v34, v34
v_exp_f32 v35, v35
v_exp_f32 v36, v36
v_exp_f32 v37, v37
v_exp_f32 v38, v38
v_exp_f32 v39, v39
v_pk_add_f32 v[32:33], v[32:33], 1.0 op_sel_hi:[1,0]
v_pk_add_f32 v[34:35], v[34:35], 1.0 op_sel_hi:[1,0]
v_pk_add_f32 v[36:37], v[36:37], 1.0 op_sel_hi:[1,0]
v_pk_add_f32 v[38:39], v[38:39], 1.0 op_sel_hi:[1,0]
v_rcp_f32 v32, v32
v_rcp_f32 v33, v33
v_rcp_f32 v34, v34
v_rcp_f32 v35, v35
v_rcp_f32 v36, v36
v_rcp_f32 v37, v37
v_rcp_f32 v38, v38
v_rcp_f32 v39, v39
v_pk_mul_f32 v[96:97], v[96:97], v[32:33]
v_pk_mul_f32 v[98:99], v[98:99], v[34:35]
v_pk_mul_f32 v[100:101], v[100:101], v[36:37]
v_pk_mul_f32 v[102:103], v[102:103], v[38:39]
v_pk_fma_f32 v[152:153], v[96:97], v[96:97], v[152:153]
v_pk_add_f32 v[144:145], v[96:97], v[144:145]
v_pk_fma_f32 v[154:155], v[98:99], v[98:99], v[154:155]
v_pk_add_f32 v[146:147], v[98:99], v[146:147]
v_pk_fma_f32 v[156:157], v[100:101], v[100:101], v[156:157]
v_pk_add_f32 v[148:149], v[100:101], v[148:149]
v_pk_fma_f32 v[158:159], v[102:103], v[102:103], v[158:159]
v_pk_add_f32 v[150:151], v[102:103], v[150:151]
v_pk_mul_f32 v[40:41], v[112:113], v[140:141] op_sel:[0,1] op_sel_hi:[1,1]
v_pk_mul_f32 v[42:43], v[114:115], v[140:141] op_sel:[0,1] op_sel_hi:[1,1]
v_pk_mul_f32 v[44:45], v[116:117], v[140:141] op_sel:[0,1] op_sel_hi:[1,1]
v_pk_mul_f32 v[46:47], v[118:119], v[140:141] op_sel:[0,1] op_sel_hi:[1,1]
v_pk_fma_f32 v[104:105], v[104:105], v[128:129], v[40:41] neg_lo:[0,0,1] neg_hi:[0,0,1]
v_pk_fma_f32 v[106:107], v[106:107], v[130:131], v[42:43] neg_lo:[0,0,1] neg_hi:[0,0,1]
v_pk_fma_f32 v[108:109], v[108:109], v[132:133], v[44:45] neg_lo:[0,0,1] neg_hi:[0,0,1]
v_pk_fma_f32 v[110:111], v[110:111], v[134:135], v[46:47] neg_lo:[0,0,1] neg_hi:[0,0,1]
v_pk_mul_f32 v[40:41], v[104:105], v[104:105]
v_pk_mul_f32 v[42:43], v[106:107], v[106:107]
v_pk_mul_f32 v[44:45], v[108:109], v[108:109]
v_pk_mul_f32 v[46:47], v[110:111], v[110:111]
v_pk_fma_f32 v[40:41], v[40:41], s[90:91], s[90:91] op_sel:[0,0,1] op_sel_hi:[1,0,1]
v_pk_fma_f32 v[42:43], v[42:43], s[90:91], s[90:91] op_sel:[0,0,1] op_sel_hi:[1,0,1]
v_pk_fma_f32 v[44:45], v[44:45], s[90:91], s[90:91] op_sel:[0,0,1] op_sel_hi:[1,0,1]
v_pk_fma_f32 v[46:47], v[46:47], s[90:91], s[90:91] op_sel:[0,0,1] op_sel_hi:[1,0,1]
v_pk_mul_f32 v[40:41], v[40:41], v[104:105]
v_pk_mul_f32 v[42:43], v[42:43], v[106:107]
v_pk_mul_f32 v[44:45], v[44:45], v[108:109]
v_pk_mul_f32 v[46:47], v[46:47], v[110:111]
v_exp_f32 v40, v40
v_exp_f32 v41, v41
v_exp_f32 v42, v42
v_exp_f32 v43, v43
v_exp_f32 v44, v44
v_exp_f32 v45, v45
v_exp_f32 v46, v46
v_exp_f32 v47, v47
v_pk_add_f32 v[40:41], v[40:41], 1.0 op_sel_hi:[1,0]
v_pk_add_f32 v[42:43], v[42:43], 1.0 op_sel_hi:[1,0]
v_pk_add_f32 v[44:45], v[44:45], 1.0 op_sel_hi:[1,0]
v_pk_add_f32 v[46:47], v[46:47], 1.0 op_sel_hi:[1,0]
v_rcp_f32 v40, v40
v_rcp_f32 v41, v41
v_rcp_f32 v42, v42
v_rcp_f32 v43, v43
v_rcp_f32 v44, v44
v_rcp_f32 v45, v45
v_rcp_f32 v46, v46
v_rcp_f32 v47, v47
v_pk_mul_f32 v[104:105], v[104:105], v[40:41]
v_pk_mul_f32 v[106:107], v[106:107], v[42:43]
v_pk_mul_f32 v[108:109], v[108:109], v[44:45]
v_pk_mul_f32 v[110:111], v[110:111], v[46:47]
v_pk_fma_f32 v[152:153], v[104:105], v[104:105], v[152:153]
v_pk_add_f32 v[144:145], v[104:105], v[144:145]
v_pk_fma_f32 v[154:155], v[106:107], v[106:107], v[154:155]
v_pk_add_f32 v[146:147], v[106:107], v[146:147]
v_pk_fma_f32 v[156:157], v[108:109], v[108:109], v[156:157]
v_pk_add_f32 v[148:149], v[108:109], v[148:149]
v_pk_fma_f32 v[158:159], v[110:111], v[110:111], v[158:159]
v_pk_add_f32 v[150:151], v[110:111], v[150:151]
v_add_f32_dpp v32, v144, v144 row_ror:8 row_mask:0xf bank_mask:0x3
v_add_f32_dpp v33, v145, v145 row_ror:8 row_mask:0xf bank_mask:0x3
v_add_f32_dpp v34, v146, v146 row_ror:8 row_mask:0xf bank_mask:0x3
v_add_f32_dpp v35, v147, v147 row_ror:8 row_mask:0xf bank_mask:0x3
v_add_f32_dpp v36, v152, v152 row_ror:8 row_mask:0xf bank_mask:0x3
v_add_f32_dpp v37, v153, v153 row_ror:8 row_mask:0xf bank_mask:0x3
v_add_f32_dpp v38, v154, v154 row_ror:8 row_mask:0xf bank_mask:0x3
v_add_f32_dpp v39, v155, v155 row_ror:8 row_mask:0xf bank_mask:0x3
v_mov_b32 v28, s73
v_add_f32_dpp v32, v148, v148 row_ror:8 row_mask:0xf bank_mask:0xc
v_add_f32_dpp v33, v149, v149 row_ror:8 row_mask:0xf bank_mask:0xc
v_add_f32_dpp v34, v150, v150 row_ror:8 row_mask:0xf bank_mask:0xc
v_add_f32_dpp v35, v151, v151 row_ror:8 row_mask:0xf bank_mask:0xc
v_add_f32_dpp v36, v156, v156 row_ror:8 row_mask:0xf bank_mask:0xc
v_add_f32_dpp v37, v157, v157 row_ror:8 row_mask:0xf bank_mask:0xc
v_add_f32_dpp v38, v158, v158 row_ror:8 row_mask:0xf bank_mask:0xc
v_add_f32_dpp v39, v159, v159 row_ror:8 row_mask:0xf bank_mask:0xc
v_add_f32_dpp v40, v32, v32 row_ror:12 row_mask:0xf bank_mask:0x5
v_add_f32_dpp v41, v33, v33 row_ror:12 row_mask:0xf bank_mask:0x5
v_add_f32_dpp v42, v36, v36 row_ror:12 row_mask:0xf bank_mask:0x5
v_add_f32_dpp v43, v37, v37 row_ror:12 row_mask:0xf bank_mask:0x5
v_bfe_u32 v29, v0, 3, 1
v_lshlrev_b32 v29, 4, v29
v_add_f32_dpp v40, v34, v34 row_ror:4 row_mask:0xf bank_mask:0xa
v_add_f32_dpp v41, v35, v35 row_ror:4 row_mask:0xf bank_mask:0xa
v_add_f32_dpp v42, v38, v38 row_ror:4 row_mask:0xf bank_mask:0xa
v_add_f32_dpp v43, v39, v39 row_ror:4 row_mask:0xf bank_mask:0xa
v_bfe_u32 v30, v0, 4, 2
v_lshl_add_u32 v29, v30, 2, v29
v_mov_b32 v45, v28
v_add_f32_dpp v40, v40, v40 quad_perm:[1,0,3,2] row_mask:0xf bank_mask:0xf
v_add_f32_dpp v41, v41, v41 quad_perm:[1,0,3,2] row_mask:0xf bank_mask:0xf
v_add_f32_dpp v42, v42, v42 quad_perm:[1,0,3,2] row_mask:0xf bank_mask:0xf
v_add_f32_dpp v43, v43, v43 quad_perm:[1,0,3,2] row_mask:0xf bank_mask:0xf
v_bfe_u32 v30, v0, 2, 1
v_lshl_add_u32 v29, v30, 1, v29
v_add_f32_dpp v40, v40, v40 quad_perm:[2,3,0,1] row_mask:0xf bank_mask:0xf
v_add_f32_dpp v41, v41, v41 quad_perm:[2,3,0,1] row_mask:0xf bank_mask:0xf
v_add_f32_dpp v42, v42, v42 quad_perm:[2,3,0,1] row_mask:0xf bank_mask:0xf
v_add_f32_dpp v43, v43, v43 quad_perm:[2,3,0,1] row_mask:0xf bank_mask:0xf
v_and_b32 v30, 1, v0
v_add_u32 v29, v29, v30
v_lshlrev_b32 v29, 4, v29
v_mov_b32 v47, v28
v_cndmask_b32 v44, v40, v41, s[92:93]
v_cndmask_b32 v46, v42, v43, s[92:93]
s_lshl_b32 s84, s45, 14
s_lshl_b32 s85, s44, 9
s_add_u32 s0, s84, s85
s_add_u32 s0, s0, 0x20000
s_lshl_b32 s85, s46, 11
s_add_u32 s84, s85, s0
s_add_u32 s85, s84, 0x40000
buffer_store_dwordx4 v[44:47], v29, s[20:23], s85 offen sc1
v_and_b32 v30, 15, v0
v_lshrrev_b32 v31, 2, v30
v_lshl_add_u32 v31, v31, 4, v30
v_lshlrev_b32 v31, 2, v31
v_cndmask_b32 v32, v128, v129, s[92:93]
v_cndmask_b32 v33, v130, v131, s[92:93]
v_cndmask_b32 v32, v32, v33, s[94:95]
ds_bpermute_b32 v184, v31, v32
v_cndmask_b32 v34, v112, v113, s[92:93]
v_cndmask_b32 v35, v114, v115, s[92:93]
v_cndmask_b32 v34, v34, v35, s[94:95]
ds_bpermute_b32 v185, v31, v34
v_cndmask_b32 v32, v132, v133, s[92:93]
v_cndmask_b32 v33, v134, v135, s[92:93]
v_cndmask_b32 v32, v32, v33, s[94:95]
ds_bpermute_b32 v186, v31, v32
v_cndmask_b32 v34, v116, v117, s[92:93]
v_cndmask_b32 v35, v118, v119, s[92:93]
v_cndmask_b32 v34, v34, v35, s[94:95]
ds_bpermute_b32 v187, v31, v34
s_lshl_b32 s84, s78, 10
v_add_u32 v4, s84, v1
s_lshl_b32 s84, s79, 10
v_add_u32 v5, s84, v1
s_lshl_b32 s84, s80, 10
v_add_u32 v6, s84, v1
v_bfe_u32 v29, v0, 2, 2
v_lshrrev_b32 v30, 4, v0
v_lshl_add_u32 v31, v30, 3, v29
v_lshlrev_b32 v31, 8, v31
v_and_b32 v30, 1, v30
v_lshl_or_b32 v29, v30, 2, v29
v_and_b32 v30, 3, v0
v_lshl_or_b32 v31, v30, 3, v31
s_and_b32 s97, s101, 3
s_add_u32 s84, s44, 0
s_cmp_ge_u32 s84, 4
s_cselect_b32 s85, 4, 0
s_sub_u32 s84, s84, s85
s_lshl_b32 s84, s84, 1
s_add_u32 s78, s84, s97
v_xor_b32 v30, s78, v29
v_lshl_or_b32 v16, v30, 5, v31
v_xor_b32 v17, 32, v16
s_add_u32 s84, s44, 1
s_cmp_ge_u32 s84, 4
s_cselect_b32 s85, 4, 0
s_sub_u32 s84, s84, s85
s_lshl_b32 s84, s84, 1
s_add_u32 s79, s84, s97
v_xor_b32 v30, s79, v29
v_lshl_or_b32 v18, v30, 5, v31
v_xor_b32 v19, 32, v18
s_add_u32 s84, s44, 2
s_cmp_ge_u32 s84, 4
s_cselect_b32 s85, 4, 0
s_sub_u32 s84, s84, s85
s_lshl_b32 s84, s84, 1
s_add_u32 s80, s84, s97
v_xor_b32 v30, s80, v29
v_lshl_or_b32 v20, v30, 5, v31
v_xor_b32 v21, 32, v20
s_add_u32 s84, s44, 3
s_cmp_ge_u32 s84, 4
s_cselect_b32 s85, 4, 0
s_sub_u32 s84, s84, s85
s_lshl_b32 s84, s84, 1
s_add_u32 s81, s84, s97
v_xor_b32 v30, s81, v29
v_lshl_or_b32 v22, v30, 5, v31
v_xor_b32 v23, 32, v22
v_and_b32 v29, 31, v0
v_lshlrev_b32 v29, 4, v29
v_lshrrev_b32 v30, 5, v0
v_lshl_add_u32 v188, v30, 11, v29
s_waitcnt lgkmcnt(0)
s_waitcnt vmcnt(17)
s_barrier
ds_read_b64_tr_b16 v[32:33], v16 offset:0
ds_read_b64_tr_b16 v[34:35], v16 offset:1024
ds_read_b64_tr_b16 v[36:37], v17 offset:0
ds_read_b64_tr_b16 v[38:39], v17 offset:1024
ds_read_b64_tr_b16 v[40:41], v18 offset:0
ds_read_b64_tr_b16 v[42:43], v18 offset:1024
ds_read_b64_tr_b16 v[44:45], v19 offset:0
ds_read_b64_tr_b16 v[46:47], v19 offset:1024
ds_read_b64_tr_b16 v[48:49], v20 offset:0
ds_read_b64_tr_b16 v[50:51], v20 offset:1024
ds_read_b64_tr_b16 v[52:53], v21 offset:0
ds_read_b64_tr_b16 v[54:55], v21 offset:1024
s_waitcnt lgkmcnt(8)
v_mfma_f32_16x16x32_bf16 v[112:115], v[32:35], a[128:131], 0
ds_read_b64_tr_b16 v[56:57], v22 offset:0
v_mfma_f32_16x16x32_bf16 v[116:119], v[32:35], a[132:135], 0
ds_read_b64_tr_b16 v[58:59], v22 offset:1024
s_add_u32 m0, s74, 32768
s_mul_i32 s82, s72, 1792
v_mfma_f32_16x16x32_bf16 v[176:179], v[32:35], v[24:27], 0
buffer_load_dwordx4 v12, s[12:15], s82 offen offset:0 lds
v_mfma_f32_16x16x32_bf16 v[120:123], v[36:39], a[128:131], 0
ds_read_b64_tr_b16 v[60:61], v23 offset:0
v_mfma_f32_16x16x32_bf16 v[124:127], v[36:39], a[132:135], 0
ds_read_b64_tr_b16 v[62:63], v23 offset:1024
v_mfma_f32_16x16x32_bf16 v[180:183], v[36:39], v[24:27], 0
buffer_load_dwordx4 v13, s[12:15], s82 offen offset:1024 lds
s_waitcnt lgkmcnt(8)
v_mfma_f32_16x16x32_bf16 v[128:131], v[40:43], a[128:131], 0
ds_read_b64_tr_b16 v[32:33], v16 offset:8192
v_mfma_f32_16x16x32_bf16 v[132:135], v[40:43], a[132:135], 0
ds_read_b64_tr_b16 v[34:35], v16 offset:9216
v_mfma_f32_16x16x32_bf16 v[136:139], v[44:47], a[128:131], 0
ds_read_b64_tr_b16 v[36:37], v17 offset:8192
buffer_load_dwordx4 v14, s[12:15], s82 offen offset:2048 lds
v_mfma_f32_16x16x32_bf16 v[140:143], v[44:47], a[132:135], 0
ds_read_b64_tr_b16 v[38:39], v17 offset:9216
s_waitcnt lgkmcnt(8)
v_mfma_f32_16x16x32_bf16 v[144:147], v[48:51], a[128:131], 0
ds_read_b64_tr_b16 v[40:41], v18 offset:8192
v_mfma_f32_16x16x32_bf16 v[148:151], v[48:51], a[132:135], 0
ds_read_b64_tr_b16 v[42:43], v18 offset:9216
buffer_load_dwordx4 v15, s[12:15], s82 offen offset:3072 lds
s_add_u32 s72, s72, 128
v_mfma_f32_16x16x32_bf16 v[152:155], v[52:55], a[128:131], 0
ds_read_b64_tr_b16 v[44:45], v19 offset:8192
s_and_b32 s72, s72, 0x380
v_mfma_f32_16x16x32_bf16 v[156:159], v[52:55], a[132:135], 0
ds_read_b64_tr_b16 v[46:47], v19 offset:9216
s_waitcnt lgkmcnt(8)
v_mfma_f32_16x16x32_bf16 v[160:163], v[56:59], a[128:131], 0
ds_read_b64_tr_b16 v[48:49], v20 offset:8192
v_mfma_f32_16x16x32_bf16 v[164:167], v[56:59], a[132:135], 0
ds_read_b64_tr_b16 v[50:51], v20 offset:9216
v_mfma_f32_16x16x32_bf16 v[168:171], v[60:63], a[128:131], 0
ds_read_b64_tr_b16 v[52:53], v21 offset:8192
v_mfma_f32_16x16x32_bf16 v[172:175], v[60:63], a[132:135], 0
ds_read_b64_tr_b16 v[54:55], v21 offset:9216
s_waitcnt lgkmcnt(8)
v_mfma_f32_16x16x32_bf16 v[112:115], v[32:35], a[136:139], v[112:115]
ds_read_b64_tr_b16 v[56:57], v22 offset:8192
v_mfma_f32_16x16x32_bf16 v[116:119], v[32:35], a[140:143], v[116:119]
ds_read_b64_tr_b16 v[58:59], v22 offset:9216
v_mfma_f32_16x16x32_bf16 v[176:179], v[32:35], v[24:27], v[176:179]
v_mfma_f32_16x16x32_bf16 v[120:123], v[36:39], a[136:139], v[120:123]
ds_read_b64_tr_b16 v[60:61], v23 offset:8192
v_mfma_f32_16x16x32_bf16 v[124:127], v[36:39], a[140:143], v[124:127]
ds_read_b64_tr_b16 v[62:63], v23 offset:9216
v_mfma_f32_16x16x32_bf16 v[180:183], v[36:39], v[24:27], v[180:183]
s_waitcnt lgkmcnt(8)
v_mfma_f32_16x16x32_bf16 v[128:131], v[40:43], a[136:139], v[128:131]
s_waitcnt vmcnt(5)
s_barrier
ds_read_b64_tr_b16 v[32:33], v16 offset:16384
v_mfma_f32_16x16x32_bf16 v[132:135], v[40:43], a[140:143], v[132:135]
ds_read_b64_tr_b16 v[34:35], v16 offset:17408
v_mfma_f32_16x16x32_bf16 v[136:139], v[44:47], a[136:139], v[136:139]
ds_read_b64_tr_b16 v[36:37], v17 offset:16384
s_add_u32 m0, s74, 49152
s_mul_i32 s82, s72, 1792
v_mfma_f32_16x16x32_bf16 v[140:143], v[44:47], a[140:143], v[140:143]
ds_read_b64_tr_b16 v[38:39], v17 offset:17408
buffer_load_dwordx4 v12, s[12:15], s82 offen offset:0 lds
s_waitcnt lgkmcnt(8)
v_mfma_f32_16x16x32_bf16 v[144:147], v[48:51], a[136:139], v[144:147]
ds_read_b64_tr_b16 v[40:41], v18 offset:16384
v_mfma_f32_16x16x32_bf16 v[148:151], v[48:51], a[140:143], v[148:151]
ds_read_b64_tr_b16 v[42:43], v18 offset:17408
v_mfma_f32_16x16x32_bf16 v[152:155], v[52:55], a[136:139], v[152:155]
ds_read_b64_tr_b16 v[44:45], v19 offset:16384
buffer_load_dwordx4 v13, s[12:15], s82 offen offset:1024 lds
v_mfma_f32_16x16x32_bf16 v[156:159], v[52:55], a[140:143], v[156:159]
ds_read_b64_tr_b16 v[46:47], v19 offset:17408
s_waitcnt lgkmcnt(8)
v_mfma_f32_16x16x32_bf16 v[160:163], v[56:59], a[136:139], v[160:163]
ds_read_b64_tr_b16 v[48:49], v20 offset:16384
v_mfma_f32_16x16x32_bf16 v[164:167], v[56:59], a[140:143], v[164:167]
ds_read_b64_tr_b16 v[50:51], v20 offset:17408
buffer_load_dwordx4 v14, s[12:15], s82 offen offset:2048 lds
v_mfma_f32_16x16x32_bf16 v[168:171], v[60:63], a[136:139], v[168:171]
ds_read_b64_tr_b16 v[52:53], v21 offset:16384
v_mfma_f32_16x16x32_bf16 v[172:175], v[60:63], a[140:143], v[172:175]
ds_read_b64_tr_b16 v[54:55], v21 offset:17408
s_waitcnt lgkmcnt(8)
v_mfma_f32_16x16x32_bf16 v[112:115], v[32:35], a[144:147], v[112:115]
ds_read_b64_tr_b16 v[56:57], v22 offset:16384
buffer_load_dwordx4 v15, s[12:15], s82 offen offset:3072 lds
s_add_u32 s72, s72, 128
v_mfma_f32_16x16x32_bf16 v[116:119], v[32:35], a[148:151], v[116:119]
ds_read_b64_tr_b16 v[58:59], v22 offset:17408
s_and_b32 s72, s72, 0x380
v_mfma_f32_16x16x32_bf16 v[176:179], v[32:35], v[24:27], v[176:179]
v_mfma_f32_16x16x32_bf16 v[120:123], v[36:39], a[144:147], v[120:123]
ds_read_b64_tr_b16 v[60:61], v23 offset:16384
v_mfma_f32_16x16x32_bf16 v[124:127], v[36:39], a[148:151], v[124:127]
ds_read_b64_tr_b16 v[62:63], v23 offset:17408
v_mfma_f32_16x16x32_bf16 v[180:183], v[36:39], v[24:27], v[180:183]
s_waitcnt lgkmcnt(8)
v_mfma_f32_16x16x32_bf16 v[128:131], v[40:43], a[144:147], v[128:131]
ds_read_b64_tr_b16 v[32:33], v16 offset:24576
v_mfma_f32_16x16x32_bf16 v[132:135], v[40:43], a[148:151], v[132:135]
ds_read_b64_tr_b16 v[34:35], v16 offset:25600
v_mfma_f32_16x16x32_bf16 v[136:139], v[44:47], a[144:147], v[136:139]
ds_read_b64_tr_b16 v[36:37], v17 offset:24576
v_mfma_f32_16x16x32_bf16 v[140:143], v[44:47], a[148:151], v[140:143]
ds_read_b64_tr_b16 v[38:39], v17 offset:25600
s_waitcnt lgkmcnt(8)
v_mfma_f32_16x16x32_bf16 v[144:147], v[48:51], a[144:147], v[144:147]
ds_read_b64_tr_b16 v[40:41], v18 offset:24576
v_mfma_f32_16x16x32_bf16 v[148:151], v[48:51], a[148:151], v[148:151]
ds_read_b64_tr_b16 v[42:43], v18 offset:25600
v_mfma_f32_16x16x32_bf16 v[152:155], v[52:55], a[144:147], v[152:155]
ds_read_b64_tr_b16 v[44:45], v19 offset:24576
v_mfma_f32_16x16x32_bf16 v[156:159], v[52:55], a[148:151], v[156:159]
ds_read_b64_tr_b16 v[46:47], v19 offset:25600
s_waitcnt lgkmcnt(8)
v_mfma_f32_16x16x32_bf16 v[160:163], v[56:59], a[144:147], v[160:163]
ds_read_b64_tr_b16 v[48:49], v20 offset:24576
v_mfma_f32_16x16x32_bf16 v[164:167], v[56:59], a[148:151], v[164:167]
ds_read_b64_tr_b16 v[50:51], v20 offset:25600
v_mfma_f32_16x16x32_bf16 v[168:171], v[60:63], a[144:147], v[168:171]
ds_read_b64_tr_b16 v[52:53], v21 offset:24576
v_mfma_f32_16x16x32_bf16 v[172:175], v[60:63], a[148:151], v[172:175]
ds_read_b64_tr_b16 v[54:55], v21 offset:25600
s_waitcnt lgkmcnt(8)
v_mfma_f32_16x16x32_bf16 v[112:115], v[32:35], a[152:155], v[112:115]
ds_read_b64_tr_b16 v[56:57], v22 offset:24576
v_mfma_f32_16x16x32_bf16 v[116:119], v[32:35], a[156:159], v[116:119]
ds_read_b64_tr_b16 v[58:59], v22 offset:25600
v_mfma_f32_16x16x32_bf16 v[176:179], v[32:35], v[24:27], v[176:179]
v_mfma_f32_16x16x32_bf16 v[120:123], v[36:39], a[152:155], v[120:123]
ds_read_b64_tr_b16 v[60:61], v23 offset:24576
v_mfma_f32_16x16x32_bf16 v[124:127], v[36:39], a[156:159], v[124:127]
ds_read_b64_tr_b16 v[62:63], v23 offset:25600
v_mfma_f32_16x16x32_bf16 v[180:183], v[36:39], v[24:27], v[180:183]
s_waitcnt lgkmcnt(8)
v_mfma_f32_16x16x32_bf16 v[128:131], v[40:43], a[152:155], v[128:131]
s_waitcnt vmcnt(4)
s_barrier
ds_read_b64_tr_b16 v[32:33], v16 offset:32768
v_mfma_f32_16x16x32_bf16 v[132:135], v[40:43], a[156:159], v[132:135]
ds_read_b64_tr_b16 v[34:35], v16 offset:33792
v_mfma_f32_16x16x32_bf16 v[136:139], v[44:47], a[152:155], v[136:139]
ds_read_b64_tr_b16 v[36:37], v17 offset:32768
s_add_u32 s85, s0, 0x40000
buffer_load_dwordx4 v[192:195], v188, s[20:23], s85 offen sc1
v_mfma_f32_16x16x32_bf16 v[140:143], v[44:47], a[156:159], v[140:143]
ds_read_b64_tr_b16 v[38:39], v17 offset:33792
s_add_u32 s85, s0, 0x41000
s_waitcnt lgkmcnt(8)
v_mfma_f32_16x16x32_bf16 v[144:147], v[48:51], a[152:155], v[144:147]
ds_read_b64_tr_b16 v[40:41], v18 offset:32768
v_mfma_f32_16x16x32_bf16 v[148:151], v[48:51], a[156:159], v[148:151]
ds_read_b64_tr_b16 v[42:43], v18 offset:33792
buffer_load_dwordx4 v[196:199], v188, s[20:23], s85 offen sc1
s_add_u32 s85, s0, 0x42000
v_mfma_f32_16x16x32_bf16 v[152:155], v[52:55], a[152:155], v[152:155]
ds_read_b64_tr_b16 v[44:45], v19 offset:32768
v_mfma_f32_16x16x32_bf16 v[156:159], v[52:55], a[156:159], v[156:159]
ds_read_b64_tr_b16 v[46:47], v19 offset:33792
s_waitcnt lgkmcnt(8)
v_mfma_f32_16x16x32_bf16 v[160:163], v[56:59], a[152:155], v[160:163]
ds_read_b64_tr_b16 v[48:49], v20 offset:32768
buffer_load_dwordx4 v[200:203], v188, s[20:23], s85 offen sc1
s_add_u32 s85, s0, 0x43000
v_mfma_f32_16x16x32_bf16 v[164:167], v[56:59], a[156:159], v[164:167]
ds_read_b64_tr_b16 v[50:51], v20 offset:33792
v_mfma_f32_16x16x32_bf16 v[168:171], v[60:63], a[152:155], v[168:171]
ds_read_b64_tr_b16 v[52:53], v21 offset:32768
v_mfma_f32_16x16x32_bf16 v[172:175], v[60:63], a[156:159], v[172:175]
ds_read_b64_tr_b16 v[54:55], v21 offset:33792
buffer_load_dwordx4 v[204:207], v188, s[20:23], s85 offen sc1
s_waitcnt lgkmcnt(8)
v_mfma_f32_16x16x32_bf16 v[112:115], v[32:35], a[160:163], v[112:115]
ds_read_b64_tr_b16 v[56:57], v22 offset:32768
s_add_u32 m0, s74, 0
s_mul_i32 s82, s72, 1792
v_mfma_f32_16x16x32_bf16 v[116:119], v[32:35], a[164:167], v[116:119]
ds_read_b64_tr_b16 v[58:59], v22 offset:33792
v_mfma_f32_16x16x32_bf16 v[176:179], v[32:35], v[24:27], v[176:179]
buffer_load_dwordx4 v12, s[12:15], s82 offen offset:0 lds
v_mfma_f32_16x16x32_bf16 v[120:123], v[36:39], a[160:163], v[120:123]
ds_read_b64_tr_b16 v[60:61], v23 offset:32768
v_mfma_f32_16x16x32_bf16 v[124:127], v[36:39], a[164:167], v[124:127]
ds_read_b64_tr_b16 v[62:63], v23 offset:33792
v_mfma_f32_16x16x32_bf16 v[180:183], v[36:39], v[24:27], v[180:183]
buffer_load_dwordx4 v13, s[12:15], s82 offen offset:1024 lds
s_waitcnt lgkmcnt(8)
v_mfma_f32_16x16x32_bf16 v[128:131], v[40:43], a[160:163], v[128:131]
ds_read_b64_tr_b16 v[32:33], v16 offset:40960
v_mfma_f32_16x16x32_bf16 v[132:135], v[40:43], a[164:167], v[132:135]
ds_read_b64_tr_b16 v[34:35], v16 offset:41984
v_mfma_f32_16x16x32_bf16 v[136:139], v[44:47], a[160:163], v[136:139]
ds_read_b64_tr_b16 v[36:37], v17 offset:40960
buffer_load_dwordx4 v14, s[12:15], s82 offen offset:2048 lds
v_mfma_f32_16x16x32_bf16 v[140:143], v[44:47], a[164:167], v[140:143]
ds_read_b64_tr_b16 v[38:39], v17 offset:41984
s_waitcnt lgkmcnt(8)
v_mfma_f32_16x16x32_bf16 v[144:147], v[48:51], a[160:163], v[144:147]
ds_read_b64_tr_b16 v[40:41], v18 offset:40960
v_mfma_f32_16x16x32_bf16 v[148:151], v[48:51], a[164:167], v[148:151]
ds_read_b64_tr_b16 v[42:43], v18 offset:41984
buffer_load_dwordx4 v15, s[12:15], s82 offen offset:3072 lds
s_add_u32 s72, s72, 128
v_mfma_f32_16x16x32_bf16 v[152:155], v[52:55], a[160:163], v[152:155]
ds_read_b64_tr_b16 v[44:45], v19 offset:40960
s_and_b32 s72, s72, 0x380
v_mfma_f32_16x16x32_bf16 v[156:159], v[52:55], a[164:167], v[156:159]
ds_read_b64_tr_b16 v[46:47], v19 offset:41984
s_waitcnt lgkmcnt(8)
v_mfma_f32_16x16x32_bf16 v[160:163], v[56:59], a[160:163], v[160:163]
ds_read_b64_tr_b16 v[48:49], v20 offset:40960
v_mfma_f32_16x16x32_bf16 v[164:167], v[56:59], a[164:167], v[164:167]
ds_read_b64_tr_b16 v[50:51], v20 offset:41984
v_mfma_f32_16x16x32_bf16 v[168:171], v[60:63], a[160:163], v[168:171]
ds_read_b64_tr_b16 v[52:53], v21 offset:40960
v_mfma_f32_16x16x32_bf16 v[172:175], v[60:63], a[164:167], v[172:175]
ds_read_b64_tr_b16 v[54:55], v21 offset:41984
s_waitcnt lgkmcnt(8)
v_mfma_f32_16x16x32_bf16 v[112:115], v[32:35], a[168:171], v[112:115]
ds_read_b64_tr_b16 v[56:57], v22 offset:40960
v_mfma_f32_16x16x32_bf16 v[116:119], v[32:35], a[172:175], v[116:119]
ds_read_b64_tr_b16 v[58:59], v22 offset:41984
v_mfma_f32_16x16x32_bf16 v[176:179], v[32:35], v[24:27], v[176:179]
v_mfma_f32_16x16x32_bf16 v[120:123], v[36:39], a[168:171], v[120:123]
ds_read_b64_tr_b16 v[60:61], v23 offset:40960
v_mfma_f32_16x16x32_bf16 v[124:127], v[36:39], a[172:175], v[124:127]
ds_read_b64_tr_b16 v[62:63], v23 offset:41984
v_mfma_f32_16x16x32_bf16 v[180:183], v[36:39], v[24:27], v[180:183]
s_waitcnt lgkmcnt(8)
v_mfma_f32_16x16x32_bf16 v[128:131], v[40:43], a[168:171], v[128:131]
s_waitcnt vmcnt(8)
s_barrier
ds_read_b64_tr_b16 v[32:33], v16 offset:49152
v_mfma_f32_16x16x32_bf16 v[132:135], v[40:43], a[172:175], v[132:135]
ds_read_b64_tr_b16 v[34:35], v16 offset:50176
v_mfma_f32_16x16x32_bf16 v[136:139], v[44:47], a[168:171], v[136:139]
ds_read_b64_tr_b16 v[36:37], v17 offset:49152
s_add_u32 m0, s74, 16384
s_mul_i32 s82, s72, 1792
v_mfma_f32_16x16x32_bf16 v[140:143], v[44:47], a[172:175], v[140:143]
ds_read_b64_tr_b16 v[38:39], v17 offset:50176
buffer_load_dwordx4 v12, s[12:15], s82 offen offset:0 lds
s_waitcnt lgkmcnt(8)
v_mfma_f32_16x16x32_bf16 v[144:147], v[48:51], a[168:171], v[144:147]
ds_read_b64_tr_b16 v[40:41], v18 offset:49152
v_mfma_f32_16x16x32_bf16 v[148:151], v[48:51], a[172:175], v[148:151]
ds_read_b64_tr_b16 v[42:43], v18 offset:50176
v_mfma_f32_16x16x32_bf16 v[152:155], v[52:55], a[168:171], v[152:155]
ds_read_b64_tr_b16 v[44:45], v19 offset:49152
buffer_load_dwordx4 v13, s[12:15], s82 offen offset:1024 lds
v_mfma_f32_16x16x32_bf16 v[156:159], v[52:55], a[172:175], v[156:159]
ds_read_b64_tr_b16 v[46:47], v19 offset:50176
s_waitcnt lgkmcnt(8)
v_mfma_f32_16x16x32_bf16 v[160:163], v[56:59], a[168:171], v[160:163]
ds_read_b64_tr_b16 v[48:49], v20 offset:49152
v_mfma_f32_16x16x32_bf16 v[164:167], v[56:59], a[172:175], v[164:167]
ds_read_b64_tr_b16 v[50:51], v20 offset:50176
buffer_load_dwordx4 v14, s[12:15], s82 offen offset:2048 lds
v_mfma_f32_16x16x32_bf16 v[168:171], v[60:63], a[168:171], v[168:171]
ds_read_b64_tr_b16 v[52:53], v21 offset:49152
v_mfma_f32_16x16x32_bf16 v[172:175], v[60:63], a[172:175], v[172:175]
ds_read_b64_tr_b16 v[54:55], v21 offset:50176
s_waitcnt lgkmcnt(8)
v_mfma_f32_16x16x32_bf16 v[112:115], v[32:35], a[176:179], v[112:115]
ds_read_b64_tr_b16 v[56:57], v22 offset:49152
buffer_load_dwordx4 v15, s[12:15], s82 offen offset:3072 lds
s_add_u32 s72, s72, 128
v_mfma_f32_16x16x32_bf16 v[116:119], v[32:35], a[180:183], v[116:119]
ds_read_b64_tr_b16 v[58:59], v22 offset:50176
s_and_b32 s72, s72, 0x380
v_mfma_f32_16x16x32_bf16 v[176:179], v[32:35], v[24:27], v[176:179]
v_mfma_f32_16x16x32_bf16 v[120:123], v[36:39], a[176:179], v[120:123]
ds_read_b64_tr_b16 v[60:61], v23 offset:49152
v_mfma_f32_16x16x32_bf16 v[124:127], v[36:39], a[180:183], v[124:127]
ds_read_b64_tr_b16 v[62:63], v23 offset:50176
v_mfma_f32_16x16x32_bf16 v[180:183], v[36:39], v[24:27], v[180:183]
s_waitcnt lgkmcnt(8)
v_mfma_f32_16x16x32_bf16 v[128:131], v[40:43], a[176:179], v[128:131]
ds_read_b64_tr_b16 v[32:33], v16 offset:57344
v_mfma_f32_16x16x32_bf16 v[132:135], v[40:43], a[180:183], v[132:135]
ds_read_b64_tr_b16 v[34:35], v16 offset:58368
v_mfma_f32_16x16x32_bf16 v[136:139], v[44:47], a[176:179], v[136:139]
ds_read_b64_tr_b16 v[36:37], v17 offset:57344
v_mfma_f32_16x16x32_bf16 v[140:143], v[44:47], a[180:183], v[140:143]
ds_read_b64_tr_b16 v[38:39], v17 offset:58368
s_waitcnt lgkmcnt(8)
v_mfma_f32_16x16x32_bf16 v[144:147], v[48:51], a[176:179], v[144:147]
ds_read_b64_tr_b16 v[40:41], v18 offset:57344
v_mfma_f32_16x16x32_bf16 v[148:151], v[48:51], a[180:183], v[148:151]
ds_read_b64_tr_b16 v[42:43], v18 offset:58368
v_mfma_f32_16x16x32_bf16 v[152:155], v[52:55], a[176:179], v[152:155]
ds_read_b64_tr_b16 v[44:45], v19 offset:57344
v_mfma_f32_16x16x32_bf16 v[156:159], v[52:55], a[180:183], v[156:159]
ds_read_b64_tr_b16 v[46:47], v19 offset:58368
s_waitcnt lgkmcnt(8)
v_mfma_f32_16x16x32_bf16 v[160:163], v[56:59], a[176:179], v[160:163]
ds_read_b64_tr_b16 v[48:49], v20 offset:57344
v_mfma_f32_16x16x32_bf16 v[164:167], v[56:59], a[180:183], v[164:167]
ds_read_b64_tr_b16 v[50:51], v20 offset:58368
v_mfma_f32_16x16x32_bf16 v[168:171], v[60:63], a[176:179], v[168:171]
ds_read_b64_tr_b16 v[52:53], v21 offset:57344
v_mfma_f32_16x16x32_bf16 v[172:175], v[60:63], a[180:183], v[172:175]
ds_read_b64_tr_b16 v[54:55], v21 offset:58368
s_waitcnt lgkmcnt(8)
v_mfma_f32_16x16x32_bf16 v[112:115], v[32:35], a[184:187], v[112:115]
ds_read_b64_tr_b16 v[56:57], v22 offset:57344
v_mfma_f32_16x16x32_bf16 v[116:119], v[32:35], a[188:191], v[116:119]
ds_read_b64_tr_b16 v[58:59], v22 offset:58368
v_mfma_f32_16x16x32_bf16 v[176:179], v[32:35], v[24:27], v[176:179]
v_mfma_f32_16x16x32_bf16 v[120:123], v[36:39], a[184:187], v[120:123]
ds_read_b64_tr_b16 v[60:61], v23 offset:57344
v_mfma_f32_16x16x32_bf16 v[124:127], v[36:39], a[188:191], v[124:127]
ds_read_b64_tr_b16 v[62:63], v23 offset:58368
v_mfma_f32_16x16x32_bf16 v[180:183], v[36:39], v[24:27], v[180:183]
s_waitcnt lgkmcnt(8)
v_mfma_f32_16x16x32_bf16 v[128:131], v[40:43], a[184:187], v[128:131]
s_waitcnt vmcnt(4)
s_barrier
ds_read_b64_tr_b16 v[32:33], v16 offset:0
v_mfma_f32_16x16x32_bf16 v[132:135], v[40:43], a[188:191], v[132:135]
ds_read_b64_tr_b16 v[34:35], v16 offset:1024
v_mfma_f32_16x16x32_bf16 v[136:139], v[44:47], a[184:187], v[136:139]
ds_read_b64_tr_b16 v[36:37], v17 offset:0
v_mfma_f32_16x16x32_bf16 v[140:143], v[44:47], a[188:191], v[140:143]
ds_read_b64_tr_b16 v[38:39], v17 offset:1024
s_waitcnt lgkmcnt(8)
v_mfma_f32_16x16x32_bf16 v[144:147], v[48:51], a[184:187], v[144:147]
ds_read_b64_tr_b16 v[40:41], v18 offset:0
v_mfma_f32_16x16x32_bf16 v[148:151], v[48:51], a[188:191], v[148:151]
ds_read_b64_tr_b16 v[42:43], v18 offset:1024
v_mfma_f32_16x16x32_bf16 v[152:155], v[52:55], a[184:187], v[152:155]
ds_read_b64_tr_b16 v[44:45], v19 offset:0
v_mfma_f32_16x16x32_bf16 v[156:159], v[52:55], a[188:191], v[156:159]
ds_read_b64_tr_b16 v[46:47], v19 offset:1024
s_waitcnt lgkmcnt(8)
v_mfma_f32_16x16x32_bf16 v[160:163], v[56:59], a[184:187], v[160:163]
ds_read_b64_tr_b16 v[48:49], v20 offset:0
v_mfma_f32_16x16x32_bf16 v[164:167], v[56:59], a[188:191], v[164:167]
ds_read_b64_tr_b16 v[50:51], v20 offset:1024
v_mfma_f32_16x16x32_bf16 v[168:171], v[60:63], a[184:187], v[168:171]
ds_read_b64_tr_b16 v[52:53], v21 offset:0
v_mfma_f32_16x16x32_bf16 v[172:175], v[60:63], a[188:191], v[172:175]
ds_read_b64_tr_b16 v[54:55], v21 offset:1024
v_xor_b32 v208, v193, v28
v_xor_b32 v195, v195, v28
v_xor_b32 v197, v197, v28
v_xor_b32 v199, v199, v28
v_xor_b32 v201, v201, v28
v_xor_b32 v203, v203, v28
v_xor_b32 v205, v205, v28
v_xor_b32 v207, v207, v28
v_or3_b32 v208, v208, v195, v197
v_or3_b32 v208, v208, v199, v201
v_or3_b32 v208, v208, v203, v205
v_or_b32 v208, v208, v207
v_cmp_ne_u32 vcc, 0, v208
s_nop 1
s_cbranch_vccnz L_pslow_9
L_pret_10:
v_add_f32 v192, v192, v196
v_add_f32 v200, v200, v204
v_add_f32 v194, v194, v198
v_add_f32 v202, v202, v206
v_add_f32 v192, v192, v200
v_add_f32 v194, v194, v202
v_mov_b32 v193, v192
v_mov_b32 v195, v194
s_lshl_b32 s85, s44, 8
s_add_u32 s85, s85, 66560
v_permlane32_swap_b32 v192, v193
v_permlane32_swap_b32 v194, v195
v_add_f32 v192, v192, v193
v_add_f32 v194, v194, v195
v_mul_f32 v192, s88, v192
v_mul_f32 v194, s88, v194
v_and_b32 v29, 31, v0
v_fma_f32 v194, -v192, v192, v194
v_lshl_add_u32 v29, v29, 2, s85
v_max_f32 v194, 0, v194
v_lshrrev_b32 v30, 4, v0
v_add_f32 v194, s89, v194
v_lshl_add_u32 v30, v30, 4, s85
v_rsq_f32 v194, v194
s_lshl_b32 s84, s45, 2
ds_write_b32 v29, v194
v_mul_f32 v192, -v192, v194
ds_write_b32 v29, v192 offset:128
ds_read_b128 v[208:211], v30 offset:0
ds_read_b128 v[216:219], v30 offset:128
ds_read_b128 v[212:215], v30 offset:64
ds_read_b128 v[220:223], v30 offset:192
s_add_u32 s84, s84, s44
s_mul_i32 s84, s84, 56
s_and_b32 s85, s100, 0xfc
s_add_u32 s84, s84, s85
s_lshl_b32 s84, s84, 10
s_add_u32 s84, s84, 0x100000
s_waitcnt lgkmcnt(2)
v_pk_fma_f32 v[64:65], v[64:65], v[208:209], v[216:217]
v_pk_fma_f32 v[66:67], v[66:67], v[210:211], v[218:219]
s_waitcnt lgkmcnt(0)
v_pk_fma_f32 v[68:69], v[68:69], v[212:213], v[220:221]
v_pk_fma_f32 v[70:71], v[70:71], v[214:215], v[222:223]
v_pk_fma_f32 v[72:73], v[72:73], v[208:209], v[216:217]
v_pk_fma_f32 v[74:75], v[74:75], v[210:211], v[218:219]
v_pk_fma_f32 v[76:77], v[76:77], v[212:213], v[220:221]
v_pk_fma_f32 v[78:79], v[78:79], v[214:215], v[222:223]
v_cvt_pk_bf16_f32 v224, v64, v65
v_cvt_pk_bf16_f32 v225, v66, v67
v_cvt_pk_bf16_f32 v226, v68, v69
v_cvt_pk_bf16_f32 v227, v70, v71
v_cvt_pk_bf16_f32 v228, v72, v73
v_cvt_pk_bf16_f32 v229, v74, v75
v_cvt_pk_bf16_f32 v230, v76, v77
v_cvt_pk_bf16_f32 v231, v78, v79
v_permlane32_swap_b32 v224, v226
v_permlane32_swap_b32 v225, v227
v_permlane32_swap_b32 v228, v230
v_permlane32_swap_b32 v229, v231
v_permlane16_swap_b32 v224, v226
v_permlane16_swap_b32 v225, v227
v_permlane16_swap_b32 v228, v230
v_permlane16_swap_b32 v229, v231
buffer_store_dwordx4 v[224:227], v4, s[20:23], s84 offen offset:0 sc1
buffer_store_dwordx4 v[228:231], v4, s[20:23], s84 offen offset:1024 sc1
v_pk_fma_f32 v[80:81], v[80:81], v[208:209], v[216:217]
v_pk_fma_f32 v[82:83], v[82:83], v[210:211], v[218:219]
v_pk_fma_f32 v[84:85], v[84:85], v[212:213], v[220:221]
v_pk_fma_f32 v[86:87], v[86:87], v[214:215], v[222:223]
v_pk_fma_f32 v[88:89], v[88:89], v[208:209], v[216:217]
v_pk_fma_f32 v[90:91], v[90:91], v[210:211], v[218:219]
v_pk_fma_f32 v[92:93], v[92:93], v[212:213], v[220:221]
v_pk_fma_f32 v[94:95], v[94:95], v[214:215], v[222:223]
v_cvt_pk_bf16_f32 v232, v80, v81
v_cvt_pk_bf16_f32 v233, v82, v83
v_cvt_pk_bf16_f32 v234, v84, v85
v_cvt_pk_bf16_f32 v235, v86, v87
v_cvt_pk_bf16_f32 v236, v88, v89
v_cvt_pk_bf16_f32 v237, v90, v91
v_cvt_pk_bf16_f32 v238, v92, v93
v_cvt_pk_bf16_f32 v239, v94, v95
v_permlane32_swap_b32 v232, v234
v_permlane32_swap_b32 v233, v235
v_permlane32_swap_b32 v236, v238
v_permlane32_swap_b32 v237, v239
v_permlane16_swap_b32 v232, v234
v_permlane16_swap_b32 v233, v235
v_permlane16_swap_b32 v236, v238
v_permlane16_swap_b32 v237, v239
buffer_store_dwordx4 v[232:235], v5, s[20:23], s84 offen offset:0 sc1
buffer_store_dwordx4 v[236:239], v5, s[20:23], s84 offen offset:1024 sc1
v_pk_fma_f32 v[96:97], v[96:97], v[208:209], v[216:217]
v_pk_fma_f32 v[98:99], v[98:99], v[210:211], v[218:219]
v_pk_fma_f32 v[100:101], v[100:101], v[212:213], v[220:221]
v_pk_fma_f32 v[102:103], v[102:103], v[214:215], v[222:223]
v_pk_fma_f32 v[104:105], v[104:105], v[208:209], v[216:217]
v_pk_fma_f32 v[106:107], v[106:107], v[210:211], v[218:219]
v_pk_fma_f32 v[108:109], v[108:109], v[212:213], v[220:221]
v_pk_fma_f32 v[110:111], v[110:111], v[214:215], v[222:223]
v_cvt_pk_bf16_f32 v224, v96, v97
v_cvt_pk_bf16_f32 v225, v98, v99
v_cvt_pk_bf16_f32 v226, v100, v101
v_cvt_pk_bf16_f32 v227, v102, v103
v_cvt_pk_bf16_f32 v228, v104, v105
v_cvt_pk_bf16_f32 v229, v106, v107
v_cvt_pk_bf16_f32 v230, v108, v109
v_cvt_pk_bf16_f32 v231, v110, v111
v_permlane32_swap_b32 v224, v226
v_permlane32_swap_b32 v225, v227
v_permlane32_swap_b32 v228, v230
v_permlane32_swap_b32 v229, v231
v_permlane16_swap_b32 v224, v226
v_permlane16_swap_b32 v225, v227
v_permlane16_swap_b32 v228, v230
v_permlane16_swap_b32 v229, v231
buffer_store_dwordx4 v[224:227], v6, s[20:23], s84 offen offset:0 sc1
buffer_store_dwordx4 v[228:231], v6, s[20:23], s84 offen offset:1024 sc1
v_mfma_f32_16x16x32_bf16 v[112:115], v[32:35], a[192:195], v[112:115]
ds_read_b64_tr_b16 v[56:57], v22 offset:0
s_add_u32 m0, s74, 32768
s_mul_i32 s82, s72, 1792
v_mfma_f32_16x16x32_bf16 v[116:119], v[32:35], a[196:199], v[116:119]
ds_read_b64_tr_b16 v[58:59], v22 offset:1024
buffer_load_dwordx4 v12, s[12:15], s82 offen offset:0 lds
v_mfma_f32_16x16x32_bf16 v[176:179], v[32:35], v[24:27], v[176:179]
v_mfma_f32_16x16x32_bf16 v[120:123], v[36:39], a[192:195], v[120:123]
ds_read_b64_tr_b16 v[60:61], v23 offset:0
v_mfma_f32_16x16x32_bf16 v[124:127], v[36:39], a[196:199], v[124:127]
ds_read_b64_tr_b16 v[62:63], v23 offset:1024
buffer_load_dwordx4 v13, s[12:15], s82 offen offset:1024 lds
v_mfma_f32_16x16x32_bf16 v[180:183], v[36:39], v[24:27], v[180:183]
v_mfma_f32_16x16x32_bf16 v[128:131], v[40:43], a[192:195], v[128:131]
ds_read_b64_tr_b16 v[32:33], v16 offset:8192
v_mfma_f32_16x16x32_bf16 v[132:135], v[40:43], a[196:199], v[132:135]
ds_read_b64_tr_b16 v[34:35], v16 offset:9216
buffer_load_dwordx4 v14, s[12:15], s82 offen offset:2048 lds
v_mfma_f32_16x16x32_bf16 v[136:139], v[44:47], a[192:195], v[136:139]
ds_read_b64_tr_b16 v[36:37], v17 offset:8192
v_mfma_f32_16x16x32_bf16 v[140:143], v[44:47], a[196:199], v[140:143]
ds_read_b64_tr_b16 v[38:39], v17 offset:9216
v_mfma_f32_16x16x32_bf16 v[144:147], v[48:51], a[192:195], v[144:147]
ds_read_b64_tr_b16 v[40:41], v18 offset:8192
buffer_load_dwordx4 v15, s[12:15], s82 offen offset:3072 lds
s_add_u32 s72, s72, 128
v_mfma_f32_16x16x32_bf16 v[148:151], v[48:51], a[196:199], v[148:151]
ds_read_b64_tr_b16 v[42:43], v18 offset:9216
s_and_b32 s72, s72, 0x380
v_mfma_f32_16x16x32_bf16 v[152:155], v[52:55], a[192:195], v[152:155]
ds_read_b64_tr_b16 v[44:45], v19 offset:8192
ds_read_b128 a[72:75], v2 offset:12288
ds_read_b128 a[76:79], v2 offset:14336
v_mfma_f32_16x16x32_bf16 v[156:159], v[52:55], a[196:199], v[156:159]
ds_read_b64_tr_b16 v[46:47], v19 offset:9216
ds_read_b128 a[88:91], v3 offset:12288
s_waitcnt lgkmcnt(11)
v_mfma_f32_16x16x32_bf16 v[160:163], v[56:59], a[192:195], v[160:163]
ds_read_b64_tr_b16 v[48:49], v20 offset:8192
ds_read_b128 a[92:95], v3 offset:14336
v_mfma_f32_16x16x32_bf16 v[164:167], v[56:59], a[196:199], v[164:167]
ds_read_b64_tr_b16 v[50:51], v20 offset:9216
s_add_u32 m0, s77, 4096
s_add_u32 s76, s76, 128
v_mfma_f32_16x16x32_bf16 v[168:171], v[60:63], a[192:195], v[168:171]
ds_read_b64_tr_b16 v[52:53], v21 offset:8192
s_and_b32 s76, s76, 0x380
s_add_u32 s82, s64, s76
v_mfma_f32_16x16x32_bf16 v[172:175], v[60:63], a[196:199], v[172:175]
ds_read_b64_tr_b16 v[54:55], v21 offset:9216
s_add_u32 s83, s66, s76
s_waitcnt lgkmcnt(12)
v_mfma_f32_16x16x32_bf16 v[112:115], v[32:35], a[200:203], v[112:115]
ds_read_b64_tr_b16 v[56:57], v22 offset:8192
buffer_load_dwordx4 v8, s[16:19], s82 offen offset:0 lds
v_mfma_f32_16x16x32_bf16 v[116:119], v[32:35], a[204:207], v[116:119]
ds_read_b64_tr_b16 v[58:59], v22 offset:9216
v_mfma_f32_16x16x32_bf16 v[176:179], v[32:35], v[24:27], v[176:179]
v_mfma_f32_16x16x32_bf16 v[120:123], v[36:39], a[200:203], v[120:123]
ds_read_b64_tr_b16 v[60:61], v23 offset:8192
buffer_load_dwordx4 v9, s[16:19], s82 offen offset:1024 lds
v_mfma_f32_16x16x32_bf16 v[124:127], v[36:39], a[204:207], v[124:127]
ds_read_b64_tr_b16 v[62:63], v23 offset:9216
v_mfma_f32_16x16x32_bf16 v[180:183], v[36:39], v[24:27], v[180:183]
s_waitcnt lgkmcnt(10)
v_mfma_f32_16x16x32_bf16 v[128:131], v[40:43], a[200:203], v[128:131]
s_waitcnt vmcnt(12)
s_barrier
ds_read_b64_tr_b16 v[32:33], v16 offset:16384
v_mfma_f32_16x16x32_bf16 v[132:135], v[40:43], a[204:207], v[132:135]
ds_read_b64_tr_b16 v[34:35], v16 offset:17408
buffer_load_dwordx4 v10, s[16:19], s83 offen offset:2048 lds
v_mfma_f32_16x16x32_bf16 v[136:139], v[44:47], a[200:203], v[136:139]
ds_read_b64_tr_b16 v[36:37], v17 offset:16384
v_mfma_f32_16x16x32_bf16 v[140:143], v[44:47], a[204:207], v[140:143]
ds_read_b64_tr_b16 v[38:39], v17 offset:17408
s_waitcnt lgkmcnt(8)
v_mfma_f32_16x16x32_bf16 v[144:147], v[48:51], a[200:203], v[144:147]
ds_read_b64_tr_b16 v[40:41], v18 offset:16384
buffer_load_dwordx4 v11, s[16:19], s83 offen offset:3072 lds
s_add_u32 m0, s74, 49152
v_mfma_f32_16x16x32_bf16 v[148:151], v[48:51], a[204:207], v[148:151]
ds_read_b64_tr_b16 v[42:43], v18 offset:17408
s_mul_i32 s82, s72, 1792
buffer_load_dwordx4 v12, s[12:15], s82 offen offset:0 lds
v_mfma_f32_16x16x32_bf16 v[152:155], v[52:55], a[200:203], v[152:155]
ds_read_b64_tr_b16 v[44:45], v19 offset:16384
v_mfma_f32_16x16x32_bf16 v[156:159], v[52:55], a[204:207], v[156:159]
ds_read_b64_tr_b16 v[46:47], v19 offset:17408
s_waitcnt lgkmcnt(8)
v_mfma_f32_16x16x32_bf16 v[160:163], v[56:59], a[200:203], v[160:163]
ds_read_b64_tr_b16 v[48:49], v20 offset:16384
buffer_load_dwordx4 v13, s[12:15], s82 offen offset:1024 lds
v_mfma_f32_16x16x32_bf16 v[164:167], v[56:59], a[204:207], v[164:167]
ds_read_b64_tr_b16 v[50:51], v20 offset:17408
v_mfma_f32_16x16x32_bf16 v[168:171], v[60:63], a[200:203], v[168:171]
ds_read_b64_tr_b16 v[52:53], v21 offset:16384
v_mfma_f32_16x16x32_bf16 v[172:175], v[60:63], a[204:207], v[172:175]
ds_read_b64_tr_b16 v[54:55], v21 offset:17408
buffer_load_dwordx4 v14, s[12:15], s82 offen offset:2048 lds
s_waitcnt lgkmcnt(8)
v_mfma_f32_16x16x32_bf16 v[112:115], v[32:35], a[208:211], v[112:115]
ds_read_b64_tr_b16 v[56:57], v22 offset:16384
v_mfma_f32_16x16x32_bf16 v[116:119], v[32:35], a[212:215], v[116:119]
ds_read_b64_tr_b16 v[58:59], v22 offset:17408
v_mfma_f32_16x16x32_bf16 v[176:179], v[32:35], v[24:27], v[176:179]
buffer_load_dwordx4 v15, s[12:15], s82 offen offset:3072 lds
s_add_u32 s72, s72, 128
s_and_b32 s72, s72, 0x380
v_mfma_f32_16x16x32_bf16 v[120:123], v[36:39], a[208:211], v[120:123]
ds_read_b64_tr_b16 v[60:61], v23 offset:16384
ds_read_b128 a[96:99], v2 offset:16384
v_mfma_f32_16x16x32_bf16 v[124:127], v[36:39], a[212:215], v[124:127]
ds_read_b64_tr_b16 v[62:63], v23 offset:17408
ds_read_b128 a[100:103], v2 offset:18432
ds_read_b128 a[112:115], v3 offset:16384
v_mfma_f32_16x16x32_bf16 v[180:183], v[36:39], v[24:27], v[180:183]
ds_read_b128 a[116:119], v3 offset:18432
s_waitcnt lgkmcnt(12)
v_mfma_f32_16x16x32_bf16 v[128:131], v[40:43], a[208:211], v[128:131]
ds_read_b64_tr_b16 v[32:33], v16 offset:24576
s_add_u32 m0, s77, 8192
s_add_u32 s82, s65, s76
v_mfma_f32_16x16x32_bf16 v[132:135], v[40:43], a[212:215], v[132:135]
ds_read_b64_tr_b16 v[34:35], v16 offset:25600
s_add_u32 s83, s67, s76
buffer_load_dwordx4 v8, s[16:19], s82 offen offset:0 lds
v_mfma_f32_16x16x32_bf16 v[136:139], v[44:47], a[208:211], v[136:139]
ds_read_b64_tr_b16 v[36:37], v17 offset:24576
v_mfma_f32_16x16x32_bf16 v[140:143], v[44:47], a[212:215], v[140:143]
ds_read_b64_tr_b16 v[38:39], v17 offset:25600
s_waitcnt lgkmcnt(12)
v_mfma_f32_16x16x32_bf16 v[144:147], v[48:51], a[208:211], v[144:147]
ds_read_b64_tr_b16 v[40:41], v18 offset:24576
buffer_load_dwordx4 v9, s[16:19], s82 offen offset:1024 lds
v_mfma_f32_16x16x32_bf16 v[148:151], v[48:51], a[212:215], v[148:151]
ds_read_b64_tr_b16 v[42:43], v18 offset:25600
v_mfma_f32_16x16x32_bf16 v[152:155], v[52:55], a[208:211], v[152:155]
ds_read_b64_tr_b16 v[44:45], v19 offset:24576
v_mfma_f32_16x16x32_bf16 v[156:159], v[52:55], a[212:215], v[156:159]
ds_read_b64_tr_b16 v[46:47], v19 offset:25600
buffer_load_dwordx4 v10, s[16:19], s83 offen offset:2048 lds
s_waitcnt lgkmcnt(11)
v_mfma_f32_16x16x32_bf16 v[160:163], v[56:59], a[208:211], v[160:163]
ds_read_b64_tr_b16 v[48:49], v20 offset:24576
v_mfma_f32_16x16x32_bf16 v[164:167], v[56:59], a[212:215], v[164:167]
ds_read_b64_tr_b16 v[50:51], v20 offset:25600
v_mfma_f32_16x16x32_bf16 v[168:171], v[60:63], a[208:211], v[168:171]
ds_read_b64_tr_b16 v[52:53], v21 offset:24576
buffer_load_dwordx4 v11, s[16:19], s83 offen offset:3072 lds
v_mfma_f32_16x16x32_bf16 v[172:175], v[60:63], a[212:215], v[172:175]
ds_read_b64_tr_b16 v[54:55], v21 offset:25600
s_waitcnt lgkmcnt(8)
v_mfma_f32_16x16x32_bf16 v[112:115], v[32:35], a[216:219], v[112:115]
ds_read_b64_tr_b16 v[56:57], v22 offset:24576
v_mfma_f32_16x16x32_bf16 v[116:119], v[32:35], a[220:223], v[116:119]
ds_read_b64_tr_b16 v[58:59], v22 offset:25600
v_mfma_f32_16x16x32_bf16 v[176:179], v[32:35], v[24:27], v[176:179]
v_mfma_f32_16x16x32_bf16 v[120:123], v[36:39], a[216:219], v[120:123]
ds_read_b64_tr_b16 v[60:61], v23 offset:24576
v_mfma_f32_16x16x32_bf16 v[124:127], v[36:39], a[220:223], v[124:127]
ds_read_b64_tr_b16 v[62:63], v23 offset:25600
v_mfma_f32_16x16x32_bf16 v[180:183], v[36:39], v[24:27], v[180:183]
s_waitcnt lgkmcnt(8)
v_mfma_f32_16x16x32_bf16 v[128:131], v[40:43], a[216:219], v[128:131]
s_waitcnt vmcnt(12)
s_barrier
ds_read_b64_tr_b16 v[32:33], v16 offset:32768
v_mfma_f32_16x16x32_bf16 v[132:135], v[40:43], a[220:223], v[132:135]
ds_read_b64_tr_b16 v[34:35], v16 offset:33792
v_mfma_f32_16x16x32_bf16 v[136:139], v[44:47], a[216:219], v[136:139]
ds_read_b64_tr_b16 v[36:37], v17 offset:32768
s_lshl_b32 s84, s45, 3
s_add_u32 s84, s84, s46
v_mfma_f32_16x16x32_bf16 v[140:143], v[44:47], a[220:223], v[140:143]
ds_read_b64_tr_b16 v[38:39], v17 offset:33792
s_lshl_b32 s84, s84, 5
s_waitcnt lgkmcnt(8)
v_mfma_f32_16x16x32_bf16 v[144:147], v[48:51], a[216:219], v[144:147]
ds_read_b64_tr_b16 v[40:41], v18 offset:32768
s_add_u32 s84, s84, s44
s_lshl_b32 s84, s84, 2
v_mfma_f32_16x16x32_bf16 v[148:151], v[48:51], a[220:223], v[148:151]
ds_read_b64_tr_b16 v[42:43], v18 offset:33792
s_add_u32 s84, s84, 0x4000
v_mfma_f32_16x16x32_bf16 v[152:155], v[52:55], a[216:219], v[152:155]
ds_read_b64_tr_b16 v[44:45], v19 offset:32768
buffer_store_dword v28, off, s[20:23], s84 sc1
v_mfma_f32_16x16x32_bf16 v[156:159], v[52:55], a[220:223], v[156:159]
ds_read_b64_tr_b16 v[46:47], v19 offset:33792
ds_read_b128 a[104:107], v2 offset:0
s_waitcnt lgkmcnt(9)
v_mfma_f32_16x16x32_bf16 v[160:163], v[56:59], a[216:219], v[160:163]
ds_read_b64_tr_b16 v[48:49], v20 offset:32768
ds_read_b128 a[108:111], v2 offset:2048
ds_read_b128 a[120:123], v3 offset:0
v_mfma_f32_16x16x32_bf16 v[164:167], v[56:59], a[220:223], v[164:167]
ds_read_b64_tr_b16 v[50:51], v20 offset:33792
ds_read_b128 a[124:127], v3 offset:2048
v_mfma_f32_16x16x32_bf16 v[168:171], v[60:63], a[216:219], v[168:171]
ds_read_b64_tr_b16 v[52:53], v21 offset:32768
s_add_u32 m0, s77, 12288
s_add_u32 s76, s76, 128
v_mfma_f32_16x16x32_bf16 v[172:175], v[60:63], a[220:223], v[172:175]
ds_read_b64_tr_b16 v[54:55], v21 offset:33792
s_and_b32 s76, s76, 0x380
s_waitcnt lgkmcnt(12)
v_mfma_f32_16x16x32_bf16 v[112:115], v[32:35], a[224:227], v[112:115]
ds_read_b64_tr_b16 v[56:57], v22 offset:32768
s_add_u32 s82, s64, s76
s_add_u32 s83, s66, s76
v_mfma_f32_16x16x32_bf16 v[116:119], v[32:35], a[228:231], v[116:119]
ds_read_b64_tr_b16 v[58:59], v22 offset:33792
buffer_load_dwordx4 v8, s[16:19], s82 offen offset:0 lds
v_mfma_f32_16x16x32_bf16 v[176:179], v[32:35], v[24:27], v[176:179]
v_mfma_f32_16x16x32_bf16 v[120:123], v[36:39], a[224:227], v[120:123]
ds_read_b64_tr_b16 v[60:61], v23 offset:32768
v_mfma_f32_16x16x32_bf16 v[124:127], v[36:39], a[228:231], v[124:127]
ds_read_b64_tr_b16 v[62:63], v23 offset:33792
buffer_load_dwordx4 v9, s[16:19], s82 offen offset:1024 lds
v_mfma_f32_16x16x32_bf16 v[180:183], v[36:39], v[24:27], v[180:183]
s_waitcnt lgkmcnt(12)
v_mfma_f32_16x16x32_bf16 v[128:131], v[40:43], a[224:227], v[128:131]
ds_read_b64_tr_b16 v[32:33], v16 offset:40960
v_mfma_f32_16x16x32_bf16 v[132:135], v[40:43], a[228:231], v[132:135]
ds_read_b64_tr_b16 v[34:35], v16 offset:41984
buffer_load_dwordx4 v10, s[16:19], s83 offen offset:2048 lds
v_mfma_f32_16x16x32_bf16 v[136:139], v[44:47], a[224:227], v[136:139]
ds_read_b64_tr_b16 v[36:37], v17 offset:40960
v_mfma_f32_16x16x32_bf16 v[140:143], v[44:47], a[228:231], v[140:143]
ds_read_b64_tr_b16 v[38:39], v17 offset:41984
s_waitcnt lgkmcnt(8)
v_mfma_f32_16x16x32_bf16 v[144:147], v[48:51], a[224:227], v[144:147]
ds_read_b64_tr_b16 v[40:41], v18 offset:40960
buffer_load_dwordx4 v11, s[16:19], s83 offen offset:3072 lds
v_mfma_f32_16x16x32_bf16 v[148:151], v[48:51], a[228:231], v[148:151]
ds_read_b64_tr_b16 v[42:43], v18 offset:41984
v_mfma_f32_16x16x32_bf16 v[152:155], v[52:55], a[224:227], v[152:155]
ds_read_b64_tr_b16 v[44:45], v19 offset:40960
v_mfma_f32_16x16x32_bf16 v[156:159], v[52:55], a[228:231], v[156:159]
ds_read_b64_tr_b16 v[46:47], v19 offset:41984
s_waitcnt lgkmcnt(8)
v_mfma_f32_16x16x32_bf16 v[160:163], v[56:59], a[224:227], v[160:163]
ds_read_b64_tr_b16 v[48:49], v20 offset:40960
v_mfma_f32_16x16x32_bf16 v[164:167], v[56:59], a[228:231], v[164:167]
ds_read_b64_tr_b16 v[50:51], v20 offset:41984
v_mfma_f32_16x16x32_bf16 v[168:171], v[60:63], a[224:227], v[168:171]
ds_read_b64_tr_b16 v[52:53], v21 offset:40960
v_mfma_f32_16x16x32_bf16 v[172:175], v[60:63], a[228:231], v[172:175]
ds_read_b64_tr_b16 v[54:55], v21 offset:41984
s_waitcnt lgkmcnt(8)
v_mfma_f32_16x16x32_bf16 v[112:115], v[32:35], a[232:235], v[112:115]
ds_read_b64_tr_b16 v[56:57], v22 offset:40960
v_lshrrev_b32 v29, 4, v0
v_lshlrev_b32 v29, 4, v29
v_mfma_f32_16x16x32_bf16 v[116:119], v[32:35], a[236:239], v[116:119]
ds_read_b64_tr_b16 v[58:59], v22 offset:41984
v_add_u32 v29, 66048, v29
s_lshl_b32 s84, s78, 6
v_mfma_f32_16x16x32_bf16 v[176:179], v[32:35], v[24:27], v[176:179]
v_add_u32 v30, s84, v29
v_mfma_f32_16x16x32_bf16 v[120:123], v[36:39], a[232:235], v[120:123]
ds_read_b64_tr_b16 v[60:61], v23 offset:40960
v_mfma_f32_16x16x32_bf16 v[124:127], v[36:39], a[236:239], v[124:127]
ds_read_b64_tr_b16 v[62:63], v23 offset:41984
v_mfma_f32_16x16x32_bf16 v[180:183], v[36:39], v[24:27], v[180:183]
s_waitcnt lgkmcnt(8)
v_mfma_f32_16x16x32_bf16 v[128:131], v[40:43], a[232:235], v[128:131]
s_waitcnt vmcnt(9)
s_barrier
ds_read_b64_tr_b16 v[32:33], v16 offset:49152
v_mfma_f32_16x16x32_bf16 v[132:135], v[40:43], a[236:239], v[132:135]
ds_read_b64_tr_b16 v[34:35], v16 offset:50176
v_mfma_f32_16x16x32_bf16 v[136:139], v[44:47], a[232:235], v[136:139]
ds_read_b64_tr_b16 v[36:37], v17 offset:49152
ds_read_b128 v[192:195], v2 offset:4096
v_mfma_f32_16x16x32_bf16 v[140:143], v[44:47], a[236:239], v[140:143]
ds_read_b64_tr_b16 v[38:39], v17 offset:50176
ds_read_b128 v[196:199], v2 offset:6144
s_waitcnt lgkmcnt(10)
v_mfma_f32_16x16x32_bf16 v[144:147], v[48:51], a[232:235], v[144:147]
ds_read_b64_tr_b16 v[40:41], v16 offset:57344
ds_read_b128 v[208:211], v3 offset:4096
ds_read_b128 v[212:215], v3 offset:6144
v_mfma_f32_16x16x32_bf16 v[148:151], v[48:51], a[236:239], v[148:151]
ds_read_b64_tr_b16 v[42:43], v16 offset:58368
s_add_u32 m0, s77, 16384
v_mfma_f32_16x16x32_bf16 v[152:155], v[52:55], a[232:235], v[152:155]
ds_read_b64_tr_b16 v[44:45], v17 offset:57344
s_add_u32 s82, s65, s76
s_add_u32 s83, s67, s76
v_mfma_f32_16x16x32_bf16 v[156:159], v[52:55], a[236:239], v[156:159]
ds_read_b64_tr_b16 v[46:47], v17 offset:58368
buffer_load_dwordx4 v8, s[16:19], s82 offen offset:0 lds
s_waitcnt lgkmcnt(12)
v_mfma_f32_16x16x32_bf16 v[160:163], v[56:59], a[232:235], v[160:163]
ds_read_b64_tr_b16 v[48:49], v18 offset:49152
v_mfma_f32_16x16x32_bf16 v[164:167], v[56:59], a[236:239], v[164:167]
ds_read_b64_tr_b16 v[50:51], v18 offset:50176
v_mfma_f32_16x16x32_bf16 v[168:171], v[60:63], a[232:235], v[168:171]
ds_read_b64_tr_b16 v[52:53], v19 offset:49152
buffer_load_dwordx4 v9, s[16:19], s82 offen offset:1024 lds
v_mfma_f32_16x16x32_bf16 v[172:175], v[60:63], a[236:239], v[172:175]
ds_read_b64_tr_b16 v[54:55], v19 offset:50176
s_waitcnt lgkmcnt(11)
v_mfma_f32_16x16x32_bf16 v[112:115], v[32:35], a[240:243], v[112:115]
ds_read_b64_tr_b16 v[56:57], v20 offset:49152
v_mfma_f32_16x16x32_bf16 v[116:119], v[32:35], a[244:247], v[116:119]
ds_read_b64_tr_b16 v[58:59], v20 offset:50176
buffer_load_dwordx4 v10, s[16:19], s83 offen offset:2048 lds
v_mfma_f32_16x16x32_bf16 v[176:179], v[32:35], v[24:27], v[176:179]
v_mfma_f32_16x16x32_bf16 v[120:123], v[36:39], a[240:243], v[120:123]
ds_read_b64_tr_b16 v[60:61], v21 offset:49152
v_mfma_f32_16x16x32_bf16 v[124:127], v[36:39], a[244:247], v[124:127]
ds_read_b64_tr_b16 v[62:63], v21 offset:50176
buffer_load_dwordx4 v11, s[16:19], s83 offen offset:3072 lds
s_lshl_b32 s84, s71, 2
v_mfma_f32_16x16x32_bf16 v[180:183], v[36:39], v[24:27], v[180:183]
s_lshr_b32 s85, 0x76443200, s84
s_and_b32 s85, s85, 15
s_waitcnt lgkmcnt(8)
v_mfma_f32_16x16x32_bf16 v[112:115], v[40:43], a[248:251], v[112:115]
ds_read_b64_tr_b16 v[32:33], v22 offset:49152
v_mov_b32 v5, s85
s_lshr_b32 s85, 0x77543310, s84
v_mfma_f32_16x16x32_bf16 v[116:119], v[40:43], a[252:255], v[116:119]
ds_read_b64_tr_b16 v[34:35], v22 offset:50176
s_and_b32 s85, s85, 15
v_mov_b32 v6, s85
v_mfma_f32_16x16x32_bf16 v[176:179], v[40:43], v[24:27], v[176:179]
v_cndmask_b32 v5, v5, v6, s[92:93]
v_lshlrev_b32 v5, 7, v5
v_bfe_u32 v6, v0, 1, 2
v_mfma_f32_16x16x32_bf16 v[120:123], v[44:47], a[248:251], v[120:123]
ds_read_b64_tr_b16 v[36:37], v23 offset:49152
v_lshl_add_u32 v6, v6, 10, v5
s_lshl_b32 s100, s44, 12
v_mfma_f32_16x16x32_bf16 v[124:127], v[44:47], a[252:255], v[124:127]
ds_read_b64_tr_b16 v[38:39], v23 offset:50176
s_add_u32 s100, s100, 0x4000
v_and_b32 v4, 1, v0
v_mfma_f32_16x16x32_bf16 v[180:183], v[44:47], v[24:27], v[180:183]
v_lshlrev_b32 v4, 7, v4
s_lshr_b32 s97, s70, 1
s_waitcnt lgkmcnt(8)
v_mfma_f32_16x16x32_bf16 v[128:131], v[48:51], a[240:243], v[128:131]
ds_read_b64_tr_b16 v[40:41], v18 offset:57344
s_lshl_b32 s97, s97, 2
s_add_u32 s97, s97, s44
v_mfma_f32_16x16x32_bf16 v[132:135], v[48:51], a[244:247], v[132:135]
ds_read_b64_tr_b16 v[42:43], v18 offset:58368
s_lshl_b32 s97, s97, 8
s_add_u32 s97, s97, 0xc000
v_mfma_f32_16x16x32_bf16 v[136:139], v[52:55], a[240:243], v[136:139]
ds_read_b64_tr_b16 v[44:45], v19 offset:57344
buffer_load_dwordx4 v[12:15], v6, s[20:23], s100 offen sc1
v_mfma_f32_16x16x32_bf16 v[140:143], v[52:55], a[244:247], v[140:143]
ds_read_b64_tr_b16 v[46:47], v19 offset:58368
ds_write_b128 v30, v[176:179]
s_waitcnt lgkmcnt(9)
v_mfma_f32_16x16x32_bf16 v[144:147], v[56:59], a[240:243], v[144:147]
ds_read_b64_tr_b16 v[48:49], v20 offset:57344
ds_write_b128 v30, v[180:183] offset:64
v_mfma_f32_16x16x32_bf16 v[148:151], v[56:59], a[244:247], v[148:151]
ds_read_b64_tr_b16 v[50:51], v20 offset:58368
v_mfma_f32_16x16x32_bf16 v[152:155], v[60:63], a[240:243], v[152:155]
ds_read_b64_tr_b16 v[52:53], v21 offset:57344
v_mfma_f32_16x16x32_bf16 v[156:159], v[60:63], a[244:247], v[156:159]
ds_read_b64_tr_b16 v[54:55], v21 offset:58368
s_waitcnt lgkmcnt(3)
v_mfma_f32_16x16x32_bf16 v[160:163], v[32:35], a[240:243], v[160:163]
ds_read_b64_tr_b16 v[56:57], v22 offset:57344
s_barrier
s_lshl_b32 s84, s78, 6
v_mfma_f32_16x16x32_bf16 v[164:167], v[32:35], a[244:247], v[164:167]
ds_read_b64_tr_b16 v[58:59], v22 offset:58368
v_add_u32 v30, s84, v29
ds_read_b128 v[64:67], v30
v_mfma_f32_16x16x32_bf16 v[168:171], v[36:39], a[240:243], v[168:171]
ds_read_b64_tr_b16 v[60:61], v23 offset:57344
ds_read_b128 v[68:71], v30 offset:64
s_lshl_b32 s84, s79, 6
v_mfma_f32_16x16x32_bf16 v[172:175], v[36:39], a[244:247], v[172:175]
ds_read_b64_tr_b16 v[62:63], v23 offset:58368
v_add_u32 v30, s84, v29
v_mfma_f32_16x16x32_bf16 v[128:131], v[40:43], a[248:251], v[128:131]
ds_read_b128 v[72:75], v30
ds_read_b128 v[76:79], v30 offset:64
s_lshl_b32 s84, s80, 6
v_mfma_f32_16x16x32_bf16 v[132:135], v[40:43], a[252:255], v[132:135]
v_add_u32 v30, s84, v29
ds_read_b128 v[80:83], v30
ds_read_b128 v[84:87], v30 offset:64
v_mfma_f32_16x16x32_bf16 v[136:139], v[44:47], a[248:251], v[136:139]
s_lshl_b32 s84, s81, 6
v_add_u32 v30, s84, v29
ds_read_b128 v[88:91], v30
v_mfma_f32_16x16x32_bf16 v[140:143], v[44:47], a[252:255], v[140:143]
ds_read_b128 v[92:95], v30 offset:64
s_waitcnt lgkmcnt(12)
v_mfma_f32_16x16x32_bf16 v[144:147], v[48:51], a[248:251], v[144:147]
v_mfma_f32_16x16x32_bf16 v[148:151], v[48:51], a[252:255], v[148:151]
v_mfma_f32_16x16x32_bf16 v[152:155], v[52:55], a[248:251], v[152:155]
v_mfma_f32_16x16x32_bf16 v[156:159], v[52:55], a[252:255], v[156:159]
s_waitcnt lgkmcnt(6)
v_mfma_f32_16x16x32_bf16 v[160:163], v[56:59], a[248:251], v[160:163]
v_mfma_f32_16x16x32_bf16 v[164:167], v[56:59], a[252:255], v[164:167]
v_mfma_f32_16x16x32_bf16 v[168:171], v[60:63], a[248:251], v[168:171]
v_mfma_f32_16x16x32_bf16 v[172:175], v[60:63], a[252:255], v[172:175]
s_lshl_b32 s85, s45, 3
s_lshl_b32 s84, s44, 1
s_add_u32 s85, s85, s84
s_mul_i32 s85, s85, 28672
s_and_b32 s84, s101, 0xfc
s_lshl_b32 s84, s84, 9
s_add_u32 s85, s85, s84
s_add_u32 s85, s85, 0x500000
v_add_u32 v29, 28672, v1
s_waitcnt vmcnt(10)
ds_read_b128 v[200:203], v2 offset:8192
s_lshl_b32 s84, s78, 9
ds_read_b128 v[204:207], v2 offset:10240
s_add_u32 s78, s84, s85
ds_read_b128 v[216:219], v3 offset:8192
v_pk_mul_f32 v[32:33], v[64:65], v[184:185] op_sel:[0,1] op_sel_hi:[1,1]
ds_read_b128 v[220:223], v3 offset:10240
v_pk_mul_f32 v[34:35], v[66:67], v[184:185] op_sel:[0,1] op_sel_hi:[1,1]
s_add_u32 m0, s77, 0
v_pk_mul_f32 v[36:37], v[68:69], v[184:185] op_sel:[0,1] op_sel_hi:[1,1]
s_add_u32 s76, s76, 128
v_pk_mul_f32 v[38:39], v[70:71], v[184:185] op_sel:[0,1] op_sel_hi:[1,1]
s_and_b32 s76, s76, 0x380
v_pk_fma_f32 v[112:113], v[112:113], v[184:185], v[32:33] op_sel_hi:[1,0,1] neg_lo:[0,0,1] neg_hi:[0,0,1]
s_add_u32 s82, s64, s76
v_pk_fma_f32 v[114:115], v[114:115], v[184:185], v[34:35] op_sel_hi:[1,0,1] neg_lo:[0,0,1] neg_hi:[0,0,1]
s_add_u32 s83, s66, s76
v_pk_fma_f32 v[120:121], v[120:121], v[184:185], v[36:37] op_sel_hi:[1,0,1] neg_lo:[0,0,1] neg_hi:[0,0,1]
buffer_load_dwordx4 v8, s[16:19], s82 offen offset:0 lds
v_pk_fma_f32 v[122:123], v[122:123], v[184:185], v[38:39] op_sel_hi:[1,0,1] neg_lo:[0,0,1] neg_hi:[0,0,1]
v_cvt_pk_bf16_f32 v40, v112, v113
v_cvt_pk_bf16_f32 v41, v114, v115
v_cvt_pk_bf16_f32 v42, v120, v121
v_cvt_pk_bf16_f32 v43, v122, v123
buffer_store_dwordx4 v[40:43], v1, s[20:23], s78 offen sc1
v_pk_mul_f32 v[32:33], v[64:65], v[186:187] op_sel:[0,1] op_sel_hi:[1,1]
v_pk_mul_f32 v[34:35], v[66:67], v[186:187] op_sel:[0,1] op_sel_hi:[1,1]
v_pk_mul_f32 v[36:37], v[68:69], v[186:187] op_sel:[0,1] op_sel_hi:[1,1]
v_pk_mul_f32 v[38:39], v[70:71], v[186:187] op_sel:[0,1] op_sel_hi:[1,1]
v_pk_fma_f32 v[116:117], v[116:117], v[186:187], v[32:33] op_sel_hi:[1,0,1] neg_lo:[0,0,1] neg_hi:[0,0,1]
v_pk_fma_f32 v[118:119], v[118:119], v[186:187], v[34:35] op_sel_hi:[1,0,1] neg_lo:[0,0,1] neg_hi:[0,0,1]
buffer_load_dwordx4 v9, s[16:19], s82 offen offset:1024 lds
v_pk_fma_f32 v[124:125], v[124:125], v[186:187], v[36:37] op_sel_hi:[1,0,1] neg_lo:[0,0,1] neg_hi:[0,0,1]
v_pk_fma_f32 v[126:127], v[126:127], v[186:187], v[38:39] op_sel_hi:[1,0,1] neg_lo:[0,0,1] neg_hi:[0,0,1]
v_cvt_pk_bf16_f32 v44, v116, v117
v_cvt_pk_bf16_f32 v45, v118, v119
v_cvt_pk_bf16_f32 v46, v124, v125
v_cvt_pk_bf16_f32 v47, v126, v127
buffer_store_dwordx4 v[44:47], v29, s[20:23], s78 offen sc1
s_lshl_b32 s84, s79, 9
s_add_u32 s79, s84, s85
s_waitcnt lgkmcnt(9)
v_pk_mul_f32 v[32:33], v[72:73], v[184:185] op_sel:[0,1] op_sel_hi:[1,1]
v_pk_mul_f32 v[34:35], v[74:75], v[184:185] op_sel:[0,1] op_sel_hi:[1,1]
s_waitcnt lgkmcnt(8)
v_pk_mul_f32 v[36:37], v[76:77], v[184:185] op_sel:[0,1] op_sel_hi:[1,1]
buffer_load_dwordx4 v10, s[16:19], s83 offen offset:2048 lds
v_pk_mul_f32 v[38:39], v[78:79], v[184:185] op_sel:[0,1] op_sel_hi:[1,1]
v_pk_fma_f32 v[128:129], v[128:129], v[184:185], v[32:33] op_sel_hi:[1,0,1] neg_lo:[0,0,1] neg_hi:[0,0,1]
v_pk_fma_f32 v[130:131], v[130:131], v[184:185], v[34:35] op_sel_hi:[1,0,1] neg_lo:[0,0,1] neg_hi:[0,0,1]
v_pk_fma_f32 v[136:137], v[136:137], v[184:185], v[36:37] op_sel_hi:[1,0,1] neg_lo:[0,0,1] neg_hi:[0,0,1]
v_pk_fma_f32 v[138:139], v[138:139], v[184:185], v[38:39] op_sel_hi:[1,0,1] neg_lo:[0,0,1] neg_hi:[0,0,1]
v_cvt_pk_bf16_f32 v48, v128, v129
v_cvt_pk_bf16_f32 v49, v130, v131
v_cvt_pk_bf16_f32 v50, v136, v137
v_cvt_pk_bf16_f32 v51, v138, v139
buffer_store_dwordx4 v[48:51], v1, s[20:23], s79 offen sc1
v_pk_mul_f32 v[32:33], v[72:73], v[186:187] op_sel:[0,1] op_sel_hi:[1,1]
v_pk_mul_f32 v[34:35], v[74:75], v[186:187] op_sel:[0,1] op_sel_hi:[1,1]
buffer_load_dwordx4 v11, s[16:19], s83 offen offset:3072 lds
v_pk_mul_f32 v[36:37], v[76:77], v[186:187] op_sel:[0,1] op_sel_hi:[1,1]
s_waitcnt vmcnt(12)
ds_read_b128 v[224:227], v2 offset:12288
v_pk_mul_f32 v[38:39], v[78:79], v[186:187] op_sel:[0,1] op_sel_hi:[1,1]
ds_read_b128 v[228:231], v2 offset:14336
v_pk_fma_f32 v[132:133], v[132:133], v[186:187], v[32:33] op_sel_hi:[1,0,1] neg_lo:[0,0,1] neg_hi:[0,0,1]
ds_read_b128 v[240:243], v3 offset:12288
v_pk_fma_f32 v[134:135], v[134:135], v[186:187], v[34:35] op_sel_hi:[1,0,1] neg_lo:[0,0,1] neg_hi:[0,0,1]
ds_read_b128 v[244:247], v3 offset:14336
v_pk_fma_f32 v[140:141], v[140:141], v[186:187], v[36:37] op_sel_hi:[1,0,1] neg_lo:[0,0,1] neg_hi:[0,0,1]
s_add_u32 m0, s77, 4096
v_pk_fma_f32 v[142:143], v[142:143], v[186:187], v[38:39] op_sel_hi:[1,0,1] neg_lo:[0,0,1] neg_hi:[0,0,1]
s_add_u32 s82, s65, s76
v_cvt_pk_bf16_f32 v52, v132, v133
s_add_u32 s83, s67, s76
v_cvt_pk_bf16_f32 v53, v134, v135
buffer_load_dwordx4 v8, s[16:19], s82 offen offset:0 lds
v_cvt_pk_bf16_f32 v54, v140, v141
v_cvt_pk_bf16_f32 v55, v142, v143
buffer_store_dwordx4 v[52:55], v29, s[20:23], s79 offen sc1
s_lshl_b32 s84, s80, 9
s_add_u32 s80, s84, s85
s_waitcnt lgkmcnt(11)
v_pk_mul_f32 v[32:33], v[80:81], v[184:185] op_sel:[0,1] op_sel_hi:[1,1]
v_pk_mul_f32 v[34:35], v[82:83], v[184:185] op_sel:[0,1] op_sel_hi:[1,1]
s_waitcnt lgkmcnt(10)
v_pk_mul_f32 v[36:37], v[84:85], v[184:185] op_sel:[0,1] op_sel_hi:[1,1]
v_pk_mul_f32 v[38:39], v[86:87], v[184:185] op_sel:[0,1] op_sel_hi:[1,1]
v_pk_fma_f32 v[144:145], v[144:145], v[184:185], v[32:33] op_sel_hi:[1,0,1] neg_lo:[0,0,1] neg_hi:[0,0,1]
v_pk_fma_f32 v[146:147], v[146:147], v[184:185], v[34:35] op_sel_hi:[1,0,1] neg_lo:[0,0,1] neg_hi:[0,0,1]
v_pk_fma_f32 v[152:153], v[152:153], v[184:185], v[36:37] op_sel_hi:[1,0,1] neg_lo:[0,0,1] neg_hi:[0,0,1]
buffer_load_dwordx4 v9, s[16:19], s82 offen offset:1024 lds
v_pk_fma_f32 v[154:155], v[154:155], v[184:185], v[38:39] op_sel_hi:[1,0,1] neg_lo:[0,0,1] neg_hi:[0,0,1]
v_cvt_pk_bf16_f32 v56, v144, v145
v_cvt_pk_bf16_f32 v57, v146, v147
v_cvt_pk_bf16_f32 v58, v152, v153
v_cvt_pk_bf16_f32 v59, v154, v155
buffer_store_dwordx4 v[56:59], v1, s[20:23], s80 offen sc1
v_pk_mul_f32 v[32:33], v[80:81], v[186:187] op_sel:[0,1] op_sel_hi:[1,1]
v_pk_mul_f32 v[34:35], v[82:83], v[186:187] op_sel:[0,1] op_sel_hi:[1,1]
v_pk_mul_f32 v[36:37], v[84:85], v[186:187] op_sel:[0,1] op_sel_hi:[1,1]
v_pk_mul_f32 v[38:39], v[86:87], v[186:187] op_sel:[0,1] op_sel_hi:[1,1]
v_pk_fma_f32 v[148:149], v[148:149], v[186:187], v[32:33] op_sel_hi:[1,0,1] neg_lo:[0,0,1] neg_hi:[0,0,1]
v_pk_fma_f32 v[150:151], v[150:151], v[186:187], v[34:35] op_sel_hi:[1,0,1] neg_lo:[0,0,1] neg_hi:[0,0,1]
buffer_load_dwordx4 v10, s[16:19], s83 offen offset:2048 lds
v_pk_fma_f32 v[156:157], v[156:157], v[186:187], v[36:37] op_sel_hi:[1,0,1] neg_lo:[0,0,1] neg_hi:[0,0,1]
v_pk_fma_f32 v[158:159], v[158:159], v[186:187], v[38:39] op_sel_hi:[1,0,1] neg_lo:[0,0,1] neg_hi:[0,0,1]
v_cvt_pk_bf16_f32 v60, v148, v149
v_cvt_pk_bf16_f32 v61, v150, v151
v_cvt_pk_bf16_f32 v62, v156, v157
v_cvt_pk_bf16_f32 v63, v158, v159
buffer_store_dwordx4 v[60:63], v29, s[20:23], s80 offen sc1
s_lshl_b32 s84, s81, 9
s_add_u32 s81, s84, s85
s_waitcnt lgkmcnt(9)
v_pk_mul_f32 v[32:33], v[88:89], v[184:185] op_sel:[0,1] op_sel_hi:[1,1]
v_pk_mul_f32 v[34:35], v[90:91], v[184:185] op_sel:[0,1] op_sel_hi:[1,1]
s_waitcnt lgkmcnt(8)
v_pk_mul_f32 v[36:37], v[92:93], v[184:185] op_sel:[0,1] op_sel_hi:[1,1]
buffer_load_dwordx4 v11, s[16:19], s83 offen offset:3072 lds
v_pk_mul_f32 v[38:39], v[94:95], v[184:185] op_sel:[0,1] op_sel_hi:[1,1]
s_waitcnt vmcnt(15)
ds_read_b128 v[232:235], v2 offset:16384
v_pk_fma_f32 v[160:161], v[160:161], v[184:185], v[32:33] op_sel_hi:[1,0,1] neg_lo:[0,0,1] neg_hi:[0,0,1]
ds_read_b128 v[236:239], v2 offset:18432
v_pk_fma_f32 v[162:163], v[162:163], v[184:185], v[34:35] op_sel_hi:[1,0,1] neg_lo:[0,0,1] neg_hi:[0,0,1]
ds_read_b128 v[248:251], v3 offset:16384
v_pk_fma_f32 v[168:169], v[168:169], v[184:185], v[36:37] op_sel_hi:[1,0,1] neg_lo:[0,0,1] neg_hi:[0,0,1]
ds_read_b128 v[252:255], v3 offset:18432
v_pk_fma_f32 v[170:171], v[170:171], v[184:185], v[38:39] op_sel_hi:[1,0,1] neg_lo:[0,0,1] neg_hi:[0,0,1]
s_waitcnt lgkmcnt(8)
s_add_u32 m0, s77, 8192
v_cvt_pk_bf16_f32 v96, v160, v161
s_add_u32 s76, s76, 128
v_cvt_pk_bf16_f32 v97, v162, v163
s_and_b32 s76, s76, 0x380
v_cvt_pk_bf16_f32 v98, v168, v169
s_add_u32 s82, s64, s76
v_cvt_pk_bf16_f32 v99, v170, v171
s_add_u32 s83, s66, s76
buffer_store_dwordx4 v[96:99], v1, s[20:23], s81 offen sc1
buffer_load_dwordx4 v8, s[16:19], s82 offen offset:0 lds
v_pk_mul_f32 v[32:33], v[88:89], v[186:187] op_sel:[0,1] op_sel_hi:[1,1]
v_pk_mul_f32 v[34:35], v[90:91], v[186:187] op_sel:[0,1] op_sel_hi:[1,1]
v_pk_mul_f32 v[36:37], v[92:93], v[186:187] op_sel:[0,1] op_sel_hi:[1,1]
v_pk_mul_f32 v[38:39], v[94:95], v[186:187] op_sel:[0,1] op_sel_hi:[1,1]
v_pk_fma_f32 v[164:165], v[164:165], v[186:187], v[32:33] op_sel_hi:[1,0,1] neg_lo:[0,0,1] neg_hi:[0,0,1]
v_pk_fma_f32 v[166:167], v[166:167], v[186:187], v[34:35] op_sel_hi:[1,0,1] neg_lo:[0,0,1] neg_hi:[0,0,1]
v_pk_fma_f32 v[172:173], v[172:173], v[186:187], v[36:37] op_sel_hi:[1,0,1] neg_lo:[0,0,1] neg_hi:[0,0,1]
v_pk_fma_f32 v[174:175], v[174:175], v[186:187], v[38:39] op_sel_hi:[1,0,1] neg_lo:[0,0,1] neg_hi:[0,0,1]
v_cvt_pk_bf16_f32 v100, v164, v165
v_cvt_pk_bf16_f32 v101, v166, v167
v_cvt_pk_bf16_f32 v102, v172, v173
v_cvt_pk_bf16_f32 v103, v174, v175
buffer_load_dwordx4 v9, s[16:19], s82 offen offset:1024 lds
buffer_store_dwordx4 v[100:103], v29, s[20:23], s81 offen sc1
s_xor_b32 s85, s46, 1
s_lshl_b32 s84, s45, 3
s_add_u32 s84, s84, s85
s_lshl_b32 s84, s84, 5
s_add_u32 s84, s84, s44
s_lshl_b32 s84, s84, 2
s_add_u32 s0, s84, 0x8000
buffer_load_dwordx4 v10, s[16:19], s83 offen offset:2048 lds
buffer_load_dwordx4 v11, s[16:19], s83 offen offset:3072 lds
s_waitcnt lgkmcnt(4)
s_add_u32 m0, s77, 12288
s_add_u32 s82, s65, s76
s_add_u32 s83, s67, s76
buffer_load_dwordx4 v8, s[16:19], s82 offen offset:0 lds
buffer_load_dwordx4 v9, s[16:19], s82 offen offset:1024 lds
buffer_load_dwordx4 v10, s[16:19], s83 offen offset:2048 lds
buffer_load_dwordx4 v11, s[16:19], s83 offen offset:3072 lds
s_waitcnt vmcnt(17)
ds_read_b128 a[128:131], v2 offset:0
ds_read_b128 a[132:135], v2 offset:2048
ds_read_b128 a[144:147], v3 offset:0
ds_read_b128 a[148:151], v3 offset:2048
s_waitcnt vmcnt(10)
ds_read_b128 a[136:139], v2 offset:4096
ds_read_b128 a[140:143], v2 offset:6144
ds_read_b128 a[152:155], v3 offset:4096
ds_read_b128 a[156:159], v3 offset:6144
s_waitcnt vmcnt(4)
ds_read_b128 a[160:163], v2 offset:8192
ds_read_b128 a[164:167], v2 offset:10240
ds_read_b128 a[176:179], v3 offset:8192
ds_read_b128 a[180:183], v3 offset:10240
s_waitcnt vmcnt(0)
ds_read_b128 a[168:171], v2 offset:12288
ds_read_b128 a[172:175], v2 offset:14336
ds_read_b128 a[184:187], v3 offset:12288
ds_read_b128 a[188:191], v3 offset:14336
v_xor_b32 v30, v12, v28
v_xor_b32 v13, v13, v28
v_xor_b32 v14, v14, v28
v_xor_b32 v15, v15, v28
v_or3_b32 v30, v30, v13, v14
v_or_b32 v30, v30, v15
v_cmp_ne_u32 vcc, 0, v30
s_nop 1
s_cbranch_vccnz L_pslow_11
L_pret_12:
s_waitcnt lgkmcnt(0)
s_branch L_p2
L_p1q:
s_mul_i32 s77, s44, 8192
s_add_u32 s77, s77, 122880
s_mul_i32 s74, s44, 3072
v_lshrrev_b32 v31, 3, v0
v_bfe_u32 v29, v0, 4, 1
s_and_b32 s82, s44, 1
s_lshl_b32 s82, s82, 1
v_or_b32 v29, s82, v29
v_bfe_u32 v30, v0, 1, 2
v_xor_b32 v29, v29, v30
v_lshlrev_b32 v29, 5, v29
v_and_b32 v30, 1, v0
v_lshl_or_b32 v29, v30, 4, v29
s_lshl_b32 s82, s44, 3
v_add_u32 v30, s82, v31
v_mul_u32_u24 v30, 3072, v30
s_lshl_b32 s82, s46, 7
v_add3_u32 v12, v30, v29, s82
s_lshl_b32 s84, s45, 17
s_sub_u32 s84, s84, 16384
s_lshl_b32 s82, s44, 8
s_add_u32 s82, s82, s72
s_and_b32 s82, s82, 0x380
s_add_u32 s82, s82, s84
v_add_u32 v13, s82, v4
v_add_u32 v14, s82, v5
s_lshl_b32 s82, s44, 8
s_add_u32 s82, s82, s72
s_add_u32 s82, s82, 128
s_and_b32 s82, s82, 0x380
s_add_u32 s82, s82, s84
s_sub_u32 s82, s82, 2048
v_add_u32 v15, s82, v4
v_add_u32 v22, s82, v5
s_lshr_b32 s83, s46, 1
s_and_b32 s84, s83, 1
s_lshl_b32 s84, s84, 1
s_sub_u32 s84, 8, s84
s_and_b32 s85, s46, 1
s_mul_i32 s84, s84, s85
s_mul_i32 s83, s83, 14
s_add_u32 s97, s83, s84
s_and_b32 s97, s97, 0xfc
s_lshl_b32 s97, s97, 5
s_add_u32 s97, s97, 1792
v_and_b32 v29, 7, v0
s_and_b32 s84, s46, 3
s_lshl_b32 s84, s84, 3
v_add_u32 v29, s84, v29
v_lshrrev_b32 v30, 3, v0
v_lshlrev_b32 v31, 7, v30
v_lshl_add_u32 v245, v29, 10, v31
v_bfe_u32 v29, v0, 1, 2
v_lshl_add_u32 v29, v30, 6, v29
s_lshl_b32 s83, s44, 4
s_lshl_b32 s84, s47, 2
s_add_u32 s83, s83, s84
v_add_u32 v29, s83, v29
v_mul_u32_u24 v29, 3584, v29
v_and_b32 v30, 1, v0
v_lshl_add_u32 v246, v30, 7, v29
s_waitcnt lgkmcnt(0)
s_add_u32 s4, s48, s75
s_addc_u32 s5, s49, 0
s_sub_u32 s6, 0x200000, s75
s_mov_b32 s7, 0x20000
s_mov_b32 s12, s50
s_mov_b32 s13, s51
s_mov_b32 s14, 0x180000
s_mov_b32 s15, 0x20000
s_mov_b32 s24, s56
s_mov_b32 s25, s57
s_mov_b32 s26, 0x1c0000
s_mov_b32 s27, 0x20000
s_mov_b32 exec_lo, 0xffffff00
s_mov_b32 exec_hi, 0x0
buffer_load_dword v23, v245, s[4:7], 0 offen
s_mov_b64 exec, -1
s_mov_b32 exec_lo, 0xffffff00
s_mov_b32 exec_hi, 0x0
buffer_load_dword v23, v246, s[24:27], s97 offen
s_mov_b64 exec, -1
s_mov_b32 exec_lo, 0x0
s_mov_b32 exec_hi, 0xffffffff
buffer_load_dword v23, v245, s[4:7], 0 offen
s_mov_b64 exec, -1
s_mov_b32 exec_lo, 0x0
s_mov_b32 exec_hi, 0xffffffff
buffer_load_dword v23, v246, s[24:27], s97 offen
s_mov_b64 exec, -1
s_mov_b32 s75, s72
s_mul_i32 s82, s75, 1536
s_add_u32 m0, s74, 0
s_nop 0
buffer_load_dwordx4 v12, s[12:15], s82 offen offset:0 lds
buffer_load_dwordx4 v12, s[12:15], s82 offen offset:1024 lds
buffer_load_dwordx4 v12, s[12:15], s82 offen offset:2048 lds
s_add_u32 m0, s74, 12288
s_add_u32 s82, s82, 98304
buffer_load_dwordx4 v12, s[12:15], s82 offen offset:0 lds
buffer_load_dwordx4 v12, s[12:15], s82 offen offset:1024 lds
buffer_load_dwordx4 v12, s[12:15], s82 offen offset:2048 lds
s_add_u32 s75, s75, 128
s_and_b32 s75, s75, 0x380
s_add_u32 m0, s77, 0
s_nop 0
buffer_load_dwordx4 v4, s[4:7], s72 offen offset:0 lds
buffer_load_dwordx4 v5, s[4:7], s72 offen offset:1024 lds
buffer_load_dwordx4 v6, s[4:7], s72 offen offset:2048 lds
buffer_load_dwordx4 v7, s[4:7], s72 offen offset:3072 lds
s_add_u32 s72, s72, 128
s_and_b32 s72, s72, 0x380
s_mov_b32 s8, s48
s_mov_b32 s9, s49
s_mov_b32 s10, 0x200000
s_mov_b32 s11, 0x20000
s_lshl_b32 s83, s44, 12
s_add_u32 m0, s83, 98304
s_nop 0
buffer_load_dwordx4 v13, s[8:11], 0 offen offset:0 lds
buffer_load_dwordx4 v14, s[8:11], 0 offen offset:1024 lds
buffer_load_dwordx4 v15, s[8:11], 0 offen offset:2048 lds
buffer_load_dwordx4 v22, s[8:11], 0 offen offset:3072 lds
s_mov_b32 s20, s68
s_mov_b32 s21, s69
s_mov_b32 s22, 0x1000000
s_mov_b32 s23, 0x20000
buffer_load_dword v28, off, s[20:23], 0 sc1
s_mov_b32 s8, s48
s_mov_b32 s9, s49
s_mov_b32 s10, 0x200000
s_mov_b32 s11, 0x20000
s_mov_b32 s24, s52
s_mov_b32 s25, s53
s_mov_b32 s26, 0x80000
s_mov_b32 s27, 0x20000
s_mov_b32 s28, s62
s_mov_b32 s29, s63
s_mov_b32 s30, 0xe0000
s_mov_b32 s31, 0x20000
s_mov_b32 s32, s64
s_mov_b32 s33, s65
s_mov_b32 s34, 0x200000
s_add_u32 m0, s77, 4096
s_mov_b32 s35, 0x20000
buffer_load_dwordx4 v4, s[4:7], s72 offen offset:0 lds
s_mov_b32 s36, s60
s_mov_b32 s37, s61
s_mov_b32 s38, 0x1000
s_mov_b32 s39, 0x20000
s_mov_b32 s40, s66
s_mov_b32 s41, s67
s_mov_b32 s42, 256
s_mov_b32 s43, 0x20000
s_and_b32 s84, s2, 7
s_lshr_b32 s85, s2, 3
s_lshr_b32 s68, s85, 2
s_and_b32 s3, s85, 3
buffer_load_dwordx4 v5, s[4:7], s72 offen offset:1024 lds
s_lshr_b32 s85, s84, 1
s_lshl_b32 s85, s85, 3
s_add_u32 s70, s85, s68
s_and_b32 s84, s84, 1
s_lshl_b32 s84, s84, 2
s_add_u32 s71, s84, s3
s_and_b32 s76, s68, 3
s_lshl_b32 s76, s76, 8
s_lshl_b32 s84, s70, 18
s_sub_u32 s84, s84, 0x100000
s_lshl_b32 s85, s44, 10
s_add_u32 s84, s84, s85
buffer_load_dwordx4 v6, s[4:7], s72 offen offset:2048 lds
s_sub_u32 s16, s58, 3072
s_subb_u32 s17, s59, 0
s_add_u32 s16, s16, s84
s_addc_u32 s17, s17, 0
s_sub_u32 s18, 0x800c00, s84
s_mov_b32 s19, 0x20000
s_and_b32 s84, s44, 2
s_lshl_b32 s64, s84, 16
s_xor_b32 s65, s64, 0x20000
s_add_u32 s85, s44, 1
s_and_b32 s84, s85, 2
s_lshl_b32 s66, s84, 16
buffer_load_dwordx4 v7, s[4:7], s72 offen offset:3072 lds
s_xor_b32 s67, s66, 0x20000
s_add_u32 s72, s72, 128
v_lshrrev_b32 v29, 3, v0
s_and_b32 s72, s72, 0x380
v_lshrrev_b32 v30, 4, v0
s_mul_i32 s82, s75, 1536
v_and_b32 v31, 7, v0
s_add_u32 m0, s74, 24576
v_xor_b32 v31, v31, v30
v_lshlrev_b32 v31, 4, v31
v_lshl_add_u32 v31, v29, 12, v31
v_xor_b32 v30, 64, v31
buffer_load_dwordx4 v12, s[12:15], s82 offen offset:0 lds
s_and_b32 s84, s44, 1
s_lshl_b32 s84, s84, 16
s_add_u32 s84, s84, 0x100000
s_xor_b32 s85, s84, 0x10000
s_add_u32 s83, s84, 3072
v_add_u32 v8, s83, v31
s_add_u32 s83, s84, 34816
v_add_u32 v9, s83, v30
s_add_u32 s83, s85, 1024
v_add_u32 v10, s83, v31
s_add_u32 s83, s85, 32768
v_add_u32 v11, s83, v30
buffer_load_dwordx4 v12, s[12:15], s82 offen offset:1024 lds
v_lshlrev_b32 v1, 4, v0
v_and_b32 v29, 15, v0
v_lshrrev_b32 v30, 4, v0
v_lshrrev_b32 v31, 1, v29
v_xor_b32 v31, v31, v30
v_lshlrev_b32 v31, 4, v31
v_lshl_add_u32 v31, v29, 7, v31
v_add_u32 v2, s77, v31
v_xor_b32 v3, 64, v2
s_mov_b32 s86, 0x3b000000
s_mov_b32 s87, 0x3727c5ac
s_mov_b32 s88, 0x3a924925
buffer_load_dwordx4 v12, s[12:15], s82 offen offset:2048 lds
s_mov_b32 s89, 0x3727c5ac
s_add_u32 m0, s74, 36864
s_mov_b32 s90, 0xbdd2d3e8
s_add_u32 s82, s82, 98304
s_mov_b32 s91, 0xc0135761
s_mov_b32 s92, 0xaaaaaaaa
s_mov_b32 s93, 0xaaaaaaaa
s_mov_b32 s94, 0xcccccccc
s_mov_b32 s95, 0xcccccccc
v_mov_b32 v24, 0x3f803f80
v_mov_b32 v25, 0x3f803f80
v_mov_b32 v26, 0x3f803f80
buffer_load_dwordx4 v12, s[12:15], s82 offen offset:0 lds
v_mov_b32 v27, 0x3f803f80
v_and_b32 v29, 15, v0
s_lshl_b32 s84, s3, 4
v_add_u32 v29, s84, v29
v_lshlrev_b32 v29, 12, v29
v_lshrrev_b32 v30, 4, v0
v_lshl_add_u32 v30, v30, 7, s76
v_and_b32 v30, 0x380, v30
v_add_u32 v246, v29, v30
v_xor_b32 v245, 0, v246
v_add_u32 v246, 0x100000, v246
v_lshrrev_b32 v30, 4, v0
buffer_load_dwordx4 v12, s[12:15], s82 offen offset:1024 lds
v_mul_u32_u24 v31, 3072, v30
v_bfe_u32 v29, v0, 2, 2
v_lshl_add_u32 v31, v29, 7, v31
v_and_b32 v29, 3, v0
v_lshl_add_u32 v31, v29, 3, v31
v_bfe_u32 v29, v0, 3, 2
v_xor_b32 v29, s44, v29
v_lshl_add_u32 v16, v29, 5, v31
v_xor_b32 v17, 32, v16
v_xor_b32 v18, 64, v16
v_xor_b32 v19, 96, v16
v_add_u32 v248, 49152, v16
buffer_load_dwordx4 v12, s[12:15], s82 offen offset:2048 lds
v_add_u32 v249, 49152, v17
s_add_u32 s75, s75, 128
v_add_u32 v250, 49152, v18
s_and_b32 s75, s75, 0x380
v_add_u32 v251, 49152, v19
s_sub_u32 s84, 98304, s77
v_add_u32 v20, s84, v2
v_add_u32 v21, s84, v3
v_lshrrev_b32 v29, 3, v0
v_lshlrev_b32 v29, 11, v29
v_and_b32 v30, 7, v0
v_lshl_add_u32 v29, v30, 4, v29
s_lshl_b32 s84, s44, 12
s_add_u32 s84, s84, 98304
v_add_u32 v31, s84, v29
s_waitcnt vmcnt(11)
s_mov_b64 exec, 0xffff
ds_write_b128 v31, v[24:27]
s_mov_b64 exec, -1
s_waitcnt lgkmcnt(0)
s_barrier
ds_read_b128 a[128:131], v2 offset:0
ds_read_b128 a[132:135], v2 offset:2048
ds_read_b128 a[136:139], v3 offset:0
ds_read_b128 a[140:143], v3 offset:2048
ds_read_b128 v[192:195], v20
ds_read_b128 v[196:199], v21
ds_read_b64_tr_b16 v[32:33], v16 offset:0
ds_read_b64_tr_b16 v[34:35], v16 offset:512
ds_read_b64_tr_b16 v[36:37], v16 offset:1024
ds_read_b64_tr_b16 v[38:39], v16 offset:1536
ds_read_b64_tr_b16 v[40:41], v16 offset:2048
ds_read_b64_tr_b16 v[42:43], v16 offset:2560
ds_read_b64_tr_b16 v[44:45], v17 offset:0
ds_read_b64_tr_b16 v[46:47], v17 offset:512
ds_read_b64_tr_b16 v[48:49], v17 offset:1024
ds_read_b64_tr_b16 v[50:51], v17 offset:1536
ds_read_b64_tr_b16 v[52:53], v17 offset:2048
ds_read_b64_tr_b16 v[54:55], v17 offset:2560
s_waitcnt lgkmcnt(8)
v_mfma_f32_16x16x32_bf16 v[64:67], v[32:35], a[128:131], 0
ds_read_b64_tr_b16 v[56:57], v18 offset:0
v_mfma_f32_16x16x32_bf16 v[68:71], v[32:35], a[132:135], 0
ds_read_b64_tr_b16 v[58:59], v18 offset:512
s_mul_i32 s82, s75, 1536
v_mfma_f32_16x16x32_bf16 v[160:163], v[32:35], v[192:195], 0
s_add_u32 m0, s74, 49152
s_nop 0
buffer_load_dwordx4 v12, s[12:15], s82 offen offset:0 lds
v_mfma_f32_16x16x32_bf16 v[96:99], v[36:39], a[128:131], 0
ds_read_b64_tr_b16 v[60:61], v18 offset:1024
v_mfma_f32_16x16x32_bf16 v[100:103], v[36:39], a[132:135], 0
ds_read_b64_tr_b16 v[62:63], v18 offset:1536
v_mfma_f32_16x16x32_bf16 v[164:167], v[36:39], v[192:195], 0
s_waitcnt lgkmcnt(8)
v_mfma_f32_16x16x32_bf16 v[128:131], a[128:131], v[40:43], 0
ds_read_b64_tr_b16 v[32:33], v18 offset:2048
buffer_load_dwordx4 v12, s[12:15], s82 offen offset:1024 lds
v_mfma_f32_16x16x32_bf16 v[132:135], a[132:135], v[40:43], 0
ds_read_b64_tr_b16 v[34:35], v18 offset:2560
v_mfma_f32_16x16x32_bf16 v[168:171], v[192:195], v[40:43], 0
v_mfma_f32_16x16x32_bf16 v[72:75], v[44:47], a[128:131], 0
ds_read_b64_tr_b16 v[36:37], v19 offset:0
v_mfma_f32_16x16x32_bf16 v[76:79], v[44:47], a[132:135], 0
ds_read_b64_tr_b16 v[38:39], v19 offset:512
s_waitcnt lgkmcnt(8)
v_mfma_f32_16x16x32_bf16 v[104:107], v[48:51], a[128:131], 0
ds_read_b64_tr_b16 v[40:41], v19 offset:1024
ds_read_b128 v[192:195], v20 offset:2048
v_mfma_f32_16x16x32_bf16 v[108:111], v[48:51], a[132:135], 0
ds_read_b64_tr_b16 v[42:43], v19 offset:1536
buffer_load_dwordx4 v12, s[12:15], s82 offen offset:2048 lds
v_mfma_f32_16x16x32_bf16 v[136:139], a[128:131], v[52:55], 0
ds_read_b64_tr_b16 v[44:45], v19 offset:2048
s_add_u32 m0, s74, 61440
v_mfma_f32_16x16x32_bf16 v[140:143], a[132:135], v[52:55], 0
ds_read_b64_tr_b16 v[46:47], v19 offset:2560
s_waitcnt lgkmcnt(9)
v_mfma_f32_16x16x32_bf16 v[80:83], v[56:59], a[128:131], 0
ds_read_b64_tr_b16 v[48:49], v16 offset:12288
s_add_u32 s82, s82, 98304
v_mfma_f32_16x16x32_bf16 v[84:87], v[56:59], a[132:135], 0
ds_read_b64_tr_b16 v[50:51], v16 offset:12800
buffer_load_dwordx4 v12, s[12:15], s82 offen offset:0 lds
v_mfma_f32_16x16x32_bf16 v[112:115], v[60:63], a[128:131], 0
ds_read_b64_tr_b16 v[52:53], v16 offset:13312
v_mfma_f32_16x16x32_bf16 v[116:119], v[60:63], a[132:135], 0
ds_read_b64_tr_b16 v[54:55], v16 offset:13824
s_waitcnt lgkmcnt(9)
v_mfma_f32_16x16x32_bf16 v[144:147], a[128:131], v[32:35], 0
ds_read_b64_tr_b16 v[56:57], v16 offset:14336
v_mfma_f32_16x16x32_bf16 v[148:151], a[132:135], v[32:35], 0
ds_read_b64_tr_b16 v[58:59], v16 offset:14848
buffer_load_dwordx4 v12, s[12:15], s82 offen offset:1024 lds
v_mfma_f32_16x16x32_bf16 v[88:91], v[36:39], a[128:131], 0
ds_read_b64_tr_b16 v[60:61], v17 offset:12288
v_mfma_f32_16x16x32_bf16 v[92:95], v[36:39], a[132:135], 0
ds_read_b64_tr_b16 v[62:63], v17 offset:12800
s_waitcnt lgkmcnt(8)
v_mfma_f32_16x16x32_bf16 v[120:123], v[40:43], a[128:131], 0
ds_read_b64_tr_b16 v[32:33], v17 offset:13312
v_mfma_f32_16x16x32_bf16 v[124:127], v[40:43], a[132:135], 0
ds_read_b64_tr_b16 v[34:35], v17 offset:13824
buffer_load_dwordx4 v12, s[12:15], s82 offen offset:2048 lds
v_mfma_f32_16x16x32_bf16 v[152:155], a[128:131], v[44:47], 0
ds_read_b64_tr_b16 v[36:37], v17 offset:14336
s_add_u32 s75, s75, 128
v_mfma_f32_16x16x32_bf16 v[156:159], a[132:135], v[44:47], 0
ds_read_b64_tr_b16 v[38:39], v17 offset:14848
s_waitcnt lgkmcnt(8)
v_mfma_f32_16x16x32_bf16 v[64:67], v[48:51], a[136:139], v[64:67]
ds_read_b64_tr_b16 v[40:41], v18 offset:12288
s_and_b32 s75, s75, 0x380
v_mfma_f32_16x16x32_bf16 v[68:71], v[48:51], a[140:143], v[68:71]
ds_read_b64_tr_b16 v[42:43], v18 offset:12800
v_mfma_f32_16x16x32_bf16 v[160:163], v[48:51], v[196:199], v[160:163]
s_add_u32 m0, s77, 0
s_nop 0
buffer_load_dwordx4 v4, s[4:7], s72 offen offset:0 lds
v_mfma_f32_16x16x32_bf16 v[96:99], v[52:55], a[136:139], v[96:99]
ds_read_b64_tr_b16 v[44:45], v18 offset:13312
v_mfma_f32_16x16x32_bf16 v[100:103], v[52:55], a[140:143], v[100:103]
ds_read_b64_tr_b16 v[46:47], v18 offset:13824
v_mfma_f32_16x16x32_bf16 v[164:167], v[52:55], v[196:199], v[164:167]
s_waitcnt lgkmcnt(8)
v_mfma_f32_16x16x32_bf16 v[128:131], a[136:139], v[56:59], v[128:131]
ds_read_b64_tr_b16 v[48:49], v18 offset:14336
buffer_load_dwordx4 v5, s[4:7], s72 offen offset:1024 lds
v_mfma_f32_16x16x32_bf16 v[132:135], a[140:143], v[56:59], v[132:135]
ds_read_b64_tr_b16 v[50:51], v18 offset:14848
v_mfma_f32_16x16x32_bf16 v[168:171], v[196:199], v[56:59], v[168:171]
v_mfma_f32_16x16x32_bf16 v[72:75], v[60:63], a[136:139], v[72:75]
ds_read_b64_tr_b16 v[52:53], v19 offset:12288
v_mfma_f32_16x16x32_bf16 v[76:79], v[60:63], a[140:143], v[76:79]
ds_read_b64_tr_b16 v[54:55], v19 offset:12800
s_waitcnt lgkmcnt(8)
v_mfma_f32_16x16x32_bf16 v[104:107], v[32:35], a[136:139], v[104:107]
ds_read_b64_tr_b16 v[56:57], v19 offset:13312
ds_read_b128 v[196:199], v21 offset:2048
v_mfma_f32_16x16x32_bf16 v[108:111], v[32:35], a[140:143], v[108:111]
ds_read_b64_tr_b16 v[58:59], v19 offset:13824
buffer_load_dwordx4 v6, s[4:7], s72 offen offset:2048 lds
v_mfma_f32_16x16x32_bf16 v[136:139], a[136:139], v[36:39], v[136:139]
ds_read_b64_tr_b16 v[60:61], v19 offset:14336
v_mfma_f32_16x16x32_bf16 v[140:143], a[140:143], v[36:39], v[140:143]
ds_read_b64_tr_b16 v[62:63], v19 offset:14848
s_waitcnt lgkmcnt(9)
v_mfma_f32_16x16x32_bf16 v[80:83], v[40:43], a[136:139], v[80:83]
s_waitcnt vmcnt(9)
s_barrier
ds_read_b64_tr_b16 v[32:33], v16 offset:24576
v_mfma_f32_16x16x32_bf16 v[84:87], v[40:43], a[140:143], v[84:87]
ds_read_b64_tr_b16 v[34:35], v16 offset:25088
buffer_load_dwordx4 v7, s[4:7], s72 offen offset:3072 lds
v_mfma_f32_16x16x32_bf16 v[112:115], v[44:47], a[136:139], v[112:115]
ds_read_b128 a[144:147], v2 offset:4096
ds_read_b64_tr_b16 v[36:37], v16 offset:25600
v_mfma_f32_16x16x32_bf16 v[116:119], v[44:47], a[140:143], v[116:119]
ds_read_b128 a[148:151], v2 offset:6144
ds_read_b64_tr_b16 v[38:39], v16 offset:26112
s_waitcnt lgkmcnt(11)
v_mfma_f32_16x16x32_bf16 v[144:147], a[136:139], v[48:51], v[144:147]
ds_read_b128 a[152:155], v3 offset:4096
ds_read_b64_tr_b16 v[40:41], v16 offset:26624
v_mfma_f32_16x16x32_bf16 v[148:151], a[140:143], v[48:51], v[148:151]
ds_read_b128 a[156:159], v3 offset:6144
ds_read_b64_tr_b16 v[42:43], v16 offset:27136
v_mfma_f32_16x16x32_bf16 v[88:91], v[52:55], a[136:139], v[88:91]
ds_read_b64_tr_b16 v[44:45], v17 offset:24576
s_add_u32 s72, s72, 128
s_and_b32 s72, s72, 0x380
v_add_u32 v28, 0x9e3779b9, v28
v_cmp_eq_u32 vcc, 0, v28
v_mov_b32 v29, 0x9e3779b9
s_lshl_b32 s85, s2, 2
v_cndmask_b32 v28, v28, v29, vcc
s_or_b32 s85, s85, s44
s_lshl_b32 s85, s85, 6
v_or_b32 v29, s85, v0
v_cmp_eq_u32 vcc, 0, v29
v_mov_b32 v30, 0x7ffffff0
s_nop 0
v_cndmask_b32 v29, v30, 0, vcc
buffer_store_dword v28, v29, s[20:23], 0 offen sc1
buffer_store_dword v28, v29, s[40:43], 0 offen sc1
v_lshlrev_b32 v253, 21, v0
v_add_u32 v253, 0x2000, v253
buffer_load_dword v255, v253, s[20:23], 0 offen sc1
buffer_load_dword v255, v253, s[16:19], 0 offen sc1
buffer_load_dword v255, v253, s[32:35], 0 offen sc1
buffer_load_dword v255, v253, s[24:27], 0 offen sc1
buffer_load_dword v255, v253, s[28:31], 0 offen sc1
buffer_load_dword v255, off, s[40:43], 0 offset:128 sc1
buffer_load_dword v255, off, s[36:39], 0
buffer_load_dword v23, v245, s[16:19], 0 offen offset:3072
v_mfma_f32_16x16x32_bf16 v[92:95], v[52:55], a[140:143], v[92:95]
ds_read_b64_tr_b16 v[46:47], v17 offset:25088
s_waitcnt lgkmcnt(12)
v_mfma_f32_16x16x32_bf16 v[120:123], v[56:59], a[136:139], v[120:123]
ds_read_b64_tr_b16 v[48:49], v17 offset:25600
s_mul_i32 s82, s75, 1536
v_mfma_f32_16x16x32_bf16 v[124:127], v[56:59], a[140:143], v[124:127]
ds_read_b64_tr_b16 v[50:51], v17 offset:26112
s_add_u32 m0, s74, 73728
v_mfma_f32_16x16x32_bf16 v[152:155], a[136:139], v[60:63], v[152:155]
ds_read_b64_tr_b16 v[52:53], v17 offset:26624
buffer_load_dwordx4 v12, s[12:15], s82 offen offset:0 lds
v_mfma_f32_16x16x32_bf16 v[156:159], a[140:143], v[60:63], v[156:159]
ds_read_b64_tr_b16 v[54:55], v17 offset:27136
s_waitcnt lgkmcnt(10)
v_mfma_f32_16x16x32_bf16 v[64:67], v[32:35], a[144:147], v[64:67]
ds_read_b64_tr_b16 v[56:57], v18 offset:24576
v_mfma_f32_16x16x32_bf16 v[68:71], v[32:35], a[148:151], v[68:71]
ds_read_b64_tr_b16 v[58:59], v18 offset:25088
v_mfma_f32_16x16x32_bf16 v[160:163], v[32:35], v[192:195], v[160:163]
buffer_load_dwordx4 v12, s[12:15], s82 offen offset:1024 lds
v_mfma_f32_16x16x32_bf16 v[96:99], v[36:39], a[144:147], v[96:99]
ds_read_b64_tr_b16 v[60:61], v18 offset:25600
v_mfma_f32_16x16x32_bf16 v[100:103], v[36:39], a[148:151], v[100:103]
ds_read_b64_tr_b16 v[62:63], v18 offset:26112
v_mfma_f32_16x16x32_bf16 v[164:167], v[36:39], v[192:195], v[164:167]
s_waitcnt lgkmcnt(8)
v_mfma_f32_16x16x32_bf16 v[128:131], a[144:147], v[40:43], v[128:131]
ds_read_b64_tr_b16 v[32:33], v18 offset:26624
buffer_load_dwordx4 v12, s[12:15], s82 offen offset:2048 lds
v_mfma_f32_16x16x32_bf16 v[132:135], a[148:151], v[40:43], v[132:135]
ds_read_b64_tr_b16 v[34:35], v18 offset:27136
s_add_u32 m0, s74, 86016
v_mfma_f32_16x16x32_bf16 v[168:171], v[192:195], v[40:43], v[168:171]
s_add_u32 s82, s82, 98304
v_mfma_f32_16x16x32_bf16 v[72:75], v[44:47], a[144:147], v[72:75]
ds_read_b64_tr_b16 v[36:37], v19 offset:24576
v_mfma_f32_16x16x32_bf16 v[76:79], v[44:47], a[148:151], v[76:79]
ds_read_b64_tr_b16 v[38:39], v19 offset:25088
s_waitcnt lgkmcnt(8)
v_mfma_f32_16x16x32_bf16 v[104:107], v[48:51], a[144:147], v[104:107]
ds_read_b64_tr_b16 v[40:41], v19 offset:25600
ds_read_b128 v[192:195], v20 offset:4096
v_mfma_f32_16x16x32_bf16 v[108:111], v[48:51], a[148:151], v[108:111]
ds_read_b64_tr_b16 v[42:43], v19 offset:26112
buffer_load_dwordx4 v12, s[12:15], s82 offen offset:0 lds
v_mfma_f32_16x16x32_bf16 v[136:139], a[144:147], v[52:55], v[136:139]
ds_read_b64_tr_b16 v[44:45], v19 offset:26624
v_mfma_f32_16x16x32_bf16 v[140:143], a[148:151], v[52:55], v[140:143]
ds_read_b64_tr_b16 v[46:47], v19 offset:27136
s_waitcnt lgkmcnt(9)
v_mfma_f32_16x16x32_bf16 v[80:83], v[56:59], a[144:147], v[80:83]
ds_read_b64_tr_b16 v[48:49], v16 offset:36864
v_mfma_f32_16x16x32_bf16 v[84:87], v[56:59], a[148:151], v[84:87]
ds_read_b64_tr_b16 v[50:51], v16 offset:37376
buffer_load_dwordx4 v12, s[12:15], s82 offen offset:1024 lds
v_mfma_f32_16x16x32_bf16 v[112:115], v[60:63], a[144:147], v[112:115]
ds_read_b64_tr_b16 v[52:53], v16 offset:37888
v_mfma_f32_16x16x32_bf16 v[116:119], v[60:63], a[148:151], v[116:119]
ds_read_b64_tr_b16 v[54:55], v16 offset:38400
s_waitcnt lgkmcnt(9)
v_mfma_f32_16x16x32_bf16 v[144:147], a[144:147], v[32:35], v[144:147]
ds_read_b64_tr_b16 v[56:57], v16 offset:38912
v_mfma_f32_16x16x32_bf16 v[148:151], a[148:151], v[32:35], v[148:151]
ds_read_b64_tr_b16 v[58:59], v16 offset:39424
buffer_load_dwordx4 v12, s[12:15], s82 offen offset:2048 lds
v_mfma_f32_16x16x32_bf16 v[88:91], v[36:39], a[144:147], v[88:91]
ds_read_b64_tr_b16 v[60:61], v17 offset:36864
s_add_u32 s75, s75, 128
v_mfma_f32_16x16x32_bf16 v[92:95], v[36:39], a[148:151], v[92:95]
ds_read_b64_tr_b16 v[62:63], v17 offset:37376
s_waitcnt lgkmcnt(8)
v_mfma_f32_16x16x32_bf16 v[120:123], v[40:43], a[144:147], v[120:123]
ds_read_b64_tr_b16 v[32:33], v17 offset:37888
s_and_b32 s75, s75, 0x380
v_mfma_f32_16x16x32_bf16 v[124:127], v[40:43], a[148:151], v[124:127]
ds_read_b64_tr_b16 v[34:35], v17 offset:38400
v_mfma_f32_16x16x32_bf16 v[152:155], a[144:147], v[44:47], v[152:155]
ds_read_b64_tr_b16 v[36:37], v17 offset:38912
s_add_u32 m0, s77, 4096
v_mfma_f32_16x16x32_bf16 v[156:159], a[148:151], v[44:47], v[156:159]
ds_read_b64_tr_b16 v[38:39], v17 offset:39424
s_waitcnt lgkmcnt(8)
v_mfma_f32_16x16x32_bf16 v[64:67], v[48:51], a[152:155], v[64:67]
ds_read_b64_tr_b16 v[40:41], v18 offset:36864
buffer_load_dwordx4 v4, s[4:7], s72 offen offset:0 lds
v_mfma_f32_16x16x32_bf16 v[68:71], v[48:51], a[156:159], v[68:71]
ds_read_b64_tr_b16 v[42:43], v18 offset:37376
v_mfma_f32_16x16x32_bf16 v[160:163], v[48:51], v[196:199], v[160:163]
v_mfma_f32_16x16x32_bf16 v[96:99], v[52:55], a[152:155], v[96:99]
ds_read_b64_tr_b16 v[44:45], v18 offset:37888
v_mfma_f32_16x16x32_bf16 v[100:103], v[52:55], a[156:159], v[100:103]
ds_read_b64_tr_b16 v[46:47], v18 offset:38400
buffer_load_dwordx4 v5, s[4:7], s72 offen offset:1024 lds
v_mfma_f32_16x16x32_bf16 v[164:167], v[52:55], v[196:199], v[164:167]
s_waitcnt lgkmcnt(8)
v_mfma_f32_16x16x32_bf16 v[128:131], a[152:155], v[56:59], v[128:131]
ds_read_b64_tr_b16 v[48:49], v18 offset:38912
v_mfma_f32_16x16x32_bf16 v[132:135], a[156:159], v[56:59], v[132:135]
ds_read_b64_tr_b16 v[50:51], v18 offset:39424
v_mfma_f32_16x16x32_bf16 v[168:171], v[196:199], v[56:59], v[168:171]
buffer_load_dwordx4 v6, s[4:7], s72 offen offset:2048 lds
v_mfma_f32_16x16x32_bf16 v[72:75], v[60:63], a[152:155], v[72:75]
ds_read_b64_tr_b16 v[52:53], v19 offset:36864
v_mfma_f32_16x16x32_bf16 v[76:79], v[60:63], a[156:159], v[76:79]
ds_read_b64_tr_b16 v[54:55], v19 offset:37376
s_waitcnt lgkmcnt(8)
v_mfma_f32_16x16x32_bf16 v[104:107], v[32:35], a[152:155], v[104:107]
ds_read_b64_tr_b16 v[56:57], v19 offset:37888
ds_read_b128 v[196:199], v21 offset:4096
v_mfma_f32_16x16x32_bf16 v[108:111], v[32:35], a[156:159], v[108:111]
ds_read_b64_tr_b16 v[58:59], v19 offset:38400
buffer_load_dwordx4 v7, s[4:7], s72 offen offset:3072 lds
v_mfma_f32_16x16x32_bf16 v[136:139], a[152:155], v[36:39], v[136:139]
ds_read_b64_tr_b16 v[60:61], v19 offset:38912
s_add_u32 s72, s72, 128
v_mfma_f32_16x16x32_bf16 v[140:143], a[156:159], v[36:39], v[140:143]
ds_read_b64_tr_b16 v[62:63], v19 offset:39424
s_waitcnt lgkmcnt(9)
v_mfma_f32_16x16x32_bf16 v[80:83], v[40:43], a[152:155], v[80:83]
s_waitcnt vmcnt(20)
s_barrier
ds_read_b64_tr_b16 v[32:33], v248 offset:0
v_mfma_f32_16x16x32_bf16 v[84:87], v[40:43], a[156:159], v[84:87]
ds_read_b64_tr_b16 v[34:35], v248 offset:512
s_and_b32 s72, s72, 0x380
v_mfma_f32_16x16x32_bf16 v[112:115], v[44:47], a[152:155], v[112:115]
ds_read_b128 a[160:163], v2 offset:0
ds_read_b64_tr_b16 v[36:37], v248 offset:1024
v_mfma_f32_16x16x32_bf16 v[116:119], v[44:47], a[156:159], v[116:119]
ds_read_b128 a[164:167], v2 offset:2048
ds_read_b64_tr_b16 v[38:39], v248 offset:1536
s_waitcnt lgkmcnt(11)
v_mfma_f32_16x16x32_bf16 v[144:147], a[152:155], v[48:51], v[144:147]
ds_read_b128 a[168:171], v3 offset:0
ds_read_b64_tr_b16 v[40:41], v248 offset:2048
v_mfma_f32_16x16x32_bf16 v[148:151], a[156:159], v[48:51], v[148:151]
ds_read_b128 a[172:175], v3 offset:2048
ds_read_b64_tr_b16 v[42:43], v248 offset:2560
v_mfma_f32_16x16x32_bf16 v[88:91], v[52:55], a[152:155], v[88:91]
ds_read_b64_tr_b16 v[44:45], v249 offset:0
s_mul_i32 s82, s75, 1536
v_mfma_f32_16x16x32_bf16 v[92:95], v[52:55], a[156:159], v[92:95]
ds_read_b64_tr_b16 v[46:47], v249 offset:512
s_waitcnt lgkmcnt(12)
v_mfma_f32_16x16x32_bf16 v[120:123], v[56:59], a[152:155], v[120:123]
ds_read_b64_tr_b16 v[48:49], v249 offset:1024
s_add_u32 m0, s74, 0
v_mfma_f32_16x16x32_bf16 v[124:127], v[56:59], a[156:159], v[124:127]
ds_read_b64_tr_b16 v[50:51], v249 offset:1536
buffer_load_dwordx4 v12, s[12:15], s82 offen offset:0 lds
v_mfma_f32_16x16x32_bf16 v[152:155], a[152:155], v[60:63], v[152:155]
ds_read_b64_tr_b16 v[52:53], v249 offset:2048
v_mfma_f32_16x16x32_bf16 v[156:159], a[156:159], v[60:63], v[156:159]
ds_read_b64_tr_b16 v[54:55], v249 offset:2560
s_waitcnt lgkmcnt(10)
v_mfma_f32_16x16x32_bf16 v[64:67], v[32:35], a[160:163], v[64:67]
ds_read_b64_tr_b16 v[56:57], v250 offset:0
v_mfma_f32_16x16x32_bf16 v[68:71], v[32:35], a[164:167], v[68:71]
ds_read_b64_tr_b16 v[58:59], v250 offset:512
buffer_load_dwordx4 v12, s[12:15], s82 offen offset:1024 lds
v_mfma_f32_16x16x32_bf16 v[160:163], v[32:35], v[192:195], v[160:163]
v_mfma_f32_16x16x32_bf16 v[96:99], v[36:39], a[160:163], v[96:99]
ds_read_b64_tr_b16 v[60:61], v250 offset:1024
v_mfma_f32_16x16x32_bf16 v[100:103], v[36:39], a[164:167], v[100:103]
ds_read_b64_tr_b16 v[62:63], v250 offset:1536
v_mfma_f32_16x16x32_bf16 v[164:167], v[36:39], v[192:195], v[164:167]
buffer_load_dwordx4 v12, s[12:15], s82 offen offset:2048 lds
s_waitcnt lgkmcnt(8)
v_mfma_f32_16x16x32_bf16 v[128:131], a[160:163], v[40:43], v[128:131]
ds_read_b64_tr_b16 v[32:33], v250 offset:2048
s_add_u32 m0, s74, 12288
v_mfma_f32_16x16x32_bf16 v[132:135], a[164:167], v[40:43], v[132:135]
ds_read_b64_tr_b16 v[34:35], v250 offset:2560
s_add_u32 s82, s82, 98304
v_mfma_f32_16x16x32_bf16 v[168:171], v[192:195], v[40:43], v[168:171]
v_mfma_f32_16x16x32_bf16 v[72:75], v[44:47], a[160:163], v[72:75]
ds_read_b64_tr_b16 v[36:37], v251 offset:0
buffer_load_dwordx4 v12, s[12:15], s82 offen offset:0 lds
v_mfma_f32_16x16x32_bf16 v[76:79], v[44:47], a[164:167], v[76:79]
ds_read_b64_tr_b16 v[38:39], v251 offset:512
s_waitcnt lgkmcnt(8)
v_mfma_f32_16x16x32_bf16 v[104:107], v[48:51], a[160:163], v[104:107]
ds_read_b64_tr_b16 v[40:41], v251 offset:1024
ds_read_b128 v[192:195], v20 offset:6144
v_mfma_f32_16x16x32_bf16 v[108:111], v[48:51], a[164:167], v[108:111]
ds_read_b64_tr_b16 v[42:43], v251 offset:1536
v_mfma_f32_16x16x32_bf16 v[136:139], a[160:163], v[52:55], v[136:139]
ds_read_b64_tr_b16 v[44:45], v251 offset:2048
buffer_load_dwordx4 v12, s[12:15], s82 offen offset:1024 lds
v_mfma_f32_16x16x32_bf16 v[140:143], a[164:167], v[52:55], v[140:143]
ds_read_b64_tr_b16 v[46:47], v251 offset:2560
s_waitcnt lgkmcnt(9)
v_mfma_f32_16x16x32_bf16 v[80:83], v[56:59], a[160:163], v[80:83]
ds_read_b64_tr_b16 v[48:49], v248 offset:12288
v_mfma_f32_16x16x32_bf16 v[84:87], v[56:59], a[164:167], v[84:87]
ds_read_b64_tr_b16 v[50:51], v248 offset:12800
v_mfma_f32_16x16x32_bf16 v[112:115], v[60:63], a[160:163], v[112:115]
ds_read_b64_tr_b16 v[52:53], v248 offset:13312
buffer_load_dwordx4 v12, s[12:15], s82 offen offset:2048 lds
v_mfma_f32_16x16x32_bf16 v[116:119], v[60:63], a[164:167], v[116:119]
ds_read_b64_tr_b16 v[54:55], v248 offset:13824
s_waitcnt lgkmcnt(9)
v_mfma_f32_16x16x32_bf16 v[144:147], a[160:163], v[32:35], v[144:147]
ds_read_b64_tr_b16 v[56:57], v248 offset:14336
s_add_u32 s75, s75, 128
v_mfma_f32_16x16x32_bf16 v[148:151], a[164:167], v[32:35], v[148:151]
ds_read_b64_tr_b16 v[58:59], v248 offset:14848
s_and_b32 s75, s75, 0x380
v_mfma_f32_16x16x32_bf16 v[88:91], v[36:39], a[160:163], v[88:91]
ds_read_b64_tr_b16 v[60:61], v249 offset:12288
v_mfma_f32_16x16x32_bf16 v[92:95], v[36:39], a[164:167], v[92:95]
ds_read_b64_tr_b16 v[62:63], v249 offset:12800
s_waitcnt lgkmcnt(8)
v_mfma_f32_16x16x32_bf16 v[120:123], v[40:43], a[160:163], v[120:123]
ds_read_b64_tr_b16 v[32:33], v249 offset:13312
s_add_u32 m0, s77, 0
v_mfma_f32_16x16x32_bf16 v[124:127], v[40:43], a[164:167], v[124:127]
ds_read_b64_tr_b16 v[34:35], v249 offset:13824
buffer_load_dwordx4 v4, s[4:7], s72 offen offset:0 lds
v_mfma_f32_16x16x32_bf16 v[152:155], a[160:163], v[44:47], v[152:155]
ds_read_b64_tr_b16 v[36:37], v249 offset:14336
v_mfma_f32_16x16x32_bf16 v[156:159], a[164:167], v[44:47], v[156:159]
ds_read_b64_tr_b16 v[38:39], v249 offset:14848
s_waitcnt lgkmcnt(8)
v_mfma_f32_16x16x32_bf16 v[64:67], v[48:51], a[168:171], v[64:67]
ds_read_b64_tr_b16 v[40:41], v250 offset:12288
v_mfma_f32_16x16x32_bf16 v[68:71], v[48:51], a[172:175], v[68:71]
ds_read_b64_tr_b16 v[42:43], v250 offset:12800
buffer_load_dwordx4 v5, s[4:7], s72 offen offset:1024 lds
v_mfma_f32_16x16x32_bf16 v[160:163], v[48:51], v[196:199], v[160:163]
v_mfma_f32_16x16x32_bf16 v[96:99], v[52:55], a[168:171], v[96:99]
ds_read_b64_tr_b16 v[44:45], v250 offset:13312
v_mfma_f32_16x16x32_bf16 v[100:103], v[52:55], a[172:175], v[100:103]
ds_read_b64_tr_b16 v[46:47], v250 offset:13824
v_mfma_f32_16x16x32_bf16 v[164:167], v[52:55], v[196:199], v[164:167]
buffer_load_dwordx4 v6, s[4:7], s72 offen offset:2048 lds
s_waitcnt lgkmcnt(8)
v_mfma_f32_16x16x32_bf16 v[128:131], a[168:171], v[56:59], v[128:131]
ds_read_b64_tr_b16 v[48:49], v250 offset:14336
v_mfma_f32_16x16x32_bf16 v[132:135], a[172:175], v[56:59], v[132:135]
ds_read_b64_tr_b16 v[50:51], v250 offset:14848
v_mfma_f32_16x16x32_bf16 v[168:171], v[196:199], v[56:59], v[168:171]
v_mfma_f32_16x16x32_bf16 v[72:75], v[60:63], a[168:171], v[72:75]
ds_read_b64_tr_b16 v[52:53], v251 offset:12288
buffer_load_dwordx4 v7, s[4:7], s72 offen offset:3072 lds
v_mfma_f32_16x16x32_bf16 v[76:79], v[60:63], a[172:175], v[76:79]
ds_read_b64_tr_b16 v[54:55], v251 offset:12800
s_waitcnt lgkmcnt(8)
v_mfma_f32_16x16x32_bf16 v[104:107], v[32:35], a[168:171], v[104:107]
ds_read_b64_tr_b16 v[56:57], v251 offset:13312
ds_read_b128 v[196:199], v21 offset:6144
v_mfma_f32_16x16x32_bf16 v[108:111], v[32:35], a[172:175], v[108:111]
ds_read_b64_tr_b16 v[58:59], v251 offset:13824
s_add_u32 s72, s72, 128
v_mfma_f32_16x16x32_bf16 v[136:139], a[168:171], v[36:39], v[136:139]
ds_read_b64_tr_b16 v[60:61], v251 offset:14336
s_and_b32 s72, s72, 0x380
v_mfma_f32_16x16x32_bf16 v[140:143], a[172:175], v[36:39], v[140:143]
ds_read_b64_tr_b16 v[62:63], v251 offset:14848
s_waitcnt lgkmcnt(9)
v_mfma_f32_16x16x32_bf16 v[80:83], v[40:43], a[168:171], v[80:83]
s_waitcnt vmcnt(10)
s_barrier
ds_read_b64_tr_b16 v[32:33], v248 offset:24576
v_mfma_f32_16x16x32_bf16 v[84:87], v[40:43], a[172:175], v[84:87]
ds_read_b64_tr_b16 v[34:35], v248 offset:25088
buffer_load_dword v23, v246, s[16:19], 0 offen offset:3072
v_mfma_f32_16x16x32_bf16 v[112:115], v[44:47], a[168:171], v[112:115]
ds_read_b128 a[176:179], v2 offset:4096
ds_read_b64_tr_b16 v[36:37], v248 offset:25600
v_mfma_f32_16x16x32_bf16 v[116:119], v[44:47], a[172:175], v[116:119]
ds_read_b128 a[180:183], v2 offset:6144
ds_read_b64_tr_b16 v[38:39], v248 offset:26112
s_waitcnt lgkmcnt(11)
v_mfma_f32_16x16x32_bf16 v[144:147], a[168:171], v[48:51], v[144:147]
ds_read_b128 a[184:187], v3 offset:4096
ds_read_b64_tr_b16 v[40:41], v248 offset:26624
v_mfma_f32_16x16x32_bf16 v[148:151], a[172:175], v[48:51], v[148:151]
ds_read_b128 a[188:191], v3 offset:6144
ds_read_b64_tr_b16 v[42:43], v248 offset:27136
v_mfma_f32_16x16x32_bf16 v[88:91], v[52:55], a[168:171], v[88:91]
ds_read_b64_tr_b16 v[44:45], v249 offset:24576
s_mul_i32 s82, s75, 1536
v_mfma_f32_16x16x32_bf16 v[92:95], v[52:55], a[172:175], v[92:95]
ds_read_b64_tr_b16 v[46:47], v249 offset:25088
s_waitcnt lgkmcnt(12)
v_mfma_f32_16x16x32_bf16 v[120:123], v[56:59], a[168:171], v[120:123]
ds_read_b64_tr_b16 v[48:49], v249 offset:25600
s_add_u32 m0, s74, 24576
v_mfma_f32_16x16x32_bf16 v[124:127], v[56:59], a[172:175], v[124:127]
ds_read_b64_tr_b16 v[50:51], v249 offset:26112
buffer_load_dwordx4 v12, s[12:15], s82 offen offset:0 lds
v_mfma_f32_16x16x32_bf16 v[152:155], a[168:171], v[60:63], v[152:155]
ds_read_b64_tr_b16 v[52:53], v249 offset:26624
v_mfma_f32_16x16x32_bf16 v[156:159], a[172:175], v[60:63], v[156:159]
ds_read_b64_tr_b16 v[54:55], v249 offset:27136
s_waitcnt lgkmcnt(10)
v_mfma_f32_16x16x32_bf16 v[64:67], v[32:35], a[176:179], v[64:67]
ds_read_b64_tr_b16 v[56:57], v250 offset:24576
v_mfma_f32_16x16x32_bf16 v[68:71], v[32:35], a[180:183], v[68:71]
ds_read_b64_tr_b16 v[58:59], v250 offset:25088
buffer_load_dwordx4 v12, s[12:15], s82 offen offset:1024 lds
v_mfma_f32_16x16x32_bf16 v[160:163], v[32:35], v[192:195], v[160:163]
v_mfma_f32_16x16x32_bf16 v[96:99], v[36:39], a[176:179], v[96:99]
ds_read_b64_tr_b16 v[60:61], v250 offset:25600
v_mfma_f32_16x16x32_bf16 v[100:103], v[36:39], a[180:183], v[100:103]
ds_read_b64_tr_b16 v[62:63], v250 offset:26112
v_mfma_f32_16x16x32_bf16 v[164:167], v[36:39], v[192:195], v[164:167]
buffer_load_dwordx4 v12, s[12:15], s82 offen offset:2048 lds
s_waitcnt lgkmcnt(8)
v_mfma_f32_16x16x32_bf16 v[128:131], a[176:179], v[40:43], v[128:131]
ds_read_b64_tr_b16 v[32:33], v250 offset:26624
s_add_u32 m0, s74, 36864
v_mfma_f32_16x16x32_bf16 v[132:135], a[180:183], v[40:43], v[132:135]
ds_read_b64_tr_b16 v[34:35], v250 offset:27136
s_add_u32 s82, s82, 98304
v_mfma_f32_16x16x32_bf16 v[168:171], v[192:195], v[40:43], v[168:171]
v_mfma_f32_16x16x32_bf16 v[72:75], v[44:47], a[176:179], v[72:75]
ds_read_b64_tr_b16 v[36:37], v251 offset:24576
buffer_load_dwordx4 v12, s[12:15], s82 offen offset:0 lds
v_mfma_f32_16x16x32_bf16 v[76:79], v[44:47], a[180:183], v[76:79]
ds_read_b64_tr_b16 v[38:39], v251 offset:25088
s_waitcnt lgkmcnt(8)
v_mfma_f32_16x16x32_bf16 v[104:107], v[48:51], a[176:179], v[104:107]
ds_read_b64_tr_b16 v[40:41], v251 offset:25600
ds_read_b128 v[192:195], v20 offset:8192
v_mfma_f32_16x16x32_bf16 v[108:111], v[48:51], a[180:183], v[108:111]
ds_read_b64_tr_b16 v[42:43], v251 offset:26112
v_mfma_f32_16x16x32_bf16 v[136:139], a[176:179], v[52:55], v[136:139]
ds_read_b64_tr_b16 v[44:45], v251 offset:26624
buffer_load_dwordx4 v12, s[12:15], s82 offen offset:1024 lds
v_mfma_f32_16x16x32_bf16 v[140:143], a[180:183], v[52:55], v[140:143]
ds_read_b64_tr_b16 v[46:47], v251 offset:27136
s_waitcnt lgkmcnt(9)
v_mfma_f32_16x16x32_bf16 v[80:83], v[56:59], a[176:179], v[80:83]
ds_read_b64_tr_b16 v[48:49], v248 offset:36864
v_mfma_f32_16x16x32_bf16 v[84:87], v[56:59], a[180:183], v[84:87]
ds_read_b64_tr_b16 v[50:51], v248 offset:37376
v_mfma_f32_16x16x32_bf16 v[112:115], v[60:63], a[176:179], v[112:115]
ds_read_b64_tr_b16 v[52:53], v248 offset:37888
buffer_load_dwordx4 v12, s[12:15], s82 offen offset:2048 lds
v_mfma_f32_16x16x32_bf16 v[116:119], v[60:63], a[180:183], v[116:119]
ds_read_b64_tr_b16 v[54:55], v248 offset:38400
s_waitcnt lgkmcnt(9)
v_mfma_f32_16x16x32_bf16 v[144:147], a[176:179], v[32:35], v[144:147]
ds_read_b64_tr_b16 v[56:57], v248 offset:38912
s_add_u32 s75, s75, 128
v_mfma_f32_16x16x32_bf16 v[148:151], a[180:183], v[32:35], v[148:151]
ds_read_b64_tr_b16 v[58:59], v248 offset:39424
s_and_b32 s75, s75, 0x380
v_mfma_f32_16x16x32_bf16 v[88:91], v[36:39], a[176:179], v[88:91]
ds_read_b64_tr_b16 v[60:61], v249 offset:36864
v_mfma_f32_16x16x32_bf16 v[92:95], v[36:39], a[180:183], v[92:95]
ds_read_b64_tr_b16 v[62:63], v249 offset:37376
s_waitcnt lgkmcnt(8)
v_mfma_f32_16x16x32_bf16 v[120:123], v[40:43], a[176:179], v[120:123]
ds_read_b64_tr_b16 v[32:33], v249 offset:37888
s_add_u32 m0, s77, 4096
v_mfma_f32_16x16x32_bf16 v[124:127], v[40:43], a[180:183], v[124:127]
ds_read_b64_tr_b16 v[34:35], v249 offset:38400
buffer_load_dwordx4 v4, s[4:7], s72 offen offset:0 lds
v_mfma_f32_16x16x32_bf16 v[152:155], a[176:179], v[44:47], v[152:155]
ds_read_b64_tr_b16 v[36:37], v249 offset:38912
v_mfma_f32_16x16x32_bf16 v[156:159], a[180:183], v[44:47], v[156:159]
ds_read_b64_tr_b16 v[38:39], v249 offset:39424
s_waitcnt lgkmcnt(8)
v_mfma_f32_16x16x32_bf16 v[64:67], v[48:51], a[184:187], v[64:67]
ds_read_b64_tr_b16 v[40:41], v250 offset:36864
v_mfma_f32_16x16x32_bf16 v[68:71], v[48:51], a[188:191], v[68:71]
ds_read_b64_tr_b16 v[42:43], v250 offset:37376
buffer_load_dwordx4 v5, s[4:7], s72 offen offset:1024 lds
v_mfma_f32_16x16x32_bf16 v[160:163], v[48:51], v[196:199], v[160:163]
v_mfma_f32_16x16x32_bf16 v[96:99], v[52:55], a[184:187], v[96:99]
ds_read_b64_tr_b16 v[44:45], v250 offset:37888
v_mfma_f32_16x16x32_bf16 v[100:103], v[52:55], a[188:191], v[100:103]
ds_read_b64_tr_b16 v[46:47], v250 offset:38400
v_mfma_f32_16x16x32_bf16 v[164:167], v[52:55], v[196:199], v[164:167]
buffer_load_dwordx4 v6, s[4:7], s72 offen offset:2048 lds
s_waitcnt lgkmcnt(8)
v_mfma_f32_16x16x32_bf16 v[128:131], a[184:187], v[56:59], v[128:131]
ds_read_b64_tr_b16 v[48:49], v250 offset:38912
v_mfma_f32_16x16x32_bf16 v[132:135], a[188:191], v[56:59], v[132:135]
ds_read_b64_tr_b16 v[50:51], v250 offset:39424
v_mfma_f32_16x16x32_bf16 v[168:171], v[196:199], v[56:59], v[168:171]
v_mfma_f32_16x16x32_bf16 v[72:75], v[60:63], a[184:187], v[72:75]
ds_read_b64_tr_b16 v[52:53], v251 offset:36864
buffer_load_dwordx4 v7, s[4:7], s72 offen offset:3072 lds
v_mfma_f32_16x16x32_bf16 v[76:79], v[60:63], a[188:191], v[76:79]
ds_read_b64_tr_b16 v[54:55], v251 offset:37376
s_waitcnt lgkmcnt(8)
v_mfma_f32_16x16x32_bf16 v[104:107], v[32:35], a[184:187], v[104:107]
ds_read_b64_tr_b16 v[56:57], v251 offset:37888
ds_read_b128 v[196:199], v21 offset:8192
v_mfma_f32_16x16x32_bf16 v[108:111], v[32:35], a[188:191], v[108:111]
ds_read_b64_tr_b16 v[58:59], v251 offset:38400
s_add_u32 s72, s72, 128
v_mfma_f32_16x16x32_bf16 v[136:139], a[184:187], v[36:39], v[136:139]
ds_read_b64_tr_b16 v[60:61], v251 offset:38912
s_and_b32 s72, s72, 0x380
v_mfma_f32_16x16x32_bf16 v[140:143], a[188:191], v[36:39], v[140:143]
ds_read_b64_tr_b16 v[62:63], v251 offset:39424
s_waitcnt lgkmcnt(9)
v_mfma_f32_16x16x32_bf16 v[80:83], v[40:43], a[184:187], v[80:83]
s_waitcnt vmcnt(11)
s_barrier
ds_read_b64_tr_b16 v[32:33], v16 offset:0
v_mfma_f32_16x16x32_bf16 v[84:87], v[40:43], a[188:191], v[84:87]
ds_read_b64_tr_b16 v[34:35], v16 offset:512
v_mfma_f32_16x16x32_bf16 v[112:115], v[44:47], a[184:187], v[112:115]
ds_read_b128 a[192:195], v2 offset:0
ds_read_b64_tr_b16 v[36:37], v16 offset:1024
v_mfma_f32_16x16x32_bf16 v[116:119], v[44:47], a[188:191], v[116:119]
ds_read_b128 a[196:199], v2 offset:2048
ds_read_b64_tr_b16 v[38:39], v16 offset:1536
s_waitcnt lgkmcnt(11)
v_mfma_f32_16x16x32_bf16 v[144:147], a[184:187], v[48:51], v[144:147]
ds_read_b128 a[200:203], v3 offset:0
ds_read_b64_tr_b16 v[40:41], v16 offset:2048
v_mfma_f32_16x16x32_bf16 v[148:151], a[188:191], v[48:51], v[148:151]
ds_read_b128 a[204:207], v3 offset:2048
ds_read_b64_tr_b16 v[42:43], v16 offset:2560
v_mfma_f32_16x16x32_bf16 v[88:91], v[52:55], a[184:187], v[88:91]
ds_read_b64_tr_b16 v[44:45], v17 offset:0
s_mul_i32 s82, s75, 1536
v_mfma_f32_16x16x32_bf16 v[92:95], v[52:55], a[188:191], v[92:95]
ds_read_b64_tr_b16 v[46:47], v17 offset:512
s_waitcnt lgkmcnt(12)
v_mfma_f32_16x16x32_bf16 v[120:123], v[56:59], a[184:187], v[120:123]
ds_read_b64_tr_b16 v[48:49], v17 offset:1024
s_add_u32 m0, s74, 49152
v_mfma_f32_16x16x32_bf16 v[124:127], v[56:59], a[188:191], v[124:127]
ds_read_b64_tr_b16 v[50:51], v17 offset:1536
buffer_load_dwordx4 v12, s[12:15], s82 offen offset:0 lds
v_mfma_f32_16x16x32_bf16 v[152:155], a[184:187], v[60:63], v[152:155]
ds_read_b64_tr_b16 v[52:53], v17 offset:2048
v_mfma_f32_16x16x32_bf16 v[156:159], a[188:191], v[60:63], v[156:159]
ds_read_b64_tr_b16 v[54:55], v17 offset:2560
s_waitcnt lgkmcnt(10)
v_mfma_f32_16x16x32_bf16 v[64:67], v[32:35], a[192:195], v[64:67]
ds_read_b64_tr_b16 v[56:57], v18 offset:0
v_mfma_f32_16x16x32_bf16 v[68:71], v[32:35], a[196:199], v[68:71]
ds_read_b64_tr_b16 v[58:59], v18 offset:512
buffer_load_dwordx4 v12, s[12:15], s82 offen offset:1024 lds
v_mfma_f32_16x16x32_bf16 v[160:163], v[32:35], v[192:195], v[160:163]
v_mfma_f32_16x16x32_bf16 v[96:99], v[36:39], a[192:195], v[96:99]
ds_read_b64_tr_b16 v[60:61], v18 offset:1024
v_mfma_f32_16x16x32_bf16 v[100:103], v[36:39], a[196:199], v[100:103]
ds_read_b64_tr_b16 v[62:63], v18 offset:1536
v_mfma_f32_16x16x32_bf16 v[164:167], v[36:39], v[192:195], v[164:167]
buffer_load_dwordx4 v12, s[12:15], s82 offen offset:2048 lds
s_waitcnt lgkmcnt(8)
v_mfma_f32_16x16x32_bf16 v[128:131], a[192:195], v[40:43], v[128:131]
ds_read_b64_tr_b16 v[32:33], v18 offset:2048
s_add_u32 m0, s74, 61440
v_mfma_f32_16x16x32_bf16 v[132:135], a[196:199], v[40:43], v[132:135]
ds_read_b64_tr_b16 v[34:35], v18 offset:2560
s_add_u32 s82, s82, 98304
v_mfma_f32_16x16x32_bf16 v[168:171], v[192:195], v[40:43], v[168:171]
v_mfma_f32_16x16x32_bf16 v[72:75], v[44:47], a[192:195], v[72:75]
ds_read_b64_tr_b16 v[36:37], v19 offset:0
buffer_load_dwordx4 v12, s[12:15], s82 offen offset:0 lds
v_mfma_f32_16x16x32_bf16 v[76:79], v[44:47], a[196:199], v[76:79]
ds_read_b64_tr_b16 v[38:39], v19 offset:512
s_waitcnt lgkmcnt(8)
v_mfma_f32_16x16x32_bf16 v[104:107], v[48:51], a[192:195], v[104:107]
ds_read_b64_tr_b16 v[40:41], v19 offset:1024
ds_read_b128 v[192:195], v20 offset:10240
v_mfma_f32_16x16x32_bf16 v[108:111], v[48:51], a[196:199], v[108:111]
ds_read_b64_tr_b16 v[42:43], v19 offset:1536
v_mfma_f32_16x16x32_bf16 v[136:139], a[192:195], v[52:55], v[136:139]
ds_read_b64_tr_b16 v[44:45], v19 offset:2048
buffer_load_dwordx4 v12, s[12:15], s82 offen offset:1024 lds
v_mfma_f32_16x16x32_bf16 v[140:143], a[196:199], v[52:55], v[140:143]
ds_read_b64_tr_b16 v[46:47], v19 offset:2560
s_waitcnt lgkmcnt(9)
v_mfma_f32_16x16x32_bf16 v[80:83], v[56:59], a[192:195], v[80:83]
ds_read_b64_tr_b16 v[48:49], v16 offset:12288
v_mfma_f32_16x16x32_bf16 v[84:87], v[56:59], a[196:199], v[84:87]
ds_read_b64_tr_b16 v[50:51], v16 offset:12800
v_mfma_f32_16x16x32_bf16 v[112:115], v[60:63], a[192:195], v[112:115]
ds_read_b64_tr_b16 v[52:53], v16 offset:13312
buffer_load_dwordx4 v12, s[12:15], s82 offen offset:2048 lds
v_mfma_f32_16x16x32_bf16 v[116:119], v[60:63], a[196:199], v[116:119]
ds_read_b64_tr_b16 v[54:55], v16 offset:13824
s_waitcnt lgkmcnt(9)
v_mfma_f32_16x16x32_bf16 v[144:147], a[192:195], v[32:35], v[144:147]
ds_read_b64_tr_b16 v[56:57], v16 offset:14336
s_add_u32 s75, s75, 128
v_mfma_f32_16x16x32_bf16 v[148:151], a[196:199], v[32:35], v[148:151]
ds_read_b64_tr_b16 v[58:59], v16 offset:14848
s_and_b32 s75, s75, 0x380
v_mfma_f32_16x16x32_bf16 v[88:91], v[36:39], a[192:195], v[88:91]
ds_read_b64_tr_b16 v[60:61], v17 offset:12288
v_mfma_f32_16x16x32_bf16 v[92:95], v[36:39], a[196:199], v[92:95]
ds_read_b64_tr_b16 v[62:63], v17 offset:12800
s_waitcnt lgkmcnt(8)
v_mfma_f32_16x16x32_bf16 v[120:123], v[40:43], a[192:195], v[120:123]
ds_read_b64_tr_b16 v[32:33], v17 offset:13312
s_add_u32 m0, s77, 0
v_mfma_f32_16x16x32_bf16 v[124:127], v[40:43], a[196:199], v[124:127]
ds_read_b64_tr_b16 v[34:35], v17 offset:13824
buffer_load_dwordx4 v4, s[4:7], s72 offen offset:0 lds
v_mfma_f32_16x16x32_bf16 v[152:155], a[192:195], v[44:47], v[152:155]
ds_read_b64_tr_b16 v[36:37], v17 offset:14336
v_mfma_f32_16x16x32_bf16 v[156:159], a[196:199], v[44:47], v[156:159]
ds_read_b64_tr_b16 v[38:39], v17 offset:14848
s_waitcnt lgkmcnt(8)
v_mfma_f32_16x16x32_bf16 v[64:67], v[48:51], a[200:203], v[64:67]
ds_read_b64_tr_b16 v[40:41], v18 offset:12288
v_mfma_f32_16x16x32_bf16 v[68:71], v[48:51], a[204:207], v[68:71]
ds_read_b64_tr_b16 v[42:43], v18 offset:12800
buffer_load_dwordx4 v5, s[4:7], s72 offen offset:1024 lds
v_mfma_f32_16x16x32_bf16 v[160:163], v[48:51], v[196:199], v[160:163]
v_mfma_f32_16x16x32_bf16 v[96:99], v[52:55], a[200:203], v[96:99]
ds_read_b64_tr_b16 v[44:45], v18 offset:13312
v_mfma_f32_16x16x32_bf16 v[100:103], v[52:55], a[204:207], v[100:103]
ds_read_b64_tr_b16 v[46:47], v18 offset:13824
v_mfma_f32_16x16x32_bf16 v[164:167], v[52:55], v[196:199], v[164:167]
buffer_load_dwordx4 v6, s[4:7], s72 offen offset:2048 lds
s_waitcnt lgkmcnt(8)
v_mfma_f32_16x16x32_bf16 v[128:131], a[200:203], v[56:59], v[128:131]
ds_read_b64_tr_b16 v[48:49], v18 offset:14336
v_mfma_f32_16x16x32_bf16 v[132:135], a[204:207], v[56:59], v[132:135]
ds_read_b64_tr_b16 v[50:51], v18 offset:14848
v_mfma_f32_16x16x32_bf16 v[168:171], v[196:199], v[56:59], v[168:171]
v_mfma_f32_16x16x32_bf16 v[72:75], v[60:63], a[200:203], v[72:75]
ds_read_b64_tr_b16 v[52:53], v19 offset:12288
buffer_load_dwordx4 v7, s[4:7], s72 offen offset:3072 lds
v_mfma_f32_16x16x32_bf16 v[76:79], v[60:63], a[204:207], v[76:79]
ds_read_b64_tr_b16 v[54:55], v19 offset:12800
s_waitcnt lgkmcnt(8)
v_mfma_f32_16x16x32_bf16 v[104:107], v[32:35], a[200:203], v[104:107]
ds_read_b64_tr_b16 v[56:57], v19 offset:13312
ds_read_b128 v[196:199], v21 offset:10240
v_mfma_f32_16x16x32_bf16 v[108:111], v[32:35], a[204:207], v[108:111]
ds_read_b64_tr_b16 v[58:59], v19 offset:13824
s_add_u32 s72, s72, 128
v_mfma_f32_16x16x32_bf16 v[136:139], a[200:203], v[36:39], v[136:139]
ds_read_b64_tr_b16 v[60:61], v19 offset:14336
s_and_b32 s72, s72, 0x380
v_mfma_f32_16x16x32_bf16 v[140:143], a[204:207], v[36:39], v[140:143]
ds_read_b64_tr_b16 v[62:63], v19 offset:14848
s_waitcnt lgkmcnt(9)
v_mfma_f32_16x16x32_bf16 v[80:83], v[40:43], a[200:203], v[80:83]
s_waitcnt vmcnt(10)
s_barrier
ds_read_b64_tr_b16 v[32:33], v16 offset:24576
v_mfma_f32_16x16x32_bf16 v[84:87], v[40:43], a[204:207], v[84:87]
ds_read_b64_tr_b16 v[34:35], v16 offset:25088
v_xor_b32 v245, 512, v245
v_mfma_f32_16x16x32_bf16 v[112:115], v[44:47], a[200:203], v[112:115]
ds_read_b128 a[208:211], v2 offset:4096
ds_read_b64_tr_b16 v[36:37], v16 offset:25600
v_mfma_f32_16x16x32_bf16 v[116:119], v[44:47], a[204:207], v[116:119]
ds_read_b128 a[212:215], v2 offset:6144
ds_read_b64_tr_b16 v[38:39], v16 offset:26112
s_waitcnt lgkmcnt(11)
v_mfma_f32_16x16x32_bf16 v[144:147], a[200:203], v[48:51], v[144:147]
ds_read_b128 a[216:219], v3 offset:4096
ds_read_b64_tr_b16 v[40:41], v16 offset:26624
v_mfma_f32_16x16x32_bf16 v[148:151], a[204:207], v[48:51], v[148:151]
ds_read_b128 a[220:223], v3 offset:6144
ds_read_b64_tr_b16 v[42:43], v16 offset:27136
v_mfma_f32_16x16x32_bf16 v[88:91], v[52:55], a[200:203], v[88:91]
ds_read_b64_tr_b16 v[44:45], v17 offset:24576
buffer_load_dword v23, v245, s[16:19], 0 offen offset:3072
v_mfma_f32_16x16x32_bf16 v[92:95], v[52:55], a[204:207], v[92:95]
ds_read_b64_tr_b16 v[46:47], v17 offset:25088
s_waitcnt lgkmcnt(12)
v_mfma_f32_16x16x32_bf16 v[120:123], v[56:59], a[200:203], v[120:123]
ds_read_b64_tr_b16 v[48:49], v17 offset:25600
s_mul_i32 s82, s75, 1536
v_mfma_f32_16x16x32_bf16 v[124:127], v[56:59], a[204:207], v[124:127]
ds_read_b64_tr_b16 v[50:51], v17 offset:26112
s_add_u32 m0, s74, 73728
v_mfma_f32_16x16x32_bf16 v[152:155], a[200:203], v[60:63], v[152:155]
ds_read_b64_tr_b16 v[52:53], v17 offset:26624
buffer_load_dwordx4 v12, s[12:15], s82 offen offset:0 lds
v_mfma_f32_16x16x32_bf16 v[156:159], a[204:207], v[60:63], v[156:159]
ds_read_b64_tr_b16 v[54:55], v17 offset:27136
s_waitcnt lgkmcnt(10)
v_mfma_f32_16x16x32_bf16 v[64:67], v[32:35], a[208:211], v[64:67]
ds_read_b64_tr_b16 v[56:57], v18 offset:24576
v_mfma_f32_16x16x32_bf16 v[68:71], v[32:35], a[212:215], v[68:71]
ds_read_b64_tr_b16 v[58:59], v18 offset:25088
v_mfma_f32_16x16x32_bf16 v[160:163], v[32:35], v[192:195], v[160:163]
buffer_load_dwordx4 v12, s[12:15], s82 offen offset:1024 lds
v_mfma_f32_16x16x32_bf16 v[96:99], v[36:39], a[208:211], v[96:99]
ds_read_b64_tr_b16 v[60:61], v18 offset:25600
v_mfma_f32_16x16x32_bf16 v[100:103], v[36:39], a[212:215], v[100:103]
ds_read_b64_tr_b16 v[62:63], v18 offset:26112
v_mfma_f32_16x16x32_bf16 v[164:167], v[36:39], v[192:195], v[164:167]
s_waitcnt lgkmcnt(8)
v_mfma_f32_16x16x32_bf16 v[128:131], a[208:211], v[40:43], v[128:131]
ds_read_b64_tr_b16 v[32:33], v18 offset:26624
buffer_load_dwordx4 v12, s[12:15], s82 offen offset:2048 lds
v_mfma_f32_16x16x32_bf16 v[132:135], a[212:215], v[40:43], v[132:135]
ds_read_b64_tr_b16 v[34:35], v18 offset:27136
s_add_u32 m0, s74, 86016
v_mfma_f32_16x16x32_bf16 v[168:171], v[192:195], v[40:43], v[168:171]
s_add_u32 s82, s82, 98304
v_mfma_f32_16x16x32_bf16 v[72:75], v[44:47], a[208:211], v[72:75]
ds_read_b64_tr_b16 v[36:37], v19 offset:24576
v_mfma_f32_16x16x32_bf16 v[76:79], v[44:47], a[212:215], v[76:79]
ds_read_b64_tr_b16 v[38:39], v19 offset:25088
s_waitcnt lgkmcnt(8)
v_mfma_f32_16x16x32_bf16 v[104:107], v[48:51], a[208:211], v[104:107]
ds_read_b64_tr_b16 v[40:41], v19 offset:25600
ds_read_b128 v[192:195], v20 offset:12288
v_mfma_f32_16x16x32_bf16 v[108:111], v[48:51], a[212:215], v[108:111]
ds_read_b64_tr_b16 v[42:43], v19 offset:26112
buffer_load_dwordx4 v12, s[12:15], s82 offen offset:0 lds
v_mfma_f32_16x16x32_bf16 v[136:139], a[208:211], v[52:55], v[136:139]
ds_read_b64_tr_b16 v[44:45], v19 offset:26624
v_mfma_f32_16x16x32_bf16 v[140:143], a[212:215], v[52:55], v[140:143]
ds_read_b64_tr_b16 v[46:47], v19 offset:27136
s_waitcnt lgkmcnt(9)
v_mfma_f32_16x16x32_bf16 v[80:83], v[56:59], a[208:211], v[80:83]
ds_read_b64_tr_b16 v[48:49], v16 offset:36864
v_mfma_f32_16x16x32_bf16 v[84:87], v[56:59], a[212:215], v[84:87]
ds_read_b64_tr_b16 v[50:51], v16 offset:37376
buffer_load_dwordx4 v12, s[12:15], s82 offen offset:1024 lds
v_mfma_f32_16x16x32_bf16 v[112:115], v[60:63], a[208:211], v[112:115]
ds_read_b64_tr_b16 v[52:53], v16 offset:37888
v_mfma_f32_16x16x32_bf16 v[116:119], v[60:63], a[212:215], v[116:119]
ds_read_b64_tr_b16 v[54:55], v16 offset:38400
s_waitcnt lgkmcnt(9)
v_mfma_f32_16x16x32_bf16 v[144:147], a[208:211], v[32:35], v[144:147]
ds_read_b64_tr_b16 v[56:57], v16 offset:38912
v_mfma_f32_16x16x32_bf16 v[148:151], a[212:215], v[32:35], v[148:151]
ds_read_b64_tr_b16 v[58:59], v16 offset:39424
buffer_load_dwordx4 v12, s[12:15], s82 offen offset:2048 lds
v_mfma_f32_16x16x32_bf16 v[88:91], v[36:39], a[208:211], v[88:91]
ds_read_b64_tr_b16 v[60:61], v17 offset:36864
s_add_u32 s75, s75, 128
v_mfma_f32_16x16x32_bf16 v[92:95], v[36:39], a[212:215], v[92:95]
ds_read_b64_tr_b16 v[62:63], v17 offset:37376
s_waitcnt lgkmcnt(8)
v_mfma_f32_16x16x32_bf16 v[120:123], v[40:43], a[208:211], v[120:123]
ds_read_b64_tr_b16 v[32:33], v17 offset:37888
s_and_b32 s75, s75, 0x380
v_mfma_f32_16x16x32_bf16 v[124:127], v[40:43], a[212:215], v[124:127]
ds_read_b64_tr_b16 v[34:35], v17 offset:38400
v_mfma_f32_16x16x32_bf16 v[152:155], a[208:211], v[44:47], v[152:155]
ds_read_b64_tr_b16 v[36:37], v17 offset:38912
s_add_u32 m0, s77, 4096
v_mfma_f32_16x16x32_bf16 v[156:159], a[212:215], v[44:47], v[156:159]
ds_read_b64_tr_b16 v[38:39], v17 offset:39424
s_waitcnt lgkmcnt(8)
v_mfma_f32_16x16x32_bf16 v[64:67], v[48:51], a[216:219], v[64:67]
ds_read_b64_tr_b16 v[40:41], v18 offset:36864
buffer_load_dwordx4 v4, s[4:7], s72 offen offset:0 lds
v_mfma_f32_16x16x32_bf16 v[68:71], v[48:51], a[220:223], v[68:71]
ds_read_b64_tr_b16 v[42:43], v18 offset:37376
v_mfma_f32_16x16x32_bf16 v[160:163], v[48:51], v[196:199], v[160:163]
v_mfma_f32_16x16x32_bf16 v[96:99], v[52:55], a[216:219], v[96:99]
ds_read_b64_tr_b16 v[44:45], v18 offset:37888
v_mfma_f32_16x16x32_bf16 v[100:103], v[52:55], a[220:223], v[100:103]
ds_read_b64_tr_b16 v[46:47], v18 offset:38400
buffer_load_dwordx4 v5, s[4:7], s72 offen offset:1024 lds
v_mfma_f32_16x16x32_bf16 v[164:167], v[52:55], v[196:199], v[164:167]
s_waitcnt lgkmcnt(8)
v_mfma_f32_16x16x32_bf16 v[128:131], a[216:219], v[56:59], v[128:131]
ds_read_b64_tr_b16 v[48:49], v18 offset:38912
v_mfma_f32_16x16x32_bf16 v[132:135], a[220:223], v[56:59], v[132:135]
ds_read_b64_tr_b16 v[50:51], v18 offset:39424
v_mfma_f32_16x16x32_bf16 v[168:171], v[196:199], v[56:59], v[168:171]
buffer_load_dwordx4 v6, s[4:7], s72 offen offset:2048 lds
v_mfma_f32_16x16x32_bf16 v[72:75], v[60:63], a[216:219], v[72:75]
ds_read_b64_tr_b16 v[52:53], v19 offset:36864
v_mfma_f32_16x16x32_bf16 v[76:79], v[60:63], a[220:223], v[76:79]
ds_read_b64_tr_b16 v[54:55], v19 offset:37376
s_waitcnt lgkmcnt(8)
v_mfma_f32_16x16x32_bf16 v[104:107], v[32:35], a[216:219], v[104:107]
ds_read_b64_tr_b16 v[56:57], v19 offset:37888
ds_read_b128 v[196:199], v21 offset:12288
v_mfma_f32_16x16x32_bf16 v[108:111], v[32:35], a[220:223], v[108:111]
ds_read_b64_tr_b16 v[58:59], v19 offset:38400
buffer_load_dwordx4 v7, s[4:7], s72 offen offset:3072 lds
v_mfma_f32_16x16x32_bf16 v[136:139], a[216:219], v[36:39], v[136:139]
ds_read_b64_tr_b16 v[60:61], v19 offset:38912
s_add_u32 s72, s72, 128
v_mfma_f32_16x16x32_bf16 v[140:143], a[220:223], v[36:39], v[140:143]
ds_read_b64_tr_b16 v[62:63], v19 offset:39424
s_waitcnt lgkmcnt(9)
v_mfma_f32_16x16x32_bf16 v[80:83], v[40:43], a[216:219], v[80:83]
s_waitcnt vmcnt(11)
s_barrier
ds_read_b64_tr_b16 v[32:33], v248 offset:0
v_mfma_f32_16x16x32_bf16 v[84:87], v[40:43], a[220:223], v[84:87]
ds_read_b64_tr_b16 v[34:35], v248 offset:512
s_and_b32 s72, s72, 0x380
v_mfma_f32_16x16x32_bf16 v[112:115], v[44:47], a[216:219], v[112:115]
ds_read_b128 a[224:227], v2 offset:0
ds_read_b64_tr_b16 v[36:37], v248 offset:1024
v_mfma_f32_16x16x32_bf16 v[116:119], v[44:47], a[220:223], v[116:119]
ds_read_b128 a[228:231], v2 offset:2048
ds_read_b64_tr_b16 v[38:39], v248 offset:1536
s_waitcnt lgkmcnt(11)
v_mfma_f32_16x16x32_bf16 v[144:147], a[216:219], v[48:51], v[144:147]
ds_read_b128 a[232:235], v3 offset:0
ds_read_b64_tr_b16 v[40:41], v248 offset:2048
v_mfma_f32_16x16x32_bf16 v[148:151], a[220:223], v[48:51], v[148:151]
ds_read_b128 a[236:239], v3 offset:2048
ds_read_b64_tr_b16 v[42:43], v248 offset:2560
v_mfma_f32_16x16x32_bf16 v[88:91], v[52:55], a[216:219], v[88:91]
ds_read_b64_tr_b16 v[44:45], v249 offset:0
v_xor_b32 v246, 512, v246
buffer_load_dword v23, v246, s[16:19], 0 offen offset:3072
v_mfma_f32_16x16x32_bf16 v[92:95], v[52:55], a[220:223], v[92:95]
ds_read_b64_tr_b16 v[46:47], v249 offset:512
s_waitcnt lgkmcnt(12)
v_mfma_f32_16x16x32_bf16 v[120:123], v[56:59], a[216:219], v[120:123]
ds_read_b64_tr_b16 v[48:49], v249 offset:1024
buffer_load_dword v28, off, s[40:43], 0 sc1
v_mfma_f32_16x16x32_bf16 v[124:127], v[56:59], a[220:223], v[124:127]
ds_read_b64_tr_b16 v[50:51], v249 offset:1536
v_mfma_f32_16x16x32_bf16 v[152:155], a[216:219], v[60:63], v[152:155]
ds_read_b64_tr_b16 v[52:53], v249 offset:2048
v_mfma_f32_16x16x32_bf16 v[156:159], a[220:223], v[60:63], v[156:159]
ds_read_b64_tr_b16 v[54:55], v249 offset:2560
s_waitcnt lgkmcnt(10)
v_mfma_f32_16x16x32_bf16 v[64:67], v[32:35], a[224:227], v[64:67]
ds_read_b64_tr_b16 v[56:57], v250 offset:0
v_mfma_f32_16x16x32_bf16 v[68:71], v[32:35], a[228:231], v[68:71]
ds_read_b64_tr_b16 v[58:59], v250 offset:512
v_mfma_f32_16x16x32_bf16 v[160:163], v[32:35], v[192:195], v[160:163]
v_mfma_f32_16x16x32_bf16 v[96:99], v[36:39], a[224:227], v[96:99]
ds_read_b64_tr_b16 v[60:61], v250 offset:1024
v_mfma_f32_16x16x32_bf16 v[100:103], v[36:39], a[228:231], v[100:103]
ds_read_b64_tr_b16 v[62:63], v250 offset:1536
v_mfma_f32_16x16x32_bf16 v[164:167], v[36:39], v[192:195], v[164:167]
s_waitcnt lgkmcnt(8)
v_mfma_f32_16x16x32_bf16 v[128:131], a[224:227], v[40:43], v[128:131]
ds_read_b64_tr_b16 v[32:33], v250 offset:2048
v_mfma_f32_16x16x32_bf16 v[132:135], a[228:231], v[40:43], v[132:135]
ds_read_b64_tr_b16 v[34:35], v250 offset:2560
v_mfma_f32_16x16x32_bf16 v[168:171], v[192:195], v[40:43], v[168:171]
v_mfma_f32_16x16x32_bf16 v[72:75], v[44:47], a[224:227], v[72:75]
ds_read_b64_tr_b16 v[36:37], v251 offset:0
v_mfma_f32_16x16x32_bf16 v[76:79], v[44:47], a[228:231], v[76:79]
ds_read_b64_tr_b16 v[38:39], v251 offset:512
s_waitcnt lgkmcnt(8)
v_mfma_f32_16x16x32_bf16 v[104:107], v[48:51], a[224:227], v[104:107]
ds_read_b64_tr_b16 v[40:41], v251 offset:1024
ds_read_b128 v[192:195], v20 offset:14336
v_mfma_f32_16x16x32_bf16 v[108:111], v[48:51], a[228:231], v[108:111]
ds_read_b64_tr_b16 v[42:43], v251 offset:1536
v_mfma_f32_16x16x32_bf16 v[136:139], a[224:227], v[52:55], v[136:139]
ds_read_b64_tr_b16 v[44:45], v251 offset:2048
v_mfma_f32_16x16x32_bf16 v[140:143], a[228:231], v[52:55], v[140:143]
ds_read_b64_tr_b16 v[46:47], v251 offset:2560
s_waitcnt lgkmcnt(9)
v_mfma_f32_16x16x32_bf16 v[80:83], v[56:59], a[224:227], v[80:83]
ds_read_b64_tr_b16 v[48:49], v248 offset:12288
v_mfma_f32_16x16x32_bf16 v[84:87], v[56:59], a[228:231], v[84:87]
ds_read_b64_tr_b16 v[50:51], v248 offset:12800
v_mfma_f32_16x16x32_bf16 v[112:115], v[60:63], a[224:227], v[112:115]
ds_read_b64_tr_b16 v[52:53], v248 offset:13312
v_mfma_f32_16x16x32_bf16 v[116:119], v[60:63], a[228:231], v[116:119]
ds_read_b64_tr_b16 v[54:55], v248 offset:13824
s_waitcnt lgkmcnt(9)
v_mfma_f32_16x16x32_bf16 v[144:147], a[224:227], v[32:35], v[144:147]
ds_read_b64_tr_b16 v[56:57], v248 offset:14336
v_mfma_f32_16x16x32_bf16 v[148:151], a[228:231], v[32:35], v[148:151]
ds_read_b64_tr_b16 v[58:59], v248 offset:14848
v_mfma_f32_16x16x32_bf16 v[88:91], v[36:39], a[224:227], v[88:91]
ds_read_b64_tr_b16 v[60:61], v249 offset:12288
v_mfma_f32_16x16x32_bf16 v[92:95], v[36:39], a[228:231], v[92:95]
ds_read_b64_tr_b16 v[62:63], v249 offset:12800
s_waitcnt lgkmcnt(8)
v_mfma_f32_16x16x32_bf16 v[120:123], v[40:43], a[224:227], v[120:123]
ds_read_b64_tr_b16 v[32:33], v249 offset:13312
v_mfma_f32_16x16x32_bf16 v[124:127], v[40:43], a[228:231], v[124:127]
ds_read_b64_tr_b16 v[34:35], v249 offset:13824
v_mfma_f32_16x16x32_bf16 v[152:155], a[224:227], v[44:47], v[152:155]
ds_read_b64_tr_b16 v[36:37], v249 offset:14336
v_mfma_f32_16x16x32_bf16 v[156:159], a[228:231], v[44:47], v[156:159]
ds_read_b64_tr_b16 v[38:39], v249 offset:14848
s_waitcnt lgkmcnt(8)
v_mfma_f32_16x16x32_bf16 v[64:67], v[48:51], a[232:235], v[64:67]
ds_read_b64_tr_b16 v[40:41], v250 offset:12288
v_lshrrev_b32 v30, 4, v0
v_mfma_f32_16x16x32_bf16 v[68:71], v[48:51], a[236:239], v[68:71]
ds_read_b64_tr_b16 v[42:43], v250 offset:12800
s_lshl_b32 s84, s44, 6
v_mfma_f32_16x16x32_bf16 v[160:163], v[48:51], v[196:199], v[160:163]
s_add_u32 s84, s84, 114688
v_lshl_add_u32 v13, v30, 4, s84
v_mfma_f32_16x16x32_bf16 v[96:99], v[52:55], a[232:235], v[96:99]
ds_read_b64_tr_b16 v[44:45], v250 offset:13312
v_and_b32 v29, 15, v0
v_mfma_f32_16x16x32_bf16 v[100:103], v[52:55], a[236:239], v[100:103]
ds_read_b64_tr_b16 v[46:47], v250 offset:13824
v_lshl_add_u32 v14, v29, 2, s84
v_mfma_f32_16x16x32_bf16 v[164:167], v[52:55], v[196:199], v[164:167]
v_mul_u32_u24 v31, 80, v30
s_waitcnt lgkmcnt(8)
v_mfma_f32_16x16x32_bf16 v[128:131], a[232:235], v[56:59], v[128:131]
ds_read_b64_tr_b16 v[48:49], v250 offset:14336
v_lshlrev_b32 v30, 6, v30
v_mfma_f32_16x16x32_bf16 v[132:135], a[236:239], v[56:59], v[132:135]
ds_read_b64_tr_b16 v[50:51], v250 offset:14848
v_mfma_f32_16x16x32_bf16 v[168:171], v[196:199], v[56:59], v[168:171]
v_mfma_f32_16x16x32_bf16 v[72:75], v[60:63], a[232:235], v[72:75]
ds_read_b64_tr_b16 v[52:53], v251 offset:12288
v_mfma_f32_16x16x32_bf16 v[76:79], v[60:63], a[236:239], v[76:79]
ds_read_b64_tr_b16 v[54:55], v251 offset:12800
s_waitcnt lgkmcnt(8)
v_mfma_f32_16x16x32_bf16 v[104:107], v[32:35], a[232:235], v[104:107]
ds_read_b64_tr_b16 v[56:57], v251 offset:13312
ds_read_b128 v[196:199], v21 offset:14336
v_mfma_f32_16x16x32_bf16 v[108:111], v[32:35], a[236:239], v[108:111]
ds_read_b64_tr_b16 v[58:59], v251 offset:13824
v_mfma_f32_16x16x32_bf16 v[136:139], a[232:235], v[36:39], v[136:139]
ds_read_b64_tr_b16 v[60:61], v251 offset:14336
v_mfma_f32_16x16x32_bf16 v[140:143], a[236:239], v[36:39], v[140:143]
ds_read_b64_tr_b16 v[62:63], v251 offset:14848
s_waitcnt lgkmcnt(9)
v_mfma_f32_16x16x32_bf16 v[80:83], v[40:43], a[232:235], v[80:83]
s_waitcnt vmcnt(2)
s_barrier
ds_read_b64_tr_b16 v[32:33], v248 offset:24576
v_mfma_f32_16x16x32_bf16 v[84:87], v[40:43], a[236:239], v[84:87]
ds_read_b64_tr_b16 v[34:35], v248 offset:25088
v_mfma_f32_16x16x32_bf16 v[112:115], v[44:47], a[232:235], v[112:115]
ds_read_b128 a[240:243], v2 offset:4096
ds_read_b64_tr_b16 v[36:37], v248 offset:25600
v_mfma_f32_16x16x32_bf16 v[116:119], v[44:47], a[236:239], v[116:119]
ds_read_b128 a[244:247], v2 offset:6144
ds_read_b64_tr_b16 v[38:39], v248 offset:26112
s_waitcnt lgkmcnt(11)
v_mfma_f32_16x16x32_bf16 v[144:147], a[232:235], v[48:51], v[144:147]
ds_read_b128 a[248:251], v3 offset:4096
ds_read_b64_tr_b16 v[40:41], v248 offset:26624
v_mfma_f32_16x16x32_bf16 v[148:151], a[236:239], v[48:51], v[148:151]
ds_read_b128 a[252:255], v3 offset:6144
ds_read_b64_tr_b16 v[42:43], v248 offset:27136
v_mfma_f32_16x16x32_bf16 v[88:91], v[52:55], a[232:235], v[88:91]
ds_read_b64_tr_b16 v[44:45], v248 offset:36864
s_lshr_b32 s84, s46, 2
v_mfma_f32_16x16x32_bf16 v[92:95], v[52:55], a[236:239], v[92:95]
ds_read_b64_tr_b16 v[46:47], v248 offset:37376
s_waitcnt lgkmcnt(12)
v_mfma_f32_16x16x32_bf16 v[120:123], v[56:59], a[232:235], v[120:123]
ds_read_b64_tr_b16 v[48:49], v248 offset:37888
s_lshl_b32 s84, s84, 4
v_mfma_f32_16x16x32_bf16 v[124:127], v[56:59], a[236:239], v[124:127]
ds_read_b64_tr_b16 v[50:51], v248 offset:38400
s_add_u32 s84, s84, s45
v_mfma_f32_16x16x32_bf16 v[152:155], a[232:235], v[60:63], v[152:155]
ds_read_b64_tr_b16 v[52:53], v248 offset:38912
s_lshl_b32 s84, s84, 11
v_mfma_f32_16x16x32_bf16 v[156:159], a[236:239], v[60:63], v[156:159]
ds_read_b64_tr_b16 v[54:55], v248 offset:39424
s_waitcnt lgkmcnt(10)
v_mfma_f32_16x16x32_bf16 v[64:67], v[32:35], a[240:243], v[64:67]
ds_read_b64_tr_b16 v[56:57], v249 offset:24576
s_add_u32 s84, s84, 0xc0000
v_mfma_f32_16x16x32_bf16 v[68:71], v[32:35], a[244:247], v[68:71]
ds_read_b64_tr_b16 v[58:59], v249 offset:25088
s_lshl_b32 s85, s44, 9
v_mfma_f32_16x16x32_bf16 v[160:163], v[32:35], v[192:195], v[160:163]
s_add_u32 s100, s84, s85
s_cmp_eq_u32 s45, 0
s_cselect_b32 s85, 0, 256
v_mfma_f32_16x16x32_bf16 v[96:99], v[36:39], a[240:243], v[96:99]
ds_read_b64_tr_b16 v[60:61], v249 offset:25600
s_sub_u32 s101, s84, s85
v_mfma_f32_16x16x32_bf16 v[100:103], v[36:39], a[244:247], v[100:103]
ds_read_b64_tr_b16 v[62:63], v249 offset:26112
v_and_b32 v184, 15, v0
v_mfma_f32_16x16x32_bf16 v[164:167], v[36:39], v[192:195], v[164:167]
v_lshlrev_b32 v184, 4, v184
s_waitcnt lgkmcnt(8)
v_mfma_f32_16x16x32_bf16 v[128:131], a[240:243], v[40:43], v[128:131]
ds_read_b64_tr_b16 v[32:33], v249 offset:26624
buffer_load_dwordx4 v[172:175], v184, s[20:23], s100 offen sc1
v_mfma_f32_16x16x32_bf16 v[132:135], a[244:247], v[40:43], v[132:135]
ds_read_b64_tr_b16 v[34:35], v249 offset:27136
v_mfma_f32_16x16x32_bf16 v[168:171], v[192:195], v[40:43], v[168:171]
v_mfma_f32_16x16x32_bf16 v[64:67], v[44:47], a[248:251], v[64:67]
ds_read_b64_tr_b16 v[36:37], v250 offset:24576
v_mfma_f32_16x16x32_bf16 v[68:71], v[44:47], a[252:255], v[68:71]
ds_read_b64_tr_b16 v[38:39], v250 offset:25088
buffer_load_dwordx4 v[176:179], v184, s[20:23], s100 offen offset:256 sc1
v_mfma_f32_16x16x32_bf16 v[160:163], v[44:47], v[196:199], v[160:163]
s_waitcnt lgkmcnt(8)
v_mfma_f32_16x16x32_bf16 v[96:99], v[48:51], a[248:251], v[96:99]
ds_read_b64_tr_b16 v[40:41], v250 offset:25600
v_mfma_f32_16x16x32_bf16 v[100:103], v[48:51], a[252:255], v[100:103]
ds_read_b64_tr_b16 v[42:43], v250 offset:26112
v_mfma_f32_16x16x32_bf16 v[164:167], v[48:51], v[196:199], v[164:167]
buffer_load_dwordx4 v[180:183], v184, s[20:23], s101 offen sc1
v_mfma_f32_16x16x32_bf16 v[128:131], a[248:251], v[52:55], v[128:131]
ds_read_b64_tr_b16 v[44:45], v250 offset:26624
v_mfma_f32_16x16x32_bf16 v[132:135], a[252:255], v[52:55], v[132:135]
ds_read_b64_tr_b16 v[46:47], v250 offset:27136
v_mfma_f32_16x16x32_bf16 v[168:171], v[196:199], v[52:55], v[168:171]
s_waitcnt lgkmcnt(8)
v_mfma_f32_16x16x32_bf16 v[72:75], v[56:59], a[240:243], v[72:75]
ds_read_b64_tr_b16 v[48:49], v251 offset:24576
v_mfma_f32_16x16x32_bf16 v[76:79], v[56:59], a[244:247], v[76:79]
ds_read_b64_tr_b16 v[50:51], v251 offset:25088
v_mfma_f32_16x16x32_bf16 v[104:107], v[60:63], a[240:243], v[104:107]
ds_read_b64_tr_b16 v[52:53], v251 offset:25600
v_mfma_f32_16x16x32_bf16 v[108:111], v[60:63], a[244:247], v[108:111]
ds_read_b64_tr_b16 v[54:55], v251 offset:26112
s_mov_b32 exec_lo, 0x00010001
s_mov_b32 exec_hi, 0x00010001
ds_write_b128 v13, v[160:163]
ds_write_b128 v13, v[164:167] offset:256
s_mov_b64 exec, 0xffff
ds_write_b32 v14, v168 offset:512
s_mov_b64 exec, -1
s_waitcnt lgkmcnt(11)
v_mfma_f32_16x16x32_bf16 v[136:139], a[240:243], v[32:35], v[136:139]
ds_read_b64_tr_b16 v[56:57], v251 offset:26624
s_waitcnt lgkmcnt(1)
s_barrier
v_mfma_f32_16x16x32_bf16 v[140:143], a[244:247], v[32:35], v[140:143]
ds_read_b64_tr_b16 v[58:59], v251 offset:27136
ds_read_b128 v[228:231], v13 offset:256
ds_read_b32 v224, v14 offset:512
v_mfma_f32_16x16x32_bf16 v[80:83], v[36:39], a[240:243], v[80:83]
ds_read_b64_tr_b16 v[60:61], v249 offset:36864
v_xor_b32 v29, 64, v13
v_xor_b32 v15, 64, v14
v_mfma_f32_16x16x32_bf16 v[84:87], v[36:39], a[244:247], v[84:87]
ds_read_b64_tr_b16 v[62:63], v249 offset:37376
ds_read_b128 v[232:235], v29 offset:256
v_mfma_f32_16x16x32_bf16 v[112:115], v[40:43], a[240:243], v[112:115]
ds_read_b64_tr_b16 v[32:33], v249 offset:37888
ds_read_b32 v225, v15 offset:512
v_xor_b32 v29, 128, v13
v_mfma_f32_16x16x32_bf16 v[116:119], v[40:43], a[244:247], v[116:119]
ds_read_b64_tr_b16 v[34:35], v249 offset:38400
v_xor_b32 v15, 128, v14
ds_read_b128 v[236:239], v29 offset:256
v_mfma_f32_16x16x32_bf16 v[144:147], a[240:243], v[44:47], v[144:147]
ds_read_b64_tr_b16 v[36:37], v249 offset:38912
ds_read_b32 v226, v15 offset:512
v_xor_b32 v29, 192, v13
v_mfma_f32_16x16x32_bf16 v[148:151], a[244:247], v[44:47], v[148:151]
ds_read_b64_tr_b16 v[38:39], v249 offset:39424
v_xor_b32 v15, 192, v14
v_mfma_f32_16x16x32_bf16 v[88:91], v[48:51], a[240:243], v[88:91]
ds_read_b64_tr_b16 v[40:41], v250 offset:36864
ds_read_b128 v[240:243], v29 offset:256
ds_read_b32 v227, v15 offset:512
v_mfma_f32_16x16x32_bf16 v[92:95], v[48:51], a[244:247], v[92:95]
ds_read_b64_tr_b16 v[42:43], v250 offset:37376
v_mfma_f32_16x16x32_bf16 v[120:123], v[52:55], a[240:243], v[120:123]
ds_read_b64_tr_b16 v[44:45], v250 offset:37888
v_mfma_f32_16x16x32_bf16 v[124:127], v[52:55], a[244:247], v[124:127]
ds_read_b64_tr_b16 v[46:47], v250 offset:38400
s_waitcnt lgkmcnt(14)
v_mfma_f32_16x16x32_bf16 v[152:155], a[240:243], v[56:59], v[152:155]
ds_read_b64_tr_b16 v[48:49], v250 offset:38912
v_mfma_f32_16x16x32_bf16 v[156:159], a[244:247], v[56:59], v[156:159]
ds_read_b64_tr_b16 v[50:51], v250 offset:39424
v_mfma_f32_16x16x32_bf16 v[72:75], v[60:63], a[248:251], v[72:75]
ds_read_b64_tr_b16 v[52:53], v251 offset:36864
v_mfma_f32_16x16x32_bf16 v[76:79], v[60:63], a[252:255], v[76:79]
ds_read_b64_tr_b16 v[54:55], v251 offset:37376
s_waitcnt lgkmcnt(10)
v_mfma_f32_16x16x32_bf16 v[104:107], v[32:35], a[248:251], v[104:107]
ds_read_b64_tr_b16 v[56:57], v251 offset:37888
v_mfma_f32_16x16x32_bf16 v[108:111], v[32:35], a[252:255], v[108:111]
ds_read_b64_tr_b16 v[58:59], v251 offset:38400
v_mfma_f32_16x16x32_bf16 v[136:139], a[248:251], v[36:39], v[136:139]
ds_read_b64_tr_b16 v[60:61], v251 offset:38912
v_mfma_f32_16x16x32_bf16 v[140:143], a[252:255], v[36:39], v[140:143]
ds_read_b64_tr_b16 v[62:63], v251 offset:39424
s_waitcnt lgkmcnt(8)
v_mfma_f32_16x16x32_bf16 v[80:83], v[40:43], a[248:251], v[80:83]
v_mfma_f32_16x16x32_bf16 v[84:87], v[40:43], a[252:255], v[84:87]
v_mfma_f32_16x16x32_bf16 v[112:115], v[44:47], a[248:251], v[112:115]
v_mfma_f32_16x16x32_bf16 v[116:119], v[44:47], a[252:255], v[116:119]
s_waitcnt lgkmcnt(4)
v_mfma_f32_16x16x32_bf16 v[144:147], a[248:251], v[48:51], v[144:147]
v_mfma_f32_16x16x32_bf16 v[148:151], a[252:255], v[48:51], v[148:151]
v_mfma_f32_16x16x32_bf16 v[88:91], v[52:55], a[248:251], v[88:91]
v_mfma_f32_16x16x32_bf16 v[92:95], v[52:55], a[252:255], v[92:95]
s_waitcnt lgkmcnt(0)
v_mfma_f32_16x16x32_bf16 v[120:123], v[56:59], a[248:251], v[120:123]
v_mfma_f32_16x16x32_bf16 v[124:127], v[56:59], a[252:255], v[124:127]
v_mfma_f32_16x16x32_bf16 v[152:155], a[248:251], v[60:63], v[152:155]
v_mfma_f32_16x16x32_bf16 v[156:159], a[252:255], v[60:63], v[156:159]
ds_read_b128 v[32:35], v13
v_xor_b32 v29, 64, v13
ds_read_b128 v[36:39], v29
v_xor_b32 v29, 128, v13
ds_read_b128 v[40:43], v29
v_xor_b32 v29, 192, v13
ds_read_b128 v[44:47], v29
s_waitcnt vmcnt(3)
v_readfirstlane_b32 s73, v28
s_nop 1
s_cmp_eq_u32 s73, 0
s_cbranch_scc1 L_tagslow_13
L_tagret_14:
v_mov_b32 v28, s73
v_lshrrev_b32 v31, 4, v0
v_lshlrev_b32 v31, 4, v31
s_waitcnt vmcnt(2)
v_xor_b32 v185, v173, v28
v_xor_b32 v175, v175, v28
s_waitcnt vmcnt(1)
v_xor_b32 v177, v177, v28
v_xor_b32 v179, v179, v28
s_waitcnt vmcnt(0)
v_xor_b32 v181, v181, v28
v_xor_b32 v183, v183, v28
v_or3_b32 v185, v185, v175, v177
v_or3_b32 v185, v185, v179, v181
v_or_b32 v185, v185, v183
v_cmp_ne_u32 vcc, 0, v185
s_nop 1
s_cbranch_vccnz L_pslow_15
L_pret_16:
ds_bpermute_b32 v212, v31, v174 offset:0
ds_bpermute_b32 v213, v31, v174 offset:4
ds_bpermute_b32 v214, v31, v174 offset:8
ds_bpermute_b32 v215, v31, v174 offset:12
ds_bpermute_b32 v200, v31, v172 offset:0
ds_bpermute_b32 v201, v31, v172 offset:4
ds_bpermute_b32 v202, v31, v172 offset:8
ds_bpermute_b32 v203, v31, v172 offset:12
ds_bpermute_b32 v216, v31, v178 offset:0
ds_bpermute_b32 v217, v31, v178 offset:4
ds_bpermute_b32 v218, v31, v178 offset:8
ds_bpermute_b32 v219, v31, v178 offset:12
ds_bpermute_b32 v204, v31, v176 offset:0
ds_bpermute_b32 v205, v31, v176 offset:4
ds_bpermute_b32 v206, v31, v176 offset:8
ds_bpermute_b32 v207, v31, v176 offset:12
ds_bpermute_b32 v220, v31, v182 offset:0
ds_bpermute_b32 v221, v31, v182 offset:4
ds_bpermute_b32 v222, v31, v182 offset:8
ds_bpermute_b32 v223, v31, v182 offset:12
ds_bpermute_b32 v208, v31, v180 offset:0
ds_bpermute_b32 v209, v31, v180 offset:4
ds_bpermute_b32 v210, v31, v180 offset:8
ds_bpermute_b32 v211, v31, v180 offset:12
v_mov_b32 v173, v174
v_mov_b32 v177, v178
v_mov_b32 v181, v182
s_barrier
s_lshl_b32 s77, s44, 14
s_add_u32 s77, s77, 24576
v_and_b32 v2, 0x7ff, v2
v_add_u32 v2, s77, v2
v_xor_b32 v3, 64, v2
v_pk_mul_f32 v[48:49], v[228:229], v[180:181] op_sel:[0,1] op_sel_hi:[1,1]
s_add_u32 m0, s77, 0
v_pk_mul_f32 v[50:51], v[230:231], v[180:181] op_sel:[0,1] op_sel_hi:[1,1]
s_add_u32 s82, s64, s76
v_pk_fma_f32 v[164:165], v[164:165], v[180:181], v[48:49] op_sel_hi:[1,0,1] neg_lo:[0,0,1] neg_hi:[0,0,1]
s_add_u32 s83, s66, s76
v_pk_fma_f32 v[166:167], v[166:167], v[180:181], v[50:51] op_sel_hi:[1,0,1] neg_lo:[0,0,1] neg_hi:[0,0,1]
buffer_load_dwordx4 v8, s[16:19], s82 offen offset:0 lds
v_pk_mul_f32 v[48:49], v[228:229], v[172:173] op_sel:[0,1] op_sel_hi:[1,1]
v_pk_mul_f32 v[50:51], v[230:231], v[172:173] op_sel:[0,1] op_sel_hi:[1,1]
v_pk_fma_f32 v[96:97], v[96:97], v[172:173], v[48:49] op_sel_hi:[1,0,1] neg_lo:[0,0,1] neg_hi:[0,0,1]
v_pk_fma_f32 v[98:99], v[98:99], v[172:173], v[50:51] op_sel_hi:[1,0,1] neg_lo:[0,0,1] neg_hi:[0,0,1]
v_pk_mul_f32 v[48:49], v[228:229], v[176:177] op_sel:[0,1] op_sel_hi:[1,1]
v_pk_mul_f32 v[50:51], v[230:231], v[176:177] op_sel:[0,1] op_sel_hi:[1,1]
v_pk_fma_f32 v[100:101], v[100:101], v[176:177], v[48:49] op_sel_hi:[1,0,1] neg_lo:[0,0,1] neg_hi:[0,0,1]
v_pk_fma_f32 v[102:103], v[102:103], v[176:177], v[50:51] op_sel_hi:[1,0,1] neg_lo:[0,0,1] neg_hi:[0,0,1]
v_pk_mul_f32 v[48:49], v[232:233], v[172:173] op_sel:[0,1] op_sel_hi:[1,1]
v_pk_mul_f32 v[50:51], v[234:235], v[172:173] op_sel:[0,1] op_sel_hi:[1,1]
v_pk_fma_f32 v[104:105], v[104:105], v[172:173], v[48:49] op_sel_hi:[1,0,1] neg_lo:[0,0,1] neg_hi:[0,0,1]
v_pk_fma_f32 v[106:107], v[106:107], v[172:173], v[50:51] op_sel_hi:[1,0,1] neg_lo:[0,0,1] neg_hi:[0,0,1]
buffer_load_dwordx4 v9, s[16:19], s82 offen offset:1024 lds
v_pk_mul_f32 v[48:49], v[232:233], v[176:177] op_sel:[0,1] op_sel_hi:[1,1]
v_pk_mul_f32 v[50:51], v[234:235], v[176:177] op_sel:[0,1] op_sel_hi:[1,1]
v_pk_fma_f32 v[108:109], v[108:109], v[176:177], v[48:49] op_sel_hi:[1,0,1] neg_lo:[0,0,1] neg_hi:[0,0,1]
v_pk_fma_f32 v[110:111], v[110:111], v[176:177], v[50:51] op_sel_hi:[1,0,1] neg_lo:[0,0,1] neg_hi:[0,0,1]
v_pk_mul_f32 v[48:49], v[236:237], v[172:173] op_sel:[0,1] op_sel_hi:[1,1]
v_pk_mul_f32 v[50:51], v[238:239], v[172:173] op_sel:[0,1] op_sel_hi:[1,1]
v_pk_fma_f32 v[112:113], v[112:113], v[172:173], v[48:49] op_sel_hi:[1,0,1] neg_lo:[0,0,1] neg_hi:[0,0,1]
v_pk_fma_f32 v[114:115], v[114:115], v[172:173], v[50:51] op_sel_hi:[1,0,1] neg_lo:[0,0,1] neg_hi:[0,0,1]
v_pk_mul_f32 v[48:49], v[236:237], v[176:177] op_sel:[0,1] op_sel_hi:[1,1]
v_pk_mul_f32 v[50:51], v[238:239], v[176:177] op_sel:[0,1] op_sel_hi:[1,1]
v_pk_fma_f32 v[116:117], v[116:117], v[176:177], v[48:49] op_sel_hi:[1,0,1] neg_lo:[0,0,1] neg_hi:[0,0,1]
v_pk_fma_f32 v[118:119], v[118:119], v[176:177], v[50:51] op_sel_hi:[1,0,1] neg_lo:[0,0,1] neg_hi:[0,0,1]
buffer_load_dwordx4 v10, s[16:19], s83 offen offset:2048 lds
v_pk_mul_f32 v[48:49], v[240:241], v[172:173] op_sel:[0,1] op_sel_hi:[1,1]
v_pk_mul_f32 v[50:51], v[242:243], v[172:173] op_sel:[0,1] op_sel_hi:[1,1]
v_pk_fma_f32 v[120:121], v[120:121], v[172:173], v[48:49] op_sel_hi:[1,0,1] neg_lo:[0,0,1] neg_hi:[0,0,1]
v_pk_fma_f32 v[122:123], v[122:123], v[172:173], v[50:51] op_sel_hi:[1,0,1] neg_lo:[0,0,1] neg_hi:[0,0,1]
v_pk_mul_f32 v[48:49], v[240:241], v[176:177] op_sel:[0,1] op_sel_hi:[1,1]
v_pk_mul_f32 v[50:51], v[242:243], v[176:177] op_sel:[0,1] op_sel_hi:[1,1]
v_pk_fma_f32 v[124:125], v[124:125], v[176:177], v[48:49] op_sel_hi:[1,0,1] neg_lo:[0,0,1] neg_hi:[0,0,1]
v_pk_fma_f32 v[126:127], v[126:127], v[176:177], v[50:51] op_sel_hi:[1,0,1] neg_lo:[0,0,1] neg_hi:[0,0,1]
s_waitcnt lgkmcnt(15)
v_pk_mul_f32 v[52:53], v[212:213], v[224:225] op_sel_hi:[1,0]
v_pk_mul_f32 v[54:55], v[214:215], v[224:225] op_sel_hi:[1,0]
v_pk_fma_f32 v[128:129], v[128:129], v[200:201], v[52:53] neg_lo:[0,0,1] neg_hi:[0,0,1]
v_pk_fma_f32 v[130:131], v[130:131], v[202:203], v[54:55] neg_lo:[0,0,1] neg_hi:[0,0,1]
buffer_load_dwordx4 v11, s[16:19], s83 offen offset:3072 lds
s_waitcnt lgkmcnt(14)
v_pk_mul_f32 v[52:53], v[216:217], v[224:225] op_sel_hi:[1,0]
s_add_u32 m0, s77, 4096
s_waitcnt lgkmcnt(12)
v_pk_mul_f32 v[54:55], v[218:219], v[224:225] op_sel_hi:[1,0]
s_add_u32 s82, s65, s76
s_waitcnt lgkmcnt(10)
v_pk_fma_f32 v[132:133], v[132:133], v[204:205], v[52:53] neg_lo:[0,0,1] neg_hi:[0,0,1]
s_add_u32 s83, s67, s76
s_waitcnt lgkmcnt(8)
v_pk_fma_f32 v[134:135], v[134:135], v[206:207], v[54:55] neg_lo:[0,0,1] neg_hi:[0,0,1]
v_pk_mul_f32 v[52:53], v[212:213], v[224:225] op_sel:[0,1] op_sel_hi:[1,1]
v_pk_mul_f32 v[54:55], v[214:215], v[224:225] op_sel:[0,1] op_sel_hi:[1,1]
v_pk_fma_f32 v[136:137], v[136:137], v[200:201], v[52:53] neg_lo:[0,0,1] neg_hi:[0,0,1]
v_pk_fma_f32 v[138:139], v[138:139], v[202:203], v[54:55] neg_lo:[0,0,1] neg_hi:[0,0,1]
v_pk_mul_f32 v[52:53], v[216:217], v[224:225] op_sel:[0,1] op_sel_hi:[1,1]
buffer_load_dwordx4 v8, s[16:19], s82 offen offset:0 lds
v_pk_mul_f32 v[54:55], v[218:219], v[224:225] op_sel:[0,1] op_sel_hi:[1,1]
v_pk_fma_f32 v[140:141], v[140:141], v[204:205], v[52:53] neg_lo:[0,0,1] neg_hi:[0,0,1]
v_pk_fma_f32 v[142:143], v[142:143], v[206:207], v[54:55] neg_lo:[0,0,1] neg_hi:[0,0,1]
v_pk_mul_f32 v[52:53], v[212:213], v[226:227] op_sel_hi:[1,0]
v_pk_mul_f32 v[54:55], v[214:215], v[226:227] op_sel_hi:[1,0]
v_pk_fma_f32 v[144:145], v[144:145], v[200:201], v[52:53] neg_lo:[0,0,1] neg_hi:[0,0,1]
v_pk_fma_f32 v[146:147], v[146:147], v[202:203], v[54:55] neg_lo:[0,0,1] neg_hi:[0,0,1]
v_pk_mul_f32 v[52:53], v[216:217], v[226:227] op_sel_hi:[1,0]
v_pk_mul_f32 v[54:55], v[218:219], v[226:227] op_sel_hi:[1,0]
v_pk_fma_f32 v[148:149], v[148:149], v[204:205], v[52:53] neg_lo:[0,0,1] neg_hi:[0,0,1]
v_pk_fma_f32 v[150:151], v[150:151], v[206:207], v[54:55] neg_lo:[0,0,1] neg_hi:[0,0,1]
v_pk_mul_f32 v[52:53], v[212:213], v[226:227] op_sel:[0,1] op_sel_hi:[1,1]
buffer_load_dwordx4 v9, s[16:19], s82 offen offset:1024 lds
v_pk_mul_f32 v[54:55], v[214:215], v[226:227] op_sel:[0,1] op_sel_hi:[1,1]
v_pk_fma_f32 v[152:153], v[152:153], v[200:201], v[52:53] neg_lo:[0,0,1] neg_hi:[0,0,1]
v_pk_fma_f32 v[154:155], v[154:155], v[202:203], v[54:55] neg_lo:[0,0,1] neg_hi:[0,0,1]
v_pk_mul_f32 v[52:53], v[216:217], v[226:227] op_sel:[0,1] op_sel_hi:[1,1]
v_pk_mul_f32 v[54:55], v[218:219], v[226:227] op_sel:[0,1] op_sel_hi:[1,1]
v_pk_fma_f32 v[156:157], v[156:157], v[204:205], v[52:53] neg_lo:[0,0,1] neg_hi:[0,0,1]
v_pk_fma_f32 v[158:159], v[158:159], v[206:207], v[54:55] neg_lo:[0,0,1] neg_hi:[0,0,1]
s_waitcnt lgkmcnt(6)
v_pk_mul_f32 v[52:53], v[220:221], v[224:225] op_sel_hi:[1,0]
s_waitcnt lgkmcnt(4)
v_pk_mul_f32 v[54:55], v[222:223], v[224:225] op_sel_hi:[1,0]
s_waitcnt lgkmcnt(2)
v_pk_fma_f32 v[168:169], v[168:169], v[208:209], v[52:53] neg_lo:[0,0,1] neg_hi:[0,0,1]
s_waitcnt lgkmcnt(0)
v_pk_fma_f32 v[170:171], v[170:171], v[210:211], v[54:55] neg_lo:[0,0,1] neg_hi:[0,0,1]
v_cvt_pk_bf16_f32 v164, v164, v165
buffer_load_dwordx4 v10, s[16:19], s83 offen offset:2048 lds
v_cvt_pk_bf16_f32 v165, v166, v167
v_cvt_pk_bf16_f32 v168, v168, v169
v_cvt_pk_bf16_f32 v169, v170, v171
v_cvt_pk_bf16_f32 v99, v98, v99
v_cvt_pk_bf16_f32 v98, v96, v97
v_cvt_pk_bf16_f32 v100, v100, v101
v_cvt_pk_bf16_f32 v101, v102, v103
v_cvt_pk_bf16_f32 v131, v130, v131
v_cvt_pk_bf16_f32 v130, v128, v129
v_cvt_pk_bf16_f32 v132, v132, v133
v_cvt_pk_bf16_f32 v133, v134, v135
v_cvt_pk_bf16_f32 v107, v106, v107
buffer_load_dwordx4 v11, s[16:19], s83 offen offset:3072 lds
v_cvt_pk_bf16_f32 v106, v104, v105
s_add_u32 m0, s77, 8192
v_cvt_pk_bf16_f32 v108, v108, v109
s_add_u32 s76, s76, 128
v_cvt_pk_bf16_f32 v109, v110, v111
s_and_b32 s76, s76, 0x380
v_cvt_pk_bf16_f32 v139, v138, v139
s_add_u32 s82, s64, s76
v_cvt_pk_bf16_f32 v138, v136, v137
s_add_u32 s83, s66, s76
v_cvt_pk_bf16_f32 v140, v140, v141
v_cvt_pk_bf16_f32 v141, v142, v143
v_cvt_pk_bf16_f32 v115, v114, v115
buffer_load_dwordx4 v8, s[16:19], s82 offen offset:0 lds
v_cvt_pk_bf16_f32 v114, v112, v113
v_cvt_pk_bf16_f32 v116, v116, v117
v_cvt_pk_bf16_f32 v117, v118, v119
v_cvt_pk_bf16_f32 v147, v146, v147
v_cvt_pk_bf16_f32 v146, v144, v145
v_cvt_pk_bf16_f32 v148, v148, v149
v_cvt_pk_bf16_f32 v149, v150, v151
v_cvt_pk_bf16_f32 v123, v122, v123
v_cvt_pk_bf16_f32 v122, v120, v121
v_cvt_pk_bf16_f32 v124, v124, v125
v_cvt_pk_bf16_f32 v125, v126, v127
v_cvt_pk_bf16_f32 v155, v154, v155
buffer_load_dwordx4 v9, s[16:19], s82 offen offset:1024 lds
v_cvt_pk_bf16_f32 v154, v152, v153
v_cvt_pk_bf16_f32 v156, v156, v157
v_cvt_pk_bf16_f32 v157, v158, v159
buffer_load_dwordx4 v10, s[16:19], s83 offen offset:2048 lds
buffer_load_dwordx4 v11, s[16:19], s83 offen offset:3072 lds
s_lshl_b32 s84, s44, 12
s_lshl_b32 s85, s44, 10
s_add_u32 s84, s84, s85
v_lshlrev_b32 v29, 3, v0
v_add_u32 v13, s84, v29
v_add_u32 v14, s85, v29
ds_write_b64 v14, v[164:165]
ds_write_b64 v14, v[168:169] offset:512
ds_write_b64 v13, v[100:101] offset:4096
ds_write_b64 v13, v[132:133] offset:4608
v_xor_b32 v17, 1024, v13
ds_write_b64 v17, v[108:109] offset:4096
ds_write_b64 v17, v[140:141] offset:4608
v_xor_b32 v18, 2048, v13
ds_write_b64 v18, v[116:117] offset:4096
ds_write_b64 v18, v[148:149] offset:4608
v_xor_b32 v19, 3072, v13
ds_write_b64 v19, v[124:125] offset:4096
ds_write_b64 v19, v[156:157] offset:4608
v_pk_mul_f32 v[48:49], v[32:33], v[172:173] op_sel:[0,1] op_sel_hi:[1,1]
s_waitcnt vmcnt(8)
ds_read_b128 a[0:3], v2 offset:0
v_pk_mul_f32 v[50:51], v[34:35], v[172:173] op_sel:[0,1] op_sel_hi:[1,1]
ds_read_b128 a[4:7], v2 offset:2048
v_pk_fma_f32 v[64:65], v[64:65], v[172:173], v[48:49] op_sel_hi:[1,0,1] neg_lo:[0,0,1] neg_hi:[0,0,1]
ds_read_b128 a[16:19], v3 offset:0
v_pk_fma_f32 v[66:67], v[66:67], v[172:173], v[50:51] op_sel_hi:[1,0,1] neg_lo:[0,0,1] neg_hi:[0,0,1]
ds_read_b128 a[20:23], v3 offset:2048
v_pk_mul_f32 v[48:49], v[32:33], v[176:177] op_sel:[0,1] op_sel_hi:[1,1]
s_add_u32 m0, s77, 12288
v_pk_mul_f32 v[50:51], v[34:35], v[176:177] op_sel:[0,1] op_sel_hi:[1,1]
s_add_u32 s82, s65, s76
v_pk_fma_f32 v[68:69], v[68:69], v[176:177], v[48:49] op_sel_hi:[1,0,1] neg_lo:[0,0,1] neg_hi:[0,0,1]
s_add_u32 s83, s67, s76
v_pk_fma_f32 v[70:71], v[70:71], v[176:177], v[50:51] op_sel_hi:[1,0,1] neg_lo:[0,0,1] neg_hi:[0,0,1]
buffer_load_dwordx4 v8, s[16:19], s82 offen offset:0 lds
v_cvt_pk_bf16_f32 v64, v64, v65
v_cvt_pk_bf16_f32 v65, v66, v67
v_cvt_pk_bf16_f32 v66, v68, v69
v_cvt_pk_bf16_f32 v67, v70, v71
v_pk_mul_f32 v[48:49], v[36:37], v[172:173] op_sel:[0,1] op_sel_hi:[1,1]
v_pk_mul_f32 v[50:51], v[38:39], v[172:173] op_sel:[0,1] op_sel_hi:[1,1]
v_pk_fma_f32 v[72:73], v[72:73], v[172:173], v[48:49] op_sel_hi:[1,0,1] neg_lo:[0,0,1] neg_hi:[0,0,1]
v_pk_fma_f32 v[74:75], v[74:75], v[172:173], v[50:51] op_sel_hi:[1,0,1] neg_lo:[0,0,1] neg_hi:[0,0,1]
v_pk_mul_f32 v[48:49], v[36:37], v[176:177] op_sel:[0,1] op_sel_hi:[1,1]
v_pk_mul_f32 v[50:51], v[38:39], v[176:177] op_sel:[0,1] op_sel_hi:[1,1]
v_pk_fma_f32 v[76:77], v[76:77], v[176:177], v[48:49] op_sel_hi:[1,0,1] neg_lo:[0,0,1] neg_hi:[0,0,1]
v_pk_fma_f32 v[78:79], v[78:79], v[176:177], v[50:51] op_sel_hi:[1,0,1] neg_lo:[0,0,1] neg_hi:[0,0,1]
buffer_load_dwordx4 v9, s[16:19], s82 offen offset:1024 lds
v_cvt_pk_bf16_f32 v72, v72, v73
v_cvt_pk_bf16_f32 v73, v74, v75
v_cvt_pk_bf16_f32 v74, v76, v77
v_cvt_pk_bf16_f32 v75, v78, v79
v_pk_mul_f32 v[48:49], v[40:41], v[172:173] op_sel:[0,1] op_sel_hi:[1,1]
v_pk_mul_f32 v[50:51], v[42:43], v[172:173] op_sel:[0,1] op_sel_hi:[1,1]
v_pk_fma_f32 v[80:81], v[80:81], v[172:173], v[48:49] op_sel_hi:[1,0,1] neg_lo:[0,0,1] neg_hi:[0,0,1]
v_pk_fma_f32 v[82:83], v[82:83], v[172:173], v[50:51] op_sel_hi:[1,0,1] neg_lo:[0,0,1] neg_hi:[0,0,1]
v_pk_mul_f32 v[48:49], v[40:41], v[176:177] op_sel:[0,1] op_sel_hi:[1,1]
v_pk_mul_f32 v[50:51], v[42:43], v[176:177] op_sel:[0,1] op_sel_hi:[1,1]
v_pk_fma_f32 v[84:85], v[84:85], v[176:177], v[48:49] op_sel_hi:[1,0,1] neg_lo:[0,0,1] neg_hi:[0,0,1]
v_pk_fma_f32 v[86:87], v[86:87], v[176:177], v[50:51] op_sel_hi:[1,0,1] neg_lo:[0,0,1] neg_hi:[0,0,1]
buffer_load_dwordx4 v10, s[16:19], s83 offen offset:2048 lds
v_cvt_pk_bf16_f32 v80, v80, v81
v_cvt_pk_bf16_f32 v81, v82, v83
v_cvt_pk_bf16_f32 v82, v84, v85
v_cvt_pk_bf16_f32 v83, v86, v87
v_pk_mul_f32 v[48:49], v[44:45], v[172:173] op_sel:[0,1] op_sel_hi:[1,1]
v_pk_mul_f32 v[50:51], v[46:47], v[172:173] op_sel:[0,1] op_sel_hi:[1,1]
v_pk_fma_f32 v[88:89], v[88:89], v[172:173], v[48:49] op_sel_hi:[1,0,1] neg_lo:[0,0,1] neg_hi:[0,0,1]
v_pk_fma_f32 v[90:91], v[90:91], v[172:173], v[50:51] op_sel_hi:[1,0,1] neg_lo:[0,0,1] neg_hi:[0,0,1]
v_pk_mul_f32 v[48:49], v[44:45], v[176:177] op_sel:[0,1] op_sel_hi:[1,1]
v_pk_mul_f32 v[50:51], v[46:47], v[176:177] op_sel:[0,1] op_sel_hi:[1,1]
v_pk_fma_f32 v[92:93], v[92:93], v[176:177], v[48:49] op_sel_hi:[1,0,1] neg_lo:[0,0,1] neg_hi:[0,0,1]
v_pk_fma_f32 v[94:95], v[94:95], v[176:177], v[50:51] op_sel_hi:[1,0,1] neg_lo:[0,0,1] neg_hi:[0,0,1]
buffer_load_dwordx4 v11, s[16:19], s83 offen offset:3072 lds
v_cvt_pk_bf16_f32 v88, v88, v89
v_cvt_pk_bf16_f32 v89, v90, v91
v_cvt_pk_bf16_f32 v90, v92, v93
v_cvt_pk_bf16_f32 v91, v94, v95
v_and_b32 v29, 14, v0
v_bfe_u32 v30, v0, 4, 2
v_lshlrev_b32 v30, 2, v30
v_sub_u32 v29, v29, v30
v_mov_b32 v30, 0xf149f2ca
v_cmp_ge_i32 vcc, -2, v29
s_nop 1
v_cndmask_b32 v184, v30, 0, vcc
v_cmp_ge_i32 vcc, 0, v29
s_nop 1
v_cndmask_b32 v185, v30, 0, vcc
v_cmp_le_i32 vcc, 0, v29
s_nop 1
v_cndmask_b32 v186, v30, 0, vcc
v_cmp_le_i32 vcc, 2, v29
s_nop 1
v_cndmask_b32 v187, v30, 0, vcc
s_lshl_b32 s84, s45, 2
s_or_b32 s84, s84, s44
s_cmp_eq_u32 s84, 0
s_cselect_b64 vcc, -1, 0
v_cndmask_b32 v188, v184, v30, vcc
v_cndmask_b32 v189, v185, v30, vcc
v_cndmask_b32 v190, 1.0, 0, s[92:93]
v_cndmask_b32 v191, 0, 1.0, s[92:93]
s_mov_b32 s84, 0x3eb8aa3b
s_mov_b32 s85, s84
s_waitcnt lgkmcnt(4)
s_barrier
ds_read_b64 v[96:97], v13
ds_read_b64 v[128:129], v13 offset:512
ds_read_b64 v[104:105], v17
ds_read_b64 v[136:137], v17 offset:512
ds_read_b64 v[112:113], v18
ds_read_b64 v[144:145], v18 offset:512
ds_read_b64 v[120:121], v19
ds_read_b64 v[152:153], v19 offset:512
v_mfma_f32_16x16x16_bf16 v[32:35], v[98:99], v[66:67], 0
s_waitcnt vmcnt(8)
ds_read_b128 a[8:11], v2 offset:4096
v_mfma_f32_16x16x16_bf16 v[36:39], v[100:101], v[66:67], 0
ds_read_b128 a[12:15], v2 offset:6144
v_mfma_f32_16x16x16_bf16 v[40:43], v[106:107], v[74:75], 0
ds_read_b128 a[24:27], v3 offset:4096
v_mfma_f32_16x16x16_bf16 v[44:47], v[108:109], v[74:75], 0
ds_read_b128 a[28:31], v3 offset:6144
v_mfma_f32_16x16x16_bf16 v[48:51], v[114:115], v[82:83], 0
s_waitcnt lgkmcnt(12)
s_add_u32 m0, s77, 0
v_mfma_f32_16x16x16_bf16 v[52:55], v[116:117], v[82:83], 0
s_add_u32 s76, s76, 128
v_mfma_f32_16x16x16_bf16 v[56:59], v[122:123], v[90:91], 0
s_and_b32 s76, s76, 0x380
v_mfma_f32_16x16x16_bf16 v[60:63], v[124:125], v[90:91], 0
s_add_u32 s82, s64, s76
v_cndmask_b32 v68, v32, v33, s[92:93]
s_add_u32 s83, s66, s76
v_cndmask_b32 v69, v34, v35, s[92:93]
buffer_load_dwordx4 v8, s[16:19], s82 offen offset:0 lds
v_cndmask_b32 v70, v36, v37, s[92:93]
v_cndmask_b32 v71, v38, v39, s[92:93]
v_cndmask_b32 v76, v40, v41, s[92:93]
v_cndmask_b32 v77, v42, v43, s[92:93]
v_cndmask_b32 v78, v44, v45, s[92:93]
v_cndmask_b32 v79, v46, v47, s[92:93]
v_cndmask_b32 v84, v48, v49, s[92:93]
v_cndmask_b32 v85, v50, v51, s[92:93]
v_cndmask_b32 v86, v52, v53, s[92:93]
v_cndmask_b32 v87, v54, v55, s[92:93]
v_cndmask_b32 v92, v56, v57, s[92:93]
v_cndmask_b32 v93, v58, v59, s[92:93]
buffer_load_dwordx4 v9, s[16:19], s82 offen offset:1024 lds
v_cndmask_b32 v94, v60, v61, s[92:93]
v_cndmask_b32 v95, v62, v63, s[92:93]
v_pk_fma_f32 v[68:69], v[68:69], s[84:85], v[184:185]
v_pk_fma_f32 v[70:71], v[70:71], s[84:85], v[186:187]
v_pk_fma_f32 v[76:77], v[76:77], s[84:85], v[184:185]
v_pk_fma_f32 v[78:79], v[78:79], s[84:85], v[186:187]
v_pk_fma_f32 v[84:85], v[84:85], s[84:85], v[184:185]
v_pk_fma_f32 v[86:87], v[86:87], s[84:85], v[186:187]
v_pk_fma_f32 v[92:93], v[92:93], s[84:85], v[184:185]
v_pk_fma_f32 v[94:95], v[94:95], s[84:85], v[186:187]
v_max3_f32 v102, v68, v69, v70
v_max3_f32 v110, v76, v77, v78
buffer_load_dwordx4 v10, s[16:19], s83 offen offset:2048 lds
v_max3_f32 v118, v84, v85, v86
v_max3_f32 v126, v92, v93, v94
v_max_f32 v102, v102, v71
v_max_f32 v110, v110, v79
v_max_f32 v118, v118, v87
v_max_f32 v126, v126, v95
v_mov_b32 v103, v102
v_mov_b32 v111, v110
v_mov_b32 v119, v118
v_mov_b32 v127, v126
v_permlane32_swap_b32 v102, v103
v_permlane32_swap_b32 v110, v111
buffer_load_dwordx4 v11, s[16:19], s83 offen offset:3072 lds
v_permlane32_swap_b32 v118, v119
s_waitcnt vmcnt(8)
ds_read_b128 a[32:35], v2 offset:8192
v_permlane32_swap_b32 v126, v127
ds_read_b128 a[36:39], v2 offset:10240
v_max_f32 v102, v102, v103
ds_read_b128 a[48:51], v3 offset:8192
v_mov_b32 v103, v102
ds_read_b128 a[52:55], v3 offset:10240
v_max_f32 v110, v110, v111
s_waitcnt lgkmcnt(4)
s_add_u32 m0, s77, 4096
v_mov_b32 v111, v110
s_add_u32 s82, s65, s76
v_max_f32 v118, v118, v119
s_add_u32 s83, s67, s76
v_mov_b32 v119, v118
buffer_load_dwordx4 v8, s[16:19], s82 offen offset:0 lds
v_max_f32 v126, v126, v127
v_mov_b32 v127, v126
v_permlane16_swap_b32 v102, v103
v_permlane16_swap_b32 v110, v111
v_permlane16_swap_b32 v118, v119
v_permlane16_swap_b32 v126, v127
v_max_f32 v102, v102, v103
v_max_f32 v110, v110, v111
v_max_f32 v118, v118, v119
v_max_f32 v126, v126, v127
v_pk_add_f32 v[68:69], v[68:69], v[102:103] op_sel_hi:[1,0] neg_lo:[0,1] neg_hi:[0,1]
v_pk_add_f32 v[70:71], v[70:71], v[102:103] op_sel_hi:[1,0] neg_lo:[0,1] neg_hi:[0,1]
buffer_load_dwordx4 v9, s[16:19], s82 offen offset:1024 lds
v_pk_add_f32 v[76:77], v[76:77], v[110:111] op_sel_hi:[1,0] neg_lo:[0,1] neg_hi:[0,1]
v_pk_add_f32 v[78:79], v[78:79], v[110:111] op_sel_hi:[1,0] neg_lo:[0,1] neg_hi:[0,1]
v_pk_add_f32 v[84:85], v[84:85], v[118:119] op_sel_hi:[1,0] neg_lo:[0,1] neg_hi:[0,1]
v_pk_add_f32 v[86:87], v[86:87], v[118:119] op_sel_hi:[1,0] neg_lo:[0,1] neg_hi:[0,1]
v_pk_add_f32 v[92:93], v[92:93], v[126:127] op_sel_hi:[1,0] neg_lo:[0,1] neg_hi:[0,1]
v_pk_add_f32 v[94:95], v[94:95], v[126:127] op_sel_hi:[1,0] neg_lo:[0,1] neg_hi:[0,1]
v_exp_f32 v68, v68
v_exp_f32 v69, v69
v_exp_f32 v70, v70
buffer_load_dwordx4 v10, s[16:19], s83 offen offset:2048 lds
v_exp_f32 v71, v71
v_exp_f32 v76, v76
v_exp_f32 v77, v77
v_exp_f32 v78, v78
v_exp_f32 v79, v79
v_exp_f32 v84, v84
v_exp_f32 v85, v85
buffer_load_dwordx4 v11, s[16:19], s83 offen offset:3072 lds
v_exp_f32 v86, v86
s_waitcnt vmcnt(8)
ds_read_b128 a[40:43], v2 offset:12288
v_exp_f32 v87, v87
ds_read_b128 a[44:47], v2 offset:14336
v_exp_f32 v92, v92
ds_read_b128 a[56:59], v3 offset:12288
v_exp_f32 v93, v93
ds_read_b128 a[60:63], v3 offset:14336
v_exp_f32 v94, v94
s_waitcnt lgkmcnt(4)
s_add_u32 m0, s77, 8192
v_exp_f32 v95, v95
s_add_u32 s76, s76, 128
v_pk_add_f32 v[102:103], v[68:69], v[70:71]
s_and_b32 s76, s76, 0x380
v_pk_add_f32 v[110:111], v[76:77], v[78:79]
s_add_u32 s82, s64, s76
v_pk_add_f32 v[118:119], v[84:85], v[86:87]
s_add_u32 s83, s66, s76
v_pk_add_f32 v[126:127], v[92:93], v[94:95]
buffer_load_dwordx4 v8, s[16:19], s82 offen offset:0 lds
v_add_f32 v102, v102, v103
v_mov_b32 v103, v102
v_add_f32 v110, v110, v111
v_mov_b32 v111, v110
v_add_f32 v118, v118, v119
v_mov_b32 v119, v118
v_add_f32 v126, v126, v127
v_mov_b32 v127, v126
v_permlane32_swap_b32 v102, v103
v_permlane32_swap_b32 v110, v111
v_permlane32_swap_b32 v118, v119
v_permlane32_swap_b32 v126, v127
buffer_load_dwordx4 v9, s[16:19], s82 offen offset:1024 lds
v_add_f32 v102, v102, v103
v_mov_b32 v103, v102
v_add_f32 v110, v110, v111
v_mov_b32 v111, v110
v_add_f32 v118, v118, v119
v_mov_b32 v119, v118
v_add_f32 v126, v126, v127
v_mov_b32 v127, v126
v_permlane16_swap_b32 v102, v103
v_permlane16_swap_b32 v110, v111
v_permlane16_swap_b32 v118, v119
v_permlane16_swap_b32 v126, v127
buffer_load_dwordx4 v10, s[16:19], s83 offen offset:2048 lds
v_add_f32 v102, v102, v103
v_add_f32 v110, v110, v111
v_add_f32 v118, v118, v119
v_add_f32 v126, v126, v127
v_rcp_f32 v102, v102
v_rcp_f32 v110, v110
v_rcp_f32 v118, v118
v_rcp_f32 v126, v126
buffer_load_dwordx4 v11, s[16:19], s83 offen offset:3072 lds
v_pk_mul_f32 v[102:103], v[190:191], v[102:103] op_sel_hi:[1,0]
s_waitcnt vmcnt(8)
ds_read_b128 a[64:67], v2 offset:0
v_pk_mul_f32 v[110:111], v[190:191], v[110:111] op_sel_hi:[1,0]
ds_read_b128 a[68:71], v2 offset:2048
v_pk_mul_f32 v[118:119], v[190:191], v[118:119] op_sel_hi:[1,0]
ds_read_b128 a[80:83], v3 offset:0
v_pk_mul_f32 v[126:127], v[190:191], v[126:127] op_sel_hi:[1,0]
ds_read_b128 a[84:87], v3 offset:2048
v_pk_mul_f32 v[32:33], v[102:103], v[68:69] op_sel_hi:[1,0]
s_waitcnt lgkmcnt(4)
s_add_u32 m0, s77, 12288
v_pk_mul_f32 v[34:35], v[102:103], v[68:69] op_sel:[0,1] op_sel_hi:[1,1]
s_add_u32 s82, s65, s76
v_pk_mul_f32 v[36:37], v[102:103], v[70:71] op_sel_hi:[1,0]
s_add_u32 s83, s67, s76
v_pk_mul_f32 v[38:39], v[102:103], v[70:71] op_sel:[0,1] op_sel_hi:[1,1]
buffer_load_dwordx4 v8, s[16:19], s82 offen offset:0 lds
v_pk_mul_f32 v[40:41], v[110:111], v[76:77] op_sel_hi:[1,0]
v_pk_mul_f32 v[42:43], v[110:111], v[76:77] op_sel:[0,1] op_sel_hi:[1,1]
v_pk_mul_f32 v[44:45], v[110:111], v[78:79] op_sel_hi:[1,0]
v_pk_mul_f32 v[46:47], v[110:111], v[78:79] op_sel:[0,1] op_sel_hi:[1,1]
v_pk_mul_f32 v[48:49], v[118:119], v[84:85] op_sel_hi:[1,0]
v_pk_mul_f32 v[50:51], v[118:119], v[84:85] op_sel:[0,1] op_sel_hi:[1,1]
v_pk_mul_f32 v[52:53], v[118:119], v[86:87] op_sel_hi:[1,0]
v_pk_mul_f32 v[54:55], v[118:119], v[86:87] op_sel:[0,1] op_sel_hi:[1,1]
v_pk_mul_f32 v[56:57], v[126:127], v[92:93] op_sel_hi:[1,0]
v_pk_mul_f32 v[58:59], v[126:127], v[92:93] op_sel:[0,1] op_sel_hi:[1,1]
v_pk_mul_f32 v[60:61], v[126:127], v[94:95] op_sel_hi:[1,0]
v_pk_mul_f32 v[62:63], v[126:127], v[94:95] op_sel:[0,1] op_sel_hi:[1,1]
buffer_load_dwordx4 v9, s[16:19], s82 offen offset:1024 lds
v_cvt_pk_bf16_f32 v68, v32, v33
v_cvt_pk_bf16_f32 v69, v34, v35
v_cvt_pk_bf16_f32 v70, v36, v37
v_cvt_pk_bf16_f32 v71, v38, v39
v_cvt_pk_bf16_f32 v76, v40, v41
v_cvt_pk_bf16_f32 v77, v42, v43
v_cvt_pk_bf16_f32 v78, v44, v45
v_cvt_pk_bf16_f32 v79, v46, v47
v_cvt_pk_bf16_f32 v84, v48, v49
v_cvt_pk_bf16_f32 v85, v50, v51
v_cvt_pk_bf16_f32 v86, v52, v53
v_cvt_pk_bf16_f32 v87, v54, v55
buffer_load_dwordx4 v10, s[16:19], s83 offen offset:2048 lds
v_cvt_pk_bf16_f32 v92, v56, v57
v_cvt_pk_bf16_f32 v93, v58, v59
v_cvt_pk_bf16_f32 v94, v60, v61
v_cvt_pk_bf16_f32 v95, v62, v63
v_mfma_f32_16x16x32_bf16 v[32:35], v[130:133], v[68:71], 0
v_mfma_f32_16x16x32_bf16 v[40:43], v[138:141], v[76:79], 0
v_mfma_f32_16x16x32_bf16 v[48:51], v[146:149], v[84:87], 0
v_mfma_f32_16x16x32_bf16 v[56:59], v[154:157], v[92:95], 0
buffer_load_dwordx4 v11, s[16:19], s83 offen offset:3072 lds
s_nop 3
v_cvt_pk_bf16_f32 v168, v32, v33
v_cvt_pk_bf16_f32 v169, v34, v35
v_cvt_pk_bf16_f32 v170, v40, v41
v_cvt_pk_bf16_f32 v171, v42, v43
v_cvt_pk_bf16_f32 v172, v48, v49
v_cvt_pk_bf16_f32 v173, v50, v51
v_cvt_pk_bf16_f32 v174, v56, v57
v_cvt_pk_bf16_f32 v175, v58, v59
v_mfma_f32_16x16x16_bf16 v[32:35], v[96:97], v[64:65], 0
s_waitcnt vmcnt(8)
ds_read_b128 a[72:75], v2 offset:4096
v_mfma_f32_16x16x16_bf16 v[36:39], v[98:99], v[64:65], 0
ds_read_b128 a[76:79], v2 offset:6144
v_mfma_f32_16x16x16_bf16 v[40:43], v[104:105], v[72:73], 0
ds_read_b128 a[88:91], v3 offset:4096
v_mfma_f32_16x16x16_bf16 v[44:47], v[106:107], v[72:73], 0
ds_read_b128 a[92:95], v3 offset:6144
v_mfma_f32_16x16x16_bf16 v[48:51], v[112:113], v[80:81], 0
s_waitcnt lgkmcnt(4)
s_add_u32 m0, s77, 0
v_mfma_f32_16x16x16_bf16 v[52:55], v[114:115], v[80:81], 0
s_add_u32 s76, s76, 128
v_mfma_f32_16x16x16_bf16 v[56:59], v[120:121], v[88:89], 0
s_and_b32 s76, s76, 0x380
v_mfma_f32_16x16x16_bf16 v[60:63], v[122:123], v[88:89], 0
s_add_u32 s82, s64, s76
v_cndmask_b32 v68, v32, v33, s[92:93]
s_add_u32 s83, s66, s76
v_cndmask_b32 v69, v34, v35, s[92:93]
buffer_load_dwordx4 v8, s[16:19], s82 offen offset:0 lds
v_cndmask_b32 v70, v36, v37, s[92:93]
v_cndmask_b32 v71, v38, v39, s[92:93]
v_cndmask_b32 v76, v40, v41, s[92:93]
v_cndmask_b32 v77, v42, v43, s[92:93]
v_cndmask_b32 v78, v44, v45, s[92:93]
v_cndmask_b32 v79, v46, v47, s[92:93]
v_cndmask_b32 v84, v48, v49, s[92:93]
v_cndmask_b32 v85, v50, v51, s[92:93]
v_cndmask_b32 v86, v52, v53, s[92:93]
v_cndmask_b32 v87, v54, v55, s[92:93]
v_cndmask_b32 v92, v56, v57, s[92:93]
v_cndmask_b32 v93, v58, v59, s[92:93]
buffer_load_dwordx4 v9, s[16:19], s82 offen offset:1024 lds
v_cndmask_b32 v94, v60, v61, s[92:93]
v_cndmask_b32 v95, v62, v63, s[92:93]
v_pk_fma_f32 v[68:69], v[68:69], s[84:85], v[188:189]
v_pk_fma_f32 v[70:71], v[70:71], s[84:85], v[186:187]
v_pk_fma_f32 v[76:77], v[76:77], s[84:85], v[188:189]
v_pk_fma_f32 v[78:79], v[78:79], s[84:85], v[186:187]
v_pk_fma_f32 v[84:85], v[84:85], s[84:85], v[188:189]
v_pk_fma_f32 v[86:87], v[86:87], s[84:85], v[186:187]
v_pk_fma_f32 v[92:93], v[92:93], s[84:85], v[188:189]
v_pk_fma_f32 v[94:95], v[94:95], s[84:85], v[186:187]
v_max3_f32 v102, v68, v69, v70
v_max3_f32 v110, v76, v77, v78
buffer_load_dwordx4 v10, s[16:19], s83 offen offset:2048 lds
v_max3_f32 v118, v84, v85, v86
v_max3_f32 v126, v92, v93, v94
v_max_f32 v102, v102, v71
v_max_f32 v110, v110, v79
v_max_f32 v118, v118, v87
v_max_f32 v126, v126, v95
v_mov_b32 v103, v102
v_mov_b32 v111, v110
v_mov_b32 v119, v118
v_mov_b32 v127, v126
v_permlane32_swap_b32 v102, v103
v_permlane32_swap_b32 v110, v111
buffer_load_dwordx4 v11, s[16:19], s83 offen offset:3072 lds
v_permlane32_swap_b32 v118, v119
s_waitcnt vmcnt(8)
ds_read_b128 a[96:99], v2 offset:8192
v_permlane32_swap_b32 v126, v127
ds_read_b128 a[100:103], v2 offset:10240
v_max_f32 v102, v102, v103
ds_read_b128 a[112:115], v3 offset:8192
v_mov_b32 v103, v102
ds_read_b128 a[116:119], v3 offset:10240
v_max_f32 v110, v110, v111
s_waitcnt lgkmcnt(4)
s_add_u32 m0, s77, 4096
v_mov_b32 v111, v110
s_add_u32 s82, s65, s76
v_max_f32 v118, v118, v119
s_add_u32 s83, s67, s76
v_mov_b32 v119, v118
buffer_load_dwordx4 v8, s[16:19], s82 offen offset:0 lds
v_max_f32 v126, v126, v127
v_mov_b32 v127, v126
v_permlane16_swap_b32 v102, v103
v_permlane16_swap_b32 v110, v111
v_permlane16_swap_b32 v118, v119
v_permlane16_swap_b32 v126, v127
v_max_f32 v102, v102, v103
v_max_f32 v110, v110, v111
v_max_f32 v118, v118, v119
v_max_f32 v126, v126, v127
v_pk_add_f32 v[68:69], v[68:69], v[102:103] op_sel_hi:[1,0] neg_lo:[0,1] neg_hi:[0,1]
v_pk_add_f32 v[70:71], v[70:71], v[102:103] op_sel_hi:[1,0] neg_lo:[0,1] neg_hi:[0,1]
buffer_load_dwordx4 v9, s[16:19], s82 offen offset:1024 lds
v_pk_add_f32 v[76:77], v[76:77], v[110:111] op_sel_hi:[1,0] neg_lo:[0,1] neg_hi:[0,1]
v_pk_add_f32 v[78:79], v[78:79], v[110:111] op_sel_hi:[1,0] neg_lo:[0,1] neg_hi:[0,1]
v_pk_add_f32 v[84:85], v[84:85], v[118:119] op_sel_hi:[1,0] neg_lo:[0,1] neg_hi:[0,1]
v_pk_add_f32 v[86:87], v[86:87], v[118:119] op_sel_hi:[1,0] neg_lo:[0,1] neg_hi:[0,1]
v_pk_add_f32 v[92:93], v[92:93], v[126:127] op_sel_hi:[1,0] neg_lo:[0,1] neg_hi:[0,1]
v_pk_add_f32 v[94:95], v[94:95], v[126:127] op_sel_hi:[1,0] neg_lo:[0,1] neg_hi:[0,1]
v_exp_f32 v68, v68
v_exp_f32 v69, v69
v_exp_f32 v70, v70
buffer_load_dwordx4 v10, s[16:19], s83 offen offset:2048 lds
v_exp_f32 v71, v71
v_exp_f32 v76, v76
v_exp_f32 v77, v77
v_exp_f32 v78, v78
v_exp_f32 v79, v79
v_exp_f32 v84, v84
v_exp_f32 v85, v85
buffer_load_dwordx4 v11, s[16:19], s83 offen offset:3072 lds
v_exp_f32 v86, v86
s_waitcnt vmcnt(8)
ds_read_b128 a[104:107], v2 offset:12288
v_exp_f32 v87, v87
ds_read_b128 a[108:111], v2 offset:14336
v_exp_f32 v92, v92
ds_read_b128 a[120:123], v3 offset:12288
v_exp_f32 v93, v93
ds_read_b128 a[124:127], v3 offset:14336
v_exp_f32 v94, v94
s_waitcnt lgkmcnt(4)
s_add_u32 m0, s77, 8192
v_exp_f32 v95, v95
s_add_u32 s76, s76, 128
v_pk_add_f32 v[102:103], v[68:69], v[70:71]
s_and_b32 s76, s76, 0x380
v_pk_add_f32 v[110:111], v[76:77], v[78:79]
s_add_u32 s82, s64, s76
v_pk_add_f32 v[118:119], v[84:85], v[86:87]
s_add_u32 s83, s66, s76
v_pk_add_f32 v[126:127], v[92:93], v[94:95]
buffer_load_dwordx4 v8, s[16:19], s82 offen offset:0 lds
v_add_f32 v102, v102, v103
v_mov_b32 v103, v102
v_add_f32 v110, v110, v111
v_mov_b32 v111, v110
v_add_f32 v118, v118, v119
v_mov_b32 v119, v118
v_add_f32 v126, v126, v127
v_mov_b32 v127, v126
v_permlane32_swap_b32 v102, v103
v_permlane32_swap_b32 v110, v111
v_permlane32_swap_b32 v118, v119
v_permlane32_swap_b32 v126, v127
buffer_load_dwordx4 v9, s[16:19], s82 offen offset:1024 lds
v_add_f32 v102, v102, v103
v_mov_b32 v103, v102
v_add_f32 v110, v110, v111
v_mov_b32 v111, v110
v_add_f32 v118, v118, v119
v_mov_b32 v119, v118
v_add_f32 v126, v126, v127
v_mov_b32 v127, v126
v_permlane16_swap_b32 v102, v103
v_permlane16_swap_b32 v110, v111
v_permlane16_swap_b32 v118, v119
v_permlane16_swap_b32 v126, v127
buffer_load_dwordx4 v10, s[16:19], s83 offen offset:2048 lds
v_add_f32 v102, v102, v103
v_add_f32 v110, v110, v111
v_add_f32 v118, v118, v119
v_add_f32 v126, v126, v127
v_rcp_f32 v102, v102
v_rcp_f32 v110, v110
v_rcp_f32 v118, v118
v_rcp_f32 v126, v126
buffer_load_dwordx4 v11, s[16:19], s83 offen offset:3072 lds
v_pk_mul_f32 v[102:103], v[190:191], v[102:103] op_sel_hi:[1,0]
s_waitcnt vmcnt(8)
ds_read_b128 v[192:195], v2 offset:0
v_pk_mul_f32 v[110:111], v[190:191], v[110:111] op_sel_hi:[1,0]
ds_read_b128 v[196:199], v2 offset:2048
v_pk_mul_f32 v[118:119], v[190:191], v[118:119] op_sel_hi:[1,0]
ds_read_b128 v[208:211], v3 offset:0
v_pk_mul_f32 v[126:127], v[190:191], v[126:127] op_sel_hi:[1,0]
ds_read_b128 v[212:215], v3 offset:2048
v_pk_mul_f32 v[32:33], v[102:103], v[68:69] op_sel_hi:[1,0]
s_waitcnt lgkmcnt(4)
s_add_u32 m0, s77, 12288
v_pk_mul_f32 v[34:35], v[102:103], v[68:69] op_sel:[0,1] op_sel_hi:[1,1]
s_add_u32 s82, s65, s76
v_pk_mul_f32 v[36:37], v[102:103], v[70:71] op_sel_hi:[1,0]
s_add_u32 s83, s67, s76
v_pk_mul_f32 v[38:39], v[102:103], v[70:71] op_sel:[0,1] op_sel_hi:[1,1]
buffer_load_dwordx4 v8, s[16:19], s82 offen offset:0 lds
v_pk_mul_f32 v[40:41], v[110:111], v[76:77] op_sel_hi:[1,0]
v_pk_mul_f32 v[42:43], v[110:111], v[76:77] op_sel:[0,1] op_sel_hi:[1,1]
v_pk_mul_f32 v[44:45], v[110:111], v[78:79] op_sel_hi:[1,0]
v_pk_mul_f32 v[46:47], v[110:111], v[78:79] op_sel:[0,1] op_sel_hi:[1,1]
v_pk_mul_f32 v[48:49], v[118:119], v[84:85] op_sel_hi:[1,0]
v_pk_mul_f32 v[50:51], v[118:119], v[84:85] op_sel:[0,1] op_sel_hi:[1,1]
v_pk_mul_f32 v[52:53], v[118:119], v[86:87] op_sel_hi:[1,0]
v_pk_mul_f32 v[54:55], v[118:119], v[86:87] op_sel:[0,1] op_sel_hi:[1,1]
v_pk_mul_f32 v[56:57], v[126:127], v[92:93] op_sel_hi:[1,0]
v_pk_mul_f32 v[58:59], v[126:127], v[92:93] op_sel:[0,1] op_sel_hi:[1,1]
v_pk_mul_f32 v[60:61], v[126:127], v[94:95] op_sel_hi:[1,0]
v_pk_mul_f32 v[62:63], v[126:127], v[94:95] op_sel:[0,1] op_sel_hi:[1,1]
buffer_load_dwordx4 v9, s[16:19], s82 offen offset:1024 lds
v_cvt_pk_bf16_f32 v68, v32, v33
v_cvt_pk_bf16_f32 v69, v34, v35
v_cvt_pk_bf16_f32 v70, v36, v37
v_cvt_pk_bf16_f32 v71, v38, v39
v_cvt_pk_bf16_f32 v76, v40, v41
v_cvt_pk_bf16_f32 v77, v42, v43
v_cvt_pk_bf16_f32 v78, v44, v45
v_cvt_pk_bf16_f32 v79, v46, v47
v_cvt_pk_bf16_f32 v84, v48, v49
v_cvt_pk_bf16_f32 v85, v50, v51
v_cvt_pk_bf16_f32 v86, v52, v53
v_cvt_pk_bf16_f32 v87, v54, v55
buffer_load_dwordx4 v10, s[16:19], s83 offen offset:2048 lds
v_cvt_pk_bf16_f32 v92, v56, v57
v_cvt_pk_bf16_f32 v93, v58, v59
v_cvt_pk_bf16_f32 v94, v60, v61
v_cvt_pk_bf16_f32 v95, v62, v63
v_mfma_f32_16x16x32_bf16 v[32:35], v[128:131], v[68:71], 0
v_mfma_f32_16x16x32_bf16 v[40:43], v[136:139], v[76:79], 0
v_mfma_f32_16x16x32_bf16 v[48:51], v[144:147], v[84:87], 0
v_mfma_f32_16x16x32_bf16 v[56:59], v[152:155], v[92:95], 0
buffer_load_dwordx4 v11, s[16:19], s83 offen offset:3072 lds
s_nop 3
v_cvt_pk_bf16_f32 v160, v32, v33
v_cvt_pk_bf16_f32 v161, v34, v35
v_cvt_pk_bf16_f32 v162, v40, v41
v_cvt_pk_bf16_f32 v163, v42, v43
v_cvt_pk_bf16_f32 v164, v48, v49
v_cvt_pk_bf16_f32 v165, v50, v51
v_cvt_pk_bf16_f32 v166, v56, v57
v_cvt_pk_bf16_f32 v167, v58, v59
s_bitcmp1_b32 s44, 0
s_cbranch_scc0 L_osw_17
v_swap_b32 v160, v162
v_swap_b32 v161, v163
v_swap_b32 v164, v166
v_swap_b32 v165, v167
v_swap_b32 v168, v170
v_swap_b32 v169, v171
v_swap_b32 v172, v174
v_swap_b32 v173, v175
L_osw_17:
s_lshl_b32 s82, s45, 3
s_lshl_b32 s83, s44, 1
s_add_u32 s82, s82, s83
s_lshl_b32 s82, s82, 4
s_lshl_b32 s83, s46, 1
s_add_u32 s82, s82, s83
s_lshr_b32 s83, s44, 1
s_add_u32 s82, s82, s83
s_lshl_b32 s82, s82, 10
s_add_u32 s82, s82, 0x900000
s_xor_b32 s83, s82, 1024
s_add_u32 s84, s82, 16384
s_add_u32 s85, s83, 16384
buffer_store_dwordx4 v[160:163], v1, s[20:23], s82 offen sc1
buffer_store_dwordx4 v[164:167], v1, s[20:23], s83 offen sc1
buffer_store_dwordx4 v[168:171], v1, s[20:23], s84 offen sc1
buffer_store_dwordx4 v[172:175], v1, s[20:23], s85 offen sc1
s_waitcnt vmcnt(12)
ds_read_b128 v[200:203], v2 offset:4096
ds_read_b128 v[204:207], v2 offset:6144
ds_read_b128 v[216:219], v3 offset:4096
ds_read_b128 v[220:223], v3 offset:6144
s_waitcnt lgkmcnt(4)
s_add_u32 m0, s77, 0
s_add_u32 s76, s76, 128
s_and_b32 s76, s76, 0x380
s_add_u32 s82, s64, s76
s_add_u32 s83, s66, s76
buffer_load_dwordx4 v8, s[16:19], s82 offen offset:0 lds
buffer_load_dwordx4 v9, s[16:19], s82 offen offset:1024 lds
buffer_load_dwordx4 v10, s[16:19], s83 offen offset:2048 lds
buffer_load_dwordx4 v11, s[16:19], s83 offen offset:3072 lds
s_waitcnt vmcnt(12)
ds_read_b128 v[224:227], v2 offset:8192
ds_read_b128 v[228:231], v2 offset:10240
ds_read_b128 v[240:243], v3 offset:8192
ds_read_b128 v[244:247], v3 offset:10240
s_waitcnt lgkmcnt(4)
s_add_u32 m0, s77, 4096
s_add_u32 s82, s65, s76
s_add_u32 s83, s67, s76
buffer_load_dwordx4 v8, s[16:19], s82 offen offset:0 lds
buffer_load_dwordx4 v9, s[16:19], s82 offen offset:1024 lds
buffer_load_dwordx4 v10, s[16:19], s83 offen offset:2048 lds
buffer_load_dwordx4 v11, s[16:19], s83 offen offset:3072 lds
s_waitcnt vmcnt(12)
ds_read_b128 v[232:235], v2 offset:12288
ds_read_b128 v[236:239], v2 offset:14336
ds_read_b128 v[248:251], v3 offset:12288
ds_read_b128 v[252:255], v3 offset:14336
s_waitcnt lgkmcnt(4)
s_add_u32 m0, s77, 8192
s_add_u32 s76, s76, 128
s_and_b32 s76, s76, 0x380
s_add_u32 s82, s64, s76
s_add_u32 s83, s66, s76
buffer_load_dwordx4 v8, s[16:19], s82 offen offset:0 lds
buffer_load_dwordx4 v9, s[16:19], s82 offen offset:1024 lds
buffer_load_dwordx4 v10, s[16:19], s83 offen offset:2048 lds
buffer_load_dwordx4 v11, s[16:19], s83 offen offset:3072 lds
s_lshl_b32 s84, s71, 2
s_lshr_b32 s85, 0x76443200, s84
s_and_b32 s85, s85, 15
v_mov_b32 v5, s85
s_lshr_b32 s85, 0x77543310, s84
s_and_b32 s85, s85, 15
v_mov_b32 v6, s85
v_cndmask_b32 v5, v5, v6, s[92:93]
v_lshlrev_b32 v5, 7, v5
v_bfe_u32 v6, v0, 1, 2
v_lshl_add_u32 v6, v6, 10, v5
s_lshl_b32 s100, s44, 12
s_add_u32 s100, s100, 0x4000
v_and_b32 v4, 1, v0
v_lshlrev_b32 v4, 7, v4
s_lshr_b32 s97, s70, 1
s_lshl_b32 s97, s97, 2
s_add_u32 s97, s97, s44
s_lshl_b32 s97, s97, 8
s_add_u32 s97, s97, 0xc000
buffer_load_dwordx4 v[12:15], v6, s[20:23], s100 offen sc1
s_waitcnt vmcnt(9)
ds_read_b128 a[128:131], v2 offset:0
ds_read_b128 a[132:135], v2 offset:2048
ds_read_b128 a[144:147], v3 offset:0
ds_read_b128 a[148:151], v3 offset:2048
s_waitcnt lgkmcnt(4)
s_add_u32 m0, s77, 12288
s_add_u32 s82, s65, s76
s_add_u32 s83, s67, s76
buffer_load_dwordx4 v8, s[16:19], s82 offen offset:0 lds
buffer_load_dwordx4 v9, s[16:19], s82 offen offset:1024 lds
buffer_load_dwordx4 v10, s[16:19], s83 offen offset:2048 lds
buffer_load_dwordx4 v11, s[16:19], s83 offen offset:3072 lds
s_waitcnt vmcnt(9)
ds_read_b128 a[136:139], v2 offset:4096
ds_read_b128 a[140:143], v2 offset:6144
ds_read_b128 a[152:155], v3 offset:4096
ds_read_b128 a[156:159], v3 offset:6144
s_waitcnt vmcnt(5)
ds_read_b128 a[160:163], v2 offset:8192
ds_read_b128 a[164:167], v2 offset:10240
ds_read_b128 a[176:179], v3 offset:8192
ds_read_b128 a[180:183], v3 offset:10240
s_waitcnt vmcnt(0)
ds_read_b128 a[168:171], v2 offset:12288
ds_read_b128 a[172:175], v2 offset:14336
ds_read_b128 a[184:187], v3 offset:12288
ds_read_b128 a[188:191], v3 offset:14336
s_lshl_b32 s84, s45, 3
s_add_u32 s84, s84, s46
s_lshl_b32 s84, s84, 5
s_add_u32 s84, s84, s44
s_lshl_b32 s84, s84, 2
s_add_u32 s0, s84, 0xc000
v_xor_b32 v30, v12, v28
v_xor_b32 v13, v13, v28
v_xor_b32 v14, v14, v28
v_xor_b32 v15, v15, v28
v_or3_b32 v30, v30, v13, v14
v_or_b32 v30, v30, v15
v_cmp_ne_u32 vcc, 0, v30
s_nop 1
s_cbranch_vccnz L_pslow_18
L_pret_19:
s_waitcnt lgkmcnt(0)
L_p2:
s_nop 7
s_mul_i32 s85, s44, 896
s_mul_i32 s84, s71, 7
s_add_u32 s85, s85, s84
s_lshl_b32 s85, s85, 10
s_add_u32 s75, s85, 0x100000
s_and_b32 s72, s68, 3
s_lshl_b32 s72, s72, 1
s_lshl_b32 s83, s70, 2
s_add_u32 s83, s83, s44
s_lshl_b32 s84, s83, 5
v_and_b32 v16, 15, v0
v_lshlrev_b32 v16, 1, v16
buffer_load_ushort v12, v16, s[36:39], s84 offen
v_add_u32 v4, 4096, v1
s_lshl_b32 s77, s44, 14
s_add_u32 s77, s77, 98304
s_mov_b32 s74, s75
v_and_b32 v2, 0x7ff, v2
v_add_u32 v2, s77, v2
v_xor_b32 v3, 64, v2
s_barrier
s_mul_i32 s75, s72, 114688
s_add_u32 s75, s75, s74
buffer_load_dwordx4 a[192:195], v1, s[20:23], s75 offen offset:0 sc1
buffer_load_dwordx4 a[196:199], v1, s[20:23], s75 offen offset:1024 sc1
buffer_load_dwordx4 a[200:203], v1, s[20:23], s75 offen offset:2048 sc1
buffer_load_dwordx4 a[204:207], v1, s[20:23], s75 offen offset:3072 sc1
buffer_load_dwordx4 a[208:211], v4, s[20:23], s75 offen offset:0 sc1
buffer_load_dwordx4 a[212:215], v4, s[20:23], s75 offen offset:1024 sc1
buffer_load_dwordx4 a[216:219], v4, s[20:23], s75 offen offset:2048 sc1
s_add_u32 s75, s75, 57344
s_add_u32 s72, s72, 1
s_and_b32 s72, s72, 7
buffer_load_dwordx4 a[220:223], v1, s[20:23], s75 offen offset:0 sc1
buffer_load_dwordx4 a[224:227], v1, s[20:23], s75 offen offset:1024 sc1
buffer_load_dwordx4 a[228:231], v1, s[20:23], s75 offen offset:2048 sc1
s_waitcnt vmcnt(10)
v_lshlrev_b32 v184, 16, v12
v_lshlrev_b32 v185, 16, v12
v_lshlrev_b32 v186, 16, v12
v_lshlrev_b32 v187, 16, v12
s_waitcnt vmcnt(9)
s_nop 0
v_mfma_f32_16x16x32_bf16 v[64:67], a[192:195], a[0:3], v[184:187]
v_mfma_f32_16x16x32_bf16 v[68:71], a[192:195], a[4:7], 0
buffer_store_dword v28, off, s[20:23], s0 sc1
v_mfma_f32_16x16x32_bf16 v[72:75], a[192:195], a[8:11], 0
buffer_load_dwordx4 a[232:235], v1, s[20:23], s75 offen offset:3072 sc1
v_mfma_f32_16x16x32_bf16 v[76:79], a[192:195], a[12:15], 0
s_waitcnt vmcnt(10)
v_mfma_f32_16x16x32_bf16 v[80:83], a[196:199], a[0:3], v[184:187]
buffer_load_dwordx4 a[236:239], v4, s[20:23], s75 offen offset:0 sc1
v_mfma_f32_16x16x32_bf16 v[84:87], a[196:199], a[4:7], 0
v_mfma_f32_16x16x32_bf16 v[88:91], a[196:199], a[8:11], 0
buffer_load_dwordx4 a[240:243], v4, s[20:23], s75 offen offset:1024 sc1
v_mfma_f32_16x16x32_bf16 v[92:95], a[196:199], a[12:15], 0
s_waitcnt vmcnt(11)
v_mfma_f32_16x16x32_bf16 v[96:99], a[200:203], a[0:3], v[184:187]
buffer_load_dwordx4 a[244:247], v4, s[20:23], s75 offen offset:2048 sc1
v_mfma_f32_16x16x32_bf16 v[100:103], a[200:203], a[4:7], 0
v_mfma_f32_16x16x32_bf16 v[104:107], a[200:203], a[8:11], 0
s_mul_i32 s75, s72, 114688
s_add_u32 s75, s75, s74
v_mfma_f32_16x16x32_bf16 v[108:111], a[200:203], a[12:15], 0
buffer_load_dwordx4 a[248:251], v1, s[20:23], s75 offen offset:0 sc1
s_waitcnt vmcnt(12)
v_mfma_f32_16x16x32_bf16 v[112:115], a[204:207], a[0:3], v[184:187]
v_mfma_f32_16x16x32_bf16 v[116:119], a[204:207], a[4:7], 0
buffer_load_dwordx4 a[252:255], v1, s[20:23], s75 offen offset:1024 sc1
v_mfma_f32_16x16x32_bf16 v[120:123], a[204:207], a[8:11], 0
v_mfma_f32_16x16x32_bf16 v[124:127], a[204:207], a[12:15], 0
buffer_load_dwordx4 v[32:35], v1, s[20:23], s75 offen offset:2048 sc1
s_waitcnt vmcnt(13)
v_mfma_f32_16x16x32_bf16 v[128:131], a[208:211], a[0:3], v[184:187]
v_lshrrev_b32 v29, 3, v0
v_bfe_u32 v30, v0, 1, 2
v_mfma_f32_16x16x32_bf16 v[132:135], a[208:211], a[4:7], 0
buffer_load_dwordx4 v[36:39], v1, s[20:23], s75 offen offset:3072 sc1
v_lshrrev_b32 v31, 4, v0
v_mfma_f32_16x16x32_bf16 v[136:139], a[208:211], a[8:11], 0
v_xor_b32 v30, v30, v31
v_lshlrev_b32 v30, 5, v30
v_mfma_f32_16x16x32_bf16 v[140:143], a[208:211], a[12:15], 0
buffer_load_dwordx4 v[40:43], v4, s[20:23], s75 offen offset:0 sc1
s_waitcnt vmcnt(14)
v_mfma_f32_16x16x32_bf16 v[144:147], a[212:215], a[0:3], v[184:187]
v_and_b32 v31, 1, v0
v_lshl_or_b32 v30, v31, 4, v30
v_mfma_f32_16x16x32_bf16 v[148:151], a[212:215], a[4:7], 0
buffer_load_dwordx4 v[44:47], v4, s[20:23], s75 offen offset:1024 sc1
s_lshl_b32 s84, s71, 7
v_mfma_f32_16x16x32_bf16 v[152:155], a[212:215], a[8:11], 0
v_lshl_add_u32 v30, v29, 10, v30
v_add_u32 v18, s84, v30
v_mfma_f32_16x16x32_bf16 v[156:159], a[212:215], a[12:15], 0
buffer_load_dwordx4 v[48:51], v4, s[20:23], s75 offen offset:2048 sc1
s_waitcnt vmcnt(15)
v_mfma_f32_16x16x32_bf16 v[160:163], a[216:219], a[0:3], v[184:187]
v_add_u32 v19, 7168, v18
v_add_u32 v20, 14336, v18
v_mfma_f32_16x16x32_bf16 v[164:167], a[216:219], a[4:7], 0
s_add_u32 s75, s75, 57344
s_add_u32 s72, s72, 1
v_mfma_f32_16x16x32_bf16 v[168:171], a[216:219], a[8:11], 0
s_and_b32 s72, s72, 7
buffer_load_dwordx4 v[52:55], v1, s[20:23], s75 offen offset:0 sc1
v_mfma_f32_16x16x32_bf16 v[172:175], a[216:219], a[12:15], 0
v_add_u32 v21, 21504, v18
s_waitcnt vmcnt(15)
v_mfma_f32_16x16x32_bf16 v[64:67], a[220:223], a[16:19], v[64:67]
buffer_load_dwordx4 v[56:59], v1, s[20:23], s75 offen offset:1024 sc1
s_lshl_b32 s84, s3, 1
v_mfma_f32_16x16x32_bf16 v[68:71], a[220:223], a[20:23], v[68:71]
s_add_u32 s84, s84, s68
s_cmp_ge_u32 s84, 7
s_cselect_b32 s85, 7, 0
v_mfma_f32_16x16x32_bf16 v[72:75], a[220:223], a[24:27], v[72:75]
buffer_load_dwordx4 a[192:195], v1, s[20:23], s75 offen offset:2048 sc1
s_sub_u32 s101, s84, s85
v_mfma_f32_16x16x32_bf16 v[76:79], a[220:223], a[28:31], v[76:79]
s_add_u32 s46, s3, s68
s_waitcnt vmcnt(16)
v_mfma_f32_16x16x32_bf16 v[80:83], a[224:227], a[16:19], v[80:83]
buffer_load_dwordx4 a[196:199], v1, s[20:23], s75 offen offset:3072 sc1
s_and_b32 s46, s46, 3
v_mfma_f32_16x16x32_bf16 v[84:87], a[224:227], a[20:23], v[84:87]
v_lshrrev_b32 v13, 2, v0
v_lshlrev_b32 v14, 7, v13
v_mfma_f32_16x16x32_bf16 v[88:91], a[224:227], a[24:27], v[88:91]
buffer_load_dwordx4 a[200:203], v4, s[20:23], s75 offen offset:0 sc1
v_and_b32 v15, 3, v0
v_mfma_f32_16x16x32_bf16 v[92:95], a[224:227], a[28:31], v[92:95]
v_lshl_add_u32 v14, v15, 3, v14
s_waitcnt vmcnt(17)
v_mfma_f32_16x16x32_bf16 v[96:99], a[228:231], a[16:19], v[96:99]
buffer_load_dwordx4 a[204:207], v4, s[20:23], s75 offen offset:1024 sc1
v_bfe_u32 v13, v0, 3, 2
v_mfma_f32_16x16x32_bf16 v[100:103], a[228:231], a[20:23], v[100:103]
v_lshl_add_u32 v14, v13, 5, v14
v_add_u32 v22, s77, v14
v_mfma_f32_16x16x32_bf16 v[104:107], a[228:231], a[24:27], v[104:107]
buffer_load_dwordx4 a[208:211], v4, s[20:23], s75 offen offset:2048 sc1
v_xor_b32 v23, 32, v22
v_mfma_f32_16x16x32_bf16 v[108:111], a[228:231], a[28:31], v[108:111]
v_xor_b32 v24, 64, v22
s_waitcnt vmcnt(17)
v_mfma_f32_16x16x32_bf16 v[112:115], a[232:235], a[16:19], v[112:115]
s_mul_i32 s75, s72, 114688
s_add_u32 s75, s75, s74
v_mfma_f32_16x16x32_bf16 v[116:119], a[232:235], a[20:23], v[116:119]
buffer_load_dwordx4 a[212:215], v1, s[20:23], s75 offen offset:0 sc1
v_xor_b32 v25, 96, v22
v_mfma_f32_16x16x32_bf16 v[120:123], a[232:235], a[24:27], v[120:123]
s_lshl_b32 s85, s70, 2
s_add_u32 s84, s44, 0
v_mfma_f32_16x16x32_bf16 v[124:127], a[232:235], a[28:31], v[124:127]
buffer_load_dwordx4 a[216:219], v1, s[20:23], s75 offen offset:1024 sc1
s_waitcnt vmcnt(18)
v_mfma_f32_16x16x32_bf16 v[128:131], a[236:239], a[16:19], v[128:131]
s_and_b32 s84, s84, 3
s_add_u32 s78, s84, s85
v_mfma_f32_16x16x32_bf16 v[132:135], a[236:239], a[20:23], v[132:135]
buffer_load_dwordx4 a[0:3], v1, s[20:23], s75 offen offset:2048 sc1
s_lshl_b32 s84, s78, 14
v_mfma_f32_16x16x32_bf16 v[136:139], a[236:239], a[24:27], v[136:139]
v_add_u32 v60, s84, v1
s_add_u32 s84, s44, 1
v_mfma_f32_16x16x32_bf16 v[140:143], a[236:239], a[28:31], v[140:143]
buffer_load_dwordx4 a[4:7], v1, s[20:23], s75 offen offset:3072 sc1
s_waitcnt vmcnt(19)
v_mfma_f32_16x16x32_bf16 v[144:147], a[240:243], a[16:19], v[144:147]
s_and_b32 s84, s84, 3
s_add_u32 s79, s84, s85
v_mfma_f32_16x16x32_bf16 v[148:151], a[240:243], a[20:23], v[148:151]
buffer_load_dwordx4 a[8:11], v4, s[20:23], s75 offen offset:0 sc1
s_lshl_b32 s84, s79, 14
v_mfma_f32_16x16x32_bf16 v[152:155], a[240:243], a[24:27], v[152:155]
v_add_u32 v61, s84, v1
s_add_u32 s84, s44, 2
v_mfma_f32_16x16x32_bf16 v[156:159], a[240:243], a[28:31], v[156:159]
buffer_load_dwordx4 a[12:15], v4, s[20:23], s75 offen offset:1024 sc1
s_waitcnt vmcnt(20)
v_mfma_f32_16x16x32_bf16 v[160:163], a[244:247], a[16:19], v[160:163]
s_and_b32 s84, s84, 3
s_add_u32 s80, s84, s85
v_mfma_f32_16x16x32_bf16 v[164:167], a[244:247], a[20:23], v[164:167]
buffer_load_dwordx4 a[220:223], v4, s[20:23], s75 offen offset:2048 sc1
s_lshl_b32 s84, s80, 14
v_mfma_f32_16x16x32_bf16 v[168:171], a[244:247], a[24:27], v[168:171]
v_add_u32 v62, s84, v1
s_add_u32 s84, s44, 3
v_mfma_f32_16x16x32_bf16 v[172:175], a[244:247], a[28:31], v[172:175]
s_and_b32 s84, s84, 3
s_waitcnt vmcnt(20)
v_mfma_f32_16x16x32_bf16 v[64:67], a[248:251], a[32:35], v[64:67]
s_add_u32 s75, s75, 57344
s_add_u32 s72, s72, 1
v_mfma_f32_16x16x32_bf16 v[68:71], a[248:251], a[36:39], v[68:71]
s_and_b32 s72, s72, 7
buffer_load_dwordx4 a[224:227], v1, s[20:23], s75 offen offset:0 sc1
v_mfma_f32_16x16x32_bf16 v[72:75], a[248:251], a[40:43], v[72:75]
s_add_u32 s81, s84, s85
s_lshl_b32 s84, s81, 14
v_mfma_f32_16x16x32_bf16 v[76:79], a[248:251], a[44:47], v[76:79]
v_add_u32 v63, s84, v1
s_waitcnt vmcnt(20)
v_mfma_f32_16x16x32_bf16 v[80:83], a[252:255], a[32:35], v[80:83]
buffer_load_dwordx4 a[228:231], v1, s[20:23], s75 offen offset:1024 sc1
v_and_b32 v6, 1, v0
v_mfma_f32_16x16x32_bf16 v[84:87], a[252:255], a[36:39], v[84:87]
v_lshlrev_b32 v6, 7, v6
v_mov_b32 v17, s91
v_mfma_f32_16x16x32_bf16 v[88:91], a[252:255], a[40:43], v[88:91]
s_lshl_b32 s84, s44, 12
s_add_u32 s69, s84, 0x900000
v_mfma_f32_16x16x32_bf16 v[92:95], a[252:255], a[44:47], v[92:95]
s_mul_i32 s84, s44, 7168
s_waitcnt vmcnt(20)
v_mfma_f32_16x16x32_bf16 v[96:99], v[32:35], a[32:35], v[96:99]
buffer_load_dwordx4 a[232:235], v1, s[20:23], s75 offen offset:2048 sc1
s_add_u32 s100, s84, 0xb00000
v_mfma_f32_16x16x32_bf16 v[100:103], v[32:35], a[36:39], v[100:103]
s_add_u32 s47, s100, 4096
v_lshrrev_b32 v13, 1, v0
v_mfma_f32_16x16x32_bf16 v[104:107], v[32:35], a[40:43], v[104:107]
v_and_b32 v14, 3, v13
v_lshrrev_b32 v13, 2, v13
v_mfma_f32_16x16x32_bf16 v[108:111], v[32:35], a[44:47], v[108:111]
v_lshlrev_b32 v13, 14, v13
s_waitcnt vmcnt(20)
v_mfma_f32_16x16x32_bf16 v[112:115], v[36:39], a[32:35], v[112:115]
buffer_load_dwordx4 a[236:239], v1, s[20:23], s75 offen offset:3072 sc1
v_lshl_add_u32 v13, v14, 10, v13
v_mfma_f32_16x16x32_bf16 v[116:119], v[36:39], a[36:39], v[116:119]
v_and_b32 v14, 1, v0
s_mul_i32 s84, s3, 2
v_mfma_f32_16x16x32_bf16 v[120:123], v[36:39], a[40:43], v[120:123]
v_add_u32 v14, s84, v14
v_lshl_add_u32 v7, v14, 7, v13
v_mfma_f32_16x16x32_bf16 v[124:127], v[36:39], a[44:47], v[124:127]
s_lshl_b32 s84, s70, 16
s_waitcnt vmcnt(20)
v_mfma_f32_16x16x32_bf16 v[128:131], v[40:43], a[32:35], v[128:131]
buffer_load_dwordx4 a[240:243], v4, s[20:23], s75 offen offset:0 sc1
s_add_u32 s97, s84, s69
v_mfma_f32_16x16x32_bf16 v[132:135], v[40:43], a[36:39], v[132:135]
v_lshrrev_b32 v13, 1, v0
v_mul_u32_u24 v14, 37, v13
v_mfma_f32_16x16x32_bf16 v[136:139], v[40:43], a[40:43], v[136:139]
v_lshrrev_b32 v14, 8, v14
v_mul_u32_u24 v14, 21, v14
v_mfma_f32_16x16x32_bf16 v[140:143], v[40:43], a[44:47], v[140:143]
v_add_u32 v13, v13, v14
s_waitcnt vmcnt(20)
v_mfma_f32_16x16x32_bf16 v[144:147], v[44:47], a[32:35], v[144:147]
buffer_load_dwordx4 a[244:247], v4, s[20:23], s75 offen offset:1024 sc1
v_and_b32 v14, 1, v0
v_mfma_f32_16x16x32_bf16 v[148:151], v[44:47], a[36:39], v[148:151]
s_mul_i32 s84, s3, 2
v_add_u32 v14, s84, v14
v_mfma_f32_16x16x32_bf16 v[152:155], v[44:47], a[40:43], v[152:155]
v_lshlrev_b32 v14, 7, v14
s_mul_i32 s84, s70, 114688
v_mfma_f32_16x16x32_bf16 v[156:159], v[44:47], a[44:47], v[156:159]
v_lshl_add_u32 v13, v13, 10, v14
s_waitcnt vmcnt(20)
v_mfma_f32_16x16x32_bf16 v[160:163], v[48:51], a[32:35], v[160:163]
buffer_load_dwordx4 a[16:19], v4, s[20:23], s75 offen offset:2048 sc1
v_add_u32 v27, s84, v13
v_mfma_f32_16x16x32_bf16 v[164:167], v[48:51], a[36:39], v[164:167]
v_mfma_f32_16x16x32_bf16 v[168:171], v[48:51], a[40:43], v[168:171]
v_mfma_f32_16x16x32_bf16 v[172:175], v[48:51], a[44:47], v[172:175]
s_waitcnt vmcnt(20)
v_mfma_f32_16x16x32_bf16 v[64:67], v[52:55], a[48:51], v[64:67]
s_mul_i32 s75, s72, 114688
s_add_u32 s75, s75, s74
v_mfma_f32_16x16x32_bf16 v[68:71], v[52:55], a[52:55], v[68:71]
buffer_load_dwordx4 a[20:23], v1, s[20:23], s75 offen offset:0 sc1
v_mfma_f32_16x16x32_bf16 v[72:75], v[52:55], a[56:59], v[72:75]
v_mfma_f32_16x16x32_bf16 v[76:79], v[52:55], a[60:63], v[76:79]
s_waitcnt vmcnt(20)
v_mfma_f32_16x16x32_bf16 v[80:83], v[56:59], a[48:51], v[80:83]
buffer_load_dwordx4 a[24:27], v1, s[20:23], s75 offen offset:1024 sc1
v_mfma_f32_16x16x32_bf16 v[84:87], v[56:59], a[52:55], v[84:87]
v_mfma_f32_16x16x32_bf16 v[88:91], v[56:59], a[56:59], v[88:91]
v_mfma_f32_16x16x32_bf16 v[92:95], v[56:59], a[60:63], v[92:95]
s_waitcnt vmcnt(20)
v_mfma_f32_16x16x32_bf16 v[96:99], a[192:195], a[48:51], v[96:99]
buffer_load_dwordx4 a[28:31], v1, s[20:23], s75 offen offset:2048 sc1
v_mfma_f32_16x16x32_bf16 v[100:103], a[192:195], a[52:55], v[100:103]
v_mfma_f32_16x16x32_bf16 v[104:107], a[192:195], a[56:59], v[104:107]
v_mfma_f32_16x16x32_bf16 v[108:111], a[192:195], a[60:63], v[108:111]
s_waitcnt vmcnt(20)
v_mfma_f32_16x16x32_bf16 v[112:115], a[196:199], a[48:51], v[112:115]
buffer_load_dwordx4 a[248:251], v1, s[20:23], s75 offen offset:3072 sc1
s_lshr_b32 s84, s70, 1
v_mfma_f32_16x16x32_bf16 v[116:119], a[196:199], a[52:55], v[116:119]
s_lshl_b32 s84, s84, 10
s_add_u32 s84, s84, 0x8000
v_mfma_f32_16x16x32_bf16 v[120:123], a[196:199], a[56:59], v[120:123]
buffer_load_dwordx4 v[180:183], v5, s[20:23], s84 offen sc1
v_mfma_f32_16x16x32_bf16 v[124:127], a[196:199], a[60:63], v[124:127]
s_waitcnt vmcnt(21)
v_mfma_f32_16x16x32_bf16 v[128:131], a[200:203], a[48:51], v[128:131]
buffer_load_dwordx4 a[252:255], v4, s[20:23], s75 offen offset:0 sc1
s_lshr_b32 s85, s70, 1
s_lshl_b32 s85, s85, 2
v_mfma_f32_16x16x32_bf16 v[132:135], a[200:203], a[52:55], v[132:135]
s_add_u32 s85, s85, s44
s_lshl_b32 s85, s85, 8
s_add_u32 s85, s85, 0xc000
v_mfma_f32_16x16x32_bf16 v[136:139], a[200:203], a[56:59], v[136:139]
buffer_load_dwordx4 v[8:11], v6, s[20:23], s85 offen sc1
v_mfma_f32_16x16x32_bf16 v[140:143], a[200:203], a[60:63], v[140:143]
s_waitcnt vmcnt(22)
v_mfma_f32_16x16x32_bf16 v[144:147], a[204:207], a[48:51], v[144:147]
buffer_load_dwordx4 a[32:35], v4, s[20:23], s75 offen offset:1024 sc1
v_mfma_f32_16x16x32_bf16 v[148:151], a[204:207], a[52:55], v[148:151]
v_mfma_f32_16x16x32_bf16 v[152:155], a[204:207], a[56:59], v[152:155]
v_mfma_f32_16x16x32_bf16 v[156:159], a[204:207], a[60:63], v[156:159]
s_waitcnt vmcnt(22)
v_mfma_f32_16x16x32_bf16 v[160:163], a[208:211], a[48:51], v[160:163]
buffer_load_dwordx4 a[36:39], v4, s[20:23], s75 offen offset:2048 sc1
v_mfma_f32_16x16x32_bf16 v[164:167], a[208:211], a[52:55], v[164:167]
v_mfma_f32_16x16x32_bf16 v[168:171], a[208:211], a[56:59], v[168:171]
v_mfma_f32_16x16x32_bf16 v[172:175], a[208:211], a[60:63], v[172:175]
s_waitcnt vmcnt(22)
v_mfma_f32_16x16x32_bf16 v[64:67], a[212:215], a[64:67], v[64:67]
s_add_u32 s75, s75, 57344
s_add_u32 s72, s72, 1
v_mfma_f32_16x16x32_bf16 v[68:71], a[212:215], a[68:71], v[68:71]
s_and_b32 s72, s72, 7
buffer_load_dwordx4 a[40:43], v1, s[20:23], s75 offen offset:0 sc1
v_mfma_f32_16x16x32_bf16 v[72:75], a[212:215], a[72:75], v[72:75]
v_mfma_f32_16x16x32_bf16 v[76:79], a[212:215], a[76:79], v[76:79]
s_waitcnt vmcnt(22)
v_mfma_f32_16x16x32_bf16 v[80:83], a[216:219], a[64:67], v[80:83]
buffer_load_dwordx4 a[44:47], v1, s[20:23], s75 offen offset:1024 sc1
v_mfma_f32_16x16x32_bf16 v[84:87], a[216:219], a[68:71], v[84:87]
v_mfma_f32_16x16x32_bf16 v[88:91], a[216:219], a[72:75], v[88:91]
v_mfma_f32_16x16x32_bf16 v[92:95], a[216:219], a[76:79], v[92:95]
s_waitcnt vmcnt(22)
v_mfma_f32_16x16x32_bf16 v[96:99], a[0:3], a[64:67], v[96:99]
buffer_load_dwordx4 a[192:195], v1, s[20:23], s75 offen offset:2048 sc1
v_mfma_f32_16x16x32_bf16 v[100:103], a[0:3], a[68:71], v[100:103]
v_mfma_f32_16x16x32_bf16 v[104:107], a[0:3], a[72:75], v[104:107]
v_mfma_f32_16x16x32_bf16 v[108:111], a[0:3], a[76:79], v[108:111]
s_waitcnt vmcnt(22)
v_mfma_f32_16x16x32_bf16 v[112:115], a[4:7], a[64:67], v[112:115]
buffer_load_dwordx4 a[196:199], v1, s[20:23], s75 offen offset:3072 sc1
v_mfma_f32_16x16x32_bf16 v[116:119], a[4:7], a[68:71], v[116:119]
v_mfma_f32_16x16x32_bf16 v[120:123], a[4:7], a[72:75], v[120:123]
v_mfma_f32_16x16x32_bf16 v[124:127], a[4:7], a[76:79], v[124:127]
s_waitcnt vmcnt(22)
v_mfma_f32_16x16x32_bf16 v[128:131], a[8:11], a[64:67], v[128:131]
buffer_load_dwordx4 a[200:203], v4, s[20:23], s75 offen offset:0 sc1
v_mfma_f32_16x16x32_bf16 v[132:135], a[8:11], a[68:71], v[132:135]
v_mfma_f32_16x16x32_bf16 v[136:139], a[8:11], a[72:75], v[136:139]
v_mfma_f32_16x16x32_bf16 v[140:143], a[8:11], a[76:79], v[140:143]
s_waitcnt vmcnt(22)
v_mfma_f32_16x16x32_bf16 v[144:147], a[12:15], a[64:67], v[144:147]
buffer_load_dwordx4 a[204:207], v4, s[20:23], s75 offen offset:1024 sc1
v_mfma_f32_16x16x32_bf16 v[148:151], a[12:15], a[68:71], v[148:151]
v_mfma_f32_16x16x32_bf16 v[152:155], a[12:15], a[72:75], v[152:155]
v_mfma_f32_16x16x32_bf16 v[156:159], a[12:15], a[76:79], v[156:159]
s_waitcnt vmcnt(22)
v_mfma_f32_16x16x32_bf16 v[160:163], a[220:223], a[64:67], v[160:163]
buffer_load_dwordx4 a[208:211], v4, s[20:23], s75 offen offset:2048 sc1
v_mfma_f32_16x16x32_bf16 v[164:167], a[220:223], a[68:71], v[164:167]
v_mfma_f32_16x16x32_bf16 v[168:171], a[220:223], a[72:75], v[168:171]
v_mfma_f32_16x16x32_bf16 v[172:175], a[220:223], a[76:79], v[172:175]
s_waitcnt vmcnt(22)
v_mfma_f32_16x16x32_bf16 v[64:67], a[224:227], a[80:83], v[64:67]
s_mul_i32 s75, s72, 114688
s_add_u32 s75, s75, s74
v_mfma_f32_16x16x32_bf16 v[68:71], a[224:227], a[84:87], v[68:71]
buffer_load_dwordx4 a[48:51], v1, s[20:23], s75 offen offset:0 sc1
v_mfma_f32_16x16x32_bf16 v[72:75], a[224:227], a[88:91], v[72:75]
v_mfma_f32_16x16x32_bf16 v[76:79], a[224:227], a[92:95], v[76:79]
s_waitcnt vmcnt(22)
v_mfma_f32_16x16x32_bf16 v[80:83], a[228:231], a[80:83], v[80:83]
buffer_load_dwordx4 a[52:55], v1, s[20:23], s75 offen offset:1024 sc1
s_waitcnt vmcnt(13)
v_xor_b32 v13, v180, v28
v_mfma_f32_16x16x32_bf16 v[84:87], a[228:231], a[84:87], v[84:87]
v_xor_b32 v181, v181, v28
v_xor_b32 v182, v182, v28
v_mfma_f32_16x16x32_bf16 v[88:91], a[228:231], a[88:91], v[88:91]
v_xor_b32 v183, v183, v28
v_or3_b32 v13, v13, v181, v182
v_mfma_f32_16x16x32_bf16 v[92:95], a[228:231], a[92:95], v[92:95]
v_or_b32 v13, v13, v183
v_mfma_f32_16x16x32_bf16 v[96:99], a[232:235], a[80:83], v[96:99]
buffer_load_dwordx4 a[56:59], v1, s[20:23], s75 offen offset:2048 sc1
v_cmp_ne_u32 vcc, 0, v13
v_mfma_f32_16x16x32_bf16 v[100:103], a[232:235], a[84:87], v[100:103]
s_nop 0
s_cbranch_vccnz L_pslow_20
L_pret_21:
v_mfma_f32_16x16x32_bf16 v[104:107], a[232:235], a[88:91], v[104:107]
s_mul_i32 s96, s78, 28
s_mul_i32 s84, s71, 7
s_lshr_b32 s84, s84, 1
v_mfma_f32_16x16x32_bf16 v[108:111], a[232:235], a[92:95], v[108:111]
s_add_u32 s96, s96, s84
s_lshl_b32 s96, s96, 10
v_mfma_f32_16x16x32_bf16 v[112:115], a[236:239], a[80:83], v[112:115]
buffer_load_dwordx4 a[60:63], v1, s[20:23], s75 offen offset:3072 sc1
s_add_u32 s0, s96, 0x500000
s_waitcnt vmcnt(13)
v_xor_b32 v191, v8, v28
v_mfma_f32_16x16x32_bf16 v[116:119], a[236:239], a[84:87], v[116:119]
s_bitcmp1_b32 s71, 0
s_cbranch_scc1 L_zodd_22
buffer_load_dwordx4 v[176:179], v1, s[20:23], s0 offen offset:0 sc1
buffer_load_dwordx4 v[180:183], v1, s[20:23], s0 offen offset:1024 sc1
buffer_load_dwordx4 v[184:187], v1, s[20:23], s0 offen offset:2048 sc1
buffer_load_dwordx2 v[188:189], v1, s[20:23], s0 offen offset:3072 sc1
s_branch L_zend_23
L_zodd_22:
buffer_load_dwordx2 v[176:177], v1, s[20:23], s0 offen offset:8 sc1
buffer_load_dwordx4 v[178:181], v1, s[20:23], s0 offen offset:1024 sc1
buffer_load_dwordx4 v[182:185], v1, s[20:23], s0 offen offset:2048 sc1
buffer_load_dwordx4 v[186:189], v1, s[20:23], s0 offen offset:3072 sc1
L_zend_23:
v_mfma_f32_16x16x32_bf16 v[120:123], a[236:239], a[88:91], v[120:123]
v_xor_b32 v9, v9, v28
v_xor_b32 v10, v10, v28
v_xor_b32 v11, v11, v28
v_mfma_f32_16x16x32_bf16 v[124:127], a[236:239], a[92:95], v[124:127]
v_or3_b32 v191, v191, v9, v10
v_or_b32 v191, v191, v11
v_mfma_f32_16x16x32_bf16 v[128:131], a[240:243], a[80:83], v[128:131]
buffer_load_dwordx4 a[212:215], v4, s[20:23], s75 offen offset:0 sc1
v_cmp_ne_u32 vcc, 0, v191
v_mfma_f32_16x16x32_bf16 v[132:135], a[240:243], a[84:87], v[132:135]
s_nop 0
s_cbranch_vccnz L_pslow_24
L_pret_25:
v_mfma_f32_16x16x32_bf16 v[136:139], a[240:243], a[88:91], v[136:139]
v_mfma_f32_16x16x32_bf16 v[140:143], a[240:243], a[92:95], v[140:143]
v_mfma_f32_16x16x32_bf16 v[144:147], a[244:247], a[80:83], v[144:147]
buffer_load_dwordx4 a[216:219], v4, s[20:23], s75 offen offset:1024 sc1
v_mfma_f32_16x16x32_bf16 v[148:151], a[244:247], a[84:87], v[148:151]
v_mfma_f32_16x16x32_bf16 v[152:155], a[244:247], a[88:91], v[152:155]
v_mfma_f32_16x16x32_bf16 v[156:159], a[244:247], a[92:95], v[156:159]
v_mfma_f32_16x16x32_bf16 v[160:163], a[16:19], a[80:83], v[160:163]
buffer_load_dwordx4 a[0:3], v4, s[20:23], s75 offen offset:2048 sc1
v_mfma_f32_16x16x32_bf16 v[164:167], a[16:19], a[84:87], v[164:167]
v_mfma_f32_16x16x32_bf16 v[168:171], a[16:19], a[88:91], v[168:171]
v_mfma_f32_16x16x32_bf16 v[172:175], a[16:19], a[92:95], v[172:175]
v_mfma_f32_16x16x32_bf16 v[64:67], a[20:23], a[96:99], v[64:67]
s_add_u32 s75, s75, 57344
s_add_u32 s72, s72, 1
v_mfma_f32_16x16x32_bf16 v[68:71], a[20:23], a[100:103], v[68:71]
s_and_b32 s72, s72, 7
buffer_load_dwordx4 a[4:7], v1, s[20:23], s75 offen offset:0 sc1
v_mfma_f32_16x16x32_bf16 v[72:75], a[20:23], a[104:107], v[72:75]
v_mfma_f32_16x16x32_bf16 v[76:79], a[20:23], a[108:111], v[76:79]
v_mfma_f32_16x16x32_bf16 v[80:83], a[24:27], a[96:99], v[80:83]
buffer_load_dwordx4 a[8:11], v1, s[20:23], s75 offen offset:1024 sc1
v_mfma_f32_16x16x32_bf16 v[84:87], a[24:27], a[100:103], v[84:87]
v_mfma_f32_16x16x32_bf16 v[88:91], a[24:27], a[104:107], v[88:91]
v_mfma_f32_16x16x32_bf16 v[92:95], a[24:27], a[108:111], v[92:95]
v_mfma_f32_16x16x32_bf16 v[96:99], a[28:31], a[96:99], v[96:99]
buffer_load_dwordx4 a[12:15], v1, s[20:23], s75 offen offset:2048 sc1
v_mfma_f32_16x16x32_bf16 v[100:103], a[28:31], a[100:103], v[100:103]
v_mfma_f32_16x16x32_bf16 v[104:107], a[28:31], a[104:107], v[104:107]
v_mfma_f32_16x16x32_bf16 v[108:111], a[28:31], a[108:111], v[108:111]
v_mfma_f32_16x16x32_bf16 v[112:115], a[248:251], a[96:99], v[112:115]
buffer_load_dwordx4 a[220:223], v1, s[20:23], s75 offen offset:3072 sc1
v_mfma_f32_16x16x32_bf16 v[116:119], a[248:251], a[100:103], v[116:119]
v_mfma_f32_16x16x32_bf16 v[120:123], a[248:251], a[104:107], v[120:123]
v_mfma_f32_16x16x32_bf16 v[124:127], a[248:251], a[108:111], v[124:127]
s_waitcnt vmcnt(7)
v_mfma_f32_16x16x32_bf16 v[128:131], a[252:255], a[96:99], v[128:131]
buffer_load_dwordx4 a[224:227], v4, s[20:23], s75 offen offset:0 sc1
v_lshlrev_b32 v32, 16, v176
v_mfma_f32_16x16x32_bf16 v[132:135], a[252:255], a[100:103], v[132:135]
v_and_b32 v33, 0xffff0000, v176
v_mul_f32 v13, v32, v32
v_mfma_f32_16x16x32_bf16 v[136:139], a[252:255], a[104:107], v[136:139]
v_mul_f32 v14, v33, v33
v_fma_f32 v13, v13, s90, v17
v_mfma_f32_16x16x32_bf16 v[140:143], a[252:255], a[108:111], v[140:143]
v_fma_f32 v14, v14, s90, v17
v_mfma_f32_16x16x32_bf16 v[144:147], a[32:35], a[96:99], v[144:147]
buffer_load_dwordx4 a[228:231], v4, s[20:23], s75 offen offset:1024 sc1
v_mul_f32 v13, v13, v32
v_mfma_f32_16x16x32_bf16 v[148:151], a[32:35], a[100:103], v[148:151]
v_mul_f32 v14, v14, v33
v_mfma_f32_16x16x32_bf16 v[152:155], a[32:35], a[104:107], v[152:155]
v_exp_f32 v13, v13
v_mfma_f32_16x16x32_bf16 v[156:159], a[32:35], a[108:111], v[156:159]
v_exp_f32 v14, v14
v_mfma_f32_16x16x32_bf16 v[160:163], a[36:39], a[96:99], v[160:163]
buffer_load_dwordx4 a[232:235], v4, s[20:23], s75 offen offset:2048 sc1
v_add_f32 v13, 1.0, v13
v_mfma_f32_16x16x32_bf16 v[164:167], a[36:39], a[100:103], v[164:167]
v_add_f32 v14, 1.0, v14
v_rcp_f32 v13, v13
v_mfma_f32_16x16x32_bf16 v[168:171], a[36:39], a[104:107], v[168:171]
v_rcp_f32 v14, v14
v_mfma_f32_16x16x32_bf16 v[172:175], a[36:39], a[108:111], v[172:175]
v_mul_f32 v32, v32, v13
v_mfma_f32_16x16x32_bf16 v[64:67], a[40:43], a[112:115], v[64:67]
s_mul_i32 s75, s72, 114688
s_add_u32 s75, s75, s74
v_mfma_f32_16x16x32_bf16 v[68:71], a[40:43], a[116:119], v[68:71]
buffer_load_dwordx4 a[236:239], v1, s[20:23], s75 offen offset:0 sc1
v_mul_f32 v33, v33, v14
v_mfma_f32_16x16x32_bf16 v[72:75], a[40:43], a[120:123], v[72:75]
v_lshlrev_b32 v34, 16, v177
v_and_b32 v35, 0xffff0000, v177
v_mfma_f32_16x16x32_bf16 v[76:79], a[40:43], a[124:127], v[76:79]
v_mul_f32 v15, v34, v34
v_mfma_f32_16x16x32_bf16 v[80:83], a[44:47], a[112:115], v[80:83]
buffer_load_dwordx4 a[240:243], v1, s[20:23], s75 offen offset:1024 sc1
v_mul_f32 v16, v35, v35
v_mfma_f32_16x16x32_bf16 v[84:87], a[44:47], a[116:119], v[84:87]
v_fma_f32 v15, v15, s90, v17
v_mfma_f32_16x16x32_bf16 v[88:91], a[44:47], a[120:123], v[88:91]
v_fma_f32 v16, v16, s90, v17
v_mul_f32 v15, v15, v34
v_mfma_f32_16x16x32_bf16 v[92:95], a[44:47], a[124:127], v[92:95]
v_mul_f32 v16, v16, v35
v_mfma_f32_16x16x32_bf16 v[96:99], a[192:195], a[112:115], v[96:99]
buffer_load_dwordx4 a[244:247], v1, s[20:23], s75 offen offset:2048 sc1
v_exp_f32 v15, v15
v_mfma_f32_16x16x32_bf16 v[100:103], a[192:195], a[116:119], v[100:103]
v_exp_f32 v16, v16
v_mfma_f32_16x16x32_bf16 v[104:107], a[192:195], a[120:123], v[104:107]
v_add_f32 v15, 1.0, v15
v_add_f32 v16, 1.0, v16
v_mfma_f32_16x16x32_bf16 v[108:111], a[192:195], a[124:127], v[108:111]
v_rcp_f32 v15, v15
v_mfma_f32_16x16x32_bf16 v[112:115], a[196:199], a[112:115], v[112:115]
buffer_load_dwordx4 a[16:19], v1, s[20:23], s75 offen offset:3072 sc1
v_rcp_f32 v16, v16
v_mfma_f32_16x16x32_bf16 v[116:119], a[196:199], a[116:119], v[116:119]
v_mul_f32 v34, v34, v15
v_mfma_f32_16x16x32_bf16 v[120:123], a[196:199], a[120:123], v[120:123]
v_mul_f32 v35, v35, v16
v_lshlrev_b32 v36, 16, v178
v_mfma_f32_16x16x32_bf16 v[124:127], a[196:199], a[124:127], v[124:127]
v_and_b32 v37, 0xffff0000, v178
v_mfma_f32_16x16x32_bf16 v[128:131], a[200:203], a[112:115], v[128:131]
buffer_load_dwordx4 a[20:23], v4, s[20:23], s75 offen offset:0 sc1
v_mul_f32 v13, v36, v36
v_mfma_f32_16x16x32_bf16 v[132:135], a[200:203], a[116:119], v[132:135]
v_mul_f32 v14, v37, v37
v_mfma_f32_16x16x32_bf16 v[136:139], a[200:203], a[120:123], v[136:139]
v_fma_f32 v13, v13, s90, v17
v_fma_f32 v14, v14, s90, v17
v_mfma_f32_16x16x32_bf16 v[140:143], a[200:203], a[124:127], v[140:143]
v_mul_f32 v13, v13, v36
v_mfma_f32_16x16x32_bf16 v[144:147], a[204:207], a[112:115], v[144:147]
buffer_load_dwordx4 a[24:27], v4, s[20:23], s75 offen offset:1024 sc1
v_mul_f32 v14, v14, v37
v_mfma_f32_16x16x32_bf16 v[148:151], a[204:207], a[116:119], v[148:151]
v_exp_f32 v13, v13
v_mfma_f32_16x16x32_bf16 v[152:155], a[204:207], a[120:123], v[152:155]
v_exp_f32 v14, v14
v_mfma_f32_16x16x32_bf16 v[156:159], a[204:207], a[124:127], v[156:159]
v_add_f32 v13, 1.0, v13
v_mfma_f32_16x16x32_bf16 v[160:163], a[208:211], a[112:115], v[160:163]
buffer_load_dwordx4 a[28:31], v4, s[20:23], s75 offen offset:2048 sc1
v_add_f32 v14, 1.0, v14
v_mfma_f32_16x16x32_bf16 v[164:167], a[208:211], a[116:119], v[164:167]
v_rcp_f32 v13, v13
v_mfma_f32_16x16x32_bf16 v[168:171], a[208:211], a[120:123], v[168:171]
v_rcp_f32 v14, v14
v_mfma_f32_16x16x32_bf16 v[172:175], a[208:211], a[124:127], v[172:175]
v_mul_f32 v36, v36, v13
v_mfma_f32_16x16x32_bf16 v[64:67], a[48:51], v[192:195], v[64:67]
s_add_u32 s75, s75, 57344
s_add_u32 s72, s72, 1
v_mfma_f32_16x16x32_bf16 v[68:71], a[48:51], v[196:199], v[68:71]
s_and_b32 s72, s72, 7
buffer_load_dwordx4 a[248:251], v1, s[20:23], s75 offen offset:0 sc1
v_mfma_f32_16x16x32_bf16 v[72:75], a[48:51], v[200:203], v[72:75]
v_mul_f32 v37, v37, v14
v_mfma_f32_16x16x32_bf16 v[76:79], a[48:51], v[204:207], v[76:79]
v_lshlrev_b32 v38, 16, v179
v_mfma_f32_16x16x32_bf16 v[80:83], a[52:55], v[192:195], v[80:83]
buffer_load_dwordx4 a[252:255], v1, s[20:23], s75 offen offset:1024 sc1
v_and_b32 v39, 0xffff0000, v179
v_mfma_f32_16x16x32_bf16 v[84:87], a[52:55], v[196:199], v[84:87]
v_mul_f32 v15, v38, v38
v_mfma_f32_16x16x32_bf16 v[88:91], a[52:55], v[200:203], v[88:91]
v_mul_f32 v16, v39, v39
v_fma_f32 v15, v15, s90, v17
v_mfma_f32_16x16x32_bf16 v[92:95], a[52:55], v[204:207], v[92:95]
v_fma_f32 v16, v16, s90, v17
v_mfma_f32_16x16x32_bf16 v[96:99], a[56:59], v[192:195], v[96:99]
buffer_load_dwordx4 a[32:35], v1, s[20:23], s75 offen offset:2048 sc1
v_mul_f32 v15, v15, v38
v_mfma_f32_16x16x32_bf16 v[100:103], a[56:59], v[196:199], v[100:103]
v_mul_f32 v16, v16, v39
v_mfma_f32_16x16x32_bf16 v[104:107], a[56:59], v[200:203], v[104:107]
v_exp_f32 v15, v15
v_mfma_f32_16x16x32_bf16 v[108:111], a[56:59], v[204:207], v[108:111]
v_exp_f32 v16, v16
v_mfma_f32_16x16x32_bf16 v[112:115], a[60:63], v[192:195], v[112:115]
buffer_load_dwordx4 a[36:39], v1, s[20:23], s75 offen offset:3072 sc1
v_add_f32 v15, 1.0, v15
v_mfma_f32_16x16x32_bf16 v[116:119], a[60:63], v[196:199], v[116:119]
v_add_f32 v16, 1.0, v16
v_mfma_f32_16x16x32_bf16 v[120:123], a[60:63], v[200:203], v[120:123]
v_rcp_f32 v15, v15
v_mfma_f32_16x16x32_bf16 v[124:127], a[60:63], v[204:207], v[124:127]
v_rcp_f32 v16, v16
s_waitcnt vmcnt(20)
v_mfma_f32_16x16x32_bf16 v[128:131], a[212:215], v[192:195], v[128:131]
buffer_load_dwordx4 a[40:43], v4, s[20:23], s75 offen offset:0 sc1
v_mul_f32 v38, v38, v15
v_mfma_f32_16x16x32_bf16 v[132:135], a[212:215], v[196:199], v[132:135]
v_mul_f32 v39, v39, v16
v_lshlrev_b32 v40, 16, v180
v_mfma_f32_16x16x32_bf16 v[136:139], a[212:215], v[200:203], v[136:139]
v_and_b32 v41, 0xffff0000, v180
v_mfma_f32_16x16x32_bf16 v[140:143], a[212:215], v[204:207], v[140:143]
v_mul_f32 v13, v40, v40
s_waitcnt vmcnt(20)
v_mfma_f32_16x16x32_bf16 v[144:147], a[216:219], v[192:195], v[144:147]
buffer_load_dwordx4 a[44:47], v4, s[20:23], s75 offen offset:1024 sc1
v_mul_f32 v14, v41, v41
v_mfma_f32_16x16x32_bf16 v[148:151], a[216:219], v[196:199], v[148:151]
v_fma_f32 v13, v13, s90, v17
v_fma_f32 v14, v14, s90, v17
v_mfma_f32_16x16x32_bf16 v[152:155], a[216:219], v[200:203], v[152:155]
v_mul_f32 v13, v13, v40
v_mfma_f32_16x16x32_bf16 v[156:159], a[216:219], v[204:207], v[156:159]
v_mul_f32 v14, v14, v41
s_waitcnt vmcnt(20)
v_mfma_f32_16x16x32_bf16 v[160:163], a[0:3], v[192:195], v[160:163]
buffer_load_dwordx4 a[192:195], v4, s[20:23], s75 offen offset:2048 sc1
v_exp_f32 v13, v13
v_mfma_f32_16x16x32_bf16 v[164:167], a[0:3], v[196:199], v[164:167]
v_exp_f32 v14, v14
v_mfma_f32_16x16x32_bf16 v[168:171], a[0:3], v[200:203], v[168:171]
v_add_f32 v13, 1.0, v13
v_mfma_f32_16x16x32_bf16 v[172:175], a[0:3], v[204:207], v[172:175]
v_add_f32 v14, 1.0, v14
s_waitcnt vmcnt(20)
v_mfma_f32_16x16x32_bf16 v[64:67], a[4:7], v[208:211], v[64:67]
s_mul_i32 s75, s72, 114688
s_add_u32 s75, s75, s74
v_mfma_f32_16x16x32_bf16 v[68:71], a[4:7], v[212:215], v[68:71]
buffer_load_dwordx4 a[196:199], v1, s[20:23], s75 offen offset:0 sc1
v_rcp_f32 v13, v13
v_mfma_f32_16x16x32_bf16 v[72:75], a[4:7], v[216:219], v[72:75]
v_rcp_f32 v14, v14
v_mfma_f32_16x16x32_bf16 v[76:79], a[4:7], v[220:223], v[76:79]
v_mul_f32 v40, v40, v13
s_waitcnt vmcnt(20)
v_mfma_f32_16x16x32_bf16 v[80:83], a[8:11], v[208:211], v[80:83]
buffer_load_dwordx4 a[200:203], v1, s[20:23], s75 offen offset:1024 sc1
v_mul_f32 v41, v41, v14
v_mfma_f32_16x16x32_bf16 v[84:87], a[8:11], v[212:215], v[84:87]
v_lshlrev_b32 v42, 16, v181
v_mfma_f32_16x16x32_bf16 v[88:91], a[8:11], v[216:219], v[88:91]
v_and_b32 v43, 0xffff0000, v181
v_mul_f32 v15, v42, v42
v_mfma_f32_16x16x32_bf16 v[92:95], a[8:11], v[220:223], v[92:95]
v_mul_f32 v16, v43, v43
s_waitcnt vmcnt(20)
v_mfma_f32_16x16x32_bf16 v[96:99], a[12:15], v[208:211], v[96:99]
buffer_load_dwordx4 a[204:207], v1, s[20:23], s75 offen offset:2048 sc1
v_fma_f32 v15, v15, s90, v17
v_mfma_f32_16x16x32_bf16 v[100:103], a[12:15], v[212:215], v[100:103]
v_fma_f32 v16, v16, s90, v17
v_mfma_f32_16x16x32_bf16 v[104:107], a[12:15], v[216:219], v[104:107]
v_mul_f32 v15, v15, v42
v_mul_f32 v16, v16, v43
v_mfma_f32_16x16x32_bf16 v[108:111], a[12:15], v[220:223], v[108:111]
v_exp_f32 v15, v15
s_waitcnt vmcnt(20)
v_mfma_f32_16x16x32_bf16 v[112:115], a[220:223], v[208:211], v[112:115]
buffer_load_dwordx4 a[208:211], v1, s[20:23], s75 offen offset:3072 sc1
v_exp_f32 v16, v16
v_mfma_f32_16x16x32_bf16 v[116:119], a[220:223], v[212:215], v[116:119]
v_add_f32 v15, 1.0, v15
v_mfma_f32_16x16x32_bf16 v[120:123], a[220:223], v[216:219], v[120:123]
v_add_f32 v16, 1.0, v16
v_rcp_f32 v15, v15
v_mfma_f32_16x16x32_bf16 v[124:127], a[220:223], v[220:223], v[124:127]
v_rcp_f32 v16, v16
s_waitcnt vmcnt(20)
v_mfma_f32_16x16x32_bf16 v[128:131], a[224:227], v[208:211], v[128:131]
buffer_load_dwordx4 a[48:51], v4, s[20:23], s75 offen offset:0 sc1
v_mul_f32 v42, v42, v15
v_mfma_f32_16x16x32_bf16 v[132:135], a[224:227], v[212:215], v[132:135]
v_mul_f32 v43, v43, v16
v_mfma_f32_16x16x32_bf16 v[136:139], a[224:227], v[216:219], v[136:139]
v_lshlrev_b32 v44, 16, v182
v_and_b32 v45, 0xffff0000, v182
v_mfma_f32_16x16x32_bf16 v[140:143], a[224:227], v[220:223], v[140:143]
v_mul_f32 v13, v44, v44
s_waitcnt vmcnt(20)
v_mfma_f32_16x16x32_bf16 v[144:147], a[228:231], v[208:211], v[144:147]
buffer_load_dwordx4 a[52:55], v4, s[20:23], s75 offen offset:1024 sc1
v_mul_f32 v14, v45, v45
v_mfma_f32_16x16x32_bf16 v[148:151], a[228:231], v[212:215], v[148:151]
v_fma_f32 v13, v13, s90, v17
v_mfma_f32_16x16x32_bf16 v[152:155], a[228:231], v[216:219], v[152:155]
v_fma_f32 v14, v14, s90, v17
v_mul_f32 v13, v13, v44
v_mfma_f32_16x16x32_bf16 v[156:159], a[228:231], v[220:223], v[156:159]
v_mul_f32 v14, v14, v45
s_waitcnt vmcnt(20)
v_mfma_f32_16x16x32_bf16 v[160:163], a[232:235], v[208:211], v[160:163]
buffer_load_dwordx4 a[56:59], v4, s[20:23], s75 offen offset:2048 sc1
v_exp_f32 v13, v13
v_mfma_f32_16x16x32_bf16 v[164:167], a[232:235], v[212:215], v[164:167]
v_exp_f32 v14, v14
v_mfma_f32_16x16x32_bf16 v[168:171], a[232:235], v[216:219], v[168:171]
v_add_f32 v13, 1.0, v13
v_add_f32 v14, 1.0, v14
v_mfma_f32_16x16x32_bf16 v[172:175], a[232:235], v[220:223], v[172:175]
v_rcp_f32 v13, v13
s_waitcnt vmcnt(20)
v_mfma_f32_16x16x32_bf16 v[64:67], a[236:239], v[224:227], v[64:67]
s_add_u32 s75, s75, 57344
s_add_u32 s72, s72, 1
v_mfma_f32_16x16x32_bf16 v[68:71], a[236:239], v[228:231], v[68:71]
s_and_b32 s72, s72, 7
buffer_load_dwordx4 a[60:63], v1, s[20:23], s75 offen offset:0 sc1
v_mfma_f32_16x16x32_bf16 v[72:75], a[236:239], v[232:235], v[72:75]
v_rcp_f32 v14, v14
v_mfma_f32_16x16x32_bf16 v[76:79], a[236:239], v[236:239], v[76:79]
v_mul_f32 v44, v44, v13
s_waitcnt vmcnt(20)
v_mfma_f32_16x16x32_bf16 v[80:83], a[240:243], v[224:227], v[80:83]
buffer_load_dwordx4 a[212:215], v1, s[20:23], s75 offen offset:1024 sc1
v_mul_f32 v45, v45, v14
v_mfma_f32_16x16x32_bf16 v[84:87], a[240:243], v[228:231], v[84:87]
v_lshlrev_b32 v46, 16, v183
v_mfma_f32_16x16x32_bf16 v[88:91], a[240:243], v[232:235], v[88:91]
v_and_b32 v47, 0xffff0000, v183
v_mul_f32 v15, v46, v46
v_mfma_f32_16x16x32_bf16 v[92:95], a[240:243], v[236:239], v[92:95]
v_mul_f32 v16, v47, v47
s_waitcnt vmcnt(20)
v_mfma_f32_16x16x32_bf16 v[96:99], a[244:247], v[224:227], v[96:99]
buffer_load_dwordx4 a[216:219], v1, s[20:23], s75 offen offset:2048 sc1
v_fma_f32 v15, v15, s90, v17
v_mfma_f32_16x16x32_bf16 v[100:103], a[244:247], v[228:231], v[100:103]
v_fma_f32 v16, v16, s90, v17
v_mfma_f32_16x16x32_bf16 v[104:107], a[244:247], v[232:235], v[104:107]
v_mul_f32 v15, v15, v46
v_mul_f32 v16, v16, v47
v_mfma_f32_16x16x32_bf16 v[108:111], a[244:247], v[236:239], v[108:111]
v_exp_f32 v15, v15
s_waitcnt vmcnt(20)
v_mfma_f32_16x16x32_bf16 v[112:115], a[16:19], v[224:227], v[112:115]
buffer_load_dwordx4 a[0:3], v1, s[20:23], s75 offen offset:3072 sc1
v_exp_f32 v16, v16
v_mfma_f32_16x16x32_bf16 v[116:119], a[16:19], v[228:231], v[116:119]
v_add_f32 v15, 1.0, v15
v_mfma_f32_16x16x32_bf16 v[120:123], a[16:19], v[232:235], v[120:123]
v_add_f32 v16, 1.0, v16
v_rcp_f32 v15, v15
v_mfma_f32_16x16x32_bf16 v[124:127], a[16:19], v[236:239], v[124:127]
v_rcp_f32 v16, v16
s_waitcnt vmcnt(20)
v_mfma_f32_16x16x32_bf16 v[128:131], a[20:23], v[224:227], v[128:131]
buffer_load_dwordx4 a[4:7], v4, s[20:23], s75 offen offset:0 sc1
v_mul_f32 v46, v46, v15
v_mfma_f32_16x16x32_bf16 v[132:135], a[20:23], v[228:231], v[132:135]
v_mul_f32 v47, v47, v16
v_mfma_f32_16x16x32_bf16 v[136:139], a[20:23], v[232:235], v[136:139]
v_lshlrev_b32 v48, 16, v184
v_and_b32 v49, 0xffff0000, v184
v_mfma_f32_16x16x32_bf16 v[140:143], a[20:23], v[236:239], v[140:143]
v_mul_f32 v13, v48, v48
s_waitcnt vmcnt(20)
v_mfma_f32_16x16x32_bf16 v[144:147], a[24:27], v[224:227], v[144:147]
buffer_load_dwordx4 a[8:11], v4, s[20:23], s75 offen offset:1024 sc1
v_mul_f32 v14, v49, v49
v_mfma_f32_16x16x32_bf16 v[148:151], a[24:27], v[228:231], v[148:151]
v_fma_f32 v13, v13, s90, v17
v_mfma_f32_16x16x32_bf16 v[152:155], a[24:27], v[232:235], v[152:155]
v_fma_f32 v14, v14, s90, v17
v_mul_f32 v13, v13, v48
v_mfma_f32_16x16x32_bf16 v[156:159], a[24:27], v[236:239], v[156:159]
v_mul_f32 v14, v14, v49
s_waitcnt vmcnt(20)
v_mfma_f32_16x16x32_bf16 v[160:163], a[28:31], v[224:227], v[160:163]
buffer_load_dwordx4 a[12:15], v4, s[20:23], s75 offen offset:2048 sc1
v_exp_f32 v13, v13
v_mfma_f32_16x16x32_bf16 v[164:167], a[28:31], v[228:231], v[164:167]
v_exp_f32 v14, v14
v_mfma_f32_16x16x32_bf16 v[168:171], a[28:31], v[232:235], v[168:171]
v_add_f32 v13, 1.0, v13
v_add_f32 v14, 1.0, v14
v_mfma_f32_16x16x32_bf16 v[172:175], a[28:31], v[236:239], v[172:175]
v_rcp_f32 v13, v13
s_waitcnt vmcnt(20)
v_mfma_f32_16x16x32_bf16 v[64:67], a[248:251], v[240:243], v[64:67]
s_mul_i32 s75, s72, 114688
s_add_u32 s75, s75, s74
v_mfma_f32_16x16x32_bf16 v[68:71], a[248:251], v[244:247], v[68:71]
buffer_load_dwordx4 a[220:223], v1, s[20:23], s75 offen offset:0 sc1
v_rcp_f32 v14, v14
v_mfma_f32_16x16x32_bf16 v[72:75], a[248:251], v[248:251], v[72:75]
v_mul_f32 v48, v48, v13
v_mfma_f32_16x16x32_bf16 v[76:79], a[248:251], v[252:255], v[76:79]
v_mul_f32 v49, v49, v14
s_waitcnt vmcnt(20)
v_mfma_f32_16x16x32_bf16 v[80:83], a[252:255], v[240:243], v[80:83]
buffer_load_dwordx4 a[224:227], v1, s[20:23], s75 offen offset:1024 sc1
v_lshlrev_b32 v50, 16, v185
v_mfma_f32_16x16x32_bf16 v[84:87], a[252:255], v[244:247], v[84:87]
v_and_b32 v51, 0xffff0000, v185
v_mfma_f32_16x16x32_bf16 v[88:91], a[252:255], v[248:251], v[88:91]
v_mul_f32 v15, v50, v50
v_mul_f32 v16, v51, v51
v_mfma_f32_16x16x32_bf16 v[92:95], a[252:255], v[252:255], v[92:95]
v_fma_f32 v15, v15, s90, v17
s_waitcnt vmcnt(20)
v_mfma_f32_16x16x32_bf16 v[96:99], a[32:35], v[240:243], v[96:99]
buffer_load_dwordx4 a[228:231], v1, s[20:23], s75 offen offset:2048 sc1
v_fma_f32 v16, v16, s90, v17
v_mfma_f32_16x16x32_bf16 v[100:103], a[32:35], v[244:247], v[100:103]
v_mul_f32 v15, v15, v50
v_mfma_f32_16x16x32_bf16 v[104:107], a[32:35], v[248:251], v[104:107]
v_mul_f32 v16, v16, v51
v_exp_f32 v15, v15
v_mfma_f32_16x16x32_bf16 v[108:111], a[32:35], v[252:255], v[108:111]
v_exp_f32 v16, v16
s_waitcnt vmcnt(20)
v_mfma_f32_16x16x32_bf16 v[112:115], a[36:39], v[240:243], v[112:115]
buffer_load_dwordx4 a[232:235], v1, s[20:23], s75 offen offset:3072 sc1
v_add_f32 v15, 1.0, v15
v_mfma_f32_16x16x32_bf16 v[116:119], a[36:39], v[244:247], v[116:119]
v_add_f32 v16, 1.0, v16
v_mfma_f32_16x16x32_bf16 v[120:123], a[36:39], v[248:251], v[120:123]
v_rcp_f32 v15, v15
v_mfma_f32_16x16x32_bf16 v[124:127], a[36:39], v[252:255], v[124:127]
v_rcp_f32 v16, v16
s_waitcnt vmcnt(20)
v_mfma_f32_16x16x32_bf16 v[128:131], a[40:43], v[240:243], v[128:131]
buffer_load_dwordx4 a[236:239], v4, s[20:23], s75 offen offset:0 sc1
v_mul_f32 v50, v50, v15
v_mfma_f32_16x16x32_bf16 v[132:135], a[40:43], v[244:247], v[132:135]
v_mul_f32 v51, v51, v16
v_mfma_f32_16x16x32_bf16 v[136:139], a[40:43], v[248:251], v[136:139]
v_lshlrev_b32 v52, 16, v186
v_mfma_f32_16x16x32_bf16 v[140:143], a[40:43], v[252:255], v[140:143]
v_and_b32 v53, 0xffff0000, v186
s_waitcnt vmcnt(20)
v_mfma_f32_16x16x32_bf16 v[144:147], a[44:47], v[240:243], v[144:147]
buffer_load_dwordx4 a[240:243], v4, s[20:23], s75 offen offset:1024 sc1
v_mul_f32 v13, v52, v52
v_mfma_f32_16x16x32_bf16 v[148:151], a[44:47], v[244:247], v[148:151]
v_mul_f32 v14, v53, v53
v_fma_f32 v13, v13, s90, v17
v_mfma_f32_16x16x32_bf16 v[152:155], a[44:47], v[248:251], v[152:155]
v_fma_f32 v14, v14, s90, v17
v_mfma_f32_16x16x32_bf16 v[156:159], a[44:47], v[252:255], v[156:159]
v_mul_f32 v13, v13, v52
s_waitcnt vmcnt(20)
v_mfma_f32_16x16x32_bf16 v[160:163], a[192:195], v[240:243], v[160:163]
buffer_load_dwordx4 a[244:247], v4, s[20:23], s75 offen offset:2048 sc1
v_mul_f32 v14, v14, v53
v_mfma_f32_16x16x32_bf16 v[164:167], a[192:195], v[244:247], v[164:167]
v_exp_f32 v13, v13
v_mfma_f32_16x16x32_bf16 v[168:171], a[192:195], v[248:251], v[168:171]
v_exp_f32 v14, v14
v_mfma_f32_16x16x32_bf16 v[172:175], a[192:195], v[252:255], v[172:175]
v_add_f32 v13, 1.0, v13
s_waitcnt vmcnt(20)
v_mfma_f32_16x16x32_bf16 v[64:67], a[196:199], a[128:131], v[64:67]
s_add_u32 s75, s75, 57344
s_add_u32 s72, s72, 1
s_add_u32 s84, s44, 1
v_mfma_f32_16x16x32_bf16 v[68:71], a[196:199], a[132:135], v[68:71]
s_and_b32 s72, s72, 7
buffer_load_dwordx4 a[16:19], v1, s[20:23], s75 offen offset:0 sc1
s_and_b32 s84, s84, 3
v_mfma_f32_16x16x32_bf16 v[72:75], a[196:199], a[136:139], v[72:75]
v_add_f32 v14, 1.0, v14
v_rcp_f32 v13, v13
v_mfma_f32_16x16x32_bf16 v[76:79], a[196:199], a[140:143], v[76:79]
v_rcp_f32 v14, v14
s_waitcnt vmcnt(20)
v_mfma_f32_16x16x32_bf16 v[80:83], a[200:203], a[128:131], v[80:83]
buffer_load_dwordx4 a[20:23], v1, s[20:23], s75 offen offset:1024 sc1
v_mul_f32 v52, v52, v13
s_mul_i32 s84, s84, 21504
v_mfma_f32_16x16x32_bf16 v[84:87], a[200:203], a[132:135], v[84:87]
v_mul_f32 v53, v53, v14
s_add_u32 s84, s84, 0
v_add_u32 v29, s84, v1
v_mfma_f32_16x16x32_bf16 v[88:91], a[200:203], a[136:139], v[88:91]
v_lshlrev_b32 v54, 16, v187
v_and_b32 v55, 0xffff0000, v187
s_add_u32 s84, s44, 2
v_mfma_f32_16x16x32_bf16 v[92:95], a[200:203], a[140:143], v[92:95]
v_mul_f32 v15, v54, v54
s_and_b32 s84, s84, 3
s_waitcnt vmcnt(20)
v_mfma_f32_16x16x32_bf16 v[96:99], a[204:207], a[128:131], v[96:99]
buffer_load_dwordx4 a[24:27], v1, s[20:23], s75 offen offset:2048 sc1
v_mul_f32 v16, v55, v55
s_mul_i32 s84, s84, 21504
v_mfma_f32_16x16x32_bf16 v[100:103], a[204:207], a[132:135], v[100:103]
v_fma_f32 v15, v15, s90, v17
s_add_u32 s84, s84, 7168
v_add_u32 v30, s84, v1
v_mfma_f32_16x16x32_bf16 v[104:107], a[204:207], a[136:139], v[104:107]
v_fma_f32 v16, v16, s90, v17
v_mul_f32 v15, v15, v54
s_add_u32 s84, s44, 3
v_mfma_f32_16x16x32_bf16 v[108:111], a[204:207], a[140:143], v[108:111]
v_mul_f32 v16, v16, v55
s_and_b32 s84, s84, 3
s_waitcnt vmcnt(20)
v_mfma_f32_16x16x32_bf16 v[112:115], a[208:211], a[128:131], v[112:115]
buffer_load_dwordx4 a[28:31], v1, s[20:23], s75 offen offset:3072 sc1
v_exp_f32 v15, v15
v_mfma_f32_16x16x32_bf16 v[116:119], a[208:211], a[132:135], v[116:119]
v_exp_f32 v16, v16
s_mul_i32 s84, s84, 21504
v_mfma_f32_16x16x32_bf16 v[120:123], a[208:211], a[136:139], v[120:123]
v_add_f32 v15, 1.0, v15
v_add_f32 v16, 1.0, v16
s_add_u32 s84, s84, 14336
v_mfma_f32_16x16x32_bf16 v[124:127], a[208:211], a[140:143], v[124:127]
v_rcp_f32 v15, v15
s_waitcnt vmcnt(20)
v_mfma_f32_16x16x32_bf16 v[128:131], a[48:51], a[128:131], v[128:131]
buffer_load_dwordx4 a[248:251], v4, s[20:23], s75 offen offset:0 sc1
v_rcp_f32 v16, v16
v_mfma_f32_16x16x32_bf16 v[132:135], a[48:51], a[132:135], v[132:135]
v_mul_f32 v54, v54, v15
v_add_u32 v31, s84, v1
s_mul_i32 s84, s44, 21504
v_mfma_f32_16x16x32_bf16 v[136:139], a[48:51], a[136:139], v[136:139]
v_mul_f32 v55, v55, v16
v_lshlrev_b32 v56, 16, v188
v_add_u32 v190, s84, v1
v_mfma_f32_16x16x32_bf16 v[140:143], a[48:51], a[140:143], v[140:143]
v_and_b32 v57, 0xffff0000, v188
s_waitcnt vmcnt(20)
v_mfma_f32_16x16x32_bf16 v[144:147], a[52:55], a[128:131], v[144:147]
buffer_load_dwordx4 a[252:255], v4, s[20:23], s75 offen offset:1024 sc1
v_mul_f32 v13, v56, v56
v_mfma_f32_16x16x32_bf16 v[148:151], a[52:55], a[132:135], v[148:151]
v_mul_f32 v14, v57, v57
v_mfma_f32_16x16x32_bf16 v[152:155], a[52:55], a[136:139], v[152:155]
v_fma_f32 v13, v13, s90, v17
v_fma_f32 v14, v14, s90, v17
v_mfma_f32_16x16x32_bf16 v[156:159], a[52:55], a[140:143], v[156:159]
v_mul_f32 v13, v13, v56
s_waitcnt vmcnt(20)
v_mfma_f32_16x16x32_bf16 v[160:163], a[56:59], a[128:131], v[160:163]
buffer_load_dwordx4 a[32:35], v4, s[20:23], s75 offen offset:2048 sc1
v_mul_f32 v14, v14, v57
v_mfma_f32_16x16x32_bf16 v[164:167], a[56:59], a[132:135], v[164:167]
v_exp_f32 v13, v13
v_mfma_f32_16x16x32_bf16 v[168:171], a[56:59], a[136:139], v[168:171]
v_exp_f32 v14, v14
s_add_u32 s82, s46, 0
v_mfma_f32_16x16x32_bf16 v[172:175], a[56:59], a[140:143], v[172:175]
v_add_f32 v13, 1.0, v13
s_and_b32 s82, s82, 3
s_mul_i32 s83, s44, 4
s_waitcnt vmcnt(20)
v_mfma_f32_16x16x32_bf16 v[68:71], a[60:63], a[148:151], v[68:71]
v_add_f32 v14, 1.0, v14
v_rcp_f32 v13, v13
v_mfma_f32_16x16x32_bf16 v[72:75], a[60:63], a[152:155], v[72:75]
v_rcp_f32 v14, v14
s_add_u32 s83, s83, s82
v_mfma_f32_16x16x32_bf16 v[76:79], a[60:63], a[156:159], v[76:79]
v_mul_f32 v56, v56, v13
v_mul_f32 v57, v57, v14
s_lshl_b32 s83, s83, 15
s_waitcnt vmcnt(13)
v_mfma_f32_16x16x32_bf16 v[68:71], a[220:223], a[164:167], v[68:71]
v_lshlrev_b32 v58, 16, v189
v_and_b32 v59, 0xffff0000, v189
s_add_u32 m0, s77, 0
v_mfma_f32_16x16x32_bf16 v[72:75], a[220:223], a[168:171], v[72:75]
v_mul_f32 v15, v58, v58
buffer_load_dwordx4 v18, s[24:27], s83 offen offset:0 lds
v_mfma_f32_16x16x32_bf16 v[76:79], a[220:223], a[172:175], v[76:79]
v_mul_f32 v16, v59, v59
v_fma_f32 v15, v15, s90, v17
s_waitcnt vmcnt(7)
v_mfma_f32_16x16x32_bf16 v[68:71], a[16:19], a[180:183], v[68:71]
v_fma_f32 v16, v16, s90, v17
v_mul_f32 v15, v15, v58
v_mfma_f32_16x16x32_bf16 v[72:75], a[16:19], a[184:187], v[72:75]
v_mul_f32 v16, v16, v59
v_mfma_f32_16x16x32_bf16 v[76:79], a[16:19], a[188:191], v[76:79]
v_exp_f32 v15, v15
v_mfma_f32_16x16x32_bf16 v[84:87], a[212:215], a[148:151], v[84:87]
v_exp_f32 v16, v16
buffer_load_dwordx4 v19, s[24:27], s83 offen offset:1024 lds
v_mfma_f32_16x16x32_bf16 v[88:91], a[212:215], a[152:155], v[88:91]
v_add_f32 v15, 1.0, v15
v_add_f32 v16, 1.0, v16
v_mfma_f32_16x16x32_bf16 v[92:95], a[212:215], a[156:159], v[92:95]
v_rcp_f32 v15, v15
ds_write_b128 v29, v[68:71] offset:0
v_mfma_f32_16x16x32_bf16 v[84:87], a[224:227], a[164:167], v[84:87]
v_rcp_f32 v16, v16
v_mfma_f32_16x16x32_bf16 v[88:91], a[224:227], a[168:171], v[88:91]
v_mul_f32 v58, v58, v15
ds_write_b128 v30, v[72:75] offset:0
v_mfma_f32_16x16x32_bf16 v[92:95], a[224:227], a[172:175], v[92:95]
v_mul_f32 v59, v59, v16
buffer_load_dwordx4 v20, s[24:27], s83 offen offset:2048 lds
s_waitcnt vmcnt(8)
v_mfma_f32_16x16x32_bf16 v[84:87], a[20:23], a[180:183], v[84:87]
ds_write_b128 v31, v[76:79] offset:0
v_mfma_f32_16x16x32_bf16 v[88:91], a[20:23], a[184:187], v[88:91]
v_mfma_f32_16x16x32_bf16 v[92:95], a[20:23], a[188:191], v[92:95]
v_mfma_f32_16x16x32_bf16 v[100:103], a[216:219], a[148:151], v[100:103]
v_mfma_f32_16x16x32_bf16 v[104:107], a[216:219], a[152:155], v[104:107]
buffer_load_dwordx4 v21, s[24:27], s83 offen offset:3072 lds
s_add_u32 s82, s46, 1
s_and_b32 s82, s82, 3
v_mfma_f32_16x16x32_bf16 v[108:111], a[216:219], a[156:159], v[108:111]
s_mul_i32 s83, s44, 4
s_add_u32 s83, s83, s82
s_lshl_b32 s83, s83, 15
ds_write_b128 v29, v[84:87] offset:1024
v_mfma_f32_16x16x32_bf16 v[100:103], a[228:231], a[164:167], v[100:103]
s_add_u32 m0, s77, 4096
v_mfma_f32_16x16x32_bf16 v[104:107], a[228:231], a[168:171], v[104:107]
ds_write_b128 v30, v[88:91] offset:1024
v_mfma_f32_16x16x32_bf16 v[108:111], a[228:231], a[172:175], v[108:111]
s_waitcnt vmcnt(8)
v_mfma_f32_16x16x32_bf16 v[100:103], a[24:27], a[180:183], v[100:103]
buffer_load_dwordx4 v18, s[24:27], s83 offen offset:0 lds
ds_write_b128 v31, v[92:95] offset:1024
v_mfma_f32_16x16x32_bf16 v[104:107], a[24:27], a[184:187], v[104:107]
v_mfma_f32_16x16x32_bf16 v[108:111], a[24:27], a[188:191], v[108:111]
v_mfma_f32_16x16x32_bf16 v[116:119], a[0:3], a[148:151], v[116:119]
v_mfma_f32_16x16x32_bf16 v[120:123], a[0:3], a[152:155], v[120:123]
v_mfma_f32_16x16x32_bf16 v[124:127], a[0:3], a[156:159], v[124:127]
buffer_load_dwordx4 v19, s[24:27], s83 offen offset:1024 lds
ds_write_b128 v29, v[100:103] offset:2048
v_mfma_f32_16x16x32_bf16 v[116:119], a[232:235], a[164:167], v[116:119]
v_mfma_f32_16x16x32_bf16 v[120:123], a[232:235], a[168:171], v[120:123]
ds_write_b128 v30, v[104:107] offset:2048
v_mfma_f32_16x16x32_bf16 v[124:127], a[232:235], a[172:175], v[124:127]
s_waitcnt vmcnt(9)
v_mfma_f32_16x16x32_bf16 v[116:119], a[28:31], a[180:183], v[116:119]
ds_write_b128 v31, v[108:111] offset:2048
v_mfma_f32_16x16x32_bf16 v[120:123], a[28:31], a[184:187], v[120:123]
buffer_load_dwordx4 v20, s[24:27], s83 offen offset:2048 lds
v_mfma_f32_16x16x32_bf16 v[124:127], a[28:31], a[188:191], v[124:127]
v_mfma_f32_16x16x32_bf16 v[132:135], a[4:7], a[148:151], v[132:135]
v_mfma_f32_16x16x32_bf16 v[136:139], a[4:7], a[152:155], v[136:139]
v_mfma_f32_16x16x32_bf16 v[140:143], a[4:7], a[156:159], v[140:143]
s_nop 0
ds_write_b128 v29, v[116:119] offset:3072
v_mfma_f32_16x16x32_bf16 v[132:135], a[236:239], a[164:167], v[132:135]
buffer_load_dwordx4 v21, s[24:27], s83 offen offset:3072 lds
s_add_u32 s82, s46, 2
s_and_b32 s82, s82, 3
v_mfma_f32_16x16x32_bf16 v[136:139], a[236:239], a[168:171], v[136:139]
s_mul_i32 s83, s44, 4
s_add_u32 s83, s83, s82
s_lshl_b32 s83, s83, 15
ds_write_b128 v30, v[120:123] offset:3072
v_mfma_f32_16x16x32_bf16 v[140:143], a[236:239], a[172:175], v[140:143]
s_add_u32 m0, s77, 8192
s_waitcnt vmcnt(10)
v_mfma_f32_16x16x32_bf16 v[132:135], a[248:251], a[180:183], v[132:135]
ds_write_b128 v31, v[124:127] offset:3072
v_mfma_f32_16x16x32_bf16 v[136:139], a[248:251], a[184:187], v[136:139]
v_mfma_f32_16x16x32_bf16 v[140:143], a[248:251], a[188:191], v[140:143]
buffer_load_dwordx4 v18, s[24:27], s83 offen offset:0 lds
v_mfma_f32_16x16x32_bf16 v[148:151], a[8:11], a[148:151], v[148:151]
v_mfma_f32_16x16x32_bf16 v[152:155], a[8:11], a[152:155], v[152:155]
v_mfma_f32_16x16x32_bf16 v[156:159], a[8:11], a[156:159], v[156:159]
s_nop 0
ds_write_b128 v29, v[132:135] offset:4096
v_mfma_f32_16x16x32_bf16 v[148:151], a[240:243], a[164:167], v[148:151]
v_mfma_f32_16x16x32_bf16 v[152:155], a[240:243], a[168:171], v[152:155]
buffer_load_dwordx4 v19, s[24:27], s83 offen offset:1024 lds
ds_write_b128 v30, v[136:139] offset:4096
v_mfma_f32_16x16x32_bf16 v[156:159], a[240:243], a[172:175], v[156:159]
s_waitcnt vmcnt(11)
v_mfma_f32_16x16x32_bf16 v[148:151], a[252:255], a[180:183], v[148:151]
ds_write_b128 v31, v[140:143] offset:4096
v_mfma_f32_16x16x32_bf16 v[152:155], a[252:255], a[184:187], v[152:155]
v_mfma_f32_16x16x32_bf16 v[156:159], a[252:255], a[188:191], v[156:159]
v_mfma_f32_16x16x32_bf16 v[164:167], a[12:15], a[148:151], v[164:167]
buffer_load_dwordx4 v20, s[24:27], s83 offen offset:2048 lds
v_mfma_f32_16x16x32_bf16 v[168:171], a[12:15], a[152:155], v[168:171]
v_mfma_f32_16x16x32_bf16 v[172:175], a[12:15], a[156:159], v[172:175]
s_nop 0
ds_write_b128 v29, v[148:151] offset:5120
v_mfma_f32_16x16x32_bf16 v[164:167], a[244:247], a[164:167], v[164:167]
v_mfma_f32_16x16x32_bf16 v[168:171], a[244:247], a[168:171], v[168:171]
ds_write_b128 v30, v[152:155] offset:5120
v_mfma_f32_16x16x32_bf16 v[172:175], a[244:247], a[172:175], v[172:175]
buffer_load_dwordx4 v21, s[24:27], s83 offen offset:3072 lds
s_add_u32 s82, s46, 3
s_and_b32 s82, s82, 3
s_waitcnt vmcnt(12)
v_mfma_f32_16x16x32_bf16 v[164:167], a[32:35], a[180:183], v[164:167]
s_mul_i32 s83, s44, 4
s_add_u32 s83, s83, s82
s_lshl_b32 s83, s83, 15
ds_write_b128 v31, v[156:159] offset:5120
v_mfma_f32_16x16x32_bf16 v[168:171], a[32:35], a[184:187], v[168:171]
s_add_u32 m0, s77, 12288
v_mfma_f32_16x16x32_bf16 v[172:175], a[32:35], a[188:191], v[172:175]
v_mfma_f32_16x16x32_bf16 v[64:67], a[60:63], a[144:147], v[64:67]
v_mfma_f32_16x16x32_bf16 v[80:83], a[212:215], a[144:147], v[80:83]
buffer_load_dwordx4 v18, s[24:27], s83 offen offset:0 lds
v_mfma_f32_16x16x32_bf16 v[96:99], a[216:219], a[144:147], v[96:99]
ds_write_b128 v29, v[164:167] offset:6144
v_mfma_f32_16x16x32_bf16 v[112:115], a[0:3], a[144:147], v[112:115]
v_mfma_f32_16x16x32_bf16 v[128:131], a[4:7], a[144:147], v[128:131]
ds_write_b128 v30, v[168:171] offset:6144
v_mfma_f32_16x16x32_bf16 v[144:147], a[8:11], a[144:147], v[144:147]
v_mfma_f32_16x16x32_bf16 v[160:163], a[12:15], a[144:147], v[160:163]
buffer_load_dwordx4 v19, s[24:27], s83 offen offset:1024 lds
ds_write_b128 v31, v[172:175] offset:6144
v_mfma_f32_16x16x32_bf16 v[64:67], a[220:223], a[160:163], v[64:67]
v_mfma_f32_16x16x32_bf16 v[80:83], a[224:227], a[160:163], v[80:83]
v_mfma_f32_16x16x32_bf16 v[96:99], a[228:231], a[160:163], v[96:99]
v_mfma_f32_16x16x32_bf16 v[112:115], a[232:235], a[160:163], v[112:115]
v_mfma_f32_16x16x32_bf16 v[128:131], a[236:239], a[160:163], v[128:131]
buffer_load_dwordx4 v20, s[24:27], s83 offen offset:2048 lds
v_mfma_f32_16x16x32_bf16 v[144:147], a[240:243], a[160:163], v[144:147]
v_mfma_f32_16x16x32_bf16 v[160:163], a[244:247], a[160:163], v[160:163]
v_mfma_f32_16x16x32_bf16 v[64:67], a[16:19], a[176:179], v[64:67]
v_mfma_f32_16x16x32_bf16 v[80:83], a[20:23], a[176:179], v[80:83]
v_mfma_f32_16x16x32_bf16 v[96:99], a[24:27], a[176:179], v[96:99]
buffer_load_dwordx4 v21, s[24:27], s83 offen offset:3072 lds
v_mfma_f32_16x16x32_bf16 v[112:115], a[28:31], a[176:179], v[112:115]
v_mfma_f32_16x16x32_bf16 v[128:131], a[248:251], a[176:179], v[128:131]
v_mfma_f32_16x16x32_bf16 v[144:147], a[252:255], a[176:179], v[144:147]
v_mfma_f32_16x16x32_bf16 v[160:163], a[32:35], a[176:179], v[160:163]
s_waitcnt vmcnt(12)
ds_read_b64_tr_b16 a[64:65], v22 offset:0
ds_read_b64_tr_b16 a[66:67], v22 offset:2048
ds_read_b64_tr_b16 a[68:69], v23 offset:0
ds_read_b64_tr_b16 a[70:71], v23 offset:2048
ds_read_b64_tr_b16 a[72:73], v24 offset:0
ds_read_b64_tr_b16 a[74:75], v24 offset:2048
ds_read_b64_tr_b16 a[76:77], v25 offset:0
ds_read_b64_tr_b16 a[78:79], v25 offset:2048
s_add_u32 s82, s46, 0
s_and_b32 s82, s82, 3
s_lshl_b32 s82, s82, 10
s_add_u32 s82, s82, s69
buffer_load_dwordx4 v[192:195], v60, s[20:23], s82 offen offset:0 sc1
buffer_load_dwordx4 v[196:199], v61, s[20:23], s82 offen offset:0 sc1
buffer_load_dwordx4 v[200:203], v62, s[20:23], s82 offen offset:0 sc1
buffer_load_dwordx4 v[204:207], v63, s[20:23], s82 offen offset:0 sc1
s_waitcnt lgkmcnt(8)
s_barrier
ds_read_b128 v[68:71], v190 offset:0
s_waitcnt lgkmcnt(1)
s_add_u32 s82, s101, 0
ds_read_b128 v[72:75], v190 offset:7168
s_cmp_ge_u32 s82, 7
s_cselect_b32 s45, 7, 0
ds_read_b128 v[76:79], v190 offset:14336
s_sub_u32 s82, s82, s45
ds_read_b128 v[84:87], v190 offset:1024
s_mul_i32 s83, s44, 7
ds_read_b128 v[88:91], v190 offset:8192
s_add_u32 s83, s83, s82
ds_read_b128 v[92:95], v190 offset:15360
s_lshl_b32 s83, s83, 15
ds_read_b128 v[100:103], v190 offset:2048
s_add_u32 m0, s77, 0
ds_read_b128 v[104:107], v190 offset:9216
buffer_load_dwordx4 v18, s[28:31], s83 offen offset:0 lds
ds_read_b128 v[108:111], v190 offset:16384
ds_read_b128 v[116:119], v190 offset:3072
ds_read_b128 v[120:123], v190 offset:10240
ds_read_b128 v[124:127], v190 offset:17408
ds_read_b128 v[132:135], v190 offset:4096
ds_read_b128 v[136:139], v190 offset:11264
ds_read_b128 v[140:143], v190 offset:18432
ds_read_b128 v[148:151], v190 offset:5120
ds_read_b128 v[152:155], v190 offset:12288
ds_read_b128 v[156:159], v190 offset:19456
ds_read_b128 v[164:167], v190 offset:6144
ds_read_b128 v[168:171], v190 offset:13312
buffer_load_dwordx4 v19, s[28:31], s83 offen offset:1024 lds
ds_read_b128 v[172:175], v190 offset:20480
s_mul_i32 s84, s78, 28
s_mul_i32 s85, s71, 7
s_lshr_b32 s85, s85, 1
s_add_u32 s84, s84, s85
s_lshl_b32 s84, s84, 10
s_add_u32 s84, s84, 0xb00000
s_waitcnt lgkmcnt(15)
v_pk_add_f32 v[64:65], v[64:65], v[68:69]
v_pk_add_f32 v[72:73], v[72:73], v[76:77]
v_pk_add_f32 v[66:67], v[66:67], v[70:71]
v_pk_add_f32 v[74:75], v[74:75], v[78:79]
v_pk_add_f32 v[64:65], v[64:65], v[72:73]
buffer_load_dwordx4 v20, s[28:31], s83 offen offset:2048 lds
v_pk_add_f32 v[66:67], v[66:67], v[74:75]
v_pk_mul_f32 v[64:65], v[64:65], v[32:33]
v_pk_mul_f32 v[66:67], v[66:67], v[34:35]
v_cvt_pk_bf16_f32 v176, v64, v65
v_cvt_pk_bf16_f32 v177, v66, v67
v_pk_add_f32 v[80:81], v[80:81], v[84:85]
v_pk_add_f32 v[88:89], v[88:89], v[92:93]
v_pk_add_f32 v[82:83], v[82:83], v[86:87]
v_pk_add_f32 v[90:91], v[90:91], v[94:95]
v_pk_add_f32 v[80:81], v[80:81], v[88:89]
v_pk_add_f32 v[82:83], v[82:83], v[90:91]
v_pk_mul_f32 v[80:81], v[80:81], v[36:37]
buffer_load_dwordx4 v21, s[28:31], s83 offen offset:3072 lds
v_pk_mul_f32 v[82:83], v[82:83], v[38:39]
s_waitcnt vmcnt(16)
ds_read_b64_tr_b16 a[80:81], v22 offset:4096
v_cvt_pk_bf16_f32 v178, v80, v81
ds_read_b64_tr_b16 a[82:83], v22 offset:6144
v_cvt_pk_bf16_f32 v179, v82, v83
ds_read_b64_tr_b16 a[84:85], v23 offset:4096
s_waitcnt lgkmcnt(15)
v_pk_add_f32 v[96:97], v[96:97], v[100:101]
ds_read_b64_tr_b16 a[86:87], v23 offset:6144
v_pk_add_f32 v[104:105], v[104:105], v[108:109]
ds_read_b64_tr_b16 a[88:89], v24 offset:4096
v_pk_add_f32 v[98:99], v[98:99], v[102:103]
ds_read_b64_tr_b16 a[90:91], v24 offset:6144
v_pk_add_f32 v[106:107], v[106:107], v[110:111]
ds_read_b64_tr_b16 a[92:93], v25 offset:4096
v_pk_add_f32 v[96:97], v[96:97], v[104:105]
ds_read_b64_tr_b16 a[94:95], v25 offset:6144
v_pk_add_f32 v[98:99], v[98:99], v[106:107]
s_add_u32 s82, s46, 1
v_pk_mul_f32 v[96:97], v[96:97], v[40:41]
s_and_b32 s82, s82, 3
v_pk_mul_f32 v[98:99], v[98:99], v[42:43]
s_lshl_b32 s82, s82, 10
v_cvt_pk_bf16_f32 v180, v96, v97
s_add_u32 s82, s82, s69
v_cvt_pk_bf16_f32 v181, v98, v99
buffer_load_dwordx4 v[208:211], v60, s[20:23], s82 offen offset:0 sc1
s_waitcnt lgkmcnt(15)
v_pk_add_f32 v[112:113], v[112:113], v[116:117]
v_pk_add_f32 v[120:121], v[120:121], v[124:125]
v_pk_add_f32 v[114:115], v[114:115], v[118:119]
v_pk_add_f32 v[122:123], v[122:123], v[126:127]
v_pk_add_f32 v[112:113], v[112:113], v[120:121]
v_pk_add_f32 v[114:115], v[114:115], v[122:123]
v_pk_mul_f32 v[112:113], v[112:113], v[44:45]
v_pk_mul_f32 v[114:115], v[114:115], v[46:47]
v_cvt_pk_bf16_f32 v182, v112, v113
v_cvt_pk_bf16_f32 v183, v114, v115
v_pk_add_f32 v[128:129], v[128:129], v[132:133]
s_waitcnt lgkmcnt(14)
v_pk_add_f32 v[136:137], v[136:137], v[140:141]
buffer_load_dwordx4 v[212:215], v61, s[20:23], s82 offen offset:0 sc1
v_pk_add_f32 v[130:131], v[130:131], v[134:135]
v_pk_add_f32 v[138:139], v[138:139], v[142:143]
v_pk_add_f32 v[128:129], v[128:129], v[136:137]
v_pk_add_f32 v[130:131], v[130:131], v[138:139]
v_pk_mul_f32 v[128:129], v[128:129], v[48:49]
v_pk_mul_f32 v[130:131], v[130:131], v[50:51]
v_cvt_pk_bf16_f32 v184, v128, v129
v_cvt_pk_bf16_f32 v185, v130, v131
s_waitcnt lgkmcnt(13)
v_pk_add_f32 v[144:145], v[144:145], v[148:149]
s_waitcnt lgkmcnt(11)
v_pk_add_f32 v[152:153], v[152:153], v[156:157]
v_pk_add_f32 v[146:147], v[146:147], v[150:151]
v_pk_add_f32 v[154:155], v[154:155], v[158:159]
buffer_load_dwordx4 v[216:219], v62, s[20:23], s82 offen offset:0 sc1
v_pk_add_f32 v[144:145], v[144:145], v[152:153]
v_pk_add_f32 v[146:147], v[146:147], v[154:155]
v_pk_mul_f32 v[144:145], v[144:145], v[52:53]
v_pk_mul_f32 v[146:147], v[146:147], v[54:55]
v_cvt_pk_bf16_f32 v186, v144, v145
v_cvt_pk_bf16_f32 v187, v146, v147
s_waitcnt lgkmcnt(10)
v_pk_add_f32 v[160:161], v[160:161], v[164:165]
s_waitcnt lgkmcnt(8)
v_pk_add_f32 v[168:169], v[168:169], v[172:173]
v_pk_add_f32 v[162:163], v[162:163], v[166:167]
v_pk_add_f32 v[170:171], v[170:171], v[174:175]
v_pk_add_f32 v[160:161], v[160:161], v[168:169]
v_pk_add_f32 v[162:163], v[162:163], v[170:171]
buffer_load_dwordx4 v[220:223], v63, s[20:23], s82 offen offset:0 sc1
v_pk_mul_f32 v[160:161], v[160:161], v[56:57]
s_waitcnt lgkmcnt(0)
s_add_u32 s82, s101, 1
v_pk_mul_f32 v[162:163], v[162:163], v[58:59]
s_cmp_ge_u32 s82, 7
s_cselect_b32 s45, 7, 0
v_cvt_pk_bf16_f32 v188, v160, v161
s_sub_u32 s82, s82, s45
v_cvt_pk_bf16_f32 v189, v162, v163
s_mul_i32 s83, s44, 7
s_bitcmp1_b32 s71, 0
s_nop 1
s_cbranch_scc1 L_hodd_26
buffer_store_dwordx4 v[176:179], v1, s[20:23], s84 offen offset:0 sc1
buffer_store_dwordx4 v[180:183], v1, s[20:23], s84 offen offset:1024 sc1
buffer_store_dwordx4 v[184:187], v1, s[20:23], s84 offen offset:2048 sc1
buffer_store_dwordx2 v[188:189], v1, s[20:23], s84 offen offset:3072 sc1
s_branch L_hend_27
L_hodd_26:
buffer_store_dwordx2 v[176:177], v1, s[20:23], s84 offen offset:8 sc1
buffer_store_dwordx4 v[178:181], v1, s[20:23], s84 offen offset:1024 sc1
buffer_store_dwordx4 v[182:185], v1, s[20:23], s84 offen offset:2048 sc1
buffer_store_dwordx4 v[186:189], v1, s[20:23], s84 offen offset:3072 sc1
L_hend_27:
s_barrier
v_and_b32 v13, 15, v0
v_lshlrev_b32 v13, 10, v13
v_bfe_u32 v14, v0, 4, 1
v_lshl_add_u32 v13, v14, 5, v13
v_bfe_u32 v14, v0, 5, 1
v_lshl_add_u32 v13, v14, 4, v13
s_lshl_b32 s74, s78, 14
s_lshl_b32 s84, s71, 7
s_add_u32 s74, s74, s84
s_mul_i32 s84, s78, 28672
v_add_u32 v14, s84, v1
s_mul_i32 s84, s79, 28672
v_add_u32 v15, s84, v1
s_mul_i32 s84, s80, 28672
v_add_u32 v16, s84, v1
s_mul_i32 s84, s81, 28672
v_add_u32 v17, s84, v1
s_add_u32 s83, s83, s82
s_lshl_b32 s83, s83, 15
s_add_u32 m0, s77, 4096
s_nop 0
buffer_load_dwordx4 v18, s[28:31], s83 offen offset:0 lds
buffer_load_dwordx4 v19, s[28:31], s83 offen offset:1024 lds
buffer_load_dwordx4 v20, s[28:31], s83 offen offset:2048 lds
buffer_load_dwordx4 v21, s[28:31], s83 offen offset:3072 lds
s_waitcnt vmcnt(24)
ds_read_b64_tr_b16 a[96:97], v22 offset:8192
ds_read_b64_tr_b16 a[98:99], v22 offset:10240
ds_read_b64_tr_b16 a[100:101], v23 offset:8192
ds_read_b64_tr_b16 a[102:103], v23 offset:10240
ds_read_b64_tr_b16 a[104:105], v24 offset:8192
ds_read_b64_tr_b16 a[106:107], v24 offset:10240
ds_read_b64_tr_b16 a[108:109], v25 offset:8192
ds_read_b64_tr_b16 a[110:111], v25 offset:10240
s_add_u32 s82, s46, 2
s_and_b32 s82, s82, 3
s_lshl_b32 s82, s82, 10
s_add_u32 s82, s82, s69
buffer_load_dwordx4 v[224:227], v60, s[20:23], s82 offen offset:0 sc1
buffer_load_dwordx4 v[228:231], v61, s[20:23], s82 offen offset:0 sc1
buffer_load_dwordx4 v[232:235], v62, s[20:23], s82 offen offset:0 sc1
buffer_load_dwordx4 v[236:239], v63, s[20:23], s82 offen offset:0 sc1
s_lshl_b32 s84, s70, 3
s_add_u32 s84, s84, s71
s_lshl_b32 s84, s84, 5
s_add_u32 s84, s84, s44
s_lshl_b32 s84, s84, 2
s_add_u32 s84, s84, 0x10000
s_waitcnt vmcnt(8)
buffer_store_dword v28, off, s[20:23], s84 sc1
s_waitcnt lgkmcnt(0)
s_add_u32 s82, s101, 2
s_cmp_ge_u32 s82, 7
s_cselect_b32 s45, 7, 0
s_sub_u32 s82, s82, s45
s_mul_i32 s83, s44, 7
s_add_u32 s83, s83, s82
s_lshl_b32 s83, s83, 15
s_add_u32 m0, s77, 8192
s_nop 0
buffer_load_dwordx4 v18, s[28:31], s83 offen offset:0 lds
buffer_load_dwordx4 v19, s[28:31], s83 offen offset:1024 lds
buffer_load_dwordx4 v20, s[28:31], s83 offen offset:2048 lds
buffer_load_dwordx4 v21, s[28:31], s83 offen offset:3072 lds
ds_read_b64_tr_b16 a[112:113], v22 offset:12288
ds_read_b64_tr_b16 a[114:115], v22 offset:14336
ds_read_b64_tr_b16 a[116:117], v23 offset:12288
ds_read_b64_tr_b16 a[118:119], v23 offset:14336
ds_read_b64_tr_b16 a[120:121], v24 offset:12288
ds_read_b64_tr_b16 a[122:123], v24 offset:14336
ds_read_b64_tr_b16 a[124:125], v25 offset:12288
ds_read_b64_tr_b16 a[126:127], v25 offset:14336
s_add_u32 s82, s46, 3
s_and_b32 s82, s82, 3
s_lshl_b32 s82, s82, 10
s_add_u32 s82, s82, s69
buffer_load_dwordx4 v[240:243], v60, s[20:23], s82 offen offset:0 sc1
buffer_load_dwordx4 v[244:247], v61, s[20:23], s82 offen offset:0 sc1
buffer_load_dwordx4 v[248:251], v62, s[20:23], s82 offen offset:0 sc1
buffer_load_dwordx4 v[252:255], v63, s[20:23], s82 offen offset:0 sc1
v_mfma_f32_16x16x32_bf16 v[64:67], a[64:67], v[192:195], 0
s_waitcnt lgkmcnt(0)
s_add_u32 s82, s101, 3
v_mfma_f32_16x16x32_bf16 v[80:83], a[68:71], v[192:195], 0
s_cmp_ge_u32 s82, 7
s_cselect_b32 s45, 7, 0
s_sub_u32 s82, s82, s45
v_mfma_f32_16x16x32_bf16 v[96:99], a[72:75], v[192:195], 0
s_mul_i32 s83, s44, 7
s_add_u32 s83, s83, s82
s_lshl_b32 s83, s83, 15
v_mfma_f32_16x16x32_bf16 v[112:115], a[76:79], v[192:195], 0
s_add_u32 m0, s77, 12288
s_nop 0
buffer_load_dwordx4 v18, s[28:31], s83 offen offset:0 lds
v_mfma_f32_16x16x32_bf16 v[68:71], a[64:67], v[196:199], 0
v_mfma_f32_16x16x32_bf16 v[84:87], a[68:71], v[196:199], 0
v_mfma_f32_16x16x32_bf16 v[100:103], a[72:75], v[196:199], 0
buffer_load_dwordx4 v19, s[28:31], s83 offen offset:1024 lds
v_mfma_f32_16x16x32_bf16 v[116:119], a[76:79], v[196:199], 0
v_mfma_f32_16x16x32_bf16 v[72:75], a[64:67], v[200:203], 0
v_mfma_f32_16x16x32_bf16 v[88:91], a[68:71], v[200:203], 0
buffer_load_dwordx4 v20, s[28:31], s83 offen offset:2048 lds
v_mfma_f32_16x16x32_bf16 v[104:107], a[72:75], v[200:203], 0
v_mfma_f32_16x16x32_bf16 v[120:123], a[76:79], v[200:203], 0
v_mfma_f32_16x16x32_bf16 v[76:79], a[64:67], v[204:207], 0
buffer_load_dwordx4 v21, s[28:31], s83 offen offset:3072 lds
ds_read_b64_tr_b16 a[0:1], v22 offset:0
v_mfma_f32_16x16x32_bf16 v[92:95], a[68:71], v[204:207], 0
ds_read_b64_tr_b16 a[2:3], v22 offset:2048
ds_read_b64_tr_b16 a[4:5], v23 offset:0
ds_read_b64_tr_b16 a[6:7], v23 offset:2048
v_mfma_f32_16x16x32_bf16 v[108:111], a[72:75], v[204:207], 0
ds_read_b64_tr_b16 a[8:9], v24 offset:0
ds_read_b64_tr_b16 a[10:11], v24 offset:2048
ds_read_b64_tr_b16 a[12:13], v25 offset:0
v_mfma_f32_16x16x32_bf16 v[124:127], a[76:79], v[204:207], 0
ds_read_b64_tr_b16 a[14:15], v25 offset:2048
s_waitcnt lgkmcnt(0)
s_add_u32 s82, s101, 4
v_mfma_f32_16x16x32_bf16 v[64:67], a[80:83], v[208:211], v[64:67]
s_cmp_ge_u32 s82, 7
s_cselect_b32 s45, 7, 0
s_sub_u32 s82, s82, s45
v_mfma_f32_16x16x32_bf16 v[80:83], a[84:87], v[208:211], v[80:83]
s_mul_i32 s83, s44, 7
s_add_u32 s83, s83, s82
s_lshl_b32 s83, s83, 15
v_mfma_f32_16x16x32_bf16 v[96:99], a[88:91], v[208:211], v[96:99]
s_add_u32 m0, s77, 0
s_nop 0
buffer_load_dwordx4 v18, s[28:31], s83 offen offset:0 lds
v_mfma_f32_16x16x32_bf16 v[112:115], a[92:95], v[208:211], v[112:115]
v_mfma_f32_16x16x32_bf16 v[68:71], a[80:83], v[212:215], v[68:71]
v_mfma_f32_16x16x32_bf16 v[84:87], a[84:87], v[212:215], v[84:87]
buffer_load_dwordx4 v19, s[28:31], s83 offen offset:1024 lds
v_mfma_f32_16x16x32_bf16 v[100:103], a[88:91], v[212:215], v[100:103]
v_mfma_f32_16x16x32_bf16 v[116:119], a[92:95], v[212:215], v[116:119]
v_mfma_f32_16x16x32_bf16 v[72:75], a[80:83], v[216:219], v[72:75]
buffer_load_dwordx4 v20, s[28:31], s83 offen offset:2048 lds
v_mfma_f32_16x16x32_bf16 v[88:91], a[84:87], v[216:219], v[88:91]
v_mfma_f32_16x16x32_bf16 v[104:107], a[88:91], v[216:219], v[104:107]
v_mfma_f32_16x16x32_bf16 v[120:123], a[92:95], v[216:219], v[120:123]
buffer_load_dwordx4 v21, s[28:31], s83 offen offset:3072 lds
s_waitcnt vmcnt(21)
ds_read_b64_tr_b16 a[16:17], v22 offset:4096
v_mfma_f32_16x16x32_bf16 v[76:79], a[80:83], v[220:223], v[76:79]
ds_read_b64_tr_b16 a[18:19], v22 offset:6144
ds_read_b64_tr_b16 a[20:21], v23 offset:4096
ds_read_b64_tr_b16 a[22:23], v23 offset:6144
v_mfma_f32_16x16x32_bf16 v[92:95], a[84:87], v[220:223], v[92:95]
ds_read_b64_tr_b16 a[24:25], v24 offset:4096
ds_read_b64_tr_b16 a[26:27], v24 offset:6144
ds_read_b64_tr_b16 a[28:29], v25 offset:4096
v_mfma_f32_16x16x32_bf16 v[108:111], a[88:91], v[220:223], v[108:111]
ds_read_b64_tr_b16 a[30:31], v25 offset:6144
s_waitcnt lgkmcnt(0)
s_add_u32 s82, s101, 5
v_mfma_f32_16x16x32_bf16 v[124:127], a[92:95], v[220:223], v[124:127]
s_cmp_ge_u32 s82, 7
s_cselect_b32 s45, 7, 0
s_sub_u32 s82, s82, s45
s_waitcnt vmcnt(20)
v_mfma_f32_16x16x32_bf16 v[64:67], a[96:99], v[224:227], v[64:67]
s_mul_i32 s83, s44, 7
s_add_u32 s83, s83, s82
s_lshl_b32 s83, s83, 15
v_mfma_f32_16x16x32_bf16 v[80:83], a[100:103], v[224:227], v[80:83]
s_add_u32 m0, s77, 4096
s_nop 0
buffer_load_dwordx4 v18, s[28:31], s83 offen offset:0 lds
v_mfma_f32_16x16x32_bf16 v[96:99], a[104:107], v[224:227], v[96:99]
v_mfma_f32_16x16x32_bf16 v[112:115], a[108:111], v[224:227], v[112:115]
s_waitcnt vmcnt(20)
v_mfma_f32_16x16x32_bf16 v[68:71], a[96:99], v[228:231], v[68:71]
buffer_load_dwordx4 v19, s[28:31], s83 offen offset:1024 lds
v_mfma_f32_16x16x32_bf16 v[84:87], a[100:103], v[228:231], v[84:87]
v_mfma_f32_16x16x32_bf16 v[100:103], a[104:107], v[228:231], v[100:103]
v_mfma_f32_16x16x32_bf16 v[116:119], a[108:111], v[228:231], v[116:119]
buffer_load_dwordx4 v20, s[28:31], s83 offen offset:2048 lds
s_waitcnt vmcnt(21)
v_mfma_f32_16x16x32_bf16 v[72:75], a[96:99], v[232:235], v[72:75]
v_mfma_f32_16x16x32_bf16 v[88:91], a[100:103], v[232:235], v[88:91]
v_mfma_f32_16x16x32_bf16 v[104:107], a[104:107], v[232:235], v[104:107]
buffer_load_dwordx4 v21, s[28:31], s83 offen offset:3072 lds
s_waitcnt vmcnt(16)
ds_read_b64_tr_b16 a[32:33], v22 offset:8192
v_mfma_f32_16x16x32_bf16 v[120:123], a[108:111], v[232:235], v[120:123]
ds_read_b64_tr_b16 a[34:35], v22 offset:10240
ds_read_b64_tr_b16 a[36:37], v23 offset:8192
ds_read_b64_tr_b16 a[38:39], v23 offset:10240
v_mfma_f32_16x16x32_bf16 v[76:79], a[96:99], v[236:239], v[76:79]
ds_read_b64_tr_b16 a[40:41], v24 offset:8192
ds_read_b64_tr_b16 a[42:43], v24 offset:10240
ds_read_b64_tr_b16 a[44:45], v25 offset:8192
v_mfma_f32_16x16x32_bf16 v[92:95], a[100:103], v[236:239], v[92:95]
ds_read_b64_tr_b16 a[46:47], v25 offset:10240
s_waitcnt lgkmcnt(0)
s_add_u32 s82, s101, 6
v_mfma_f32_16x16x32_bf16 v[108:111], a[104:107], v[236:239], v[108:111]
s_cmp_ge_u32 s82, 7
s_cselect_b32 s45, 7, 0
s_sub_u32 s82, s82, s45
v_mfma_f32_16x16x32_bf16 v[124:127], a[108:111], v[236:239], v[124:127]
s_mul_i32 s83, s44, 7
s_add_u32 s83, s83, s82
s_lshl_b32 s83, s83, 15
s_waitcnt vmcnt(15)
v_mfma_f32_16x16x32_bf16 v[64:67], a[112:115], v[240:243], v[64:67]
s_add_u32 m0, s77, 8192
s_nop 0
buffer_load_dwordx4 v18, s[28:31], s83 offen offset:0 lds
v_mfma_f32_16x16x32_bf16 v[80:83], a[116:119], v[240:243], v[80:83]
v_mfma_f32_16x16x32_bf16 v[96:99], a[120:123], v[240:243], v[96:99]
v_mfma_f32_16x16x32_bf16 v[112:115], a[124:127], v[240:243], v[112:115]
buffer_load_dwordx4 v19, s[28:31], s83 offen offset:1024 lds
s_waitcnt vmcnt(16)
v_mfma_f32_16x16x32_bf16 v[68:71], a[112:115], v[244:247], v[68:71]
v_mfma_f32_16x16x32_bf16 v[84:87], a[116:119], v[244:247], v[84:87]
v_mfma_f32_16x16x32_bf16 v[100:103], a[120:123], v[244:247], v[100:103]
buffer_load_dwordx4 v20, s[28:31], s83 offen offset:2048 lds
v_mfma_f32_16x16x32_bf16 v[116:119], a[124:127], v[244:247], v[116:119]
s_waitcnt vmcnt(16)
v_mfma_f32_16x16x32_bf16 v[72:75], a[112:115], v[248:251], v[72:75]
v_mfma_f32_16x16x32_bf16 v[88:91], a[116:119], v[248:251], v[88:91]
buffer_load_dwordx4 v21, s[28:31], s83 offen offset:3072 lds
s_waitcnt vmcnt(12)
ds_read_b64_tr_b16 a[48:49], v22 offset:12288
v_mfma_f32_16x16x32_bf16 v[104:107], a[120:123], v[248:251], v[104:107]
ds_read_b64_tr_b16 a[50:51], v22 offset:14336
ds_read_b64_tr_b16 a[52:53], v23 offset:12288
ds_read_b64_tr_b16 a[54:55], v23 offset:14336
v_mfma_f32_16x16x32_bf16 v[120:123], a[124:127], v[248:251], v[120:123]
ds_read_b64_tr_b16 a[56:57], v24 offset:12288
ds_read_b64_tr_b16 a[58:59], v24 offset:14336
ds_read_b64_tr_b16 a[60:61], v25 offset:12288
v_mfma_f32_16x16x32_bf16 v[76:79], a[112:115], v[252:255], v[76:79]
ds_read_b64_tr_b16 a[62:63], v25 offset:14336
buffer_load_dwordx4 v[32:35], v13, s[8:11], s74 offen
v_mfma_f32_16x16x32_bf16 v[92:95], a[116:119], v[252:255], v[92:95]
v_mfma_f32_16x16x32_bf16 v[108:111], a[120:123], v[252:255], v[108:111]
v_mfma_f32_16x16x32_bf16 v[124:127], a[124:127], v[252:255], v[124:127]
buffer_load_dwordx4 v[36:39], v13, s[8:11], s74 offen offset:64
s_lshl_b32 s97, s70, 2
s_add_u32 s97, s97, s44
s_lshl_b32 s97, s97, 8
s_add_u32 s97, s97, 0x10000
buffer_load_dwordx4 v[8:11], v6, s[20:23], s97 offen sc1
s_waitcnt vmcnt(11)
ds_read_b64_tr_b16 a[128:129], v22 offset:0
ds_read_b64_tr_b16 a[130:131], v22 offset:2048
ds_read_b64_tr_b16 a[132:133], v23 offset:0
ds_read_b64_tr_b16 a[134:135], v23 offset:2048
ds_read_b64_tr_b16 a[136:137], v24 offset:0
ds_read_b64_tr_b16 a[138:139], v24 offset:2048
ds_read_b64_tr_b16 a[140:141], v25 offset:0
ds_read_b64_tr_b16 a[142:143], v25 offset:2048
s_waitcnt vmcnt(7)
ds_read_b64_tr_b16 a[144:145], v22 offset:4096
ds_read_b64_tr_b16 a[146:147], v22 offset:6144
ds_read_b64_tr_b16 a[148:149], v23 offset:4096
ds_read_b64_tr_b16 a[150:151], v23 offset:6144
ds_read_b64_tr_b16 a[152:153], v24 offset:4096
ds_read_b64_tr_b16 a[154:155], v24 offset:6144
ds_read_b64_tr_b16 a[156:157], v25 offset:4096
ds_read_b64_tr_b16 a[158:159], v25 offset:6144
s_waitcnt vmcnt(3)
ds_read_b64_tr_b16 a[160:161], v22 offset:8192
ds_read_b64_tr_b16 a[162:163], v22 offset:10240
ds_read_b64_tr_b16 a[164:165], v23 offset:8192
ds_read_b64_tr_b16 a[166:167], v23 offset:10240
ds_read_b64_tr_b16 a[168:169], v24 offset:8192
ds_read_b64_tr_b16 a[170:171], v24 offset:10240
ds_read_b64_tr_b16 a[172:173], v25 offset:8192
ds_read_b64_tr_b16 a[174:175], v25 offset:10240
s_waitcnt vmcnt(0)
v_xor_b32 v12, v8, v28
v_xor_b32 v9, v9, v28
v_xor_b32 v10, v10, v28
v_xor_b32 v11, v11, v28
v_or3_b32 v12, v12, v9, v10
v_or_b32 v12, v12, v11
v_cmp_ne_u32 vcc, 0, v12
s_nop 1
s_cbranch_vccnz L_pslow_28
L_pret_29:
s_add_u32 s82, s101, 0
s_cmp_ge_u32 s82, 7
s_cselect_b32 s45, 7, 0
s_sub_u32 s82, s82, s45
s_lshl_b32 s82, s82, 10
s_add_u32 s82, s82, s100
buffer_load_dwordx4 v[128:131], v14, s[20:23], s82 offen sc1
buffer_load_dwordx4 v[132:135], v15, s[20:23], s82 offen sc1
buffer_load_dwordx4 v[136:139], v16, s[20:23], s82 offen sc1
buffer_load_dwordx4 v[140:143], v17, s[20:23], s82 offen sc1
s_add_u32 s82, s101, 1
s_cmp_ge_u32 s82, 7
s_cselect_b32 s45, 7, 0
s_sub_u32 s82, s82, s45
s_lshl_b32 s82, s82, 10
s_add_u32 s82, s82, s100
buffer_load_dwordx4 v[144:147], v14, s[20:23], s82 offen sc1
buffer_load_dwordx4 v[148:151], v15, s[20:23], s82 offen sc1
buffer_load_dwordx4 v[152:155], v16, s[20:23], s82 offen sc1
buffer_load_dwordx4 v[156:159], v17, s[20:23], s82 offen sc1
s_waitcnt vmcnt(7)
v_mfma_f32_16x16x32_bf16 v[64:67], a[0:3], v[128:131], v[64:67]
v_mfma_f32_16x16x32_bf16 v[80:83], a[4:7], v[128:131], v[80:83]
v_mfma_f32_16x16x32_bf16 v[96:99], a[8:11], v[128:131], v[96:99]
s_add_u32 s82, s101, 2
s_cmp_ge_u32 s82, 7
s_cselect_b32 s45, 7, 0
v_mfma_f32_16x16x32_bf16 v[112:115], a[12:15], v[128:131], v[112:115]
s_sub_u32 s82, s82, s45
s_lshl_b32 s82, s82, 10
s_add_u32 s82, s82, s100
s_waitcnt vmcnt(6)
v_mfma_f32_16x16x32_bf16 v[68:71], a[0:3], v[132:135], v[68:71]
buffer_load_dwordx4 v[160:163], v14, s[20:23], s82 offen sc1
v_mfma_f32_16x16x32_bf16 v[84:87], a[4:7], v[132:135], v[84:87]
v_mfma_f32_16x16x32_bf16 v[100:103], a[8:11], v[132:135], v[100:103]
v_mfma_f32_16x16x32_bf16 v[116:119], a[12:15], v[132:135], v[116:119]
buffer_load_dwordx4 v[164:167], v15, s[20:23], s82 offen sc1
s_waitcnt vmcnt(7)
v_mfma_f32_16x16x32_bf16 v[72:75], a[0:3], v[136:139], v[72:75]
v_mfma_f32_16x16x32_bf16 v[88:91], a[4:7], v[136:139], v[88:91]
v_mfma_f32_16x16x32_bf16 v[104:107], a[8:11], v[136:139], v[104:107]
buffer_load_dwordx4 v[168:171], v16, s[20:23], s82 offen sc1
v_mfma_f32_16x16x32_bf16 v[120:123], a[12:15], v[136:139], v[120:123]
s_waitcnt vmcnt(7)
v_mfma_f32_16x16x32_bf16 v[76:79], a[0:3], v[140:143], v[76:79]
v_mfma_f32_16x16x32_bf16 v[92:95], a[4:7], v[140:143], v[92:95]
buffer_load_dwordx4 v[172:175], v17, s[20:23], s82 offen sc1
v_mfma_f32_16x16x32_bf16 v[108:111], a[8:11], v[140:143], v[108:111]
v_mfma_f32_16x16x32_bf16 v[124:127], a[12:15], v[140:143], v[124:127]
s_add_u32 s82, s101, 3
s_cmp_ge_u32 s82, 7
s_cselect_b32 s45, 7, 0
s_waitcnt vmcnt(7)
v_mfma_f32_16x16x32_bf16 v[64:67], a[16:19], v[144:147], v[64:67]
s_sub_u32 s82, s82, s45
s_lshl_b32 s82, s82, 10
s_add_u32 s82, s82, s100
v_mfma_f32_16x16x32_bf16 v[80:83], a[20:23], v[144:147], v[80:83]
buffer_load_dwordx4 a[176:179], v14, s[20:23], s82 offen sc1
v_mfma_f32_16x16x32_bf16 v[96:99], a[24:27], v[144:147], v[96:99]
v_mfma_f32_16x16x32_bf16 v[112:115], a[28:31], v[144:147], v[112:115]
s_waitcnt vmcnt(7)
v_mfma_f32_16x16x32_bf16 v[68:71], a[16:19], v[148:151], v[68:71]
buffer_load_dwordx4 a[180:183], v15, s[20:23], s82 offen sc1
v_mfma_f32_16x16x32_bf16 v[84:87], a[20:23], v[148:151], v[84:87]
v_mfma_f32_16x16x32_bf16 v[100:103], a[24:27], v[148:151], v[100:103]
v_mfma_f32_16x16x32_bf16 v[116:119], a[28:31], v[148:151], v[116:119]
buffer_load_dwordx4 a[184:187], v16, s[20:23], s82 offen sc1
s_waitcnt vmcnt(8)
v_mfma_f32_16x16x32_bf16 v[72:75], a[16:19], v[152:155], v[72:75]
v_mfma_f32_16x16x32_bf16 v[88:91], a[20:23], v[152:155], v[88:91]
v_mfma_f32_16x16x32_bf16 v[104:107], a[24:27], v[152:155], v[104:107]
buffer_load_dwordx4 a[188:191], v17, s[20:23], s82 offen sc1
v_mfma_f32_16x16x32_bf16 v[120:123], a[28:31], v[152:155], v[120:123]
s_waitcnt vmcnt(8)
v_mfma_f32_16x16x32_bf16 v[76:79], a[16:19], v[156:159], v[76:79]
s_add_u32 s82, s101, 4
s_cmp_ge_u32 s82, 7
s_cselect_b32 s45, 7, 0
v_mfma_f32_16x16x32_bf16 v[92:95], a[20:23], v[156:159], v[92:95]
s_sub_u32 s82, s82, s45
s_lshl_b32 s82, s82, 10
s_add_u32 s82, s82, s100
v_mfma_f32_16x16x32_bf16 v[108:111], a[24:27], v[156:159], v[108:111]
buffer_load_dwordx4 a[192:195], v14, s[20:23], s82 offen sc1
v_mfma_f32_16x16x32_bf16 v[124:127], a[28:31], v[156:159], v[124:127]
s_waitcnt vmcnt(8)
v_mfma_f32_16x16x32_bf16 v[64:67], a[32:35], v[160:163], v[64:67]
v_mfma_f32_16x16x32_bf16 v[80:83], a[36:39], v[160:163], v[80:83]
buffer_load_dwordx4 a[196:199], v15, s[20:23], s82 offen sc1
v_mfma_f32_16x16x32_bf16 v[96:99], a[40:43], v[160:163], v[96:99]
v_mfma_f32_16x16x32_bf16 v[112:115], a[44:47], v[160:163], v[112:115]
s_waitcnt vmcnt(8)
v_mfma_f32_16x16x32_bf16 v[68:71], a[32:35], v[164:167], v[68:71]
buffer_load_dwordx4 a[200:203], v16, s[20:23], s82 offen sc1
v_mfma_f32_16x16x32_bf16 v[84:87], a[36:39], v[164:167], v[84:87]
v_mfma_f32_16x16x32_bf16 v[100:103], a[40:43], v[164:167], v[100:103]
v_mfma_f32_16x16x32_bf16 v[116:119], a[44:47], v[164:167], v[116:119]
buffer_load_dwordx4 a[204:207], v17, s[20:23], s82 offen sc1
s_waitcnt vmcnt(9)
v_mfma_f32_16x16x32_bf16 v[72:75], a[32:35], v[168:171], v[72:75]
v_mfma_f32_16x16x32_bf16 v[88:91], a[36:39], v[168:171], v[88:91]
s_add_u32 s82, s101, 5
s_cmp_ge_u32 s82, 7
s_cselect_b32 s45, 7, 0
v_mfma_f32_16x16x32_bf16 v[104:107], a[40:43], v[168:171], v[104:107]
s_sub_u32 s82, s82, s45
s_lshl_b32 s82, s82, 10
s_add_u32 s82, s82, s100
v_mfma_f32_16x16x32_bf16 v[120:123], a[44:47], v[168:171], v[120:123]
buffer_load_dwordx4 a[208:211], v14, s[20:23], s82 offen sc1
s_waitcnt vmcnt(9)
v_mfma_f32_16x16x32_bf16 v[76:79], a[32:35], v[172:175], v[76:79]
v_mfma_f32_16x16x32_bf16 v[92:95], a[36:39], v[172:175], v[92:95]
v_mfma_f32_16x16x32_bf16 v[108:111], a[40:43], v[172:175], v[108:111]
buffer_load_dwordx4 a[212:215], v15, s[20:23], s82 offen sc1
v_mfma_f32_16x16x32_bf16 v[124:127], a[44:47], v[172:175], v[124:127]
s_waitcnt vmcnt(9) lgkmcnt(15)
v_mfma_f32_16x16x32_bf16 v[64:67], a[48:51], a[176:179], v[64:67]
v_mfma_f32_16x16x32_bf16 v[80:83], a[52:55], a[176:179], v[80:83]
buffer_load_dwordx4 a[216:219], v16, s[20:23], s82 offen sc1
v_mfma_f32_16x16x32_bf16 v[96:99], a[56:59], a[176:179], v[96:99]
v_mfma_f32_16x16x32_bf16 v[112:115], a[60:63], a[176:179], v[112:115]
s_waitcnt vmcnt(9)
v_mfma_f32_16x16x32_bf16 v[68:71], a[48:51], a[180:183], v[68:71]
buffer_load_dwordx4 a[220:223], v17, s[20:23], s82 offen sc1
v_mfma_f32_16x16x32_bf16 v[84:87], a[52:55], a[180:183], v[84:87]
v_mfma_f32_16x16x32_bf16 v[100:103], a[56:59], a[180:183], v[100:103]
s_add_u32 s82, s101, 6
s_cmp_ge_u32 s82, 7
s_cselect_b32 s45, 7, 0
v_mfma_f32_16x16x32_bf16 v[116:119], a[60:63], a[180:183], v[116:119]
s_sub_u32 s82, s82, s45
s_lshl_b32 s82, s82, 10
s_add_u32 s82, s82, s100
s_waitcnt vmcnt(9)
v_mfma_f32_16x16x32_bf16 v[72:75], a[48:51], a[184:187], v[72:75]
buffer_load_dwordx4 a[224:227], v14, s[20:23], s82 offen sc1
v_mfma_f32_16x16x32_bf16 v[88:91], a[52:55], a[184:187], v[88:91]
v_mfma_f32_16x16x32_bf16 v[104:107], a[56:59], a[184:187], v[104:107]
v_mfma_f32_16x16x32_bf16 v[120:123], a[60:63], a[184:187], v[120:123]
buffer_load_dwordx4 a[228:231], v15, s[20:23], s82 offen sc1
s_waitcnt vmcnt(10)
v_mfma_f32_16x16x32_bf16 v[76:79], a[48:51], a[188:191], v[76:79]
v_mfma_f32_16x16x32_bf16 v[92:95], a[52:55], a[188:191], v[92:95]
v_mfma_f32_16x16x32_bf16 v[108:111], a[56:59], a[188:191], v[108:111]
buffer_load_dwordx4 a[232:235], v16, s[20:23], s82 offen sc1
v_mfma_f32_16x16x32_bf16 v[124:127], a[60:63], a[188:191], v[124:127]
s_waitcnt vmcnt(10)
v_mfma_f32_16x16x32_bf16 v[64:67], a[128:131], a[192:195], v[64:67]
v_mfma_f32_16x16x32_bf16 v[80:83], a[132:135], a[192:195], v[80:83]
buffer_load_dwordx4 a[236:239], v17, s[20:23], s82 offen sc1
v_mfma_f32_16x16x32_bf16 v[96:99], a[136:139], a[192:195], v[96:99]
s_add_u32 s84, s44, 1
s_and_b32 s84, s84, 3
v_mfma_f32_16x16x32_bf16 v[112:115], a[140:143], a[192:195], v[112:115]
s_mul_i32 s84, s84, 12288
s_add_u32 s84, s84, 0
s_waitcnt vmcnt(10)
v_mfma_f32_16x16x32_bf16 v[68:71], a[128:131], a[196:199], v[68:71]
v_add_u32 v29, s84, v1
s_add_u32 s84, s44, 2
v_mfma_f32_16x16x32_bf16 v[84:87], a[132:135], a[196:199], v[84:87]
s_and_b32 s84, s84, 3
s_mul_i32 s84, s84, 12288
v_mfma_f32_16x16x32_bf16 v[100:103], a[136:139], a[196:199], v[100:103]
s_add_u32 s84, s84, 4096
v_add_u32 v30, s84, v1
v_mfma_f32_16x16x32_bf16 v[116:119], a[140:143], a[196:199], v[116:119]
s_add_u32 s84, s44, 3
s_and_b32 s84, s84, 3
s_waitcnt vmcnt(9)
v_mfma_f32_16x16x32_bf16 v[72:75], a[128:131], a[200:203], v[72:75]
s_mul_i32 s84, s84, 12288
s_add_u32 s84, s84, 8192
v_mfma_f32_16x16x32_bf16 v[88:91], a[132:135], a[200:203], v[88:91]
v_add_u32 v31, s84, v1
s_mul_i32 s84, s44, 12288
v_mfma_f32_16x16x32_bf16 v[104:107], a[136:139], a[200:203], v[104:107]
v_add_u32 v7, s84, v1
v_mfma_f32_16x16x32_bf16 v[120:123], a[140:143], a[200:203], v[120:123]
s_waitcnt vmcnt(8)
v_mfma_f32_16x16x32_bf16 v[76:79], a[128:131], a[204:207], v[76:79]
v_mfma_f32_16x16x32_bf16 v[92:95], a[132:135], a[204:207], v[92:95]
v_mfma_f32_16x16x32_bf16 v[108:111], a[136:139], a[204:207], v[108:111]
v_mfma_f32_16x16x32_bf16 v[124:127], a[140:143], a[204:207], v[124:127]
s_waitcnt vmcnt(6) lgkmcnt(14)
v_mfma_f32_16x16x32_bf16 v[68:71], a[144:147], a[212:215], v[68:71]
s_waitcnt lgkmcnt(12)
v_mfma_f32_16x16x32_bf16 v[84:87], a[148:151], a[212:215], v[84:87]
s_waitcnt lgkmcnt(10)
v_mfma_f32_16x16x32_bf16 v[100:103], a[152:155], a[212:215], v[100:103]
s_waitcnt lgkmcnt(8)
v_mfma_f32_16x16x32_bf16 v[116:119], a[156:159], a[212:215], v[116:119]
s_waitcnt vmcnt(2) lgkmcnt(6)
v_mfma_f32_16x16x32_bf16 v[68:71], a[160:163], a[228:231], v[68:71]
s_waitcnt lgkmcnt(4)
v_mfma_f32_16x16x32_bf16 v[84:87], a[164:167], a[228:231], v[84:87]
s_waitcnt lgkmcnt(2)
v_mfma_f32_16x16x32_bf16 v[100:103], a[168:171], a[228:231], v[100:103]
s_waitcnt lgkmcnt(0)
v_mfma_f32_16x16x32_bf16 v[116:119], a[172:175], a[228:231], v[116:119]
v_mfma_f32_16x16x32_bf16 v[72:75], a[144:147], a[216:219], v[72:75]
v_mfma_f32_16x16x32_bf16 v[88:91], a[148:151], a[216:219], v[88:91]
ds_write_b128 v29, v[68:71] offset:0
v_mfma_f32_16x16x32_bf16 v[104:107], a[152:155], a[216:219], v[104:107]
v_mfma_f32_16x16x32_bf16 v[120:123], a[156:159], a[216:219], v[120:123]
ds_write_b128 v29, v[84:87] offset:1024
s_waitcnt vmcnt(1)
v_mfma_f32_16x16x32_bf16 v[72:75], a[160:163], a[232:235], v[72:75]
v_mfma_f32_16x16x32_bf16 v[88:91], a[164:167], a[232:235], v[88:91]
ds_write_b128 v29, v[100:103] offset:2048
v_mfma_f32_16x16x32_bf16 v[104:107], a[168:171], a[232:235], v[104:107]
v_mfma_f32_16x16x32_bf16 v[120:123], a[172:175], a[232:235], v[120:123]
ds_write_b128 v29, v[116:119] offset:3072
v_mfma_f32_16x16x32_bf16 v[76:79], a[144:147], a[220:223], v[76:79]
v_mfma_f32_16x16x32_bf16 v[92:95], a[148:151], a[220:223], v[92:95]
s_nop 0
ds_write_b128 v30, v[72:75] offset:0
v_mfma_f32_16x16x32_bf16 v[108:111], a[152:155], a[220:223], v[108:111]
v_mfma_f32_16x16x32_bf16 v[124:127], a[156:159], a[220:223], v[124:127]
ds_write_b128 v30, v[88:91] offset:1024
s_waitcnt vmcnt(0)
v_mfma_f32_16x16x32_bf16 v[76:79], a[160:163], a[236:239], v[76:79]
v_mfma_f32_16x16x32_bf16 v[92:95], a[164:167], a[236:239], v[92:95]
ds_write_b128 v30, v[104:107] offset:2048
v_mfma_f32_16x16x32_bf16 v[108:111], a[168:171], a[236:239], v[108:111]
v_mfma_f32_16x16x32_bf16 v[124:127], a[172:175], a[236:239], v[124:127]
ds_write_b128 v30, v[120:123] offset:3072
v_mfma_f32_16x16x32_bf16 v[64:67], a[144:147], a[208:211], v[64:67]
v_mfma_f32_16x16x32_bf16 v[80:83], a[148:151], a[208:211], v[80:83]
s_nop 0
ds_write_b128 v31, v[76:79] offset:0
v_mfma_f32_16x16x32_bf16 v[96:99], a[152:155], a[208:211], v[96:99]
v_mfma_f32_16x16x32_bf16 v[112:115], a[156:159], a[208:211], v[112:115]
ds_write_b128 v31, v[92:95] offset:1024
v_mfma_f32_16x16x32_bf16 v[64:67], a[160:163], a[224:227], v[64:67]
v_mfma_f32_16x16x32_bf16 v[80:83], a[164:167], a[224:227], v[80:83]
ds_write_b128 v31, v[108:111] offset:2048
v_mfma_f32_16x16x32_bf16 v[96:99], a[168:171], a[224:227], v[96:99]
v_mfma_f32_16x16x32_bf16 v[112:115], a[172:175], a[224:227], v[112:115]
ds_write_b128 v31, v[124:127] offset:3072
v_and_b32 v14, 0x1fff, v13
v_bfe_u32 v15, v0, 3, 1
v_lshl_add_u32 v14, v15, 6, v14
s_add_u32 s75, s74, 8192
v_lshlrev_b32 v40, 16, v32
v_and_b32 v41, 0xffff0000, v32
v_lshlrev_b32 v42, 16, v33
v_and_b32 v43, 0xffff0000, v33
v_lshlrev_b32 v44, 16, v34
v_and_b32 v45, 0xffff0000, v34
v_lshlrev_b32 v46, 16, v35
v_and_b32 v47, 0xffff0000, v35
v_lshlrev_b32 v48, 16, v36
v_and_b32 v49, 0xffff0000, v36
v_lshlrev_b32 v50, 16, v37
v_and_b32 v51, 0xffff0000, v37
v_lshlrev_b32 v52, 16, v38
v_and_b32 v53, 0xffff0000, v38
v_lshlrev_b32 v54, 16, v39
v_and_b32 v55, 0xffff0000, v39
s_waitcnt lgkmcnt(0)
s_barrier
ds_read_b128 v[68:71], v7 offset:0
ds_read_b128 v[72:75], v7 offset:4096
ds_read_b128 v[76:79], v7 offset:8192
ds_read_b128 v[84:87], v7 offset:1024
ds_read_b128 v[88:91], v7 offset:5120
ds_read_b128 v[92:95], v7 offset:9216
ds_read_b128 v[100:103], v7 offset:2048
ds_read_b128 v[104:107], v7 offset:6144
ds_read_b128 v[108:111], v7 offset:10240
ds_read_b128 v[116:119], v7 offset:3072
ds_read_b128 v[120:123], v7 offset:7168
ds_read_b128 v[124:127], v7 offset:11264
s_waitcnt lgkmcnt(11)
v_pk_add_f32 v[64:65], v[64:65], v[68:69]
s_waitcnt lgkmcnt(9)
v_pk_add_f32 v[72:73], v[72:73], v[76:77]
v_pk_add_f32 v[66:67], v[66:67], v[70:71]
v_pk_add_f32 v[74:75], v[74:75], v[78:79]
s_waitcnt lgkmcnt(8)
v_pk_add_f32 v[80:81], v[80:81], v[84:85]
s_waitcnt lgkmcnt(6)
v_pk_add_f32 v[88:89], v[88:89], v[92:93]
v_pk_add_f32 v[82:83], v[82:83], v[86:87]
v_pk_add_f32 v[90:91], v[90:91], v[94:95]
v_pk_add_f32 v[64:65], v[64:65], v[72:73]
v_pk_add_f32 v[66:67], v[66:67], v[74:75]
v_pk_add_f32 v[80:81], v[80:81], v[88:89]
v_pk_add_f32 v[82:83], v[82:83], v[90:91]
s_nop 0
v_permlane16_swap_b32 v64, v80
v_permlane16_swap_b32 v65, v81
v_permlane16_swap_b32 v66, v82
v_permlane16_swap_b32 v67, v83
v_pk_add_f32 v[64:65], v[64:65], v[40:41]
v_pk_add_f32 v[66:67], v[66:67], v[42:43]
v_pk_add_f32 v[80:81], v[80:81], v[44:45]
v_pk_add_f32 v[82:83], v[82:83], v[46:47]
v_cvt_pk_bf16_f32 v32, v64, v65
v_cvt_pk_bf16_f32 v33, v66, v67
v_cvt_pk_bf16_f32 v34, v80, v81
v_cvt_pk_bf16_f32 v35, v82, v83
s_waitcnt lgkmcnt(5)
v_pk_add_f32 v[96:97], v[96:97], v[100:101]
s_waitcnt lgkmcnt(3)
v_pk_add_f32 v[104:105], v[104:105], v[108:109]
v_pk_add_f32 v[98:99], v[98:99], v[102:103]
v_pk_add_f32 v[106:107], v[106:107], v[110:111]
s_waitcnt lgkmcnt(2)
v_pk_add_f32 v[112:113], v[112:113], v[116:117]
s_waitcnt lgkmcnt(0)
v_pk_add_f32 v[120:121], v[120:121], v[124:125]
v_pk_add_f32 v[114:115], v[114:115], v[118:119]
v_pk_add_f32 v[122:123], v[122:123], v[126:127]
v_pk_add_f32 v[96:97], v[96:97], v[104:105]
v_pk_add_f32 v[98:99], v[98:99], v[106:107]
v_pk_add_f32 v[112:113], v[112:113], v[120:121]
v_pk_add_f32 v[114:115], v[114:115], v[122:123]
s_nop 0
v_permlane16_swap_b32 v96, v112
v_permlane16_swap_b32 v97, v113
v_permlane16_swap_b32 v98, v114
v_permlane16_swap_b32 v99, v115
v_pk_add_f32 v[96:97], v[96:97], v[48:49]
v_pk_add_f32 v[98:99], v[98:99], v[50:51]
v_pk_add_f32 v[112:113], v[112:113], v[52:53]
v_pk_add_f32 v[114:115], v[114:115], v[54:55]
v_cvt_pk_bf16_f32 v36, v96, v97
v_cvt_pk_bf16_f32 v37, v98, v99
v_cvt_pk_bf16_f32 v38, v112, v113
v_cvt_pk_bf16_f32 v39, v114, v115
v_mov_b32 v40, v32
v_mov_b32 v41, v33
v_mov_b32 v42, v34
v_mov_b32 v43, v35
v_mov_b32_dpp v32, v36 row_ror:8 row_mask:0xf bank_mask:0xc
v_mov_b32_dpp v33, v37 row_ror:8 row_mask:0xf bank_mask:0xc
v_mov_b32_dpp v34, v38 row_ror:8 row_mask:0xf bank_mask:0xc
v_mov_b32_dpp v35, v39 row_ror:8 row_mask:0xf bank_mask:0xc
v_mov_b32_dpp v36, v40 row_ror:8 row_mask:0xf bank_mask:0x3
v_mov_b32_dpp v37, v41 row_ror:8 row_mask:0xf bank_mask:0x3
v_mov_b32_dpp v38, v42 row_ror:8 row_mask:0xf bank_mask:0x3
v_mov_b32_dpp v39, v43 row_ror:8 row_mask:0xf bank_mask:0x3
buffer_store_dwordx4 v[32:35], v14, s[32:35], s74 offen sc0 sc1 nt
buffer_store_dwordx4 v[36:39], v14, s[32:35], s75 offen sc0 sc1 nt
L_end:
s_endpgm
L_tagslow_1:
s_mov_b32 s96, 524288
L_tagslow_1_l:
s_sleep 1
buffer_load_dword v28, off, s[40:43], 0 sc1
s_waitcnt vmcnt(0)
v_readfirstlane_b32 s73, v28
s_sub_u32 s96, s96, 1
s_cbranch_scc1 L_tagret_2
s_cmp_eq_u32 s73, 0
s_cbranch_scc1 L_tagslow_1_l
s_branch L_tagret_2
L_pslow_3:
s_mov_b32 s96, 524288
L_pslow_3_l:
s_add_u32 s85, s0, 0x40000
buffer_load_dwordx4 v[192:195], v188, s[20:23], s85 offen sc1
s_add_u32 s85, s0, 0x41000
buffer_load_dwordx4 v[196:199], v188, s[20:23], s85 offen sc1
s_add_u32 s85, s0, 0x42000
buffer_load_dwordx4 v[200:203], v188, s[20:23], s85 offen sc1
s_add_u32 s85, s0, 0x43000
buffer_load_dwordx4 v[204:207], v188, s[20:23], s85 offen sc1
s_waitcnt vmcnt(0)
v_xor_b32 v208, v193, v28
v_xor_b32 v195, v195, v28
v_xor_b32 v197, v197, v28
v_xor_b32 v199, v199, v28
v_xor_b32 v201, v201, v28
v_xor_b32 v203, v203, v28
v_xor_b32 v205, v205, v28
v_xor_b32 v207, v207, v28
v_or3_b32 v208, v208, v195, v197
v_or3_b32 v208, v208, v199, v201
v_or3_b32 v208, v208, v203, v205
v_or_b32 v208, v208, v207
v_cmp_ne_u32 vcc, 0, v208
s_nop 1
s_cbranch_vccz L_pret_4
s_sleep 1
s_sub_u32 s96, s96, 1
s_cbranch_scc0 L_pslow_3_l
s_branch L_pret_4
L_pslow_5:
s_mov_b32 s96, 524288
L_pslow_5_l:
buffer_load_dwordx4 v[12:15], v6, s[20:23], s100 offen sc1
s_waitcnt vmcnt(0)
v_xor_b32 v30, v12, v28
v_xor_b32 v13, v13, v28
v_xor_b32 v14, v14, v28
v_xor_b32 v15, v15, v28
v_or3_b32 v30, v30, v13, v14
v_or_b32 v30, v30, v15
v_cmp_ne_u32 vcc, 0, v30
s_nop 1
s_cbranch_vccz L_pret_6
s_sleep 1
s_sub_u32 s96, s96, 1
s_cbranch_scc0 L_pslow_5_l
s_branch L_pret_6
L_tagslow_7:
s_mov_b32 s96, 524288
L_tagslow_7_l:
s_sleep 1
buffer_load_dword v28, off, s[40:43], 0 sc1
s_waitcnt vmcnt(0)
v_readfirstlane_b32 s73, v28
s_sub_u32 s96, s96, 1
s_cbranch_scc1 L_tagret_8
s_cmp_eq_u32 s73, 0
s_cbranch_scc1 L_tagslow_7_l
s_branch L_tagret_8
L_pslow_9:
s_mov_b32 s96, 524288
L_pslow_9_l:
s_add_u32 s85, s0, 0x40000
buffer_load_dwordx4 v[192:195], v188, s[20:23], s85 offen sc1
s_add_u32 s85, s0, 0x41000
buffer_load_dwordx4 v[196:199], v188, s[20:23], s85 offen sc1
s_add_u32 s85, s0, 0x42000
buffer_load_dwordx4 v[200:203], v188, s[20:23], s85 offen sc1
s_add_u32 s85, s0, 0x43000
buffer_load_dwordx4 v[204:207], v188, s[20:23], s85 offen sc1
s_waitcnt vmcnt(0)
v_xor_b32 v208, v193, v28
v_xor_b32 v195, v195, v28
v_xor_b32 v197, v197, v28
v_xor_b32 v199, v199, v28
v_xor_b32 v201, v201, v28
v_xor_b32 v203, v203, v28
v_xor_b32 v205, v205, v28
v_xor_b32 v207, v207, v28
v_or3_b32 v208, v208, v195, v197
v_or3_b32 v208, v208, v199, v201
v_or3_b32 v208, v208, v203, v205
v_or_b32 v208, v208, v207
v_cmp_ne_u32 vcc, 0, v208
s_nop 1
s_cbranch_vccz L_pret_10
s_sleep 1
s_sub_u32 s96, s96, 1
s_cbranch_scc0 L_pslow_9_l
s_branch L_pret_10
L_pslow_11:
s_mov_b32 s96, 524288
L_pslow_11_l:
buffer_load_dwordx4 v[12:15], v6, s[20:23], s100 offen sc1
s_waitcnt vmcnt(0)
v_xor_b32 v30, v12, v28
v_xor_b32 v13, v13, v28
v_xor_b32 v14, v14, v28
v_xor_b32 v15, v15, v28
v_or3_b32 v30, v30, v13, v14
v_or_b32 v30, v30, v15
v_cmp_ne_u32 vcc, 0, v30
s_nop 1
s_cbranch_vccz L_pret_12
s_sleep 1
s_sub_u32 s96, s96, 1
s_cbranch_scc0 L_pslow_11_l
s_branch L_pret_12
L_tagslow_13:
s_mov_b32 s96, 524288
L_tagslow_13_l:
s_sleep 1
buffer_load_dword v28, off, s[40:43], 0 sc1
s_waitcnt vmcnt(0)
v_readfirstlane_b32 s73, v28
s_sub_u32 s96, s96, 1
s_cbranch_scc1 L_tagret_14
s_cmp_eq_u32 s73, 0
s_cbranch_scc1 L_tagslow_13_l
s_branch L_tagret_14
L_pslow_15:
s_mov_b32 s96, 524288
L_pslow_15_l:
buffer_load_dwordx4 v[172:175], v184, s[20:23], s100 offen sc1
buffer_load_dwordx4 v[176:179], v184, s[20:23], s100 offen offset:256 sc1
buffer_load_dwordx4 v[180:183], v184, s[20:23], s101 offen sc1
s_waitcnt vmcnt(0)
v_xor_b32 v185, v173, v28
v_xor_b32 v175, v175, v28
v_xor_b32 v177, v177, v28
v_xor_b32 v179, v179, v28
v_xor_b32 v181, v181, v28
v_xor_b32 v183, v183, v28
v_or3_b32 v185, v185, v175, v177
v_or3_b32 v185, v185, v179, v181
v_or_b32 v185, v185, v183
v_cmp_ne_u32 vcc, 0, v185
s_nop 1
s_cbranch_vccz L_pret_16
s_sleep 1
s_sub_u32 s96, s96, 1
s_cbranch_scc0 L_pslow_15_l
s_branch L_pret_16
L_pslow_18:
s_mov_b32 s96, 524288
L_pslow_18_l:
buffer_load_dwordx4 v[12:15], v6, s[20:23], s100 offen sc1
s_waitcnt vmcnt(0)
v_xor_b32 v30, v12, v28
v_xor_b32 v13, v13, v28
v_xor_b32 v14, v14, v28
v_xor_b32 v15, v15, v28
v_or3_b32 v30, v30, v13, v14
v_or_b32 v30, v30, v15
v_cmp_ne_u32 vcc, 0, v30
s_nop 1
s_cbranch_vccz L_pret_19
s_sleep 1
s_sub_u32 s96, s96, 1
s_cbranch_scc0 L_pslow_18_l
s_branch L_pret_19
L_pslow_20:
s_mov_b32 s96, 524288
L_pslow_20_l:
s_lshr_b32 s84, s70, 1
s_lshl_b32 s84, s84, 10
s_add_u32 s84, s84, 0x8000
buffer_load_dwordx4 v[180:183], v5, s[20:23], s84 offen sc1
s_waitcnt vmcnt(0)
v_xor_b32 v13, v180, v28
v_xor_b32 v181, v181, v28
v_xor_b32 v182, v182, v28
v_xor_b32 v183, v183, v28
v_or3_b32 v13, v13, v181, v182
v_or_b32 v13, v13, v183
v_cmp_ne_u32 vcc, 0, v13
s_nop 1
s_cbranch_vccz L_pret_21
s_sleep 1
s_sub_u32 s96, s96, 1
s_cbranch_scc0 L_pslow_20_l
s_branch L_pret_21
L_pslow_24:
s_mov_b32 s96, 524288
L_pslow_24_l:
s_lshr_b32 s85, s70, 1
s_lshl_b32 s85, s85, 2
s_add_u32 s85, s85, s44
s_lshl_b32 s85, s85, 8
s_add_u32 s85, s85, 0xc000
buffer_load_dwordx4 v[8:11], v6, s[20:23], s85 offen sc1
s_waitcnt vmcnt(0)
v_xor_b32 v191, v8, v28
v_xor_b32 v9, v9, v28
v_xor_b32 v10, v10, v28
v_xor_b32 v11, v11, v28
v_or3_b32 v191, v191, v9, v10
v_or_b32 v191, v191, v11
v_cmp_ne_u32 vcc, 0, v191
s_nop 1
s_cbranch_vccz L_pret_25
s_sleep 1
s_sub_u32 s96, s96, 1
s_cbranch_scc0 L_pslow_24_l
s_branch L_pret_25
L_pslow_28:
s_mov_b32 s96, 524288
L_pslow_28_l:
s_lshl_b32 s97, s70, 2
s_add_u32 s97, s97, s44
s_lshl_b32 s97, s97, 8
s_add_u32 s97, s97, 0x10000
buffer_load_dwordx4 v[8:11], v6, s[20:23], s97 offen sc1
s_waitcnt vmcnt(0)
v_xor_b32 v12, v8, v28
v_xor_b32 v9, v9, v28
v_xor_b32 v10, v10, v28
v_xor_b32 v11, v11, v28
v_or3_b32 v12, v12, v9, v10
v_or_b32 v12, v12, v11
v_cmp_ne_u32 vcc, 0, v12
s_nop 1
s_cbranch_vccz L_pret_29
s_sleep 1
s_sub_u32 s96, s96, 1
s_cbranch_scc0 L_pslow_28_l
s_branch L_pret_29
L_codeend:
s_endpgm
.section .rodata,"a"
.p2align 6
.amdhsa_kernel parallel_sum__sliding_local_dilated__mixer_gmlp__prompt_kernel
  .amdhsa_next_free_vgpr 512
  .amdhsa_next_free_sgpr 102
  .amdhsa_accum_offset 256
  .amdhsa_group_segment_fixed_size 0
  .amdhsa_kernarg_size 88
  .amdhsa_user_sgpr_count 2
  .amdhsa_user_sgpr_kernarg_segment_ptr 1
  .amdhsa_system_sgpr_workgroup_id_x 1
.end_amdhsa_kernel
```
